```python
import torch

def _softmax(x, axis=-1):
    return torch.softmax(x, dim=axis)

def _gelu(x):
    return torch.nn.functional.gelu(x, approximate='tanh')

def _silu(x):
    return torch.nn.functional.silu(x)

def _sigmoid(x):
    return torch.sigmoid(x)

def _layernorm(x, axis=-1, eps=1e-05):
    m = x.mean(dim=axis, keepdim=True)
    v = x.var(dim=axis, keepdim=True, unbiased=False)
    return (x - m) / torch.sqrt(v + eps)

def _scatter_add(tgt, idx, src, axis=0):
    return tgt.clone().index_add_(axis, idx, src)

def _segment_sum(src, seg, n):
    out = torch.zeros((n,) + src.shape[1:], dtype=src.dtype)
    return out.index_add_(0, seg, src)

def _pad(x, pw):
    flat = tuple((v for pair in reversed(pw) for v in pair))
    return torch.nn.functional.pad(x, flat)
kernel_name = 'interleave_layers__sliding_block__memory_aug_recurrent_mem_tr__prompt'

def setup_inputs():

    _w = lambda a: (lambda t: t.to(torch.bfloat16) if t.is_floating_point() else t)(torch.as_tensor(a))

    def _A_setup():
        B, S, D = (1, 2048, 576)
        return {'x': _w((lambda *s: torch.randn(*s, dtype=torch.bfloat16) * 0.05)(B, S, D)), 'wqkv': _w((lambda *s: torch.randn(*s, dtype=torch.bfloat16) * 0.05)(D, 3 * D)), 'wo': _w((lambda *s: torch.randn(*s, dtype=torch.bfloat16) * 0.05)(D, D))}
    _A_in = _A_setup()

    def _B_setup():
        B, S, Dm = (1, 2048, 576)
        H, Dh = (32, 128)
        M, seg = (8, 32)
        seg = min(seg, S)
        S = S // seg * seg
        return {'x': _w((lambda *s: torch.randn(*s, dtype=torch.bfloat16) * 0.05)(B, S, Dm)), 'mem0': _w((lambda *s: torch.randn(*s, dtype=torch.bfloat16) * 0.8)(B, M, Dm)), 'Wq': _w((lambda *s: torch.randn(*s, dtype=torch.bfloat16) * 1.6)(Dm, H, Dh) * Dm ** (-0.5)), 'Wk': _w((lambda *s: torch.randn(*s, dtype=torch.bfloat16) * 1.6)(Dm, H, Dh) * Dm ** (-0.5)), 'Wv': _w((lambda *s: torch.randn(*s, dtype=torch.bfloat16) * 0.8)(Dm, H, Dh) * Dm ** (-0.5)), 'Wo': _w((lambda *s: torch.randn(*s, dtype=torch.bfloat16) * 0.8)(H, Dh, Dm) * (H * Dh) ** (-0.5)), 'seg_len': seg}
    _B_in = _B_setup()
    return {'A_x': _A_in['x'], 'A_wqkv': _A_in['wqkv'], 'A_wo': _A_in['wo'], 'B_x': _B_in['x'], 'B_mem0': _B_in['mem0'], 'B_Wq': _B_in['Wq'], 'B_Wk': _B_in['Wk'], 'B_Wv': _B_in['Wv'], 'B_Wo': _B_in['Wo'], 'B_seg_len': _B_in['seg_len']}

def reference(A_x, A_wqkv, A_wo, B_x, B_mem0, B_Wq, B_Wk, B_Wv, B_Wo, B_seg_len):

    def _A_ref(x, wqkv, wo):
        B, S, D = x.shape
        H = 32
        Dh = D // H
        W = 256
        qkv = (lambda x, *d: x.permute(*d))((x @ wqkv).reshape(B, S, 3, H, Dh), 2, 0, 3, 1, 4)
        q, k, v = (qkv[0], qkv[1], qkv[2])
        scores = torch.einsum('bhqd,bhkd->bhqk', q, k) * Dh ** (-0.5)
        idx = torch.arange(S)
        mask = (idx[:, None] - idx[None, :] >= 0) & (idx[:, None] - idx[None, :] < W)
        scores = torch.where(mask[None, None], scores, -1000000000.0)
        p = _softmax(scores, axis=-1)
        o = torch.einsum('bhqk,bhkd->bhqd', p, v)
        return (lambda x, *d: x.permute(*d))(o, 0, 2, 1, 3).reshape(B, S, D) @ wo

    def _B_ref(x, mem0, Wq, Wk, Wv, Wo, seg_len):
        B, S, Dm = x.shape
        H, Dh = (Wq.shape[1], Wq.shape[2])
        M = mem0.shape[1]
        scale = Dh ** (-0.5)
        n_seg = S // seg_len
        L = M + seg_len
        idx = torch.arange(L)
        mask = (idx[:, None] < M) | (idx[:, None] >= idx[None, :])
        mem = mem0
        outs = []
        for s in range(n_seg):
            xs = x[:, s * seg_len:(s + 1) * seg_len, :].clone()
            h = torch.concatenate([mem, xs], axis=1)
            q = torch.einsum('btd,dhe->bhte', h, Wq)
            k = torch.einsum('btd,dhe->bhte', h, Wk)
            v = torch.einsum('btd,dhe->bhte', h, Wv)
            scores = torch.einsum('bhqe,bhke->bhqk', q, k) * scale
            scores = torch.where(mask[None, None], scores, -1000000000.0)
            p = _softmax(scores, axis=-1)
            o = torch.einsum('bhqk,bhke->bhqe', p, v)
            o = torch.einsum('bhte,hed->btd', o, Wo)
            mem = o[:, :M, :].clone()
            outs.append(o[:, M:, :])
        return torch.concatenate(outs, axis=1)
    x = A_x
    x = x + _A_ref(_layernorm(x, axis=-1), A_wqkv, A_wo)
    x = x + _B_ref(_layernorm(x, axis=-1), B_mem0, B_Wq, B_Wk, B_Wv, B_Wo, B_seg_len)
    x = x + _A_ref(_layernorm(x, axis=-1), A_wqkv, A_wo)
    x = x + _B_ref(_layernorm(x, axis=-1), B_mem0, B_Wq, B_Wk, B_Wv, B_Wo, B_seg_len)
    return x
```

```asm
; @launch grid=(256,1,1) block=(256,1,1) lds=163840
.amdgcn_target "amdgcn-amd-amdhsa--gfx950"
.text
.globl interleave_layers__sliding_block__memory_aug_recurrent_mem_tr__prompt_kernel
.p2align 8
.type interleave_layers__sliding_block__memory_aug_recurrent_mem_tr__prompt_kernel,@function
interleave_layers__sliding_block__memory_aug_recurrent_mem_tr__prompt_kernel:
s_cmp_ge_u32 s2, 256
s_cbranch_scc1 L_END
s_load_dwordx4 s[24:27], s[0:1], 88
v_lshrrev_b32 v1, 6, v0
s_lshr_b32 s21, s2, 3
v_readfirstlane_b32 s20, v1
s_waitcnt lgkmcnt(0)
s_mov_b32 s4, s26
s_and_b32 s5, s27, 0xffff
s_mov_b32 s6, 0x10000000
s_mov_b32 s7, 0x20000
s_mov_b32 s16, s24
s_and_b32 s17, s25, 0xffff
s_mov_b32 s18, 0x100
s_mov_b32 s19, 0x20000
s_and_b32 s3, s2, 7
s_cmp_eq_u32 s3, 7
s_cbranch_scc0 L_nozero_1
v_lshlrev_b32 v1, 4, v0
s_lshl_b32 s3, s21, 15
v_mov_b32 v4, 0
v_mov_b32 v5, 0
v_mov_b32 v6, 0
v_mov_b32 v7, 0
buffer_store_dwordx4 v[4:7], v1, s[4:7], s3 offen sc1
s_add_u32 s3, s3, 4096
buffer_store_dwordx4 v[4:7], v1, s[4:7], s3 offen sc1
s_add_u32 s3, s3, 4096
buffer_store_dwordx4 v[4:7], v1, s[4:7], s3 offen sc1
s_add_u32 s3, s3, 4096
buffer_store_dwordx4 v[4:7], v1, s[4:7], s3 offen sc1
s_add_u32 s3, s3, 4096
buffer_store_dwordx4 v[4:7], v1, s[4:7], s3 offen sc1
s_add_u32 s3, s3, 4096
buffer_store_dwordx4 v[4:7], v1, s[4:7], s3 offen sc1
s_add_u32 s3, s3, 4096
buffer_store_dwordx4 v[4:7], v1, s[4:7], s3 offen sc1
s_add_u32 s3, s3, 4096
buffer_store_dwordx4 v[4:7], v1, s[4:7], s3 offen sc1
s_waitcnt vmcnt(0)
s_barrier
s_cmp_lg_u32 s20, 0
s_cbranch_scc1 L_arr_2
s_mov_b64 exec, 1
v_mov_b32 v1, 1
buffer_atomic_add v1, off, s[16:19], 0 sc1
s_mov_b64 exec, -1
L_arr_2:
L_nozero_1:
s_and_b32 s3, s2, 7
s_cmp_lt_u32 s3, 2
s_cbranch_scc1 L_R_chain
s_cmp_eq_u32 s3, 2
s_cbranch_scc1 L_R_bk
s_cmp_eq_u32 s3, 3
s_cbranch_scc1 L_R_bv
s_cmp_eq_u32 s3, 4
s_cbranch_scc1 L_R_qa
s_cmp_eq_u32 s3, 5
s_cbranch_scc1 L_X5
s_cmp_eq_u32 s3, 6
s_cbranch_scc1 L_X6
s_mov_b32 s60, s21
s_cmp_lt_u32 s21, 10
s_cbranch_scc1 L_R_fin
s_sub_u32 s60, s21, 2
s_branch L_R_aa
L_X5:
s_cmp_ge_u32 s21, 27
s_cbranch_scc1 L_X5b
s_mul_i32 s60, s21, 57
s_lshr_b32 s60, s60, 9
s_mul_i32 s3, s60, 9
s_sub_u32 s61, s21, s3
s_branch L_R_op
L_X5b:
s_sub_u32 s21, s21, 27
s_branch L_R_aw
L_X6:
s_cmp_ge_u32 s21, 9
s_cbranch_scc1 L_X6b
s_mov_b32 s60, 3
s_mov_b32 s61, s21
s_branch L_R_op
L_X6b:
s_cmp_ge_u32 s21, 24
s_cbranch_scc1 L_X6c
s_sub_u32 s21, s21, 9
s_branch L_R_aq
L_X6c:
s_sub_u32 s60, s21, 24
s_branch L_R_aa
L_IDLE:
s_branch L_END
L_R_chain:
s_and_b32 s22, s2, 1
s_mov_b32 s23, s21
v_and_b32 v40, 63, v0
v_mov_b32 v44, -1
v_mov_b32 v45, -1
v_mov_b32 v46, -1
v_mov_b32 v47, -1
v_lshlrev_b32 v41, 4, v0
s_mul_i32 s3, s22, 589824
s_mul_i32 s73, s23, 9216
s_add_u32 s3, s3, s73
s_add_u32 s3, s3, 3145728
s_add_u32 s73, s3, 0
buffer_store_dwordx4 v[44:47], v41, s[4:7], s73 offen sc1
s_add_u32 s73, s3, 4096
buffer_store_dwordx4 v[44:47], v41, s[4:7], s73 offen sc1
s_add_u32 s73, s3, 8192
v_cmp_gt_u32 vcc, 64, v0
s_nop 0
s_and_saveexec_b64 s[90:91], vcc
buffer_store_dwordx4 v[44:47], v41, s[4:7], s73 offen sc1
s_mov_b64 exec, s[90:91]
s_add_u32 s73, s3, 294912
buffer_store_dwordx4 v[44:47], v41, s[4:7], s73 offen sc1
s_add_u32 s73, s3, 299008
buffer_store_dwordx4 v[44:47], v41, s[4:7], s73 offen sc1
s_add_u32 s73, s3, 303104
v_cmp_gt_u32 vcc, 64, v0
s_nop 0
s_and_saveexec_b64 s[90:91], vcc
buffer_store_dwordx4 v[44:47], v41, s[4:7], s73 offen sc1
s_mov_b64 exec, s[90:91]
s_mul_i32 s3, s22, 589824
s_mul_i32 s73, s23, 18432
s_add_u32 s3, s3, s73
s_add_u32 s3, s3, 1048576
s_add_u32 s73, s3, 0
buffer_store_dwordx4 v[44:47], v41, s[4:7], s73 offen sc1
s_add_u32 s73, s3, 4096
buffer_store_dwordx4 v[44:47], v41, s[4:7], s73 offen sc1
s_add_u32 s73, s3, 8192
buffer_store_dwordx4 v[44:47], v41, s[4:7], s73 offen sc1
s_add_u32 s73, s3, 12288
buffer_store_dwordx4 v[44:47], v41, s[4:7], s73 offen sc1
s_add_u32 s73, s3, 16384
v_cmp_gt_u32 vcc, 128, v0
s_nop 0
s_and_saveexec_b64 s[90:91], vcc
buffer_store_dwordx4 v[44:47], v41, s[4:7], s73 offen sc1
s_mov_b64 exec, s[90:91]
s_getreg_b32 s3, hwreg(HW_REG_XCC_ID)
s_and_b32 s3, s3, 15
s_lshl_b32 s3, 1, s3
s_mov_b32 s97, s3
v_and_b32 v40, 63, v0
s_lshl_b32 s47, s20, 10
s_lshr_b32 s3, s20, 1
s_and_b32 s73, s20, 1
v_lshlrev_b32 v41, 4, v40
v_add_u32 v1, 147456, v41
s_lshl_b32 s74, s3, 10
s_lshl_b32 s90, s73, 8
s_add_u32 s74, s74, s90
s_add_u32 s74, s74, 156672
v_lshrrev_b32 v41, 5, v40
v_lshlrev_b32 v41, 9, v41
v_and_b32 v42, 15, v40
v_lshl_add_u32 v41, v42, 4, v41
v_bfe_u32 v42, v40, 4, 1
v_lshl_add_u32 v41, v42, 3, v41
v_add_u32 v2, s74, v41
v_lshrrev_b32 v41, 5, v40
v_lshlrev_b32 v41, 8, v41
v_bfe_u32 v42, v40, 4, 1
v_lshl_add_u32 v41, v42, 6, v41
v_bfe_u32 v42, v40, 2, 2
v_lshl_add_u32 v41, v42, 4, v41
v_and_b32 v42, 1, v40
v_lshl_add_u32 v41, v42, 3, v41
v_add_u32 v3, 156672, v41
v_lshrrev_b32 v41, 5, v40
v_lshlrev_b32 v41, 10, v41
v_bfe_u32 v42, v40, 4, 1
v_lshl_add_u32 v41, v42, 9, v41
v_bfe_u32 v42, v40, 3, 1
v_lshl_add_u32 v41, v42, 8, v41
v_and_b32 v42, 7, v40
v_lshl_add_u32 v4, v42, 4, v41
s_lshl_b32 s74, s3, 12
s_lshl_b32 s90, s73, 8
s_add_u32 s74, s74, s90
s_add_u32 s74, s74, 8192
v_lshrrev_b32 v41, 5, v40
v_lshlrev_b32 v41, 10, v41
v_bfe_u32 v42, v40, 4, 1
v_lshl_add_u32 v41, v42, 9, v41
v_and_b32 v42, 15, v40
v_lshl_add_u32 v41, v42, 4, v41
v_add_u32 v5, s74, v41
s_lshl_b32 s74, s3, 10
s_lshl_b32 s90, s73, 7
s_add_u32 s74, s74, s90
s_add_u32 s74, s74, 147456
v_lshrrev_b32 v41, 4, v40
v_lshlrev_b32 v41, 8, v41
v_and_b32 v42, 7, v40
v_lshl_add_u32 v41, v42, 4, v41
v_add_u32 v6, s74, v41
v_lshrrev_b32 v41, 3, v40
v_mul_u32_u24 v41, 9216, v41
v_and_b32 v42, 4, v40
v_lshl_add_u32 v41, v42, 6, v41
v_and_b32 v42, 3, v40
v_lshl_add_u32 v7, v42, 4, v41
v_and_b32 v41, 4, v40
v_bfe_u32 v42, v40, 4, 1
v_lshl_add_u32 v41, v42, 1, v41
v_bfe_u32 v42, v40, 3, 1
v_add_u32 v41, v42, v41
v_lshlrev_b32 v41, 4, v41
v_and_b32 v42, 3, v40
v_lshl_add_u32 v8, v42, 2, v41
s_lshr_b32 s3, s20, 1
s_lshl_b32 s3, s3, 10
s_and_b32 s73, s20, 1
s_lshl_b32 s74, s73, 8
s_add_u32 s3, s3, s74
s_add_u32 s3, s3, 156672
v_and_b32 v41, 15, v40
v_lshlrev_b32 v41, 4, v41
v_lshrrev_b32 v42, 4, v40
v_lshl_add_u32 v41, v42, 2, v41
v_add_u32 v2, s3, v41
v_lshrrev_b32 v41, 5, v40
v_lshlrev_b32 v41, 8, v41
v_bfe_u32 v42, v40, 4, 1
v_lshl_add_u32 v41, v42, 6, v41
v_bfe_u32 v42, v40, 2, 2
v_lshl_add_u32 v41, v42, 4, v41
v_bfe_u32 v42, v40, 1, 1
v_lshl_add_u32 v41, v42, 3, v41
v_add_u32 v3, 156672, v41
s_lshr_b32 s3, s20, 1
s_lshl_b32 s3, s3, 10
s_lshl_b32 s74, s73, 5
s_add_u32 s3, s3, s74
s_add_u32 s3, s3, 147456
v_lshrrev_b32 v41, 4, v40
v_lshlrev_b32 v41, 8, v41
v_bfe_u32 v42, v40, 3, 1
v_lshl_add_u32 v41, v42, 7, v41
v_bfe_u32 v42, v40, 1, 1
v_lshl_add_u32 v41, v42, 6, v41
v_and_b32 v42, 1, v40
v_lshl_add_u32 v41, v42, 4, v41
v_add_u32 v6, s3, v41
v_mov_b32 v41, 0x44444444
v_mov_b32 v42, 0xeeeeeeee
v_and_b32 v43, 2, v40
v_cmp_eq_u32 vcc, 0, v43
s_nop 1
v_cndmask_b32 v0, v42, v41, vcc
v_and_b32 v41, 3, v40
v_lshlrev_b32 v41, 4, v41
v_bfe_u32 v42, v40, 2, 2
v_lshl_add_u32 v41, v42, 13, v41
v_bfe_u32 v42, v40, 5, 1
v_lshl_add_u32 v41, v42, 12, v41
v_bfe_u32 v42, v40, 4, 1
v_lshl_add_u32 v7, v42, 6, v41
v_bfe_u32 v41, v40, 1, 1
v_lshlrev_b32 v41, 6, v41
v_bfe_u32 v42, v40, 2, 1
v_lshl_add_u32 v41, v42, 5, v41
v_bfe_u32 v42, v40, 3, 1
v_lshl_add_u32 v41, v42, 4, v41
v_and_b32 v42, 1, v40
v_lshl_add_u32 v41, v42, 3, v41
v_bfe_u32 v42, v40, 4, 1
v_lshl_add_u32 v41, v42, 2, v41
s_cmp_eq_u32 s20, 3
s_cselect_b64 vcc, -1, 0
v_cndmask_b32 v8, v8, v41, vcc
s_load_dwordx2 s[90:91], s[0:1], 32
s_waitcnt lgkmcnt(0)
s_mov_b32 s12, s90
s_and_b32 s13, s91, 0xffff
s_mov_b32 s14, 0x2400
s_mov_b32 s15, 0x20000
v_subrev_u32 v60, 147456, v1
v_lshrrev_b32 v61, 4, v60
v_bfe_u32 v62, v61, 2, 2
v_lshlrev_b32 v62, 1, v62
v_and_b32 v63, 1, v61
v_add_u32 v62, v62, v63
v_mul_u32_u24 v62, 1152, v62
v_lshrrev_b32 v63, 4, v61
v_lshl_add_u32 v62, v63, 4, v62
v_bfe_u32 v63, v61, 1, 1
v_lshl_add_u32 v62, v63, 6, v62
s_lshl_b32 s3, s20, 7
buffer_load_dwordx4 v[64:67], v62, s[12:15], s3 offen
buffer_load_dwordx4 v[68:71], v62, s[12:15], s3 offen offset:512
buffer_load_dwordx4 v[72:75], v62, s[12:15], 0 offen offset:1024
v_lshrrev_b32 v41, 4, v40
v_lshlrev_b32 v41, 15, v41
v_and_b32 v42, 15, v40
v_lshl_add_u32 v41, v42, 3, v41
s_and_b32 s3, s20, 1
s_lshl_b32 s3, s3, 7
s_lshr_b32 s73, s20, 1
s_lshl_b32 s73, s73, 2
s_add_u32 s3, s3, s73
s_lshl_b32 s73, s23, 8
s_add_u32 s3, s3, s73
v_add_u32 v41, s3, v41
v_add_u32 v42, 8192, v41
v_add_u32 v43, 8192, v42
v_add_u32 v44, 8192, v43
s_mov_b32 s70, 0x05040100
s_mov_b32 s71, 0x07060302
s_load_dwordx2 s[90:91], s[0:1], 40
s_waitcnt lgkmcnt(0)
s_mov_b32 s8, s90
s_and_b32 s9, s91, 0xffff
s_mov_b32 s10, 0x480000
s_mov_b32 s11, 0x20000
s_mov_b32 s73, 0
buffer_load_dword v46, v41, s[8:11], s73 offen
buffer_load_dword v47, v42, s[8:11], s73 offen
buffer_load_dword v48, v43, s[8:11], s73 offen
buffer_load_dword v49, v44, s[8:11], s73 offen
s_mov_b32 s73, 262144
buffer_load_dword v50, v41, s[8:11], s73 offen
buffer_load_dword v51, v42, s[8:11], s73 offen
buffer_load_dword v52, v43, s[8:11], s73 offen
buffer_load_dword v53, v44, s[8:11], s73 offen
s_mov_b32 s73, 131072
buffer_load_dword v54, v41, s[8:11], s73 offen
buffer_load_dword v55, v42, s[8:11], s73 offen
buffer_load_dword v56, v43, s[8:11], s73 offen
buffer_load_dword v57, v44, s[8:11], s73 offen
s_mov_b32 s73, 393216
buffer_load_dword v58, v41, s[8:11], s73 offen
buffer_load_dword v59, v42, s[8:11], s73 offen
buffer_load_dword v60, v43, s[8:11], s73 offen
buffer_load_dword v61, v44, s[8:11], s73 offen
s_waitcnt vmcnt(16)
v_add_u32 v79, s47, v1
ds_write_b128 v79, v[64:67]
ds_write_b128 v79, v[68:71] offset:4096
ds_write_b128 v1, v[72:75] offset:8192
s_waitcnt lgkmcnt(0)
s_mov_b32 s73, 524288
buffer_load_dword v62, v41, s[8:11], s73 offen
buffer_load_dword v63, v42, s[8:11], s73 offen
buffer_load_dword v64, v43, s[8:11], s73 offen
buffer_load_dword v65, v44, s[8:11], s73 offen
s_mov_b32 s73, 786432
buffer_load_dword v66, v41, s[8:11], s73 offen
buffer_load_dword v67, v42, s[8:11], s73 offen
buffer_load_dword v68, v43, s[8:11], s73 offen
buffer_load_dword v69, v44, s[8:11], s73 offen
s_mov_b32 s73, 655360
buffer_load_dword v70, v41, s[8:11], s73 offen
buffer_load_dword v71, v42, s[8:11], s73 offen
buffer_load_dword v72, v43, s[8:11], s73 offen
buffer_load_dword v73, v44, s[8:11], s73 offen
s_mov_b32 s73, 917504
buffer_load_dword v74, v41, s[8:11], s73 offen
buffer_load_dword v75, v42, s[8:11], s73 offen
buffer_load_dword v76, v43, s[8:11], s73 offen
buffer_load_dword v77, v44, s[8:11], s73 offen
s_waitcnt vmcnt(16)
v_perm_b32 v78, v47, v46, s70
v_accvgpr_write_b32 a0, v78
v_perm_b32 v78, v47, v46, s71
v_accvgpr_write_b32 a72, v78
v_perm_b32 v78, v51, v50, s70
v_accvgpr_write_b32 a1, v78
v_perm_b32 v78, v51, v50, s71
v_accvgpr_write_b32 a73, v78
v_perm_b32 v78, v49, v48, s70
v_accvgpr_write_b32 a2, v78
v_perm_b32 v78, v49, v48, s71
v_accvgpr_write_b32 a74, v78
v_perm_b32 v78, v53, v52, s70
v_accvgpr_write_b32 a3, v78
v_perm_b32 v78, v53, v52, s71
v_accvgpr_write_b32 a75, v78
v_perm_b32 v78, v55, v54, s70
v_accvgpr_write_b32 a4, v78
v_perm_b32 v78, v55, v54, s71
v_accvgpr_write_b32 a76, v78
v_perm_b32 v78, v59, v58, s70
v_accvgpr_write_b32 a5, v78
v_perm_b32 v78, v59, v58, s71
v_accvgpr_write_b32 a77, v78
v_perm_b32 v78, v57, v56, s70
v_accvgpr_write_b32 a6, v78
v_perm_b32 v78, v57, v56, s71
v_accvgpr_write_b32 a78, v78
v_perm_b32 v78, v61, v60, s70
v_accvgpr_write_b32 a7, v78
v_perm_b32 v78, v61, v60, s71
v_accvgpr_write_b32 a79, v78
s_mov_b32 s73, 1048576
buffer_load_dword v46, v41, s[8:11], s73 offen
buffer_load_dword v47, v42, s[8:11], s73 offen
buffer_load_dword v48, v43, s[8:11], s73 offen
buffer_load_dword v49, v44, s[8:11], s73 offen
s_mov_b32 s73, 1310720
buffer_load_dword v50, v41, s[8:11], s73 offen
buffer_load_dword v51, v42, s[8:11], s73 offen
buffer_load_dword v52, v43, s[8:11], s73 offen
buffer_load_dword v53, v44, s[8:11], s73 offen
s_mov_b32 s73, 1179648
buffer_load_dword v54, v41, s[8:11], s73 offen
buffer_load_dword v55, v42, s[8:11], s73 offen
buffer_load_dword v56, v43, s[8:11], s73 offen
buffer_load_dword v57, v44, s[8:11], s73 offen
s_mov_b32 s73, 1441792
buffer_load_dword v58, v41, s[8:11], s73 offen
buffer_load_dword v59, v42, s[8:11], s73 offen
buffer_load_dword v60, v43, s[8:11], s73 offen
buffer_load_dword v61, v44, s[8:11], s73 offen
s_waitcnt vmcnt(16)
v_perm_b32 v78, v63, v62, s70
v_accvgpr_write_b32 a8, v78
v_perm_b32 v78, v63, v62, s71
v_accvgpr_write_b32 a80, v78
v_perm_b32 v78, v67, v66, s70
v_accvgpr_write_b32 a9, v78
v_perm_b32 v78, v67, v66, s71
v_accvgpr_write_b32 a81, v78
v_perm_b32 v78, v65, v64, s70
v_accvgpr_write_b32 a10, v78
v_perm_b32 v78, v65, v64, s71
v_accvgpr_write_b32 a82, v78
v_perm_b32 v78, v69, v68, s70
v_accvgpr_write_b32 a11, v78
v_perm_b32 v78, v69, v68, s71
v_accvgpr_write_b32 a83, v78
v_perm_b32 v78, v71, v70, s70
v_accvgpr_write_b32 a12, v78
v_perm_b32 v78, v71, v70, s71
v_accvgpr_write_b32 a84, v78
v_perm_b32 v78, v75, v74, s70
v_accvgpr_write_b32 a13, v78
v_perm_b32 v78, v75, v74, s71
v_accvgpr_write_b32 a85, v78
v_perm_b32 v78, v73, v72, s70
v_accvgpr_write_b32 a14, v78
v_perm_b32 v78, v73, v72, s71
v_accvgpr_write_b32 a86, v78
v_perm_b32 v78, v77, v76, s70
v_accvgpr_write_b32 a15, v78
v_perm_b32 v78, v77, v76, s71
v_accvgpr_write_b32 a87, v78
s_mov_b32 s73, 1572864
buffer_load_dword v62, v41, s[8:11], s73 offen
buffer_load_dword v63, v42, s[8:11], s73 offen
buffer_load_dword v64, v43, s[8:11], s73 offen
buffer_load_dword v65, v44, s[8:11], s73 offen
s_mov_b32 s73, 1835008
buffer_load_dword v66, v41, s[8:11], s73 offen
buffer_load_dword v67, v42, s[8:11], s73 offen
buffer_load_dword v68, v43, s[8:11], s73 offen
buffer_load_dword v69, v44, s[8:11], s73 offen
s_mov_b32 s73, 1703936
buffer_load_dword v70, v41, s[8:11], s73 offen
buffer_load_dword v71, v42, s[8:11], s73 offen
buffer_load_dword v72, v43, s[8:11], s73 offen
buffer_load_dword v73, v44, s[8:11], s73 offen
s_mov_b32 s73, 1966080
buffer_load_dword v74, v41, s[8:11], s73 offen
buffer_load_dword v75, v42, s[8:11], s73 offen
buffer_load_dword v76, v43, s[8:11], s73 offen
buffer_load_dword v77, v44, s[8:11], s73 offen
s_waitcnt vmcnt(16)
v_perm_b32 v78, v47, v46, s70
v_accvgpr_write_b32 a16, v78
v_perm_b32 v78, v47, v46, s71
v_accvgpr_write_b32 a88, v78
v_perm_b32 v78, v51, v50, s70
v_accvgpr_write_b32 a17, v78
v_perm_b32 v78, v51, v50, s71
v_accvgpr_write_b32 a89, v78
v_perm_b32 v78, v49, v48, s70
v_accvgpr_write_b32 a18, v78
v_perm_b32 v78, v49, v48, s71
v_accvgpr_write_b32 a90, v78
v_perm_b32 v78, v53, v52, s70
v_accvgpr_write_b32 a19, v78
v_perm_b32 v78, v53, v52, s71
v_accvgpr_write_b32 a91, v78
v_perm_b32 v78, v55, v54, s70
v_accvgpr_write_b32 a20, v78
v_perm_b32 v78, v55, v54, s71
v_accvgpr_write_b32 a92, v78
v_perm_b32 v78, v59, v58, s70
v_accvgpr_write_b32 a21, v78
v_perm_b32 v78, v59, v58, s71
v_accvgpr_write_b32 a93, v78
v_perm_b32 v78, v57, v56, s70
v_accvgpr_write_b32 a22, v78
v_perm_b32 v78, v57, v56, s71
v_accvgpr_write_b32 a94, v78
v_perm_b32 v78, v61, v60, s70
v_accvgpr_write_b32 a23, v78
v_perm_b32 v78, v61, v60, s71
v_accvgpr_write_b32 a95, v78
s_mov_b32 s73, 2097152
buffer_load_dword v46, v41, s[8:11], s73 offen
buffer_load_dword v47, v42, s[8:11], s73 offen
buffer_load_dword v48, v43, s[8:11], s73 offen
buffer_load_dword v49, v44, s[8:11], s73 offen
s_mov_b32 s73, 2359296
buffer_load_dword v50, v41, s[8:11], s73 offen
buffer_load_dword v51, v42, s[8:11], s73 offen
buffer_load_dword v52, v43, s[8:11], s73 offen
buffer_load_dword v53, v44, s[8:11], s73 offen
s_mov_b32 s73, 2228224
buffer_load_dword v54, v41, s[8:11], s73 offen
buffer_load_dword v55, v42, s[8:11], s73 offen
buffer_load_dword v56, v43, s[8:11], s73 offen
buffer_load_dword v57, v44, s[8:11], s73 offen
s_mov_b32 s73, 2490368
buffer_load_dword v58, v41, s[8:11], s73 offen
buffer_load_dword v59, v42, s[8:11], s73 offen
buffer_load_dword v60, v43, s[8:11], s73 offen
buffer_load_dword v61, v44, s[8:11], s73 offen
s_waitcnt vmcnt(16)
v_perm_b32 v78, v63, v62, s70
v_accvgpr_write_b32 a24, v78
v_perm_b32 v78, v63, v62, s71
v_accvgpr_write_b32 a96, v78
v_perm_b32 v78, v67, v66, s70
v_accvgpr_write_b32 a25, v78
v_perm_b32 v78, v67, v66, s71
v_accvgpr_write_b32 a97, v78
v_perm_b32 v78, v65, v64, s70
v_accvgpr_write_b32 a26, v78
v_perm_b32 v78, v65, v64, s71
v_accvgpr_write_b32 a98, v78
v_perm_b32 v78, v69, v68, s70
v_accvgpr_write_b32 a27, v78
v_perm_b32 v78, v69, v68, s71
v_accvgpr_write_b32 a99, v78
v_perm_b32 v78, v71, v70, s70
v_accvgpr_write_b32 a28, v78
v_perm_b32 v78, v71, v70, s71
v_accvgpr_write_b32 a100, v78
v_perm_b32 v78, v75, v74, s70
v_accvgpr_write_b32 a29, v78
v_perm_b32 v78, v75, v74, s71
v_accvgpr_write_b32 a101, v78
v_perm_b32 v78, v73, v72, s70
v_accvgpr_write_b32 a30, v78
v_perm_b32 v78, v73, v72, s71
v_accvgpr_write_b32 a102, v78
v_perm_b32 v78, v77, v76, s70
v_accvgpr_write_b32 a31, v78
v_perm_b32 v78, v77, v76, s71
v_accvgpr_write_b32 a103, v78
s_mov_b32 s73, 2621440
buffer_load_dword v62, v41, s[8:11], s73 offen
buffer_load_dword v63, v42, s[8:11], s73 offen
buffer_load_dword v64, v43, s[8:11], s73 offen
buffer_load_dword v65, v44, s[8:11], s73 offen
s_mov_b32 s73, 2883584
buffer_load_dword v66, v41, s[8:11], s73 offen
buffer_load_dword v67, v42, s[8:11], s73 offen
buffer_load_dword v68, v43, s[8:11], s73 offen
buffer_load_dword v69, v44, s[8:11], s73 offen
s_mov_b32 s73, 2752512
buffer_load_dword v70, v41, s[8:11], s73 offen
buffer_load_dword v71, v42, s[8:11], s73 offen
buffer_load_dword v72, v43, s[8:11], s73 offen
buffer_load_dword v73, v44, s[8:11], s73 offen
s_mov_b32 s73, 3014656
buffer_load_dword v74, v41, s[8:11], s73 offen
buffer_load_dword v75, v42, s[8:11], s73 offen
buffer_load_dword v76, v43, s[8:11], s73 offen
buffer_load_dword v77, v44, s[8:11], s73 offen
s_waitcnt vmcnt(16)
v_perm_b32 v78, v47, v46, s70
v_accvgpr_write_b32 a32, v78
v_perm_b32 v78, v47, v46, s71
v_accvgpr_write_b32 a104, v78
v_perm_b32 v78, v51, v50, s70
v_accvgpr_write_b32 a33, v78
v_perm_b32 v78, v51, v50, s71
v_accvgpr_write_b32 a105, v78
v_perm_b32 v78, v49, v48, s70
v_accvgpr_write_b32 a34, v78
v_perm_b32 v78, v49, v48, s71
v_accvgpr_write_b32 a106, v78
v_perm_b32 v78, v53, v52, s70
v_accvgpr_write_b32 a35, v78
v_perm_b32 v78, v53, v52, s71
v_accvgpr_write_b32 a107, v78
v_perm_b32 v78, v55, v54, s70
v_accvgpr_write_b32 a36, v78
v_perm_b32 v78, v55, v54, s71
v_accvgpr_write_b32 a108, v78
v_perm_b32 v78, v59, v58, s70
v_accvgpr_write_b32 a37, v78
v_perm_b32 v78, v59, v58, s71
v_accvgpr_write_b32 a109, v78
v_perm_b32 v78, v57, v56, s70
v_accvgpr_write_b32 a38, v78
v_perm_b32 v78, v57, v56, s71
v_accvgpr_write_b32 a110, v78
v_perm_b32 v78, v61, v60, s70
v_accvgpr_write_b32 a39, v78
v_perm_b32 v78, v61, v60, s71
v_accvgpr_write_b32 a111, v78
s_mov_b32 s73, 3145728
buffer_load_dword v46, v41, s[8:11], s73 offen
buffer_load_dword v47, v42, s[8:11], s73 offen
buffer_load_dword v48, v43, s[8:11], s73 offen
buffer_load_dword v49, v44, s[8:11], s73 offen
s_mov_b32 s73, 3407872
buffer_load_dword v50, v41, s[8:11], s73 offen
buffer_load_dword v51, v42, s[8:11], s73 offen
buffer_load_dword v52, v43, s[8:11], s73 offen
buffer_load_dword v53, v44, s[8:11], s73 offen
s_mov_b32 s73, 3276800
buffer_load_dword v54, v41, s[8:11], s73 offen
buffer_load_dword v55, v42, s[8:11], s73 offen
buffer_load_dword v56, v43, s[8:11], s73 offen
buffer_load_dword v57, v44, s[8:11], s73 offen
s_mov_b32 s73, 3538944
buffer_load_dword v58, v41, s[8:11], s73 offen
buffer_load_dword v59, v42, s[8:11], s73 offen
buffer_load_dword v60, v43, s[8:11], s73 offen
buffer_load_dword v61, v44, s[8:11], s73 offen
s_waitcnt vmcnt(16)
v_perm_b32 v78, v63, v62, s70
v_accvgpr_write_b32 a40, v78
v_perm_b32 v78, v63, v62, s71
v_accvgpr_write_b32 a112, v78
v_perm_b32 v78, v67, v66, s70
v_accvgpr_write_b32 a41, v78
v_perm_b32 v78, v67, v66, s71
v_accvgpr_write_b32 a113, v78
v_perm_b32 v78, v65, v64, s70
v_accvgpr_write_b32 a42, v78
v_perm_b32 v78, v65, v64, s71
v_accvgpr_write_b32 a114, v78
v_perm_b32 v78, v69, v68, s70
v_accvgpr_write_b32 a43, v78
v_perm_b32 v78, v69, v68, s71
v_accvgpr_write_b32 a115, v78
v_perm_b32 v78, v71, v70, s70
v_accvgpr_write_b32 a44, v78
v_perm_b32 v78, v71, v70, s71
v_accvgpr_write_b32 a116, v78
v_perm_b32 v78, v75, v74, s70
v_accvgpr_write_b32 a45, v78
v_perm_b32 v78, v75, v74, s71
v_accvgpr_write_b32 a117, v78
v_perm_b32 v78, v73, v72, s70
v_accvgpr_write_b32 a46, v78
v_perm_b32 v78, v73, v72, s71
v_accvgpr_write_b32 a118, v78
v_perm_b32 v78, v77, v76, s70
v_accvgpr_write_b32 a47, v78
v_perm_b32 v78, v77, v76, s71
v_accvgpr_write_b32 a119, v78
s_mov_b32 s73, 3670016
buffer_load_dword v62, v41, s[8:11], s73 offen
buffer_load_dword v63, v42, s[8:11], s73 offen
buffer_load_dword v64, v43, s[8:11], s73 offen
buffer_load_dword v65, v44, s[8:11], s73 offen
s_mov_b32 s73, 3932160
buffer_load_dword v66, v41, s[8:11], s73 offen
buffer_load_dword v67, v42, s[8:11], s73 offen
buffer_load_dword v68, v43, s[8:11], s73 offen
buffer_load_dword v69, v44, s[8:11], s73 offen
s_mov_b32 s73, 3801088
buffer_load_dword v70, v41, s[8:11], s73 offen
buffer_load_dword v71, v42, s[8:11], s73 offen
buffer_load_dword v72, v43, s[8:11], s73 offen
buffer_load_dword v73, v44, s[8:11], s73 offen
s_mov_b32 s73, 4063232
buffer_load_dword v74, v41, s[8:11], s73 offen
buffer_load_dword v75, v42, s[8:11], s73 offen
buffer_load_dword v76, v43, s[8:11], s73 offen
buffer_load_dword v77, v44, s[8:11], s73 offen
s_waitcnt vmcnt(16)
v_perm_b32 v78, v47, v46, s70
v_accvgpr_write_b32 a48, v78
v_perm_b32 v78, v47, v46, s71
v_accvgpr_write_b32 a120, v78
v_perm_b32 v78, v51, v50, s70
v_accvgpr_write_b32 a49, v78
v_perm_b32 v78, v51, v50, s71
v_accvgpr_write_b32 a121, v78
v_perm_b32 v78, v49, v48, s70
v_accvgpr_write_b32 a50, v78
v_perm_b32 v78, v49, v48, s71
v_accvgpr_write_b32 a122, v78
v_perm_b32 v78, v53, v52, s70
v_accvgpr_write_b32 a51, v78
v_perm_b32 v78, v53, v52, s71
v_accvgpr_write_b32 a123, v78
v_perm_b32 v78, v55, v54, s70
v_accvgpr_write_b32 a52, v78
v_perm_b32 v78, v55, v54, s71
v_accvgpr_write_b32 a124, v78
v_perm_b32 v78, v59, v58, s70
v_accvgpr_write_b32 a53, v78
v_perm_b32 v78, v59, v58, s71
v_accvgpr_write_b32 a125, v78
v_perm_b32 v78, v57, v56, s70
v_accvgpr_write_b32 a54, v78
v_perm_b32 v78, v57, v56, s71
v_accvgpr_write_b32 a126, v78
v_perm_b32 v78, v61, v60, s70
v_accvgpr_write_b32 a55, v78
v_perm_b32 v78, v61, v60, s71
v_accvgpr_write_b32 a127, v78
s_mov_b32 s73, 4194304
buffer_load_dword v46, v41, s[8:11], s73 offen
buffer_load_dword v47, v42, s[8:11], s73 offen
buffer_load_dword v48, v43, s[8:11], s73 offen
buffer_load_dword v49, v44, s[8:11], s73 offen
s_mov_b32 s73, 4456448
buffer_load_dword v50, v41, s[8:11], s73 offen
buffer_load_dword v51, v42, s[8:11], s73 offen
buffer_load_dword v52, v43, s[8:11], s73 offen
buffer_load_dword v53, v44, s[8:11], s73 offen
s_mov_b32 s73, 4325376
buffer_load_dword v54, v41, s[8:11], s73 offen
buffer_load_dword v55, v42, s[8:11], s73 offen
buffer_load_dword v56, v43, s[8:11], s73 offen
buffer_load_dword v57, v44, s[8:11], s73 offen
s_mov_b32 s73, 4587520
buffer_load_dword v58, v41, s[8:11], s73 offen
buffer_load_dword v59, v42, s[8:11], s73 offen
buffer_load_dword v60, v43, s[8:11], s73 offen
buffer_load_dword v61, v44, s[8:11], s73 offen
s_waitcnt vmcnt(16)
v_perm_b32 v78, v63, v62, s70
v_accvgpr_write_b32 a56, v78
v_perm_b32 v78, v63, v62, s71
v_accvgpr_write_b32 a128, v78
v_perm_b32 v78, v67, v66, s70
v_accvgpr_write_b32 a57, v78
v_perm_b32 v78, v67, v66, s71
v_accvgpr_write_b32 a129, v78
v_perm_b32 v78, v65, v64, s70
v_accvgpr_write_b32 a58, v78
v_perm_b32 v78, v65, v64, s71
v_accvgpr_write_b32 a130, v78
v_perm_b32 v78, v69, v68, s70
v_accvgpr_write_b32 a59, v78
v_perm_b32 v78, v69, v68, s71
v_accvgpr_write_b32 a131, v78
v_perm_b32 v78, v71, v70, s70
v_accvgpr_write_b32 a60, v78
v_perm_b32 v78, v71, v70, s71
v_accvgpr_write_b32 a132, v78
v_perm_b32 v78, v75, v74, s70
v_accvgpr_write_b32 a61, v78
v_perm_b32 v78, v75, v74, s71
v_accvgpr_write_b32 a133, v78
v_perm_b32 v78, v73, v72, s70
v_accvgpr_write_b32 a62, v78
v_perm_b32 v78, v73, v72, s71
v_accvgpr_write_b32 a134, v78
v_perm_b32 v78, v77, v76, s70
v_accvgpr_write_b32 a63, v78
v_perm_b32 v78, v77, v76, s71
v_accvgpr_write_b32 a135, v78
s_waitcnt vmcnt(0)
s_load_dwordx2 s[90:91], s[0:1], 48
s_waitcnt lgkmcnt(0)
s_mov_b32 s8, s90
s_and_b32 s9, s91, 0xffff
s_mov_b32 s10, 0x480000
s_mov_b32 s11, 0x20000
s_mov_b32 s73, 0
buffer_load_dword v62, v41, s[8:11], s73 offen
buffer_load_dword v63, v42, s[8:11], s73 offen
buffer_load_dword v64, v43, s[8:11], s73 offen
buffer_load_dword v65, v44, s[8:11], s73 offen
s_mov_b32 s73, 262144
buffer_load_dword v66, v41, s[8:11], s73 offen
buffer_load_dword v67, v42, s[8:11], s73 offen
buffer_load_dword v68, v43, s[8:11], s73 offen
buffer_load_dword v69, v44, s[8:11], s73 offen
s_mov_b32 s73, 131072
buffer_load_dword v70, v41, s[8:11], s73 offen
buffer_load_dword v71, v42, s[8:11], s73 offen
buffer_load_dword v72, v43, s[8:11], s73 offen
buffer_load_dword v73, v44, s[8:11], s73 offen
s_mov_b32 s73, 393216
buffer_load_dword v74, v41, s[8:11], s73 offen
buffer_load_dword v75, v42, s[8:11], s73 offen
buffer_load_dword v76, v43, s[8:11], s73 offen
buffer_load_dword v77, v44, s[8:11], s73 offen
s_waitcnt vmcnt(16)
v_perm_b32 v78, v47, v46, s70
v_accvgpr_write_b32 a64, v78
v_perm_b32 v78, v47, v46, s71
v_accvgpr_write_b32 a136, v78
v_perm_b32 v78, v51, v50, s70
v_accvgpr_write_b32 a65, v78
v_perm_b32 v78, v51, v50, s71
v_accvgpr_write_b32 a137, v78
v_perm_b32 v78, v49, v48, s70
v_accvgpr_write_b32 a66, v78
v_perm_b32 v78, v49, v48, s71
v_accvgpr_write_b32 a138, v78
v_perm_b32 v78, v53, v52, s70
v_accvgpr_write_b32 a67, v78
v_perm_b32 v78, v53, v52, s71
v_accvgpr_write_b32 a139, v78
v_perm_b32 v78, v55, v54, s70
v_accvgpr_write_b32 a68, v78
v_perm_b32 v78, v55, v54, s71
v_accvgpr_write_b32 a140, v78
v_perm_b32 v78, v59, v58, s70
v_accvgpr_write_b32 a69, v78
v_perm_b32 v78, v59, v58, s71
v_accvgpr_write_b32 a141, v78
v_perm_b32 v78, v57, v56, s70
v_accvgpr_write_b32 a70, v78
v_perm_b32 v78, v57, v56, s71
v_accvgpr_write_b32 a142, v78
v_perm_b32 v78, v61, v60, s70
v_accvgpr_write_b32 a71, v78
v_perm_b32 v78, v61, v60, s71
v_accvgpr_write_b32 a143, v78
v_mov_b32 v79, s97
s_lshl_b32 s96, s22, 2
s_add_u32 s96, s96, 136
s_mov_b64 exec, 1
buffer_atomic_or v79, off, s[16:19], s96 sc1
s_mov_b64 exec, -1
s_sub_u32 s96, s96, 8
s_waitcnt vmcnt(0)
s_barrier
s_cmp_lg_u32 s20, 0
s_cbranch_scc1 L_carr_3
s_mov_b64 exec, 1
v_mov_b32 v79, 1
buffer_atomic_add v79, off, s[16:19], s96 sc1
s_mov_b64 exec, -1
L_carr_3:
s_mov_b32 s73, 524288
buffer_load_dword v46, v41, s[8:11], s73 offen
buffer_load_dword v47, v42, s[8:11], s73 offen
buffer_load_dword v48, v43, s[8:11], s73 offen
buffer_load_dword v49, v44, s[8:11], s73 offen
s_mov_b32 s73, 786432
buffer_load_dword v50, v41, s[8:11], s73 offen
buffer_load_dword v51, v42, s[8:11], s73 offen
buffer_load_dword v52, v43, s[8:11], s73 offen
buffer_load_dword v53, v44, s[8:11], s73 offen
s_mov_b32 s73, 655360
buffer_load_dword v54, v41, s[8:11], s73 offen
buffer_load_dword v55, v42, s[8:11], s73 offen
buffer_load_dword v56, v43, s[8:11], s73 offen
buffer_load_dword v57, v44, s[8:11], s73 offen
s_mov_b32 s73, 917504
buffer_load_dword v58, v41, s[8:11], s73 offen
buffer_load_dword v59, v42, s[8:11], s73 offen
buffer_load_dword v60, v43, s[8:11], s73 offen
buffer_load_dword v61, v44, s[8:11], s73 offen
s_waitcnt vmcnt(18)
v_perm_b32 v78, v63, v62, s70
v_accvgpr_write_b32 a144, v78
v_perm_b32 v78, v63, v62, s71
v_accvgpr_write_b32 a216, v78
v_perm_b32 v78, v67, v66, s70
v_accvgpr_write_b32 a145, v78
v_perm_b32 v78, v67, v66, s71
v_accvgpr_write_b32 a217, v78
v_perm_b32 v78, v65, v64, s70
v_accvgpr_write_b32 a146, v78
v_perm_b32 v78, v65, v64, s71
v_accvgpr_write_b32 a218, v78
v_perm_b32 v78, v69, v68, s70
v_accvgpr_write_b32 a147, v78
v_perm_b32 v78, v69, v68, s71
v_accvgpr_write_b32 a219, v78
v_perm_b32 v78, v71, v70, s70
v_accvgpr_write_b32 a148, v78
v_perm_b32 v78, v71, v70, s71
v_accvgpr_write_b32 a220, v78
v_perm_b32 v78, v75, v74, s70
v_accvgpr_write_b32 a149, v78
v_perm_b32 v78, v75, v74, s71
v_accvgpr_write_b32 a221, v78
v_perm_b32 v78, v73, v72, s70
v_accvgpr_write_b32 a150, v78
v_perm_b32 v78, v73, v72, s71
v_accvgpr_write_b32 a222, v78
v_perm_b32 v78, v77, v76, s70
v_accvgpr_write_b32 a151, v78
v_perm_b32 v78, v77, v76, s71
v_accvgpr_write_b32 a223, v78
s_mov_b32 s73, 1048576
buffer_load_dword v62, v41, s[8:11], s73 offen
buffer_load_dword v63, v42, s[8:11], s73 offen
buffer_load_dword v64, v43, s[8:11], s73 offen
buffer_load_dword v65, v44, s[8:11], s73 offen
s_mov_b32 s73, 1310720
buffer_load_dword v66, v41, s[8:11], s73 offen
buffer_load_dword v67, v42, s[8:11], s73 offen
buffer_load_dword v68, v43, s[8:11], s73 offen
buffer_load_dword v69, v44, s[8:11], s73 offen
s_mov_b32 s73, 1179648
buffer_load_dword v70, v41, s[8:11], s73 offen
buffer_load_dword v71, v42, s[8:11], s73 offen
buffer_load_dword v72, v43, s[8:11], s73 offen
buffer_load_dword v73, v44, s[8:11], s73 offen
s_mov_b32 s73, 1441792
buffer_load_dword v74, v41, s[8:11], s73 offen
buffer_load_dword v75, v42, s[8:11], s73 offen
buffer_load_dword v76, v43, s[8:11], s73 offen
buffer_load_dword v77, v44, s[8:11], s73 offen
s_waitcnt vmcnt(16)
v_perm_b32 v78, v47, v46, s70
v_accvgpr_write_b32 a152, v78
v_perm_b32 v78, v47, v46, s71
v_accvgpr_write_b32 a224, v78
v_perm_b32 v78, v51, v50, s70
v_accvgpr_write_b32 a153, v78
v_perm_b32 v78, v51, v50, s71
v_accvgpr_write_b32 a225, v78
v_perm_b32 v78, v49, v48, s70
v_accvgpr_write_b32 a154, v78
v_perm_b32 v78, v49, v48, s71
v_accvgpr_write_b32 a226, v78
v_perm_b32 v78, v53, v52, s70
v_accvgpr_write_b32 a155, v78
v_perm_b32 v78, v53, v52, s71
v_accvgpr_write_b32 a227, v78
v_perm_b32 v78, v55, v54, s70
v_accvgpr_write_b32 a156, v78
v_perm_b32 v78, v55, v54, s71
v_accvgpr_write_b32 a228, v78
v_perm_b32 v78, v59, v58, s70
v_accvgpr_write_b32 a157, v78
v_perm_b32 v78, v59, v58, s71
v_accvgpr_write_b32 a229, v78
v_perm_b32 v78, v57, v56, s70
v_accvgpr_write_b32 a158, v78
v_perm_b32 v78, v57, v56, s71
v_accvgpr_write_b32 a230, v78
v_perm_b32 v78, v61, v60, s70
v_accvgpr_write_b32 a159, v78
v_perm_b32 v78, v61, v60, s71
v_accvgpr_write_b32 a231, v78
s_mov_b32 s73, 1572864
buffer_load_dword v46, v41, s[8:11], s73 offen
buffer_load_dword v47, v42, s[8:11], s73 offen
buffer_load_dword v48, v43, s[8:11], s73 offen
buffer_load_dword v49, v44, s[8:11], s73 offen
s_mov_b32 s73, 1835008
buffer_load_dword v50, v41, s[8:11], s73 offen
buffer_load_dword v51, v42, s[8:11], s73 offen
buffer_load_dword v52, v43, s[8:11], s73 offen
buffer_load_dword v53, v44, s[8:11], s73 offen
s_mov_b32 s73, 1703936
buffer_load_dword v54, v41, s[8:11], s73 offen
buffer_load_dword v55, v42, s[8:11], s73 offen
buffer_load_dword v56, v43, s[8:11], s73 offen
buffer_load_dword v57, v44, s[8:11], s73 offen
s_mov_b32 s73, 1966080
buffer_load_dword v58, v41, s[8:11], s73 offen
buffer_load_dword v59, v42, s[8:11], s73 offen
buffer_load_dword v60, v43, s[8:11], s73 offen
buffer_load_dword v61, v44, s[8:11], s73 offen
s_waitcnt vmcnt(16)
v_perm_b32 v78, v63, v62, s70
v_accvgpr_write_b32 a160, v78
v_perm_b32 v78, v63, v62, s71
v_accvgpr_write_b32 a232, v78
v_perm_b32 v78, v67, v66, s70
v_accvgpr_write_b32 a161, v78
v_perm_b32 v78, v67, v66, s71
v_accvgpr_write_b32 a233, v78
v_perm_b32 v78, v65, v64, s70
v_accvgpr_write_b32 a162, v78
v_perm_b32 v78, v65, v64, s71
v_accvgpr_write_b32 a234, v78
v_perm_b32 v78, v69, v68, s70
v_accvgpr_write_b32 a163, v78
v_perm_b32 v78, v69, v68, s71
v_accvgpr_write_b32 a235, v78
v_perm_b32 v78, v71, v70, s70
v_accvgpr_write_b32 a164, v78
v_perm_b32 v78, v71, v70, s71
v_accvgpr_write_b32 a236, v78
v_perm_b32 v78, v75, v74, s70
v_accvgpr_write_b32 a165, v78
v_perm_b32 v78, v75, v74, s71
v_accvgpr_write_b32 a237, v78
v_perm_b32 v78, v73, v72, s70
v_accvgpr_write_b32 a166, v78
v_perm_b32 v78, v73, v72, s71
v_accvgpr_write_b32 a238, v78
v_perm_b32 v78, v77, v76, s70
v_accvgpr_write_b32 a167, v78
v_perm_b32 v78, v77, v76, s71
v_accvgpr_write_b32 a239, v78
s_mov_b32 s73, 2097152
buffer_load_dword v62, v41, s[8:11], s73 offen
buffer_load_dword v63, v42, s[8:11], s73 offen
buffer_load_dword v64, v43, s[8:11], s73 offen
buffer_load_dword v65, v44, s[8:11], s73 offen
s_mov_b32 s73, 2359296
buffer_load_dword v66, v41, s[8:11], s73 offen
buffer_load_dword v67, v42, s[8:11], s73 offen
buffer_load_dword v68, v43, s[8:11], s73 offen
buffer_load_dword v69, v44, s[8:11], s73 offen
s_mov_b32 s73, 2228224
buffer_load_dword v70, v41, s[8:11], s73 offen
buffer_load_dword v71, v42, s[8:11], s73 offen
buffer_load_dword v72, v43, s[8:11], s73 offen
buffer_load_dword v73, v44, s[8:11], s73 offen
s_mov_b32 s73, 2490368
buffer_load_dword v74, v41, s[8:11], s73 offen
buffer_load_dword v75, v42, s[8:11], s73 offen
buffer_load_dword v76, v43, s[8:11], s73 offen
buffer_load_dword v77, v44, s[8:11], s73 offen
s_waitcnt vmcnt(16)
v_perm_b32 v78, v47, v46, s70
v_accvgpr_write_b32 a168, v78
v_perm_b32 v78, v47, v46, s71
v_accvgpr_write_b32 a240, v78
v_perm_b32 v78, v51, v50, s70
v_accvgpr_write_b32 a169, v78
v_perm_b32 v78, v51, v50, s71
v_accvgpr_write_b32 a241, v78
v_perm_b32 v78, v49, v48, s70
v_accvgpr_write_b32 a170, v78
v_perm_b32 v78, v49, v48, s71
v_accvgpr_write_b32 a242, v78
v_perm_b32 v78, v53, v52, s70
v_accvgpr_write_b32 a171, v78
v_perm_b32 v78, v53, v52, s71
v_accvgpr_write_b32 a243, v78
v_perm_b32 v78, v55, v54, s70
v_accvgpr_write_b32 a172, v78
v_perm_b32 v78, v55, v54, s71
v_accvgpr_write_b32 a244, v78
v_perm_b32 v78, v59, v58, s70
v_accvgpr_write_b32 a173, v78
v_perm_b32 v78, v59, v58, s71
v_accvgpr_write_b32 a245, v78
v_perm_b32 v78, v57, v56, s70
v_accvgpr_write_b32 a174, v78
v_perm_b32 v78, v57, v56, s71
v_accvgpr_write_b32 a246, v78
v_perm_b32 v78, v61, v60, s70
v_accvgpr_write_b32 a175, v78
v_perm_b32 v78, v61, v60, s71
v_accvgpr_write_b32 a247, v78
s_mov_b32 s73, 2621440
buffer_load_dword v46, v41, s[8:11], s73 offen
buffer_load_dword v47, v42, s[8:11], s73 offen
buffer_load_dword v48, v43, s[8:11], s73 offen
buffer_load_dword v49, v44, s[8:11], s73 offen
s_mov_b32 s73, 2883584
buffer_load_dword v50, v41, s[8:11], s73 offen
buffer_load_dword v51, v42, s[8:11], s73 offen
buffer_load_dword v52, v43, s[8:11], s73 offen
buffer_load_dword v53, v44, s[8:11], s73 offen
s_mov_b32 s73, 2752512
buffer_load_dword v54, v41, s[8:11], s73 offen
buffer_load_dword v55, v42, s[8:11], s73 offen
buffer_load_dword v56, v43, s[8:11], s73 offen
buffer_load_dword v57, v44, s[8:11], s73 offen
s_mov_b32 s73, 3014656
buffer_load_dword v58, v41, s[8:11], s73 offen
buffer_load_dword v59, v42, s[8:11], s73 offen
buffer_load_dword v60, v43, s[8:11], s73 offen
buffer_load_dword v61, v44, s[8:11], s73 offen
s_waitcnt vmcnt(16)
v_perm_b32 v78, v63, v62, s70
v_accvgpr_write_b32 a176, v78
v_perm_b32 v78, v63, v62, s71
v_accvgpr_write_b32 a248, v78
v_perm_b32 v78, v67, v66, s70
v_accvgpr_write_b32 a177, v78
v_perm_b32 v78, v67, v66, s71
v_accvgpr_write_b32 a249, v78
v_perm_b32 v78, v65, v64, s70
v_accvgpr_write_b32 a178, v78
v_perm_b32 v78, v65, v64, s71
v_accvgpr_write_b32 a250, v78
v_perm_b32 v78, v69, v68, s70
v_accvgpr_write_b32 a179, v78
v_perm_b32 v78, v69, v68, s71
v_accvgpr_write_b32 a251, v78
v_perm_b32 v78, v71, v70, s70
v_accvgpr_write_b32 a180, v78
v_perm_b32 v78, v71, v70, s71
v_accvgpr_write_b32 a252, v78
v_perm_b32 v78, v75, v74, s70
v_accvgpr_write_b32 a181, v78
v_perm_b32 v78, v75, v74, s71
v_accvgpr_write_b32 a253, v78
v_perm_b32 v78, v73, v72, s70
v_accvgpr_write_b32 a182, v78
v_perm_b32 v78, v73, v72, s71
v_accvgpr_write_b32 a254, v78
v_perm_b32 v78, v77, v76, s70
v_accvgpr_write_b32 a183, v78
v_perm_b32 v78, v77, v76, s71
v_accvgpr_write_b32 a255, v78
s_mov_b32 s73, 3145728
buffer_load_dword v62, v41, s[8:11], s73 offen
buffer_load_dword v63, v42, s[8:11], s73 offen
buffer_load_dword v64, v43, s[8:11], s73 offen
buffer_load_dword v65, v44, s[8:11], s73 offen
s_mov_b32 s73, 3407872
buffer_load_dword v66, v41, s[8:11], s73 offen
buffer_load_dword v67, v42, s[8:11], s73 offen
buffer_load_dword v68, v43, s[8:11], s73 offen
buffer_load_dword v69, v44, s[8:11], s73 offen
s_mov_b32 s73, 3276800
buffer_load_dword v70, v41, s[8:11], s73 offen
buffer_load_dword v71, v42, s[8:11], s73 offen
buffer_load_dword v72, v43, s[8:11], s73 offen
buffer_load_dword v73, v44, s[8:11], s73 offen
s_mov_b32 s73, 3538944
buffer_load_dword v74, v41, s[8:11], s73 offen
buffer_load_dword v75, v42, s[8:11], s73 offen
buffer_load_dword v76, v43, s[8:11], s73 offen
buffer_load_dword v77, v44, s[8:11], s73 offen
s_waitcnt vmcnt(16)
v_perm_b32 v78, v47, v46, s70
v_accvgpr_write_b32 a184, v78
v_perm_b32 v80, v47, v46, s71
v_perm_b32 v78, v51, v50, s70
v_accvgpr_write_b32 a185, v78
v_perm_b32 v81, v51, v50, s71
v_perm_b32 v78, v49, v48, s70
v_accvgpr_write_b32 a186, v78
v_perm_b32 v82, v49, v48, s71
v_perm_b32 v78, v53, v52, s70
v_accvgpr_write_b32 a187, v78
v_perm_b32 v83, v53, v52, s71
v_perm_b32 v78, v55, v54, s70
v_accvgpr_write_b32 a188, v78
v_perm_b32 v84, v55, v54, s71
v_perm_b32 v78, v59, v58, s70
v_accvgpr_write_b32 a189, v78
v_perm_b32 v85, v59, v58, s71
v_perm_b32 v78, v57, v56, s70
v_accvgpr_write_b32 a190, v78
v_perm_b32 v86, v57, v56, s71
v_perm_b32 v78, v61, v60, s70
v_accvgpr_write_b32 a191, v78
v_perm_b32 v87, v61, v60, s71
s_mov_b32 s73, 3670016
buffer_load_dword v46, v41, s[8:11], s73 offen
buffer_load_dword v47, v42, s[8:11], s73 offen
buffer_load_dword v48, v43, s[8:11], s73 offen
buffer_load_dword v49, v44, s[8:11], s73 offen
s_mov_b32 s73, 3932160
buffer_load_dword v50, v41, s[8:11], s73 offen
buffer_load_dword v51, v42, s[8:11], s73 offen
buffer_load_dword v52, v43, s[8:11], s73 offen
buffer_load_dword v53, v44, s[8:11], s73 offen
s_mov_b32 s73, 3801088
buffer_load_dword v54, v41, s[8:11], s73 offen
buffer_load_dword v55, v42, s[8:11], s73 offen
buffer_load_dword v56, v43, s[8:11], s73 offen
buffer_load_dword v57, v44, s[8:11], s73 offen
s_mov_b32 s73, 4063232
buffer_load_dword v58, v41, s[8:11], s73 offen
buffer_load_dword v59, v42, s[8:11], s73 offen
buffer_load_dword v60, v43, s[8:11], s73 offen
buffer_load_dword v61, v44, s[8:11], s73 offen
s_waitcnt vmcnt(16)
v_perm_b32 v78, v63, v62, s70
v_accvgpr_write_b32 a192, v78
v_perm_b32 v88, v63, v62, s71
v_perm_b32 v78, v67, v66, s70
v_accvgpr_write_b32 a193, v78
v_perm_b32 v89, v67, v66, s71
v_perm_b32 v78, v65, v64, s70
v_accvgpr_write_b32 a194, v78
v_perm_b32 v90, v65, v64, s71
v_perm_b32 v78, v69, v68, s70
v_accvgpr_write_b32 a195, v78
v_perm_b32 v91, v69, v68, s71
v_perm_b32 v78, v71, v70, s70
v_accvgpr_write_b32 a196, v78
v_perm_b32 v92, v71, v70, s71
v_perm_b32 v78, v75, v74, s70
v_accvgpr_write_b32 a197, v78
v_perm_b32 v93, v75, v74, s71
v_perm_b32 v78, v73, v72, s70
v_accvgpr_write_b32 a198, v78
v_perm_b32 v94, v73, v72, s71
v_perm_b32 v78, v77, v76, s70
v_accvgpr_write_b32 a199, v78
v_perm_b32 v95, v77, v76, s71
s_mov_b32 s73, 4194304
buffer_load_dword v62, v41, s[8:11], s73 offen
buffer_load_dword v63, v42, s[8:11], s73 offen
buffer_load_dword v64, v43, s[8:11], s73 offen
buffer_load_dword v65, v44, s[8:11], s73 offen
s_mov_b32 s73, 4456448
buffer_load_dword v66, v41, s[8:11], s73 offen
buffer_load_dword v67, v42, s[8:11], s73 offen
buffer_load_dword v68, v43, s[8:11], s73 offen
buffer_load_dword v69, v44, s[8:11], s73 offen
s_mov_b32 s73, 4325376
buffer_load_dword v70, v41, s[8:11], s73 offen
buffer_load_dword v71, v42, s[8:11], s73 offen
buffer_load_dword v72, v43, s[8:11], s73 offen
buffer_load_dword v73, v44, s[8:11], s73 offen
s_mov_b32 s73, 4587520
buffer_load_dword v74, v41, s[8:11], s73 offen
buffer_load_dword v75, v42, s[8:11], s73 offen
buffer_load_dword v76, v43, s[8:11], s73 offen
buffer_load_dword v77, v44, s[8:11], s73 offen
s_waitcnt vmcnt(16)
v_perm_b32 v78, v47, v46, s70
v_accvgpr_write_b32 a200, v78
v_perm_b32 v96, v47, v46, s71
v_perm_b32 v78, v51, v50, s70
v_accvgpr_write_b32 a201, v78
v_perm_b32 v97, v51, v50, s71
v_perm_b32 v78, v49, v48, s70
v_accvgpr_write_b32 a202, v78
v_perm_b32 v98, v49, v48, s71
v_perm_b32 v78, v53, v52, s70
v_accvgpr_write_b32 a203, v78
v_perm_b32 v99, v53, v52, s71
v_perm_b32 v78, v55, v54, s70
v_accvgpr_write_b32 a204, v78
v_perm_b32 v100, v55, v54, s71
v_perm_b32 v78, v59, v58, s70
v_accvgpr_write_b32 a205, v78
v_perm_b32 v101, v59, v58, s71
v_perm_b32 v78, v57, v56, s70
v_accvgpr_write_b32 a206, v78
v_perm_b32 v102, v57, v56, s71
v_perm_b32 v78, v61, v60, s70
v_accvgpr_write_b32 a207, v78
v_perm_b32 v103, v61, v60, s71
s_lshl_b32 s96, s22, 2
s_add_u32 s96, s96, 128
buffer_load_dword v38, off, s[16:19], 0 sc1
buffer_load_dword v39, off, s[16:19], s96 sc1
s_waitcnt vmcnt(0)
s_mov_b32 s95, 0
L_carr_4:
v_min_u32 v38, v38, v39
v_cmp_gt_u32 vcc, 32, v38
s_nop 0
s_nop 2
s_cbranch_vccz L_carrok_5
s_add_u32 s95, s95, 1
s_cmp_gt_u32 s95, 200000
s_cbranch_scc1 L_FAIL
s_sleep 4
buffer_load_dword v38, off, s[16:19], 0 sc1
buffer_load_dword v39, off, s[16:19], s96 sc1
s_waitcnt vmcnt(0)
s_branch L_carr_4
L_carrok_5:
s_load_dwordx2 s[90:91], s[0:1], 56
s_waitcnt lgkmcnt(0)
s_mov_b32 s8, s90
s_and_b32 s9, s91, 0xffff
s_mov_b32 s10, 0x480000
s_mov_b32 s11, 0x20000
s_mov_b32 s73, 0
buffer_load_dword v46, v41, s[8:11], s73 offen
buffer_load_dword v47, v42, s[8:11], s73 offen
buffer_load_dword v48, v43, s[8:11], s73 offen
buffer_load_dword v49, v44, s[8:11], s73 offen
s_mov_b32 s73, 262144
buffer_load_dword v50, v41, s[8:11], s73 offen
buffer_load_dword v51, v42, s[8:11], s73 offen
buffer_load_dword v52, v43, s[8:11], s73 offen
buffer_load_dword v53, v44, s[8:11], s73 offen
s_mov_b32 s73, 131072
buffer_load_dword v54, v41, s[8:11], s73 offen
buffer_load_dword v55, v42, s[8:11], s73 offen
buffer_load_dword v56, v43, s[8:11], s73 offen
buffer_load_dword v57, v44, s[8:11], s73 offen
s_mov_b32 s73, 393216
buffer_load_dword v58, v41, s[8:11], s73 offen
buffer_load_dword v59, v42, s[8:11], s73 offen
buffer_load_dword v60, v43, s[8:11], s73 offen
buffer_load_dword v61, v44, s[8:11], s73 offen
s_waitcnt vmcnt(16)
v_perm_b32 v78, v63, v62, s70
v_accvgpr_write_b32 a208, v78
v_perm_b32 v104, v63, v62, s71
v_perm_b32 v78, v67, v66, s70
v_accvgpr_write_b32 a209, v78
v_perm_b32 v105, v67, v66, s71
v_perm_b32 v78, v65, v64, s70
v_accvgpr_write_b32 a210, v78
v_perm_b32 v106, v65, v64, s71
v_perm_b32 v78, v69, v68, s70
v_accvgpr_write_b32 a211, v78
v_perm_b32 v107, v69, v68, s71
v_perm_b32 v78, v71, v70, s70
v_accvgpr_write_b32 a212, v78
v_perm_b32 v108, v71, v70, s71
v_perm_b32 v78, v75, v74, s70
v_accvgpr_write_b32 a213, v78
v_perm_b32 v109, v75, v74, s71
v_perm_b32 v78, v73, v72, s70
v_accvgpr_write_b32 a214, v78
v_perm_b32 v110, v73, v72, s71
v_perm_b32 v78, v77, v76, s70
v_accvgpr_write_b32 a215, v78
v_perm_b32 v111, v77, v76, s71
s_mov_b32 s73, 524288
buffer_load_dword v62, v41, s[8:11], s73 offen
buffer_load_dword v63, v42, s[8:11], s73 offen
buffer_load_dword v64, v43, s[8:11], s73 offen
buffer_load_dword v65, v44, s[8:11], s73 offen
s_mov_b32 s73, 786432
buffer_load_dword v66, v41, s[8:11], s73 offen
buffer_load_dword v67, v42, s[8:11], s73 offen
buffer_load_dword v68, v43, s[8:11], s73 offen
buffer_load_dword v69, v44, s[8:11], s73 offen
s_mov_b32 s73, 655360
buffer_load_dword v70, v41, s[8:11], s73 offen
buffer_load_dword v71, v42, s[8:11], s73 offen
buffer_load_dword v72, v43, s[8:11], s73 offen
buffer_load_dword v73, v44, s[8:11], s73 offen
s_mov_b32 s73, 917504
buffer_load_dword v74, v41, s[8:11], s73 offen
buffer_load_dword v75, v42, s[8:11], s73 offen
buffer_load_dword v76, v43, s[8:11], s73 offen
buffer_load_dword v77, v44, s[8:11], s73 offen
s_waitcnt vmcnt(16)
v_perm_b32 v112, v47, v46, s70
v_perm_b32 v184, v47, v46, s71
v_perm_b32 v113, v51, v50, s70
v_perm_b32 v185, v51, v50, s71
v_perm_b32 v114, v49, v48, s70
v_perm_b32 v186, v49, v48, s71
v_perm_b32 v115, v53, v52, s70
v_perm_b32 v187, v53, v52, s71
v_perm_b32 v116, v55, v54, s70
v_perm_b32 v188, v55, v54, s71
v_perm_b32 v117, v59, v58, s70
v_perm_b32 v189, v59, v58, s71
v_perm_b32 v118, v57, v56, s70
v_perm_b32 v190, v57, v56, s71
v_perm_b32 v119, v61, v60, s70
v_perm_b32 v191, v61, v60, s71
s_mov_b32 s73, 1048576
buffer_load_dword v46, v41, s[8:11], s73 offen
buffer_load_dword v47, v42, s[8:11], s73 offen
buffer_load_dword v48, v43, s[8:11], s73 offen
buffer_load_dword v49, v44, s[8:11], s73 offen
s_mov_b32 s73, 1310720
buffer_load_dword v50, v41, s[8:11], s73 offen
buffer_load_dword v51, v42, s[8:11], s73 offen
buffer_load_dword v52, v43, s[8:11], s73 offen
buffer_load_dword v53, v44, s[8:11], s73 offen
s_mov_b32 s73, 1179648
buffer_load_dword v54, v41, s[8:11], s73 offen
buffer_load_dword v55, v42, s[8:11], s73 offen
buffer_load_dword v56, v43, s[8:11], s73 offen
buffer_load_dword v57, v44, s[8:11], s73 offen
s_mov_b32 s73, 1441792
buffer_load_dword v58, v41, s[8:11], s73 offen
buffer_load_dword v59, v42, s[8:11], s73 offen
buffer_load_dword v60, v43, s[8:11], s73 offen
buffer_load_dword v61, v44, s[8:11], s73 offen
s_waitcnt vmcnt(16)
v_perm_b32 v120, v63, v62, s70
v_perm_b32 v192, v63, v62, s71
v_perm_b32 v121, v67, v66, s70
v_perm_b32 v193, v67, v66, s71
v_perm_b32 v122, v65, v64, s70
v_perm_b32 v194, v65, v64, s71
v_perm_b32 v123, v69, v68, s70
v_perm_b32 v195, v69, v68, s71
v_perm_b32 v124, v71, v70, s70
v_perm_b32 v196, v71, v70, s71
v_perm_b32 v125, v75, v74, s70
v_perm_b32 v197, v75, v74, s71
v_perm_b32 v126, v73, v72, s70
v_perm_b32 v198, v73, v72, s71
v_perm_b32 v127, v77, v76, s70
v_perm_b32 v199, v77, v76, s71
s_mov_b32 s73, 1572864
buffer_load_dword v62, v41, s[8:11], s73 offen
buffer_load_dword v63, v42, s[8:11], s73 offen
buffer_load_dword v64, v43, s[8:11], s73 offen
buffer_load_dword v65, v44, s[8:11], s73 offen
s_mov_b32 s73, 1835008
buffer_load_dword v66, v41, s[8:11], s73 offen
buffer_load_dword v67, v42, s[8:11], s73 offen
buffer_load_dword v68, v43, s[8:11], s73 offen
buffer_load_dword v69, v44, s[8:11], s73 offen
s_mov_b32 s73, 1703936
buffer_load_dword v70, v41, s[8:11], s73 offen
buffer_load_dword v71, v42, s[8:11], s73 offen
buffer_load_dword v72, v43, s[8:11], s73 offen
buffer_load_dword v73, v44, s[8:11], s73 offen
s_mov_b32 s73, 1966080
buffer_load_dword v74, v41, s[8:11], s73 offen
buffer_load_dword v75, v42, s[8:11], s73 offen
buffer_load_dword v76, v43, s[8:11], s73 offen
buffer_load_dword v77, v44, s[8:11], s73 offen
s_waitcnt vmcnt(16)
v_perm_b32 v128, v47, v46, s70
v_perm_b32 v200, v47, v46, s71
v_perm_b32 v129, v51, v50, s70
v_perm_b32 v201, v51, v50, s71
v_perm_b32 v130, v49, v48, s70
v_perm_b32 v202, v49, v48, s71
v_perm_b32 v131, v53, v52, s70
v_perm_b32 v203, v53, v52, s71
v_perm_b32 v132, v55, v54, s70
v_perm_b32 v204, v55, v54, s71
v_perm_b32 v133, v59, v58, s70
v_perm_b32 v205, v59, v58, s71
v_perm_b32 v134, v57, v56, s70
v_perm_b32 v206, v57, v56, s71
v_perm_b32 v135, v61, v60, s70
v_perm_b32 v207, v61, v60, s71
s_mov_b32 s73, 2097152
buffer_load_dword v46, v41, s[8:11], s73 offen
buffer_load_dword v47, v42, s[8:11], s73 offen
buffer_load_dword v48, v43, s[8:11], s73 offen
buffer_load_dword v49, v44, s[8:11], s73 offen
s_mov_b32 s73, 2359296
buffer_load_dword v50, v41, s[8:11], s73 offen
buffer_load_dword v51, v42, s[8:11], s73 offen
buffer_load_dword v52, v43, s[8:11], s73 offen
buffer_load_dword v53, v44, s[8:11], s73 offen
s_mov_b32 s73, 2228224
buffer_load_dword v54, v41, s[8:11], s73 offen
buffer_load_dword v55, v42, s[8:11], s73 offen
buffer_load_dword v56, v43, s[8:11], s73 offen
buffer_load_dword v57, v44, s[8:11], s73 offen
s_mov_b32 s73, 2490368
buffer_load_dword v58, v41, s[8:11], s73 offen
buffer_load_dword v59, v42, s[8:11], s73 offen
buffer_load_dword v60, v43, s[8:11], s73 offen
buffer_load_dword v61, v44, s[8:11], s73 offen
s_waitcnt vmcnt(16)
v_perm_b32 v136, v63, v62, s70
v_perm_b32 v208, v63, v62, s71
v_perm_b32 v137, v67, v66, s70
v_perm_b32 v209, v67, v66, s71
v_perm_b32 v138, v65, v64, s70
v_perm_b32 v210, v65, v64, s71
v_perm_b32 v139, v69, v68, s70
v_perm_b32 v211, v69, v68, s71
v_perm_b32 v140, v71, v70, s70
v_perm_b32 v212, v71, v70, s71
v_perm_b32 v141, v75, v74, s70
v_perm_b32 v213, v75, v74, s71
v_perm_b32 v142, v73, v72, s70
v_perm_b32 v214, v73, v72, s71
v_perm_b32 v143, v77, v76, s70
v_perm_b32 v215, v77, v76, s71
s_mov_b32 s73, 2621440
buffer_load_dword v62, v41, s[8:11], s73 offen
buffer_load_dword v63, v42, s[8:11], s73 offen
buffer_load_dword v64, v43, s[8:11], s73 offen
buffer_load_dword v65, v44, s[8:11], s73 offen
s_mov_b32 s73, 2883584
buffer_load_dword v66, v41, s[8:11], s73 offen
buffer_load_dword v67, v42, s[8:11], s73 offen
buffer_load_dword v68, v43, s[8:11], s73 offen
buffer_load_dword v69, v44, s[8:11], s73 offen
s_mov_b32 s73, 2752512
buffer_load_dword v70, v41, s[8:11], s73 offen
buffer_load_dword v71, v42, s[8:11], s73 offen
buffer_load_dword v72, v43, s[8:11], s73 offen
buffer_load_dword v73, v44, s[8:11], s73 offen
s_mov_b32 s73, 3014656
buffer_load_dword v74, v41, s[8:11], s73 offen
buffer_load_dword v75, v42, s[8:11], s73 offen
buffer_load_dword v76, v43, s[8:11], s73 offen
buffer_load_dword v77, v44, s[8:11], s73 offen
s_waitcnt vmcnt(16)
v_perm_b32 v144, v47, v46, s70
v_perm_b32 v216, v47, v46, s71
v_perm_b32 v145, v51, v50, s70
v_perm_b32 v217, v51, v50, s71
v_perm_b32 v146, v49, v48, s70
v_perm_b32 v218, v49, v48, s71
v_perm_b32 v147, v53, v52, s70
v_perm_b32 v219, v53, v52, s71
v_perm_b32 v148, v55, v54, s70
v_perm_b32 v220, v55, v54, s71
v_perm_b32 v149, v59, v58, s70
v_perm_b32 v221, v59, v58, s71
v_perm_b32 v150, v57, v56, s70
v_perm_b32 v222, v57, v56, s71
v_perm_b32 v151, v61, v60, s70
v_perm_b32 v223, v61, v60, s71
s_mov_b32 s73, 3145728
buffer_load_dword v46, v41, s[8:11], s73 offen
buffer_load_dword v47, v42, s[8:11], s73 offen
buffer_load_dword v48, v43, s[8:11], s73 offen
buffer_load_dword v49, v44, s[8:11], s73 offen
s_mov_b32 s73, 3407872
buffer_load_dword v50, v41, s[8:11], s73 offen
buffer_load_dword v51, v42, s[8:11], s73 offen
buffer_load_dword v52, v43, s[8:11], s73 offen
buffer_load_dword v53, v44, s[8:11], s73 offen
s_mov_b32 s73, 3276800
buffer_load_dword v54, v41, s[8:11], s73 offen
buffer_load_dword v55, v42, s[8:11], s73 offen
buffer_load_dword v56, v43, s[8:11], s73 offen
buffer_load_dword v57, v44, s[8:11], s73 offen
s_mov_b32 s73, 3538944
buffer_load_dword v58, v41, s[8:11], s73 offen
buffer_load_dword v59, v42, s[8:11], s73 offen
buffer_load_dword v60, v43, s[8:11], s73 offen
buffer_load_dword v61, v44, s[8:11], s73 offen
s_waitcnt vmcnt(16)
v_perm_b32 v152, v63, v62, s70
v_perm_b32 v224, v63, v62, s71
v_perm_b32 v153, v67, v66, s70
v_perm_b32 v225, v67, v66, s71
v_perm_b32 v154, v65, v64, s70
v_perm_b32 v226, v65, v64, s71
v_perm_b32 v155, v69, v68, s70
v_perm_b32 v227, v69, v68, s71
v_perm_b32 v156, v71, v70, s70
v_perm_b32 v228, v71, v70, s71
v_perm_b32 v157, v75, v74, s70
v_perm_b32 v229, v75, v74, s71
v_perm_b32 v158, v73, v72, s70
v_perm_b32 v230, v73, v72, s71
v_perm_b32 v159, v77, v76, s70
v_perm_b32 v231, v77, v76, s71
s_mov_b32 s73, 3670016
buffer_load_dword v62, v41, s[8:11], s73 offen
buffer_load_dword v63, v42, s[8:11], s73 offen
buffer_load_dword v64, v43, s[8:11], s73 offen
buffer_load_dword v65, v44, s[8:11], s73 offen
s_mov_b32 s73, 3932160
buffer_load_dword v66, v41, s[8:11], s73 offen
buffer_load_dword v67, v42, s[8:11], s73 offen
buffer_load_dword v68, v43, s[8:11], s73 offen
buffer_load_dword v69, v44, s[8:11], s73 offen
s_mov_b32 s73, 3801088
buffer_load_dword v70, v41, s[8:11], s73 offen
buffer_load_dword v71, v42, s[8:11], s73 offen
buffer_load_dword v72, v43, s[8:11], s73 offen
buffer_load_dword v73, v44, s[8:11], s73 offen
s_mov_b32 s73, 4063232
buffer_load_dword v74, v41, s[8:11], s73 offen
buffer_load_dword v75, v42, s[8:11], s73 offen
buffer_load_dword v76, v43, s[8:11], s73 offen
buffer_load_dword v77, v44, s[8:11], s73 offen
s_waitcnt vmcnt(16)
v_perm_b32 v160, v47, v46, s70
v_perm_b32 v232, v47, v46, s71
v_perm_b32 v161, v51, v50, s70
v_perm_b32 v233, v51, v50, s71
v_perm_b32 v162, v49, v48, s70
v_perm_b32 v234, v49, v48, s71
v_perm_b32 v163, v53, v52, s70
v_perm_b32 v235, v53, v52, s71
v_perm_b32 v164, v55, v54, s70
v_perm_b32 v236, v55, v54, s71
v_perm_b32 v165, v59, v58, s70
v_perm_b32 v237, v59, v58, s71
v_perm_b32 v166, v57, v56, s70
v_perm_b32 v238, v57, v56, s71
v_perm_b32 v167, v61, v60, s70
v_perm_b32 v239, v61, v60, s71
s_mov_b32 s73, 4194304
buffer_load_dword v46, v41, s[8:11], s73 offen
buffer_load_dword v47, v42, s[8:11], s73 offen
buffer_load_dword v48, v43, s[8:11], s73 offen
buffer_load_dword v49, v44, s[8:11], s73 offen
s_mov_b32 s73, 4456448
buffer_load_dword v50, v41, s[8:11], s73 offen
buffer_load_dword v51, v42, s[8:11], s73 offen
buffer_load_dword v52, v43, s[8:11], s73 offen
buffer_load_dword v53, v44, s[8:11], s73 offen
s_mov_b32 s73, 4325376
buffer_load_dword v54, v41, s[8:11], s73 offen
buffer_load_dword v55, v42, s[8:11], s73 offen
buffer_load_dword v56, v43, s[8:11], s73 offen
buffer_load_dword v57, v44, s[8:11], s73 offen
s_mov_b32 s73, 4587520
buffer_load_dword v58, v41, s[8:11], s73 offen
buffer_load_dword v59, v42, s[8:11], s73 offen
buffer_load_dword v60, v43, s[8:11], s73 offen
buffer_load_dword v61, v44, s[8:11], s73 offen
s_waitcnt vmcnt(16)
v_perm_b32 v168, v63, v62, s70
v_perm_b32 v240, v63, v62, s71
v_perm_b32 v169, v67, v66, s70
v_perm_b32 v241, v67, v66, s71
v_perm_b32 v170, v65, v64, s70
v_perm_b32 v242, v65, v64, s71
v_perm_b32 v171, v69, v68, s70
v_perm_b32 v243, v69, v68, s71
v_perm_b32 v172, v71, v70, s70
v_perm_b32 v244, v71, v70, s71
v_perm_b32 v173, v75, v74, s70
v_perm_b32 v245, v75, v74, s71
v_perm_b32 v174, v73, v72, s70
v_perm_b32 v246, v73, v72, s71
v_perm_b32 v175, v77, v76, s70
v_perm_b32 v247, v77, v76, s71
s_add_u32 s96, s96, 8
buffer_load_dword v38, off, s[16:19], s96 sc1
s_waitcnt vmcnt(1)
v_perm_b32 v176, v47, v46, s70
v_perm_b32 v248, v47, v46, s71
v_perm_b32 v177, v51, v50, s70
v_perm_b32 v249, v51, v50, s71
v_perm_b32 v178, v49, v48, s70
v_perm_b32 v250, v49, v48, s71
v_perm_b32 v179, v53, v52, s70
v_perm_b32 v251, v53, v52, s71
v_perm_b32 v180, v55, v54, s70
v_perm_b32 v252, v55, v54, s71
v_perm_b32 v181, v59, v58, s70
v_perm_b32 v253, v59, v58, s71
v_perm_b32 v182, v57, v56, s70
v_perm_b32 v254, v57, v56, s71
v_perm_b32 v183, v61, v60, s70
v_perm_b32 v255, v61, v60, s71
s_waitcnt vmcnt(0)
v_readfirstlane_b32 s97, v38
s_load_dwordx2 s[90:91], s[0:1], 64
s_waitcnt lgkmcnt(0)
s_mov_b32 s8, s90
s_and_b32 s9, s91, 0xffff
s_mov_b32 s10, 0x480000
s_mov_b32 s11, 0x20000
v_lshrrev_b32 v41, 4, v40
v_mul_u32_u24 v41, 9216, v41
v_and_b32 v42, 15, v40
v_lshl_add_u32 v41, v42, 2, v41
v_add_u32 v42, 1152, v41
v_add_u32 v43, 4608, v41
v_add_u32 v44, 5760, v41
v_lshlrev_b32 v45, 4, v40
s_mov_b32 s90, s20
L_wo_6:
s_lshr_b32 s91, s90, 2
s_bfe_u32 s92, s90, 0x10001
s_and_b32 s93, s90, 1
s_mul_i32 s3, s23, 147456
s_lshl_b32 s94, s91, 7
s_add_u32 s3, s3, s94
s_lshl_b32 s94, s92, 6
s_add_u32 s3, s3, s94
s_mul_i32 s94, s93, 2304
s_add_u32 s3, s3, s94
s_add_u32 s94, s3, 0
buffer_load_dword v46, v41, s[8:11], s94 offen
buffer_load_dword v47, v42, s[8:11], s94 offen
buffer_load_dword v48, v43, s[8:11], s94 offen
buffer_load_dword v49, v44, s[8:11], s94 offen
s_add_u32 s94, s3, 73728
buffer_load_dword v50, v41, s[8:11], s94 offen
buffer_load_dword v51, v42, s[8:11], s94 offen
buffer_load_dword v52, v43, s[8:11], s94 offen
buffer_load_dword v53, v44, s[8:11], s94 offen
s_add_u32 s94, s3, 36864
buffer_load_dword v54, v41, s[8:11], s94 offen
buffer_load_dword v55, v42, s[8:11], s94 offen
buffer_load_dword v56, v43, s[8:11], s94 offen
buffer_load_dword v57, v44, s[8:11], s94 offen
s_add_u32 s94, s3, 110592
buffer_load_dword v58, v41, s[8:11], s94 offen
buffer_load_dword v59, v42, s[8:11], s94 offen
buffer_load_dword v60, v43, s[8:11], s94 offen
buffer_load_dword v61, v44, s[8:11], s94 offen
s_lshl_b32 s94, s91, 14
s_lshl_b32 s95, s92, 12
s_add_u32 s94, s94, s95
s_lshl_b32 s95, s93, 11
s_add_u32 s94, s94, s95
v_add_u32 v62, s94, v45
s_waitcnt vmcnt(0)
v_perm_b32 v64, v47, v46, s70
v_perm_b32 v65, v51, v50, s70
v_perm_b32 v66, v49, v48, s70
v_perm_b32 v67, v53, v52, s70
ds_write_b128 v62, v[64:67] offset:0
v_perm_b32 v68, v55, v54, s70
v_perm_b32 v69, v59, v58, s70
v_perm_b32 v70, v57, v56, s70
v_perm_b32 v71, v61, v60, s70
ds_write_b128 v62, v[68:71] offset:1024
v_perm_b32 v72, v47, v46, s71
v_perm_b32 v73, v51, v50, s71
v_perm_b32 v74, v49, v48, s71
v_perm_b32 v75, v53, v52, s71
ds_write_b128 v62, v[72:75] offset:8192
v_perm_b32 v76, v55, v54, s71
v_perm_b32 v77, v59, v58, s71
v_perm_b32 v78, v57, v56, s71
v_perm_b32 v79, v61, v60, s71
ds_write_b128 v62, v[76:79] offset:9216
s_add_u32 s90, s90, 4
s_cmp_lt_u32 s90, 36
s_cbranch_scc1 L_wo_6
s_waitcnt lgkmcnt(0)
s_mov_b32 s28, 0
s_mul_i32 s3, s22, 589824
s_add_u32 s3, s3, 901120
s_lshl_b32 s8, s20, 11
s_min_u32 s73, s20, 1
s_lshl_b32 s73, s73, 10
s_add_u32 s8, s8, s73
s_add_u32 s29, s3, s8
s_mul_i32 s3, s22, 589824
s_add_u32 s75, s3, 1057792
s_lshl_b32 s3, s22, 11
s_add_u32 s3, s3, s23
s_lshl_b32 s32, s3, 14
s_add_u32 s32, s32, 88080384
s_add_u32 s33, s32, 4096
s_lshl_b32 s34, s3, 12
s_add_u32 s34, s34, 50331648
s_lshl_b32 s36, s3, 6
s_add_u32 s38, s36, 393216
s_add_u32 s36, s36, 131072
s_mov_b32 s37, 960000
s_lshl_b32 s68, s20, 15
s_lshl_b32 s77, s23, 7
s_add_u32 s9, s77, 262144
s_cmp_eq_u32 s20, 3
s_cselect_b32 s3, 64, 0
s_add_u32 s9, s9, s3
s_lshl_b32 s3, s20, 16
s_add_u32 s77, s77, s3
s_sub_u32 s3, s20, 1
s_lshl_b32 s3, s3, 5
s_add_u32 s45, s3, s23
s_cmp_eq_u32 s20, 0
s_cselect_b32 s45, 1000, s45
s_lshl_b32 s46, s45, 12
s_sub_u32 s46, s46, 147456
s_mul_i32 s3, s22, 589824
s_add_u32 s3, s3, 1057792
s_lshl_b32 s44, s45, 7
s_add_u32 s44, s44, s3
s_lshl_b32 s3, s20, 7
s_cmp_ge_u32 s20, 2
s_cselect_b32 s48, 2048, s3
s_min_u32 s3, s20, 2
s_lshl_b32 s3, s3, 10
s_add_u32 s11, s3, 160768
s_mov_b32 s50, 0x3e0293ee
s_mov_b32 s51, 0x3e0293ee
s_mov_b32 s49, 0xbe0293ee
s_mov_b32 s52, -1
s_mov_b32 s53, 0
s_mov_b32 s30, 0xffff0000
s_mov_b32 s31, 0xffff0000
s_mov_b32 s54, 0x3030303
s_mov_b32 s55, 0x3030303
s_mov_b32 s56, 0xc0c0c0c
s_mov_b32 s57, 0xc0c0c0c
s_mov_b32 s58, 0x30303030
s_mov_b32 s59, 0x30303030
s_mov_b32 s60, 0xc0c0c0c0
s_mov_b32 s61, 0xc0c0c0c0
s_mov_b32 s62, 0xaaaaaaaa
s_mov_b32 s63, 0xaaaaaaaa
s_mov_b32 s64, 0x3f80
s_mov_b32 s65, 0x3f800000
s_mov_b32 s78, 0x3f803f80
s_mov_b32 s79, 0x3f803f80
s_mov_b32 s76, 0
s_barrier
s_bcnt1_i32_b32 s90, s97
s_cmp_eq_u32 s90, 1
s_cbranch_scc0 L_ch_slow
s_cmp_eq_u32 s20, 0
s_cbranch_scc1 L_cls0p
s_cmp_eq_u32 s20, 2
s_cbranch_scc1 L_cls2p
s_cmp_eq_u32 s20, 3
s_cbranch_scc1 L_cls3p
v_mov_b64 v[50:51], 0
v_mov_b64 v[52:53], 0
v_mov_b64 v[54:55], 0
v_mov_b64 v[56:57], 0
v_mov_b64 v[58:59], 0
v_mov_b64 v[60:61], 0
v_mov_b64 v[62:63], 0
v_mov_b64 v[64:65], 0
v_mov_b64 v[66:67], 0
v_mov_b64 v[68:69], 0
v_mov_b64 v[70:71], 0
v_mov_b64 v[72:73], 0
v_subrev_u32 v76, 147456, v1
v_and_b32 v78, 0x30, v76
v_bfe_u32 v75, v76, 7, 1
v_lshl_add_u32 v78, v75, 6, v78
v_lshrrev_b32 v76, 8, v76
v_lshl_add_u32 v78, v76, 7, v78
v_lshl_add_u32 v78, s20, 9, v78
s_lshl_b32 s3, s20, 9
v_add_u32 v79, s3, v3
v_add_u32 v77, s8, v1
ds_read_b128 v[10:13], v77 offset:0
ds_read_b128 v[14:17], v77 offset:1024
s_waitcnt lgkmcnt(0)
s_branch L_ch_b1_p1
L_ch_top_p1:
s_barrier
s_mov_b32 s67, 0
L_ag_7:
buffer_load_dwordx4 v[10:13], v1, s[4:7], s29 offen offset:0 sc1
buffer_load_dwordx4 v[14:17], v1, s[4:7], s29 offen offset:1024 sc1
s_add_u32 s67, s67, 1
s_cmp_gt_u32 s67, 200000
s_cbranch_scc1 L_FAIL
s_waitcnt vmcnt(1)
ds_write_b128 v77, v[10:13] offset:0
s_waitcnt vmcnt(0)
ds_write_b128 v77, v[14:17] offset:1024
v_max3_u32 v74, v10, v11, v12
v_max3_u32 v75, v13, v14, v15
v_max3_u32 v74, v74, v16, v17
v_max3_u32 v74, v74, v75, v75
v_cmp_eq_u32 vcc, -1, v74
s_nop 0
s_cbranch_vccnz L_ag_7
L_ch_b1_p1:
v_smfmac_f32_16x16x64_bf16 v[50:53], v[10:13], a[24:31], v0
v_smfmac_f32_16x16x64_bf16 v[54:57], v[10:13], a[96:103], v0
v_smfmac_f32_16x16x64_bf16 v[58:61], v[10:13], a[168:175], v0
v_smfmac_f32_16x16x64_bf16 v[62:65], v[10:13], a[240:247], v0
s_waitcnt lgkmcnt(0)
s_barrier
v_smfmac_f32_16x16x64_bf16 v[50:53], v[14:17], a[32:39], v0
ds_read_b128 v[38:41], v1 offset:0
v_smfmac_f32_16x16x64_bf16 v[54:57], v[14:17], a[104:111], v0
ds_read_b128 v[42:45], v1 offset:1024
v_smfmac_f32_16x16x64_bf16 v[58:61], v[14:17], a[176:183], v0
ds_read_b128 v[46:49], v1 offset:2048
v_smfmac_f32_16x16x64_bf16 v[62:65], v[14:17], a[248:255], v0
s_mov_b32 m0, s11
s_add_u32 s3, s32, s48
v_smfmac_f32_16x16x64_bf16 v[66:69], v[10:13], v[136:143], v0
buffer_load_dwordx4 v4, s[4:7], s3 offen sc1 lds
v_smfmac_f32_16x16x64_bf16 v[70:73], v[10:13], v[208:215], v0
v_smfmac_f32_16x16x64_bf16 v[66:69], v[14:17], v[144:151], v0
v_smfmac_f32_16x16x64_bf16 v[70:73], v[14:17], v[216:223], v0
buffer_load_dwordx4 v[22:25], v4, s[4:7], s33 offen offset:2048 sc1
s_waitcnt lgkmcnt(2)
v_smfmac_f32_16x16x64_bf16 v[50:53], v[38:41], a[0:7], v0
v_smfmac_f32_16x16x64_bf16 v[54:57], v[38:41], a[72:79], v0
v_smfmac_f32_16x16x64_bf16 v[58:61], v[38:41], a[144:151], v0
buffer_load_dwordx4 v[26:29], v4, s[4:7], s33 offen offset:2176 sc1
v_smfmac_f32_16x16x64_bf16 v[62:65], v[38:41], a[216:223], v0
ds_read_b128 v[38:41], v1 offset:5120
s_waitcnt lgkmcnt(2)
v_smfmac_f32_16x16x64_bf16 v[50:53], v[42:45], a[8:15], v0
v_smfmac_f32_16x16x64_bf16 v[54:57], v[42:45], a[80:87], v0
buffer_load_dwordx4 v[18:21], v4, s[4:7], s33 offen offset:128 sc1
v_smfmac_f32_16x16x64_bf16 v[58:61], v[42:45], a[152:159], v0
v_smfmac_f32_16x16x64_bf16 v[62:65], v[42:45], a[224:231], v0
ds_read_b128 v[42:45], v1 offset:6144
s_waitcnt lgkmcnt(2)
v_smfmac_f32_16x16x64_bf16 v[50:53], v[46:49], a[16:23], v0
buffer_load_dwordx4 v[10:13], v4, s[4:7], s32 offen offset:2176 sc1
v_smfmac_f32_16x16x64_bf16 v[54:57], v[46:49], a[88:95], v0
v_smfmac_f32_16x16x64_bf16 v[58:61], v[46:49], a[160:167], v0
buffer_load_dwordx4 v[14:17], v4, s[4:7], s33 offen offset:0 sc1
v_smfmac_f32_16x16x64_bf16 v[62:65], v[46:49], a[232:239], v0
ds_read_b128 v[46:49], v1 offset:7168
s_waitcnt lgkmcnt(2)
v_smfmac_f32_16x16x64_bf16 v[50:53], v[38:41], a[40:47], v0
buffer_load_dwordx4 v[30:33], v5, s[4:7], s32 offen offset:0 sc1
v_smfmac_f32_16x16x64_bf16 v[54:57], v[38:41], a[112:119], v0
v_smfmac_f32_16x16x64_bf16 v[58:61], v[38:41], a[184:191], v0
buffer_load_dwordx4 v[34:37], v5, s[4:7], s32 offen offset:2048 sc1
v_smfmac_f32_16x16x64_bf16 v[62:65], v[38:41], v[80:87], v0
ds_read_b128 v[38:41], v1 offset:8192
s_waitcnt lgkmcnt(2)
v_smfmac_f32_16x16x64_bf16 v[50:53], v[42:45], a[48:55], v0
v_smfmac_f32_16x16x64_bf16 v[54:57], v[42:45], a[120:127], v0
v_smfmac_f32_16x16x64_bf16 v[58:61], v[42:45], a[192:199], v0
v_smfmac_f32_16x16x64_bf16 v[62:65], v[42:45], v[88:95], v0
ds_read_b128 v[42:45], v1 offset:0
s_waitcnt lgkmcnt(2)
v_smfmac_f32_16x16x64_bf16 v[50:53], v[46:49], a[56:63], v0
v_smfmac_f32_16x16x64_bf16 v[54:57], v[46:49], a[128:135], v0
v_smfmac_f32_16x16x64_bf16 v[58:61], v[46:49], a[200:207], v0
v_smfmac_f32_16x16x64_bf16 v[62:65], v[46:49], v[96:103], v0
ds_read_b128 v[46:49], v1 offset:1024
s_waitcnt lgkmcnt(2)
v_smfmac_f32_16x16x64_bf16 v[50:53], v[38:41], a[64:71], v0
v_smfmac_f32_16x16x64_bf16 v[54:57], v[38:41], a[136:143], v0
v_smfmac_f32_16x16x64_bf16 v[58:61], v[38:41], a[208:215], v0
v_smfmac_f32_16x16x64_bf16 v[62:65], v[38:41], v[104:111], v0
ds_read_b128 v[38:41], v1 offset:2048
s_waitcnt lgkmcnt(2)
v_smfmac_f32_16x16x64_bf16 v[66:69], v[42:45], v[112:119], v0
v_smfmac_f32_16x16x64_bf16 v[70:73], v[42:45], v[184:191], v0
ds_read_b128 v[42:45], v1 offset:5120
v_add_f32 v50, v50, v52
v_add_f32 v51, v51, v53
v_add_f32 v54, v54, v56
v_add_f32 v55, v55, v57
v_cvt_pk_bf16_f32 v74, v50, v51
v_cvt_pk_bf16_f32 v75, v54, v55
ds_write2_b32 v2, v74, v75 offset0:0 offset1:128
v_add_f32 v58, v58, v60
v_add_f32 v59, v59, v61
v_add_f32 v62, v62, v64
v_add_f32 v63, v63, v65
v_cvt_pk_bf16_f32 v76, v58, v59
v_cvt_pk_bf16_f32 v77, v62, v63
ds_write_b32 v2, v76 offset:2048
ds_write_b32 v2, v77 offset:2560
s_waitcnt lgkmcnt(5)
v_smfmac_f32_16x16x64_bf16 v[66:69], v[46:49], v[120:127], v0
v_smfmac_f32_16x16x64_bf16 v[70:73], v[46:49], v[192:199], v0
ds_read_b128 v[46:49], v1 offset:6144
s_waitcnt lgkmcnt(5)
v_smfmac_f32_16x16x64_bf16 v[66:69], v[38:41], v[128:135], v0
v_smfmac_f32_16x16x64_bf16 v[70:73], v[38:41], v[200:207], v0
ds_read_b128 v[38:41], v1 offset:7168
s_waitcnt lgkmcnt(2)
s_waitcnt vmcnt(7)
s_barrier
ds_read_b64_tr_b16 v[50:51], v3 offset:1536
ds_read_b64_tr_b16 v[52:53], v3 offset:1664
ds_read_b64_tr_b16 v[54:55], v3 offset:3584
ds_read_b64_tr_b16 v[56:57], v3 offset:3712
s_waitcnt lgkmcnt(9)
v_smfmac_f32_16x16x64_bf16 v[66:69], v[42:45], v[152:159], v0
ds_read_b64_tr_b16 v[58:59], v3 offset:1024
ds_read_b64_tr_b16 v[60:61], v3 offset:1152
v_smfmac_f32_16x16x64_bf16 v[70:73], v[42:45], v[224:231], v0
ds_read_b128 v[42:45], v1 offset:8192
ds_read_b64_tr_b16 v[62:63], v3 offset:3072
ds_read_b64_tr_b16 v[64:65], v3 offset:3200
s_waitcnt lgkmcnt(10)
v_smfmac_f32_16x16x64_bf16 v[66:69], v[46:49], v[160:167], v0
ds_read_b64_tr_b16 v[74:75], v3 offset:512
ds_read_b64_tr_b16 v[76:77], v3 offset:640
v_smfmac_f32_16x16x64_bf16 v[70:73], v[46:49], v[232:239], v0
s_waitcnt lgkmcnt(11)
v_smfmac_f32_16x16x64_bf16 v[66:69], v[38:41], v[168:175], v0
v_smfmac_f32_16x16x64_bf16 v[70:73], v[38:41], v[240:247], v0
s_waitcnt lgkmcnt(4)
v_smfmac_f32_16x16x64_bf16 v[66:69], v[42:45], v[176:183], v0
v_smfmac_f32_16x16x64_bf16 v[70:73], v[42:45], v[248:255], v0
s_waitcnt lgkmcnt(7)
s_waitcnt vmcnt(5)
v_mfma_f32_16x16x32_bf16 v[42:45], v[22:25], v[50:53], 0
v_mfma_f32_16x16x32_bf16 v[46:49], v[26:29], v[50:53], 0
v_mfma_f32_16x16x32_bf16 v[38:41], v[54:57], v[50:53], 0
ds_read_b64_tr_b16 v[54:55], v3 offset:2560
ds_read_b64_tr_b16 v[56:57], v3 offset:2688
ds_read_b128 v[22:25], v1 offset:15360
ds_read_b64_tr_b16 v[50:51], v3 offset:0
ds_read_b64_tr_b16 v[52:53], v3 offset:128
ds_read_b128 v[26:29], v1 offset:13312
s_waitcnt lgkmcnt(8)
s_waitcnt vmcnt(2)
v_mfma_f32_16x16x32_bf16 v[42:45], v[14:17], v[58:61], v[42:45]
v_mfma_f32_16x16x32_bf16 v[46:49], v[18:21], v[58:61], v[46:49]
v_mfma_f32_16x16x32_bf16 v[38:41], v[62:65], v[58:61], v[38:41]
ds_read_b64_tr_b16 v[58:59], v3 offset:2048
ds_read_b64_tr_b16 v[60:61], v3 offset:2176
ds_read_b128 v[14:17], v1 offset:14336
ds_read_b64_tr_b16 v[62:63], v79 offset:2048
ds_read_b64_tr_b16 v[64:65], v79 offset:2176
s_waitcnt vmcnt(3)
s_waitcnt lgkmcnt(11)
v_mfma_f32_16x16x32_bf16 v[46:49], v[10:13], v[74:77], v[46:49]
v_add_f32 v70, v70, v72
v_add_f32 v71, v71, v73
s_waitcnt lgkmcnt(8)
v_mfma_f32_16x16x32_bf16 v[42:45], v[22:25], v[74:77], v[42:45]
v_add_f32 v66, v66, v68
v_add_f32 v67, v67, v69
s_waitcnt lgkmcnt(9)
v_mfma_f32_16x16x32_bf16 v[38:41], v[54:57], v[74:77], v[38:41]
v_cvt_pk_bf16_f32 v70, v70, v71
v_cvt_pk_bf16_f32 v72, v66, v67
s_waitcnt lgkmcnt(5)
v_mfma_f32_16x16x32_bf16 v[42:45], v[26:29], v[50:53], v[42:45]
v_mov_b32 v71, 0
v_mov_b32 v73, 0
s_waitcnt lgkmcnt(3)
v_mfma_f32_16x16x32_bf16 v[38:41], v[58:61], v[50:53], v[38:41]
v_mov_b64 v[74:75], s[78:79]
v_mov_b64 v[76:77], s[78:79]
s_waitcnt lgkmcnt(2)
v_mfma_f32_16x16x32_bf16 v[46:49], v[14:17], v[50:53], v[46:49]
s_add_u32 s3, s34, -154624
buffer_store_dword v72, v2, s[4:7], s3 offen sc1
buffer_store_dword v70, v2, s[4:7], s3 offen offset:512 sc1
s_waitcnt lgkmcnt(0)
buffer_store_dwordx4 v[62:65], v78, s[4:7], s34 offen sc1
s_cmp_eq_u32 s28, 63
s_cbranch_scc1 L_ch_end_p1
v_cndmask_b32_e64 v38, v38, v40, s[30:31]
v_cndmask_b32_e64 v39, v39, v41, s[30:31]
v_max3_f32 v50, v42, v43, v44
v_max3_f32 v51, v45, v46, v47
v_max3_f32 v52, v48, v49, v38
v_max3_f32 v50, v50, v51, v39
v_max_f32 v50, v50, v52
v_mov_b32 v51, v50
v_mov_b64 v[66:67], 0
v_mov_b32 v65, 0
v_permlane16_swap_b32 v50, v51
v_max_f32 v50, v50, v51
v_mov_b32 v51, v50
v_subrev_u32 v40, 147456, v1
s_nop 0
v_permlane32_swap_b32 v50, v51
v_max_f32 v50, v50, v51
v_mul_f32 v50, s49, v50
v_pk_fma_f32 v[42:43], v[42:43], s[50:51], v[50:51] op_sel_hi:[1,0,0]
v_pk_fma_f32 v[44:45], v[44:45], s[50:51], v[50:51] op_sel_hi:[1,0,0]
v_pk_fma_f32 v[46:47], v[46:47], s[50:51], v[50:51] op_sel_hi:[1,0,0]
v_pk_fma_f32 v[48:49], v[48:49], s[50:51], v[50:51] op_sel_hi:[1,0,0]
v_pk_fma_f32 v[38:39], v[38:39], s[50:51], v[50:51] op_sel_hi:[1,0,0]
v_exp_f32 v42, v42
v_exp_f32 v43, v43
v_exp_f32 v44, v44
v_exp_f32 v45, v45
v_exp_f32 v46, v46
v_exp_f32 v47, v47
v_exp_f32 v48, v48
v_exp_f32 v49, v49
v_cvt_pk_bf16_f32 v52, v42, v43
v_cvt_pk_bf16_f32 v53, v44, v45
v_cvt_pk_bf16_f32 v54, v46, v47
v_cvt_pk_bf16_f32 v55, v48, v49
s_waitcnt vmcnt(3)
s_nop 0
v_mfma_f32_16x16x32_bf16 v[42:45], v[74:77], v[52:55], 0
v_exp_f32 v38, v38
v_mfma_f32_16x16x32_bf16 v[56:59], v[30:33], v[52:55], 0
v_exp_f32 v39, v39
v_mfma_f32_16x16x32_bf16 v[60:63], v[34:37], v[52:55], 0
v_add_u32 v47, s68, v40
v_cvt_pk_bf16_f32 v64, v38, v39
s_nop 1
v_mfma_f32_16x16x32_bf16 v[42:45], v[74:77], v[64:67], v[42:45]
v_mfma_f32_16x16x32_bf16 v[56:59], v[72:75], v[64:67], v[56:59]
v_mfma_f32_16x16x32_bf16 v[60:63], v[70:73], v[64:67], v[60:63]
ds_read_b128 v[10:13], v47 offset:0
ds_read_b128 v[14:17], v47 offset:1024
ds_read_b128 v[18:21], v47 offset:8192
ds_read_b128 v[22:25], v47 offset:9216
v_rcp_f32 v42, v42
s_nop 0
v_pk_mul_f32 v[56:57], v[56:57], v[42:43] op_sel_hi:[1,0]
v_pk_mul_f32 v[58:59], v[58:59], v[42:43] op_sel_hi:[1,0]
v_pk_mul_f32 v[60:61], v[60:61], v[42:43] op_sel_hi:[1,0]
v_pk_mul_f32 v[62:63], v[62:63], v[42:43] op_sel_hi:[1,0]
v_cvt_pk_bf16_f32 v56, v56, v60
v_cvt_pk_bf16_f32 v57, v57, v61
v_cvt_pk_bf16_f32 v58, v58, v62
v_cvt_pk_bf16_f32 v59, v59, v63
ds_write_b128 v6, v[56:59]
ds_read_b128 v[26:29], v47 offset:2048
ds_read_b128 v[30:33], v47 offset:3072
v_mov_b64 v[72:73], 0
v_mov_b64 v[74:75], 0
v_mov_b64 v[42:43], 0
v_mov_b64 v[44:45], 0
v_mov_b64 v[60:61], 0
v_mov_b64 v[62:63], 0
ds_read_b128 v[48:51], v47 offset:10240
ds_read_b128 v[52:55], v47 offset:11264
s_waitcnt lgkmcnt(4)
s_barrier
ds_read_b128 v[34:37], v1
ds_read_b128 v[38:41], v1 offset:1024
ds_read_b128 v[64:67], v47 offset:4096
ds_read_b128 v[68:71], v47 offset:5120
v_mov_b64 v[56:57], 0
v_mov_b64 v[58:59], 0
s_mul_i32 s3, s22, 589824
s_and_b32 s73, s28, 1
s_mul_i32 s73, s73, 294912
s_add_u32 s72, s3, s73
s_add_u32 s72, s72, 3145728
s_add_u32 s39, s72, s77
s_add_u32 s41, s39, 32768
s_bfe_u32 s35, s28, 0x10001
s_waitcnt lgkmcnt(3)
s_waitcnt lgkmcnt(9)
v_smfmac_f32_16x16x64_bf16 v[56:59], v[34:37], v[10:17], v0
ds_read_b128 v[10:13], v47 offset:12288
ds_read_b128 v[14:17], v47 offset:13312
v_smfmac_f32_16x16x64_bf16 v[60:63], v[34:37], v[18:25], v0
ds_read_b128 v[18:21], v47 offset:6144
ds_read_b128 v[22:25], v47 offset:7168
s_waitcnt lgkmcnt(6)
s_waitcnt lgkmcnt(8)
v_smfmac_f32_16x16x64_bf16 v[56:59], v[38:41], v[26:33], v0
ds_read_b128 v[26:29], v47 offset:14336
ds_read_b128 v[30:33], v47 offset:15360
v_smfmac_f32_16x16x64_bf16 v[60:63], v[38:41], v[48:55], v0
ds_read_b128 v[48:51], v47 offset:16384
ds_read_b128 v[52:55], v47 offset:17408
s_waitcnt lgkmcnt(6)
v_smfmac_f32_16x16x64_bf16 v[72:75], v[34:37], v[64:71], v0
ds_read_b128 v[64:67], v47 offset:24576
ds_read_b128 v[68:71], v47 offset:25600
v_smfmac_f32_16x16x64_bf16 v[42:45], v[34:37], v[10:17], v0
ds_read_b128 v[10:13], v47 offset:18432
ds_read_b128 v[14:17], v47 offset:19456
v_add_f32 v56, v56, v58
v_add_f32 v57, v57, v59
v_add_f32 v60, v60, v62
s_waitcnt lgkmcnt(6)
v_smfmac_f32_16x16x64_bf16 v[72:75], v[38:41], v[18:25], v0
ds_read_b128 v[18:21], v47 offset:26624
ds_read_b128 v[22:25], v47 offset:27648
v_add_f32 v61, v61, v63
v_cvt_pk_bf16_f32 v76, v56, v60
v_cvt_pk_bf16_f32 v77, v57, v61
v_smfmac_f32_16x16x64_bf16 v[42:45], v[38:41], v[26:33], v0
ds_read_b128 v[26:29], v47 offset:20480
ds_read_b128 v[30:33], v47 offset:21504
v_mov_b64 v[56:57], 0
v_mov_b64 v[58:59], 0
v_mov_b64 v[60:61], 0
v_mov_b64 v[62:63], 0
s_waitcnt lgkmcnt(6)
v_smfmac_f32_16x16x64_bf16 v[56:59], v[34:37], v[48:55], v0
ds_read_b128 v[48:51], v47 offset:28672
ds_read_b128 v[52:55], v47 offset:29696
v_smfmac_f32_16x16x64_bf16 v[60:63], v[34:37], v[64:71], v0
ds_read_b128 v[64:67], v47 offset:22528
ds_read_b128 v[68:71], v47 offset:23552
v_add_f32 v72, v72, v74
v_add_f32 v73, v73, v75
v_add_f32 v42, v42, v44
s_waitcnt lgkmcnt(6)
v_smfmac_f32_16x16x64_bf16 v[56:59], v[38:41], v[10:17], v0
ds_read_b128 v[10:13], v47 offset:30720
ds_read_b128 v[14:17], v47 offset:31744
v_add_f32 v43, v43, v45
v_cvt_pk_bf16_f32 v78, v72, v42
v_cvt_pk_bf16_f32 v79, v73, v43
v_smfmac_f32_16x16x64_bf16 v[60:63], v[38:41], v[18:25], v0
v_bfi_b32 v79, 1, s35, v79
buffer_store_dwordx4 v[76:79], v7, s[4:7], s39 offen
v_mov_b64 v[72:73], 0
v_mov_b64 v[74:75], 0
v_mov_b64 v[42:43], 0
v_mov_b64 v[44:45], 0
s_waitcnt lgkmcnt(4)
v_smfmac_f32_16x16x64_bf16 v[72:75], v[34:37], v[26:33], v0
v_smfmac_f32_16x16x64_bf16 v[42:45], v[34:37], v[48:55], v0
v_add_f32 v56, v56, v58
v_add_f32 v57, v57, v59
v_add_f32 v60, v60, v62
s_waitcnt lgkmcnt(0)
v_smfmac_f32_16x16x64_bf16 v[72:75], v[38:41], v[64:71], v0
v_add_f32 v61, v61, v63
v_cvt_pk_bf16_f32 v76, v56, v60
v_cvt_pk_bf16_f32 v77, v57, v61
v_smfmac_f32_16x16x64_bf16 v[42:45], v[38:41], v[10:17], v0
s_nop 3
v_add_f32 v72, v72, v74
v_add_f32 v73, v73, v75
s_nop 1
v_add_f32 v42, v42, v44
v_add_f32 v43, v43, v45
v_cvt_pk_bf16_f32 v78, v72, v42
v_cvt_pk_bf16_f32 v79, v73, v43
v_bfi_b32 v79, 1, s35, v79
buffer_store_dwordx4 v[76:79], v7, s[4:7], s41 offen
s_add_u32 s29, s29, 9216
s_add_u32 s75, s75, 9216
s_add_u32 s32, s32, 0x80000
s_add_u32 s33, s33, 0x80000
s_add_u32 s36, s36, 2048
s_mov_b32 s37, s38
s_add_u32 s38, s38, 2048
s_add_u32 s34, s34, 0x20000
s_add_u32 s28, s28, 1
s_add_u32 s40, s72, s46
v_mov_b32 v42, s64
v_mov_b32 v43, s65
v_cndmask_b32_e64 v42, v42, v43, s[62:63]
v_cndmask_b32_e64 v38, 0, v42, s[54:55]
v_cndmask_b32_e64 v39, 0, v42, s[56:57]
v_cndmask_b32_e64 v40, 0, v42, s[58:59]
v_cndmask_b32_e64 v41, 0, v42, s[60:61]
s_mov_b32 s90, 0xff00ff00
s_mov_b32 s91, 0xff00ff00
s_mov_b32 s13, 0
s_waitcnt vmcnt(0)
L_rs_9:
buffer_load_dwordx4 v[48:51], v1, s[4:7], s40 offen offset:0 sc1
buffer_load_dwordx4 v[52:55], v1, s[4:7], s40 offen offset:1024 sc1
buffer_load_dwordx4 v[56:59], v1, s[4:7], s40 offen offset:2048 sc1
buffer_load_dwordx4 v[60:63], v1, s[4:7], s40 offen offset:3072 sc1
s_add_u32 s13, s13, 1
s_cmp_gt_u32 s13, 200000
s_cbranch_scc1 L_FAIL
s_waitcnt vmcnt(0)
v_mfma_f32_16x16x32_bf16 v[64:67], v[38:41], v[48:51], 0
v_bitop3_b32 v44, v51, v55, s35 bitop3:0x7e
v_mfma_f32_16x16x32_bf16 v[64:67], v[38:41], v[52:55], v[64:67]
v_bitop3_b32 v45, v59, v63, s35 bitop3:0x7e
v_mfma_f32_16x16x32_bf16 v[64:67], v[38:41], v[56:59], v[64:67]
v_bitop3_b32 v44, v44, v45, 1 bitop3:0xa8
v_mfma_f32_16x16x32_bf16 v[64:67], v[38:41], v[60:63], v[64:67]
v_cmp_ne_u32 vcc, 0, v44
s_nop 0
s_cbranch_vccnz L_rs_9
s_nop 4
v_add_f32_dpp v68, v64, v64 row_ror:8 row_mask:0xf bank_mask:0xf
v_add_f32_dpp v69, v65, v65 row_ror:8 row_mask:0xf bank_mask:0xf
v_add_f32_dpp v70, v66, v66 row_ror:8 row_mask:0xf bank_mask:0xf
v_add_f32_dpp v71, v67, v67 row_ror:8 row_mask:0xf bank_mask:0xf
v_cvt_pk_bf16_f32 v72, v68, v69
v_cvt_pk_bf16_f32 v73, v70, v71
v_cndmask_b32_e64 v72, v72, v73, s[90:91]
s_mov_b64 exec, s[52:53]
buffer_store_dword v72, v8, s[4:7], s44 offen
s_mov_b64 exec, -1
s_add_u32 s44, s44, 9216
v_mov_b64 v[50:51], 0
v_mov_b64 v[52:53], 0
v_mov_b64 v[54:55], 0
v_mov_b64 v[56:57], 0
v_mov_b64 v[58:59], 0
v_mov_b64 v[60:61], 0
v_mov_b64 v[62:63], 0
v_mov_b64 v[64:65], 0
v_mov_b64 v[66:67], 0
v_mov_b64 v[68:69], 0
v_mov_b64 v[70:71], 0
v_mov_b64 v[72:73], 0
v_subrev_u32 v76, 147456, v1
v_and_b32 v78, 0x30, v76
v_bfe_u32 v75, v76, 7, 1
v_lshl_add_u32 v78, v75, 6, v78
v_lshrrev_b32 v76, 8, v76
v_lshl_add_u32 v78, v76, 7, v78
v_lshl_add_u32 v78, s20, 9, v78
s_lshl_b32 s3, s20, 9
v_add_u32 v79, s3, v3
v_add_u32 v77, s8, v1
s_nop 0
s_branch L_ch_top_p1
L_ch_end_p1:
s_nop 7
s_nop 7
s_waitcnt vmcnt(0)
s_mov_b32 s37, s38
s_mov_b64 exec, 1
v_mov_b32 v44, 1
buffer_atomic_add v44, off, s[4:7], s37 sc1
s_mov_b64 exec, -1
s_branch L_END
L_cls0p:
v_subrev_u32 v75, 147456, v1
v_and_b32 v75, 256, v75
v_lshlrev_b32 v75, 3, v75
s_mov_b32 s67, 0
L_w0f_11:
buffer_load_dword v8, v75, s[4:7], s36 offen sc1
s_add_u32 s67, s67, 1
s_cmp_gt_u32 s67, 200000
s_cbranch_scc1 L_FAIL
s_waitcnt vmcnt(0)
v_readlane_b32 s3, v8, 0
s_nop 0
s_cmp_ge_u32 s3, 2
s_nop 1
s_cbranch_scc0 L_w0f_11
v_readlane_b32 s3, v8, 16
s_add_u32 s66, s32, 0x80000
s_cmp_ge_u32 s3, 2
s_cselect_b32 s66, s66, 0x7ffee000
v_mov_b64 v[50:51], 0
v_mov_b64 v[52:53], 0
v_mov_b64 v[54:55], 0
v_mov_b64 v[56:57], 0
v_mov_b64 v[58:59], 0
v_mov_b64 v[60:61], 0
v_mov_b64 v[62:63], 0
v_mov_b64 v[64:65], 0
v_mov_b64 v[66:67], 0
v_mov_b64 v[68:69], 0
v_mov_b64 v[70:71], 0
v_mov_b64 v[72:73], 0
v_subrev_u32 v76, 147456, v1
v_and_b32 v78, 0x30, v76
v_bfe_u32 v75, v76, 7, 1
v_lshl_add_u32 v78, v75, 6, v78
v_lshrrev_b32 v76, 8, v76
v_lshl_add_u32 v78, v76, 7, v78
v_lshl_add_u32 v78, s20, 9, v78
s_lshl_b32 s3, s20, 9
v_add_u32 v79, s3, v3
v_add_u32 v77, s8, v1
ds_read_b128 v[10:13], v77 offset:0
ds_read_b128 v[14:17], v77 offset:1024
ds_read_b128 v[18:21], v77 offset:2048
s_waitcnt lgkmcnt(0)
s_branch L_ch_b1_p0
L_ch_top_p0:
s_barrier
s_mov_b32 s67, 0
L_ag_12:
buffer_load_dwordx4 v[10:13], v1, s[4:7], s29 offen offset:0 sc1
buffer_load_dwordx4 v[14:17], v1, s[4:7], s29 offen offset:1024 sc1
buffer_load_dwordx4 v[18:21], v1, s[4:7], s29 offen offset:2048 sc1
s_add_u32 s67, s67, 1
s_cmp_gt_u32 s67, 200000
s_cbranch_scc1 L_FAIL
s_waitcnt vmcnt(2)
ds_write_b128 v77, v[10:13] offset:0
s_waitcnt vmcnt(1)
ds_write_b128 v77, v[14:17] offset:1024
s_waitcnt vmcnt(0)
ds_write_b128 v77, v[18:21] offset:2048
v_max3_u32 v74, v10, v11, v12
v_max3_u32 v75, v13, v14, v15
v_max3_u32 v76, v16, v17, v18
v_max3_u32 v74, v74, v19, v20
v_max3_u32 v75, v75, v76, v21
v_max_u32 v74, v74, v75
v_cmp_eq_u32 vcc, -1, v74
s_nop 0
s_cbranch_vccnz L_ag_12
L_ch_b1_p0:
v_smfmac_f32_16x16x64_bf16 v[50:53], v[10:13], a[0:7], v0
v_smfmac_f32_16x16x64_bf16 v[54:57], v[10:13], a[72:79], v0
v_smfmac_f32_16x16x64_bf16 v[58:61], v[10:13], a[144:151], v0
v_smfmac_f32_16x16x64_bf16 v[62:65], v[10:13], a[216:223], v0
s_waitcnt lgkmcnt(0)
s_barrier
v_smfmac_f32_16x16x64_bf16 v[50:53], v[14:17], a[8:15], v0
ds_read_b128 v[38:41], v1 offset:3072
v_smfmac_f32_16x16x64_bf16 v[54:57], v[14:17], a[80:87], v0
ds_read_b128 v[42:45], v1 offset:4096
v_smfmac_f32_16x16x64_bf16 v[58:61], v[14:17], a[152:159], v0
ds_read_b128 v[46:49], v1 offset:5120
v_smfmac_f32_16x16x64_bf16 v[62:65], v[14:17], a[224:231], v0
s_mov_b32 m0, s11
s_add_u32 s3, s32, s48
v_smfmac_f32_16x16x64_bf16 v[50:53], v[18:21], a[16:23], v0
buffer_load_dwordx4 v4, s[4:7], s3 offen sc1 lds
v_smfmac_f32_16x16x64_bf16 v[54:57], v[18:21], a[88:95], v0
v_subrev_u32 v76, 147456, v1
v_lshlrev_b32 v76, 3, v76
v_smfmac_f32_16x16x64_bf16 v[58:61], v[18:21], a[160:167], v0
v_and_b32 v74, 0x380, v76
v_and_b32 v75, 0x800, v76
v_smfmac_f32_16x16x64_bf16 v[62:65], v[18:21], a[232:239], v0
buffer_load_dwordx4 v[22:25], v4, s[4:7], s33 offen offset:2048 sc1
s_waitcnt lgkmcnt(2)
v_smfmac_f32_16x16x64_bf16 v[50:53], v[38:41], a[24:31], v0
v_smfmac_f32_16x16x64_bf16 v[54:57], v[38:41], a[96:103], v0
v_smfmac_f32_16x16x64_bf16 v[58:61], v[38:41], a[168:175], v0
buffer_load_dwordx4 v[26:29], v4, s[4:7], s33 offen offset:2176 sc1
v_smfmac_f32_16x16x64_bf16 v[62:65], v[38:41], a[240:247], v0
ds_read_b128 v[38:41], v1 offset:6144
s_waitcnt lgkmcnt(2)
v_smfmac_f32_16x16x64_bf16 v[50:53], v[42:45], a[32:39], v0
v_smfmac_f32_16x16x64_bf16 v[54:57], v[42:45], a[104:111], v0
buffer_load_dwordx4 v[10:13], v4, s[4:7], s32 offen offset:2176 sc1
v_smfmac_f32_16x16x64_bf16 v[58:61], v[42:45], a[176:183], v0
v_smfmac_f32_16x16x64_bf16 v[62:65], v[42:45], a[248:255], v0
ds_read_b128 v[42:45], v1 offset:7168
s_waitcnt lgkmcnt(2)
v_smfmac_f32_16x16x64_bf16 v[50:53], v[46:49], a[40:47], v0
buffer_load_dwordx4 v[14:17], v4, s[4:7], s33 offen offset:0 sc1
v_smfmac_f32_16x16x64_bf16 v[54:57], v[46:49], a[112:119], v0
v_smfmac_f32_16x16x64_bf16 v[58:61], v[46:49], a[184:191], v0
buffer_load_dwordx4 v[18:21], v4, s[4:7], s33 offen offset:128 sc1
v_smfmac_f32_16x16x64_bf16 v[62:65], v[46:49], v[80:87], v0
ds_read_b128 v[46:49], v1 offset:8192
s_waitcnt lgkmcnt(2)
v_smfmac_f32_16x16x64_bf16 v[50:53], v[38:41], a[48:55], v0
buffer_load_dwordx4 v[30:33], v5, s[4:7], s32 offen offset:0 sc1
v_smfmac_f32_16x16x64_bf16 v[54:57], v[38:41], a[120:127], v0
v_smfmac_f32_16x16x64_bf16 v[58:61], v[38:41], a[192:199], v0
buffer_load_dwordx4 v[34:37], v5, s[4:7], s32 offen offset:2048 sc1
v_smfmac_f32_16x16x64_bf16 v[62:65], v[38:41], v[88:95], v0
ds_read_b128 v[38:41], v1 offset:0
s_waitcnt lgkmcnt(2)
v_smfmac_f32_16x16x64_bf16 v[50:53], v[42:45], a[56:63], v0
v_smfmac_f32_16x16x64_bf16 v[54:57], v[42:45], a[128:135], v0
v_smfmac_f32_16x16x64_bf16 v[58:61], v[42:45], a[200:207], v0
v_smfmac_f32_16x16x64_bf16 v[62:65], v[42:45], v[96:103], v0
ds_read_b128 v[42:45], v1 offset:1024
buffer_load_dword v9, v76, s[4:7], s66 offen sc1
s_waitcnt lgkmcnt(2)
v_smfmac_f32_16x16x64_bf16 v[50:53], v[46:49], a[64:71], v0
s_add_u32 s3, s66, 8192
buffer_load_dword v9, v76, s[4:7], s3 offen sc1
v_smfmac_f32_16x16x64_bf16 v[54:57], v[46:49], a[136:143], v0
buffer_load_dword v9, v76, s[4:7], s75 offen sc1
v_smfmac_f32_16x16x64_bf16 v[58:61], v[46:49], a[208:215], v0
s_add_u32 s3, s75, 8192
buffer_load_dword v9, v74, s[4:7], s3 offen sc1
v_smfmac_f32_16x16x64_bf16 v[62:65], v[46:49], v[104:111], v0
ds_read_b128 v[46:49], v1 offset:2048
buffer_load_dword v8, v75, s[4:7], s36 offen offset:2048 sc1
s_mov_b64 exec, 1
v_mov_b32 v77, 4
buffer_atomic_add v77, off, s[4:7], s37 sc1
s_mov_b64 exec, -1
s_waitcnt lgkmcnt(2)
v_smfmac_f32_16x16x64_bf16 v[66:69], v[38:41], v[112:119], v0
v_smfmac_f32_16x16x64_bf16 v[70:73], v[38:41], v[184:191], v0
ds_read_b128 v[38:41], v1 offset:3072
v_add_f32 v50, v50, v52
v_add_f32 v51, v51, v53
v_add_f32 v54, v54, v56
v_add_f32 v55, v55, v57
v_cvt_pk_bf16_f32 v74, v50, v51
v_cvt_pk_bf16_f32 v75, v54, v55
ds_write2_b32 v2, v74, v75 offset0:0 offset1:128
v_add_f32 v58, v58, v60
v_add_f32 v59, v59, v61
v_add_f32 v62, v62, v64
v_add_f32 v63, v63, v65
v_cvt_pk_bf16_f32 v76, v58, v59
v_cvt_pk_bf16_f32 v77, v62, v63
ds_write_b32 v2, v76 offset:2048
ds_write_b32 v2, v77 offset:2560
s_waitcnt lgkmcnt(5)
v_smfmac_f32_16x16x64_bf16 v[66:69], v[42:45], v[120:127], v0
v_smfmac_f32_16x16x64_bf16 v[70:73], v[42:45], v[192:199], v0
ds_read_b128 v[42:45], v1 offset:4096
s_waitcnt lgkmcnt(5)
v_smfmac_f32_16x16x64_bf16 v[66:69], v[46:49], v[128:135], v0
v_smfmac_f32_16x16x64_bf16 v[70:73], v[46:49], v[200:207], v0
ds_read_b128 v[46:49], v1 offset:5120
s_waitcnt lgkmcnt(2)
s_waitcnt vmcnt(13)
s_barrier
ds_read_b64_tr_b16 v[50:51], v3 offset:1536
ds_read_b64_tr_b16 v[52:53], v3 offset:1664
ds_read_b64_tr_b16 v[54:55], v3 offset:3584
ds_read_b64_tr_b16 v[56:57], v3 offset:3712
s_waitcnt lgkmcnt(9)
v_smfmac_f32_16x16x64_bf16 v[66:69], v[38:41], v[136:143], v0
ds_read_b64_tr_b16 v[58:59], v3 offset:1024
ds_read_b64_tr_b16 v[60:61], v3 offset:1152
v_smfmac_f32_16x16x64_bf16 v[70:73], v[38:41], v[208:215], v0
ds_read_b128 v[38:41], v1 offset:6144
ds_read_b64_tr_b16 v[62:63], v3 offset:3072
ds_read_b64_tr_b16 v[64:65], v3 offset:3200
s_waitcnt lgkmcnt(10)
v_smfmac_f32_16x16x64_bf16 v[66:69], v[42:45], v[144:151], v0
ds_read_b64_tr_b16 v[74:75], v3 offset:512
ds_read_b64_tr_b16 v[76:77], v3 offset:640
v_smfmac_f32_16x16x64_bf16 v[70:73], v[42:45], v[216:223], v0
ds_read_b128 v[42:45], v1 offset:7168
s_waitcnt lgkmcnt(12)
v_smfmac_f32_16x16x64_bf16 v[66:69], v[46:49], v[152:159], v0
v_smfmac_f32_16x16x64_bf16 v[70:73], v[46:49], v[224:231], v0
ds_read_b128 v[46:49], v1 offset:8192
s_waitcnt lgkmcnt(6)
v_smfmac_f32_16x16x64_bf16 v[66:69], v[38:41], v[160:167], v0
v_smfmac_f32_16x16x64_bf16 v[70:73], v[38:41], v[232:239], v0
s_waitcnt lgkmcnt(1)
v_smfmac_f32_16x16x64_bf16 v[66:69], v[42:45], v[168:175], v0
v_smfmac_f32_16x16x64_bf16 v[70:73], v[42:45], v[240:247], v0
s_waitcnt lgkmcnt(0)
v_smfmac_f32_16x16x64_bf16 v[66:69], v[46:49], v[176:183], v0
v_smfmac_f32_16x16x64_bf16 v[70:73], v[46:49], v[248:255], v0
s_waitcnt lgkmcnt(9)
s_waitcnt vmcnt(11)
v_mfma_f32_16x16x32_bf16 v[42:45], v[22:25], v[50:53], 0
v_mfma_f32_16x16x32_bf16 v[46:49], v[26:29], v[50:53], 0
v_mfma_f32_16x16x32_bf16 v[38:41], v[54:57], v[50:53], 0
ds_read_b64_tr_b16 v[54:55], v3 offset:2560
ds_read_b64_tr_b16 v[56:57], v3 offset:2688
ds_read_b128 v[22:25], v1 offset:15360
ds_read_b64_tr_b16 v[50:51], v3 offset:0
ds_read_b64_tr_b16 v[52:53], v3 offset:128
ds_read_b128 v[26:29], v1 offset:13312
s_waitcnt lgkmcnt(10)
s_waitcnt vmcnt(8)
v_mfma_f32_16x16x32_bf16 v[42:45], v[14:17], v[58:61], v[42:45]
v_mfma_f32_16x16x32_bf16 v[46:49], v[18:21], v[58:61], v[46:49]
v_mfma_f32_16x16x32_bf16 v[38:41], v[62:65], v[58:61], v[38:41]
ds_read_b64_tr_b16 v[58:59], v3 offset:2048
ds_read_b64_tr_b16 v[60:61], v3 offset:2176
ds_read_b128 v[14:17], v1 offset:14336
ds_read_b64_tr_b16 v[62:63], v79 offset:2048
ds_read_b64_tr_b16 v[64:65], v79 offset:2176
s_waitcnt vmcnt(10)
s_waitcnt lgkmcnt(13)
v_mfma_f32_16x16x32_bf16 v[46:49], v[10:13], v[74:77], v[46:49]
v_add_f32 v70, v70, v72
v_add_f32 v71, v71, v73
s_waitcnt lgkmcnt(8)
v_mfma_f32_16x16x32_bf16 v[42:45], v[22:25], v[74:77], v[42:45]
v_add_f32 v66, v66, v68
v_add_f32 v67, v67, v69
s_waitcnt lgkmcnt(9)
v_mfma_f32_16x16x32_bf16 v[38:41], v[54:57], v[74:77], v[38:41]
v_cvt_pk_bf16_f32 v70, v70, v71
v_cvt_pk_bf16_f32 v72, v66, v67
s_waitcnt lgkmcnt(5)
v_mfma_f32_16x16x32_bf16 v[42:45], v[26:29], v[50:53], v[42:45]
v_mov_b32 v71, 0
v_mov_b32 v73, 0
s_waitcnt lgkmcnt(3)
v_mfma_f32_16x16x32_bf16 v[38:41], v[58:61], v[50:53], v[38:41]
v_mov_b64 v[74:75], s[78:79]
v_mov_b64 v[76:77], s[78:79]
s_waitcnt lgkmcnt(2)
v_mfma_f32_16x16x32_bf16 v[46:49], v[14:17], v[50:53], v[46:49]
s_add_u32 s3, s34, -154624
buffer_store_dword v72, v2, s[4:7], s3 offen sc1
buffer_store_dword v70, v2, s[4:7], s3 offen offset:512 sc1
s_waitcnt lgkmcnt(0)
buffer_store_dwordx4 v[62:65], v78, s[4:7], s34 offen sc1
s_cmp_eq_u32 s28, 63
s_cbranch_scc1 L_ch_end_p0
v_cndmask_b32_e64 v38, v38, v40, s[30:31]
v_cndmask_b32_e64 v39, v39, v41, s[30:31]
v_max3_f32 v50, v42, v43, v44
v_max3_f32 v51, v45, v46, v47
v_max3_f32 v52, v48, v49, v38
v_max3_f32 v50, v50, v51, v39
v_max_f32 v50, v50, v52
v_mov_b32 v51, v50
v_mov_b64 v[66:67], 0
v_mov_b32 v65, 0
v_permlane16_swap_b32 v50, v51
v_max_f32 v50, v50, v51
v_mov_b32 v51, v50
v_subrev_u32 v40, 147456, v1
s_nop 0
v_permlane32_swap_b32 v50, v51
v_max_f32 v50, v50, v51
v_mul_f32 v50, s49, v50
v_pk_fma_f32 v[42:43], v[42:43], s[50:51], v[50:51] op_sel_hi:[1,0,0]
v_pk_fma_f32 v[44:45], v[44:45], s[50:51], v[50:51] op_sel_hi:[1,0,0]
v_pk_fma_f32 v[46:47], v[46:47], s[50:51], v[50:51] op_sel_hi:[1,0,0]
v_pk_fma_f32 v[48:49], v[48:49], s[50:51], v[50:51] op_sel_hi:[1,0,0]
v_pk_fma_f32 v[38:39], v[38:39], s[50:51], v[50:51] op_sel_hi:[1,0,0]
v_exp_f32 v42, v42
v_exp_f32 v43, v43
v_exp_f32 v44, v44
v_exp_f32 v45, v45
v_exp_f32 v46, v46
v_exp_f32 v47, v47
v_exp_f32 v48, v48
v_exp_f32 v49, v49
v_cvt_pk_bf16_f32 v52, v42, v43
v_cvt_pk_bf16_f32 v53, v44, v45
v_cvt_pk_bf16_f32 v54, v46, v47
v_cvt_pk_bf16_f32 v55, v48, v49
s_waitcnt vmcnt(9)
s_nop 0
v_mfma_f32_16x16x32_bf16 v[42:45], v[74:77], v[52:55], 0
v_exp_f32 v38, v38
v_mfma_f32_16x16x32_bf16 v[56:59], v[30:33], v[52:55], 0
v_exp_f32 v39, v39
v_mfma_f32_16x16x32_bf16 v[60:63], v[34:37], v[52:55], 0
v_add_u32 v47, s68, v40
v_cvt_pk_bf16_f32 v64, v38, v39
v_add_u32 v46, 0x20000, v40
s_nop 0
v_mfma_f32_16x16x32_bf16 v[42:45], v[74:77], v[64:67], v[42:45]
v_mfma_f32_16x16x32_bf16 v[56:59], v[72:75], v[64:67], v[56:59]
v_mfma_f32_16x16x32_bf16 v[60:63], v[70:73], v[64:67], v[60:63]
ds_read_b128 v[10:13], v47 offset:0
ds_read_b128 v[14:17], v47 offset:1024
ds_read_b128 v[18:21], v47 offset:8192
ds_read_b128 v[22:25], v47 offset:9216
v_rcp_f32 v42, v42
s_nop 0
v_pk_mul_f32 v[56:57], v[56:57], v[42:43] op_sel_hi:[1,0]
v_pk_mul_f32 v[58:59], v[58:59], v[42:43] op_sel_hi:[1,0]
v_pk_mul_f32 v[60:61], v[60:61], v[42:43] op_sel_hi:[1,0]
v_pk_mul_f32 v[62:63], v[62:63], v[42:43] op_sel_hi:[1,0]
v_cvt_pk_bf16_f32 v56, v56, v60
v_cvt_pk_bf16_f32 v57, v57, v61
v_cvt_pk_bf16_f32 v58, v58, v62
v_cvt_pk_bf16_f32 v59, v59, v63
ds_write_b128 v6, v[56:59]
ds_read_b128 v[26:29], v47 offset:2048
ds_read_b128 v[30:33], v47 offset:3072
v_mov_b64 v[72:73], 0
v_mov_b64 v[74:75], 0
v_mov_b64 v[42:43], 0
v_mov_b64 v[44:45], 0
v_mov_b64 v[60:61], 0
v_mov_b64 v[62:63], 0
ds_read_b128 v[48:51], v47 offset:10240
ds_read_b128 v[52:55], v47 offset:11264
s_waitcnt lgkmcnt(4)
s_barrier
ds_read_b128 v[34:37], v1
ds_read_b128 v[38:41], v1 offset:1024
ds_read_b128 v[64:67], v47 offset:4096
ds_read_b128 v[68:71], v47 offset:5120
v_mov_b64 v[56:57], 0
v_mov_b64 v[58:59], 0
s_mul_i32 s3, s22, 589824
s_and_b32 s73, s28, 1
s_mul_i32 s73, s73, 294912
s_add_u32 s72, s3, s73
s_add_u32 s72, s72, 3145728
s_add_u32 s39, s72, s77
s_add_u32 s41, s39, 32768
s_bfe_u32 s35, s28, 0x10001
s_add_u32 s10, s72, s9
s_waitcnt lgkmcnt(3)
s_waitcnt lgkmcnt(9)
v_smfmac_f32_16x16x64_bf16 v[56:59], v[34:37], v[10:17], v0
ds_read_b128 v[10:13], v47 offset:12288
ds_read_b128 v[14:17], v47 offset:13312
v_smfmac_f32_16x16x64_bf16 v[60:63], v[34:37], v[18:25], v0
ds_read_b128 v[18:21], v47 offset:6144
ds_read_b128 v[22:25], v47 offset:7168
s_waitcnt lgkmcnt(6)
s_waitcnt lgkmcnt(8)
v_smfmac_f32_16x16x64_bf16 v[56:59], v[38:41], v[26:33], v0
ds_read_b128 v[26:29], v47 offset:14336
ds_read_b128 v[30:33], v47 offset:15360
v_smfmac_f32_16x16x64_bf16 v[60:63], v[38:41], v[48:55], v0
ds_read_b128 v[48:51], v47 offset:16384
ds_read_b128 v[52:55], v47 offset:17408
s_waitcnt lgkmcnt(6)
v_smfmac_f32_16x16x64_bf16 v[72:75], v[34:37], v[64:71], v0
ds_read_b128 v[64:67], v47 offset:24576
ds_read_b128 v[68:71], v47 offset:25600
v_smfmac_f32_16x16x64_bf16 v[42:45], v[34:37], v[10:17], v0
ds_read_b128 v[10:13], v47 offset:18432
ds_read_b128 v[14:17], v47 offset:19456
v_add_f32 v56, v56, v58
v_add_f32 v57, v57, v59
v_add_f32 v60, v60, v62
s_waitcnt lgkmcnt(6)
v_smfmac_f32_16x16x64_bf16 v[72:75], v[38:41], v[18:25], v0
ds_read_b128 v[18:21], v47 offset:26624
ds_read_b128 v[22:25], v47 offset:27648
v_add_f32 v61, v61, v63
v_cvt_pk_bf16_f32 v76, v56, v60
v_cvt_pk_bf16_f32 v77, v57, v61
v_smfmac_f32_16x16x64_bf16 v[42:45], v[38:41], v[26:33], v0
ds_read_b128 v[26:29], v47 offset:20480
ds_read_b128 v[30:33], v47 offset:21504
v_mov_b64 v[56:57], 0
v_mov_b64 v[58:59], 0
v_mov_b64 v[60:61], 0
v_mov_b64 v[62:63], 0
s_waitcnt lgkmcnt(6)
v_smfmac_f32_16x16x64_bf16 v[56:59], v[34:37], v[48:55], v0
ds_read_b128 v[48:51], v47 offset:28672
ds_read_b128 v[52:55], v47 offset:29696
v_smfmac_f32_16x16x64_bf16 v[60:63], v[34:37], v[64:71], v0
ds_read_b128 v[64:67], v47 offset:22528
ds_read_b128 v[68:71], v47 offset:23552
v_add_f32 v72, v72, v74
v_add_f32 v73, v73, v75
v_add_f32 v42, v42, v44
s_waitcnt lgkmcnt(6)
v_smfmac_f32_16x16x64_bf16 v[56:59], v[38:41], v[10:17], v0
ds_read_b128 v[10:13], v47 offset:30720
ds_read_b128 v[14:17], v47 offset:31744
v_add_f32 v43, v43, v45
v_cvt_pk_bf16_f32 v78, v72, v42
v_cvt_pk_bf16_f32 v79, v73, v43
v_smfmac_f32_16x16x64_bf16 v[60:63], v[38:41], v[18:25], v0
ds_read_b128 v[18:21], v46 offset:0
ds_read_b128 v[22:25], v46 offset:1024
v_bfi_b32 v79, 1, s35, v79
buffer_store_dwordx4 v[76:79], v7, s[4:7], s39 offen
v_mov_b64 v[72:73], 0
v_mov_b64 v[74:75], 0
v_mov_b64 v[42:43], 0
v_mov_b64 v[44:45], 0
s_waitcnt lgkmcnt(6)
v_smfmac_f32_16x16x64_bf16 v[72:75], v[34:37], v[26:33], v0
ds_read_b128 v[26:29], v46 offset:8192
ds_read_b128 v[30:33], v46 offset:9216
v_smfmac_f32_16x16x64_bf16 v[42:45], v[34:37], v[48:55], v0
ds_read_b128 v[48:51], v46 offset:2048
ds_read_b128 v[52:55], v46 offset:3072
v_add_f32 v56, v56, v58
v_add_f32 v57, v57, v59
v_add_f32 v60, v60, v62
s_waitcnt lgkmcnt(6)
v_smfmac_f32_16x16x64_bf16 v[72:75], v[38:41], v[64:71], v0
ds_read_b128 v[64:67], v46 offset:10240
ds_read_b128 v[68:71], v46 offset:11264
v_add_f32 v61, v61, v63
v_cvt_pk_bf16_f32 v76, v56, v60
v_cvt_pk_bf16_f32 v77, v57, v61
v_smfmac_f32_16x16x64_bf16 v[42:45], v[38:41], v[10:17], v0
v_mov_b64 v[56:57], 0
v_mov_b64 v[58:59], 0
v_mov_b64 v[60:61], 0
v_mov_b64 v[62:63], 0
s_waitcnt lgkmcnt(4)
v_smfmac_f32_16x16x64_bf16 v[56:59], v[34:37], v[18:25], v0
v_smfmac_f32_16x16x64_bf16 v[60:63], v[34:37], v[26:33], v0
v_and_b32 v46, 0x70, v7
v_lshrrev_b32 v46, 1, v46
v_sub_u32 v46, v7, v46
s_waitcnt lgkmcnt(0)
v_smfmac_f32_16x16x64_bf16 v[56:59], v[38:41], v[48:55], v0
v_add_f32 v72, v72, v74
v_add_f32 v73, v73, v75
v_add_f32 v42, v42, v44
v_smfmac_f32_16x16x64_bf16 v[60:63], v[38:41], v[64:71], v0
v_add_f32 v43, v43, v45
v_cvt_pk_bf16_f32 v78, v72, v42
v_cvt_pk_bf16_f32 v79, v73, v43
v_bfi_b32 v79, 1, s35, v79
buffer_store_dwordx4 v[76:79], v7, s[4:7], s41 offen
v_add_f32 v56, v56, v58
v_add_f32 v57, v57, v59
s_nop 0
v_add_f32 v60, v60, v62
v_add_f32 v61, v61, v63
v_cvt_pk_bf16_f32 v76, v56, v60
v_cvt_pk_bf16_f32 v77, v57, v61
v_bfi_b32 v77, 1, s35, v77
buffer_store_dwordx2 v[76:77], v46, s[4:7], s10 offen
s_add_u32 s29, s29, 9216
s_add_u32 s75, s75, 9216
s_add_u32 s32, s32, 0x80000
s_add_u32 s33, s33, 0x80000
s_add_u32 s36, s36, 2048
s_mov_b32 s37, s38
s_add_u32 s38, s38, 2048
s_add_u32 s34, s34, 0x20000
s_add_u32 s28, s28, 1
s_waitcnt vmcnt(3)
v_readlane_b32 s3, v8, 0
s_nop 0
s_cmp_ge_u32 s3, 2
s_nop 1
s_cbranch_scc1 L_w0ok_14
v_subrev_u32 v75, 147456, v1
v_and_b32 v75, 256, v75
v_lshlrev_b32 v75, 3, v75
s_mov_b32 s67, 0
L_w0f_15:
buffer_load_dword v8, v75, s[4:7], s36 offen sc1
s_add_u32 s67, s67, 1
s_cmp_gt_u32 s67, 200000
s_cbranch_scc1 L_FAIL
s_waitcnt vmcnt(0)
v_readlane_b32 s3, v8, 0
s_nop 0
s_cmp_ge_u32 s3, 2
s_nop 1
s_cbranch_scc0 L_w0f_15
L_w0ok_14:
v_readlane_b32 s3, v8, 16
s_add_u32 s66, s32, 0x80000
s_cmp_ge_u32 s3, 2
s_cselect_b32 s66, s66, 0x7ffee000
v_mov_b64 v[50:51], 0
v_mov_b64 v[52:53], 0
v_mov_b64 v[54:55], 0
v_mov_b64 v[56:57], 0
v_mov_b64 v[58:59], 0
v_mov_b64 v[60:61], 0
v_mov_b64 v[62:63], 0
v_mov_b64 v[64:65], 0
v_mov_b64 v[66:67], 0
v_mov_b64 v[68:69], 0
v_mov_b64 v[70:71], 0
v_mov_b64 v[72:73], 0
v_subrev_u32 v76, 147456, v1
v_and_b32 v78, 0x30, v76
v_bfe_u32 v75, v76, 7, 1
v_lshl_add_u32 v78, v75, 6, v78
v_lshrrev_b32 v76, 8, v76
v_lshl_add_u32 v78, v76, 7, v78
v_lshl_add_u32 v78, s20, 9, v78
s_lshl_b32 s3, s20, 9
v_add_u32 v79, s3, v3
v_add_u32 v77, s8, v1
s_nop 0
s_branch L_ch_top_p0
L_ch_end_p0:
s_nop 7
s_nop 7
s_waitcnt vmcnt(0)
s_mov_b32 s37, s38
s_mov_b64 exec, 1
v_mov_b32 v44, 1
buffer_atomic_add v44, off, s[4:7], s37 sc1
s_mov_b64 exec, -1
s_branch L_END
L_cls2p:
v_mov_b64 v[50:51], 0
v_mov_b64 v[52:53], 0
v_mov_b64 v[54:55], 0
v_mov_b64 v[56:57], 0
v_mov_b64 v[58:59], 0
v_mov_b64 v[60:61], 0
v_mov_b64 v[62:63], 0
v_mov_b64 v[64:65], 0
v_mov_b64 v[66:67], 0
v_mov_b64 v[68:69], 0
v_mov_b64 v[70:71], 0
v_mov_b64 v[72:73], 0
v_subrev_u32 v76, 147456, v1
v_and_b32 v78, 0x30, v76
v_bfe_u32 v75, v76, 7, 1
v_lshl_add_u32 v78, v75, 6, v78
v_lshrrev_b32 v76, 8, v76
v_lshl_add_u32 v78, v76, 7, v78
v_lshl_add_u32 v78, s20, 9, v78
s_lshl_b32 s3, s20, 9
v_add_u32 v79, s3, v3
v_add_u32 v77, s8, v1
ds_read_b128 v[10:13], v77 offset:0
ds_read_b128 v[14:17], v77 offset:1024
s_waitcnt lgkmcnt(0)
s_branch L_ch_b1_p2
L_ch_top_p2:
s_barrier
s_mov_b32 s67, 0
L_ag_16:
buffer_load_dwordx4 v[10:13], v1, s[4:7], s29 offen offset:0 sc1
buffer_load_dwordx4 v[14:17], v1, s[4:7], s29 offen offset:1024 sc1
s_add_u32 s67, s67, 1
s_cmp_gt_u32 s67, 200000
s_cbranch_scc1 L_FAIL
s_waitcnt vmcnt(1)
ds_write_b128 v77, v[10:13] offset:0
s_waitcnt vmcnt(0)
ds_write_b128 v77, v[14:17] offset:1024
v_max3_u32 v74, v10, v11, v12
v_max3_u32 v75, v13, v14, v15
v_max3_u32 v74, v74, v16, v17
v_max3_u32 v74, v74, v75, v75
v_cmp_eq_u32 vcc, -1, v74
s_nop 0
s_cbranch_vccnz L_ag_16
L_ch_b1_p2:
v_smfmac_f32_16x16x64_bf16 v[50:53], v[10:13], a[40:47], v0
v_smfmac_f32_16x16x64_bf16 v[54:57], v[10:13], a[112:119], v0
v_smfmac_f32_16x16x64_bf16 v[58:61], v[10:13], a[184:191], v0
v_smfmac_f32_16x16x64_bf16 v[62:65], v[10:13], v[80:87], v0
s_waitcnt lgkmcnt(0)
s_barrier
v_smfmac_f32_16x16x64_bf16 v[50:53], v[14:17], a[48:55], v0
ds_read_b128 v[38:41], v1 offset:0
v_smfmac_f32_16x16x64_bf16 v[54:57], v[14:17], a[120:127], v0
ds_read_b128 v[42:45], v1 offset:1024
v_smfmac_f32_16x16x64_bf16 v[58:61], v[14:17], a[192:199], v0
ds_read_b128 v[46:49], v1 offset:2048
v_smfmac_f32_16x16x64_bf16 v[62:65], v[14:17], v[88:95], v0
s_mov_b32 m0, s11
s_add_u32 s3, s32, s48
v_smfmac_f32_16x16x64_bf16 v[66:69], v[10:13], v[152:159], v0
v_smfmac_f32_16x16x64_bf16 v[70:73], v[10:13], v[224:231], v0
buffer_load_dwordx4 v4, s[4:7], s3 offen sc1 lds
v_smfmac_f32_16x16x64_bf16 v[66:69], v[14:17], v[160:167], v0
v_smfmac_f32_16x16x64_bf16 v[70:73], v[14:17], v[232:239], v0
s_waitcnt lgkmcnt(2)
v_smfmac_f32_16x16x64_bf16 v[50:53], v[38:41], a[0:7], v0
buffer_load_dwordx4 v[22:25], v4, s[4:7], s33 offen offset:2048 sc1
v_smfmac_f32_16x16x64_bf16 v[54:57], v[38:41], a[72:79], v0
v_smfmac_f32_16x16x64_bf16 v[58:61], v[38:41], a[144:151], v0
v_smfmac_f32_16x16x64_bf16 v[62:65], v[38:41], a[216:223], v0
ds_read_b128 v[38:41], v1 offset:3072
buffer_load_dwordx4 v[26:29], v4, s[4:7], s33 offen offset:2176 sc1
s_waitcnt lgkmcnt(2)
v_smfmac_f32_16x16x64_bf16 v[50:53], v[42:45], a[8:15], v0
v_smfmac_f32_16x16x64_bf16 v[54:57], v[42:45], a[80:87], v0
v_smfmac_f32_16x16x64_bf16 v[58:61], v[42:45], a[152:159], v0
buffer_load_dwordx4 v[18:21], v4, s[4:7], s33 offen offset:128 sc1
v_smfmac_f32_16x16x64_bf16 v[62:65], v[42:45], a[224:231], v0
ds_read_b128 v[42:45], v1 offset:4096
s_waitcnt lgkmcnt(2)
v_smfmac_f32_16x16x64_bf16 v[50:53], v[46:49], a[16:23], v0
v_smfmac_f32_16x16x64_bf16 v[54:57], v[46:49], a[88:95], v0
buffer_load_dwordx4 v[10:13], v4, s[4:7], s32 offen offset:2176 sc1
v_smfmac_f32_16x16x64_bf16 v[58:61], v[46:49], a[160:167], v0
v_smfmac_f32_16x16x64_bf16 v[62:65], v[46:49], a[232:239], v0
ds_read_b128 v[46:49], v1 offset:7168
buffer_load_dwordx4 v[14:17], v4, s[4:7], s33 offen offset:0 sc1
s_waitcnt lgkmcnt(2)
v_smfmac_f32_16x16x64_bf16 v[50:53], v[38:41], a[24:31], v0
v_smfmac_f32_16x16x64_bf16 v[54:57], v[38:41], a[96:103], v0
buffer_load_dwordx4 v[30:33], v5, s[4:7], s32 offen offset:0 sc1
v_smfmac_f32_16x16x64_bf16 v[58:61], v[38:41], a[168:175], v0
v_smfmac_f32_16x16x64_bf16 v[62:65], v[38:41], a[240:247], v0
ds_read_b128 v[38:41], v1 offset:8192
buffer_load_dwordx4 v[34:37], v5, s[4:7], s32 offen offset:2048 sc1
s_waitcnt lgkmcnt(2)
v_smfmac_f32_16x16x64_bf16 v[50:53], v[42:45], a[32:39], v0
v_smfmac_f32_16x16x64_bf16 v[54:57], v[42:45], a[104:111], v0
v_smfmac_f32_16x16x64_bf16 v[58:61], v[42:45], a[176:183], v0
v_smfmac_f32_16x16x64_bf16 v[62:65], v[42:45], a[248:255], v0
ds_read_b128 v[42:45], v1 offset:0
s_waitcnt lgkmcnt(2)
v_smfmac_f32_16x16x64_bf16 v[50:53], v[46:49], a[56:63], v0
v_smfmac_f32_16x16x64_bf16 v[54:57], v[46:49], a[128:135], v0
v_smfmac_f32_16x16x64_bf16 v[58:61], v[46:49], a[200:207], v0
v_smfmac_f32_16x16x64_bf16 v[62:65], v[46:49], v[96:103], v0
ds_read_b128 v[46:49], v1 offset:1024
s_waitcnt lgkmcnt(2)
v_smfmac_f32_16x16x64_bf16 v[50:53], v[38:41], a[64:71], v0
v_smfmac_f32_16x16x64_bf16 v[54:57], v[38:41], a[136:143], v0
v_smfmac_f32_16x16x64_bf16 v[58:61], v[38:41], a[208:215], v0
v_smfmac_f32_16x16x64_bf16 v[62:65], v[38:41], v[104:111], v0
ds_read_b128 v[38:41], v1 offset:2048
s_waitcnt lgkmcnt(2)
v_smfmac_f32_16x16x64_bf16 v[66:69], v[42:45], v[112:119], v0
v_smfmac_f32_16x16x64_bf16 v[70:73], v[42:45], v[184:191], v0
ds_read_b128 v[42:45], v1 offset:3072
v_add_f32 v50, v50, v52
v_add_f32 v51, v51, v53
v_add_f32 v54, v54, v56
v_add_f32 v55, v55, v57
v_cvt_pk_bf16_f32 v74, v50, v51
v_cvt_pk_bf16_f32 v75, v54, v55
ds_write2_b32 v2, v74, v75 offset0:0 offset1:128
v_add_f32 v58, v58, v60
v_add_f32 v59, v59, v61
v_add_f32 v62, v62, v64
v_add_f32 v63, v63, v65
v_cvt_pk_bf16_f32 v76, v58, v59
v_cvt_pk_bf16_f32 v77, v62, v63
ds_write_b32 v2, v76 offset:2048
ds_write_b32 v2, v77 offset:2560
s_waitcnt lgkmcnt(5)
v_smfmac_f32_16x16x64_bf16 v[66:69], v[46:49], v[120:127], v0
v_smfmac_f32_16x16x64_bf16 v[70:73], v[46:49], v[192:199], v0
ds_read_b128 v[46:49], v1 offset:4096
s_waitcnt lgkmcnt(5)
v_smfmac_f32_16x16x64_bf16 v[66:69], v[38:41], v[128:135], v0
v_smfmac_f32_16x16x64_bf16 v[70:73], v[38:41], v[200:207], v0
ds_read_b128 v[38:41], v1 offset:7168
s_waitcnt lgkmcnt(2)
s_waitcnt vmcnt(7)
s_barrier
ds_read_b64_tr_b16 v[50:51], v3 offset:1536
ds_read_b64_tr_b16 v[52:53], v3 offset:1664
ds_read_b64_tr_b16 v[54:55], v3 offset:3584
ds_read_b64_tr_b16 v[56:57], v3 offset:3712
s_waitcnt lgkmcnt(9)
v_smfmac_f32_16x16x64_bf16 v[66:69], v[42:45], v[136:143], v0
ds_read_b64_tr_b16 v[58:59], v3 offset:1024
ds_read_b64_tr_b16 v[60:61], v3 offset:1152
v_smfmac_f32_16x16x64_bf16 v[70:73], v[42:45], v[208:215], v0
ds_read_b128 v[42:45], v1 offset:8192
ds_read_b64_tr_b16 v[62:63], v3 offset:3072
ds_read_b64_tr_b16 v[64:65], v3 offset:3200
s_waitcnt lgkmcnt(10)
v_smfmac_f32_16x16x64_bf16 v[66:69], v[46:49], v[144:151], v0
ds_read_b64_tr_b16 v[74:75], v3 offset:512
ds_read_b64_tr_b16 v[76:77], v3 offset:640
v_smfmac_f32_16x16x64_bf16 v[70:73], v[46:49], v[216:223], v0
s_waitcnt lgkmcnt(11)
v_smfmac_f32_16x16x64_bf16 v[66:69], v[38:41], v[168:175], v0
v_smfmac_f32_16x16x64_bf16 v[70:73], v[38:41], v[240:247], v0
s_waitcnt lgkmcnt(4)
v_smfmac_f32_16x16x64_bf16 v[66:69], v[42:45], v[176:183], v0
v_smfmac_f32_16x16x64_bf16 v[70:73], v[42:45], v[248:255], v0
s_waitcnt lgkmcnt(7)
s_waitcnt vmcnt(5)
v_mfma_f32_16x16x32_bf16 v[42:45], v[22:25], v[50:53], 0
v_mfma_f32_16x16x32_bf16 v[46:49], v[26:29], v[50:53], 0
v_mfma_f32_16x16x32_bf16 v[38:41], v[54:57], v[50:53], 0
ds_read_b64_tr_b16 v[54:55], v3 offset:2560
ds_read_b64_tr_b16 v[56:57], v3 offset:2688
ds_read_b128 v[22:25], v1 offset:15360
ds_read_b64_tr_b16 v[50:51], v3 offset:0
ds_read_b64_tr_b16 v[52:53], v3 offset:128
ds_read_b128 v[26:29], v1 offset:13312
s_waitcnt lgkmcnt(8)
s_waitcnt vmcnt(2)
v_mfma_f32_16x16x32_bf16 v[42:45], v[14:17], v[58:61], v[42:45]
v_mfma_f32_16x16x32_bf16 v[46:49], v[18:21], v[58:61], v[46:49]
v_mfma_f32_16x16x32_bf16 v[38:41], v[62:65], v[58:61], v[38:41]
ds_read_b64_tr_b16 v[58:59], v3 offset:2048
ds_read_b64_tr_b16 v[60:61], v3 offset:2176
ds_read_b128 v[14:17], v1 offset:14336
ds_read_b64_tr_b16 v[62:63], v79 offset:2048
ds_read_b64_tr_b16 v[64:65], v79 offset:2176
s_waitcnt vmcnt(3)
s_waitcnt lgkmcnt(11)
v_mfma_f32_16x16x32_bf16 v[46:49], v[10:13], v[74:77], v[46:49]
v_add_f32 v70, v70, v72
v_add_f32 v71, v71, v73
s_waitcnt lgkmcnt(8)
v_mfma_f32_16x16x32_bf16 v[42:45], v[22:25], v[74:77], v[42:45]
v_add_f32 v66, v66, v68
v_add_f32 v67, v67, v69
s_waitcnt lgkmcnt(9)
v_mfma_f32_16x16x32_bf16 v[38:41], v[54:57], v[74:77], v[38:41]
v_cvt_pk_bf16_f32 v70, v70, v71
v_cvt_pk_bf16_f32 v72, v66, v67
s_waitcnt lgkmcnt(5)
v_mfma_f32_16x16x32_bf16 v[42:45], v[26:29], v[50:53], v[42:45]
v_mov_b32 v71, 0
v_mov_b32 v73, 0
s_waitcnt lgkmcnt(3)
v_mfma_f32_16x16x32_bf16 v[38:41], v[58:61], v[50:53], v[38:41]
v_mov_b64 v[74:75], s[78:79]
v_mov_b64 v[76:77], s[78:79]
s_waitcnt lgkmcnt(2)
v_mfma_f32_16x16x32_bf16 v[46:49], v[14:17], v[50:53], v[46:49]
s_add_u32 s3, s34, -154624
buffer_store_dword v72, v2, s[4:7], s3 offen sc1
buffer_store_dword v70, v2, s[4:7], s3 offen offset:512 sc1
s_waitcnt lgkmcnt(0)
buffer_store_dwordx4 v[62:65], v78, s[4:7], s34 offen sc1
s_cmp_eq_u32 s28, 63
s_cbranch_scc1 L_ch_end_p2
v_cndmask_b32_e64 v38, v38, v40, s[30:31]
v_cndmask_b32_e64 v39, v39, v41, s[30:31]
v_max3_f32 v50, v42, v43, v44
v_max3_f32 v51, v45, v46, v47
v_max3_f32 v52, v48, v49, v38
v_max3_f32 v50, v50, v51, v39
v_max_f32 v50, v50, v52
v_mov_b32 v51, v50
v_mov_b64 v[66:67], 0
v_mov_b32 v65, 0
v_permlane16_swap_b32 v50, v51
v_max_f32 v50, v50, v51
v_mov_b32 v51, v50
v_subrev_u32 v40, 147456, v1
s_nop 0
v_permlane32_swap_b32 v50, v51
v_max_f32 v50, v50, v51
v_mul_f32 v50, s49, v50
v_pk_fma_f32 v[42:43], v[42:43], s[50:51], v[50:51] op_sel_hi:[1,0,0]
v_pk_fma_f32 v[44:45], v[44:45], s[50:51], v[50:51] op_sel_hi:[1,0,0]
v_pk_fma_f32 v[46:47], v[46:47], s[50:51], v[50:51] op_sel_hi:[1,0,0]
v_pk_fma_f32 v[48:49], v[48:49], s[50:51], v[50:51] op_sel_hi:[1,0,0]
v_pk_fma_f32 v[38:39], v[38:39], s[50:51], v[50:51] op_sel_hi:[1,0,0]
v_exp_f32 v42, v42
v_exp_f32 v43, v43
v_exp_f32 v44, v44
v_exp_f32 v45, v45
v_exp_f32 v46, v46
v_exp_f32 v47, v47
v_exp_f32 v48, v48
v_exp_f32 v49, v49
v_cvt_pk_bf16_f32 v52, v42, v43
v_cvt_pk_bf16_f32 v53, v44, v45
v_cvt_pk_bf16_f32 v54, v46, v47
v_cvt_pk_bf16_f32 v55, v48, v49
s_waitcnt vmcnt(3)
s_nop 0
v_mfma_f32_16x16x32_bf16 v[42:45], v[74:77], v[52:55], 0
v_exp_f32 v38, v38
v_mfma_f32_16x16x32_bf16 v[56:59], v[30:33], v[52:55], 0
v_exp_f32 v39, v39
v_mfma_f32_16x16x32_bf16 v[60:63], v[34:37], v[52:55], 0
v_add_u32 v47, s68, v40
v_cvt_pk_bf16_f32 v64, v38, v39
s_nop 1
v_mfma_f32_16x16x32_bf16 v[42:45], v[74:77], v[64:67], v[42:45]
v_mfma_f32_16x16x32_bf16 v[56:59], v[72:75], v[64:67], v[56:59]
v_mfma_f32_16x16x32_bf16 v[60:63], v[70:73], v[64:67], v[60:63]
ds_read_b128 v[10:13], v47 offset:0
ds_read_b128 v[14:17], v47 offset:1024
ds_read_b128 v[18:21], v47 offset:8192
ds_read_b128 v[22:25], v47 offset:9216
v_rcp_f32 v42, v42
s_nop 0
v_pk_mul_f32 v[56:57], v[56:57], v[42:43] op_sel_hi:[1,0]
v_pk_mul_f32 v[58:59], v[58:59], v[42:43] op_sel_hi:[1,0]
v_pk_mul_f32 v[60:61], v[60:61], v[42:43] op_sel_hi:[1,0]
v_pk_mul_f32 v[62:63], v[62:63], v[42:43] op_sel_hi:[1,0]
v_cvt_pk_bf16_f32 v56, v56, v60
v_cvt_pk_bf16_f32 v57, v57, v61
v_cvt_pk_bf16_f32 v58, v58, v62
v_cvt_pk_bf16_f32 v59, v59, v63
ds_write_b128 v6, v[56:59]
ds_read_b128 v[26:29], v47 offset:2048
ds_read_b128 v[30:33], v47 offset:3072
v_mov_b64 v[72:73], 0
v_mov_b64 v[74:75], 0
v_mov_b64 v[42:43], 0
v_mov_b64 v[44:45], 0
v_mov_b64 v[60:61], 0
v_mov_b64 v[62:63], 0
ds_read_b128 v[48:51], v47 offset:10240
ds_read_b128 v[52:55], v47 offset:11264
s_waitcnt lgkmcnt(4)
s_barrier
ds_read_b128 v[34:37], v1
ds_read_b128 v[38:41], v1 offset:1024
ds_read_b128 v[64:67], v47 offset:4096
ds_read_b128 v[68:71], v47 offset:5120
v_mov_b64 v[56:57], 0
v_mov_b64 v[58:59], 0
s_mul_i32 s3, s22, 589824
s_and_b32 s73, s28, 1
s_mul_i32 s73, s73, 294912
s_add_u32 s72, s3, s73
s_add_u32 s72, s72, 3145728
s_add_u32 s39, s72, s77
s_add_u32 s41, s39, 32768
s_bfe_u32 s35, s28, 0x10001
s_waitcnt lgkmcnt(3)
s_waitcnt lgkmcnt(9)
v_smfmac_f32_16x16x64_bf16 v[56:59], v[34:37], v[10:17], v0
ds_read_b128 v[10:13], v47 offset:12288
ds_read_b128 v[14:17], v47 offset:13312
v_smfmac_f32_16x16x64_bf16 v[60:63], v[34:37], v[18:25], v0
ds_read_b128 v[18:21], v47 offset:6144
ds_read_b128 v[22:25], v47 offset:7168
s_waitcnt lgkmcnt(6)
s_waitcnt lgkmcnt(8)
v_smfmac_f32_16x16x64_bf16 v[56:59], v[38:41], v[26:33], v0
ds_read_b128 v[26:29], v47 offset:14336
ds_read_b128 v[30:33], v47 offset:15360
v_smfmac_f32_16x16x64_bf16 v[60:63], v[38:41], v[48:55], v0
ds_read_b128 v[48:51], v47 offset:16384
ds_read_b128 v[52:55], v47 offset:17408
s_waitcnt lgkmcnt(6)
v_smfmac_f32_16x16x64_bf16 v[72:75], v[34:37], v[64:71], v0
ds_read_b128 v[64:67], v47 offset:24576
ds_read_b128 v[68:71], v47 offset:25600
v_smfmac_f32_16x16x64_bf16 v[42:45], v[34:37], v[10:17], v0
ds_read_b128 v[10:13], v47 offset:18432
ds_read_b128 v[14:17], v47 offset:19456
v_add_f32 v56, v56, v58
v_add_f32 v57, v57, v59
v_add_f32 v60, v60, v62
s_waitcnt lgkmcnt(6)
v_smfmac_f32_16x16x64_bf16 v[72:75], v[38:41], v[18:25], v0
ds_read_b128 v[18:21], v47 offset:26624
ds_read_b128 v[22:25], v47 offset:27648
v_add_f32 v61, v61, v63
v_cvt_pk_bf16_f32 v76, v56, v60
v_cvt_pk_bf16_f32 v77, v57, v61
v_smfmac_f32_16x16x64_bf16 v[42:45], v[38:41], v[26:33], v0
ds_read_b128 v[26:29], v47 offset:20480
ds_read_b128 v[30:33], v47 offset:21504
v_mov_b64 v[56:57], 0
v_mov_b64 v[58:59], 0
v_mov_b64 v[60:61], 0
v_mov_b64 v[62:63], 0
s_waitcnt lgkmcnt(6)
v_smfmac_f32_16x16x64_bf16 v[56:59], v[34:37], v[48:55], v0
ds_read_b128 v[48:51], v47 offset:28672
ds_read_b128 v[52:55], v47 offset:29696
v_smfmac_f32_16x16x64_bf16 v[60:63], v[34:37], v[64:71], v0
ds_read_b128 v[64:67], v47 offset:22528
ds_read_b128 v[68:71], v47 offset:23552
v_add_f32 v72, v72, v74
v_add_f32 v73, v73, v75
v_add_f32 v42, v42, v44
s_waitcnt lgkmcnt(6)
v_smfmac_f32_16x16x64_bf16 v[56:59], v[38:41], v[10:17], v0
ds_read_b128 v[10:13], v47 offset:30720
ds_read_b128 v[14:17], v47 offset:31744
v_add_f32 v43, v43, v45
v_cvt_pk_bf16_f32 v78, v72, v42
v_cvt_pk_bf16_f32 v79, v73, v43
v_smfmac_f32_16x16x64_bf16 v[60:63], v[38:41], v[18:25], v0
v_bfi_b32 v79, 1, s35, v79
buffer_store_dwordx4 v[76:79], v7, s[4:7], s39 offen
v_mov_b64 v[72:73], 0
v_mov_b64 v[74:75], 0
v_mov_b64 v[42:43], 0
v_mov_b64 v[44:45], 0
s_waitcnt lgkmcnt(4)
v_smfmac_f32_16x16x64_bf16 v[72:75], v[34:37], v[26:33], v0
v_smfmac_f32_16x16x64_bf16 v[42:45], v[34:37], v[48:55], v0
v_add_f32 v56, v56, v58
v_add_f32 v57, v57, v59
v_add_f32 v60, v60, v62
s_waitcnt lgkmcnt(0)
v_smfmac_f32_16x16x64_bf16 v[72:75], v[38:41], v[64:71], v0
v_add_f32 v61, v61, v63
v_cvt_pk_bf16_f32 v76, v56, v60
v_cvt_pk_bf16_f32 v77, v57, v61
v_smfmac_f32_16x16x64_bf16 v[42:45], v[38:41], v[10:17], v0
s_nop 3
v_add_f32 v72, v72, v74
v_add_f32 v73, v73, v75
s_nop 1
v_add_f32 v42, v42, v44
v_add_f32 v43, v43, v45
v_cvt_pk_bf16_f32 v78, v72, v42
v_cvt_pk_bf16_f32 v79, v73, v43
v_bfi_b32 v79, 1, s35, v79
buffer_store_dwordx4 v[76:79], v7, s[4:7], s41 offen
s_add_u32 s29, s29, 9216
s_add_u32 s75, s75, 9216
s_add_u32 s32, s32, 0x80000
s_add_u32 s33, s33, 0x80000
s_add_u32 s36, s36, 2048
s_mov_b32 s37, s38
s_add_u32 s38, s38, 2048
s_add_u32 s34, s34, 0x20000
s_add_u32 s28, s28, 1
s_add_u32 s40, s72, s46
v_mov_b32 v42, s64
v_mov_b32 v43, s65
v_cndmask_b32_e64 v42, v42, v43, s[62:63]
v_cndmask_b32_e64 v38, 0, v42, s[54:55]
v_cndmask_b32_e64 v39, 0, v42, s[56:57]
v_cndmask_b32_e64 v40, 0, v42, s[58:59]
v_cndmask_b32_e64 v41, 0, v42, s[60:61]
s_mov_b32 s90, 0xff00ff00
s_mov_b32 s91, 0xff00ff00
s_mov_b32 s13, 0
s_waitcnt vmcnt(0)
L_rs_18:
buffer_load_dwordx4 v[48:51], v1, s[4:7], s40 offen offset:0 sc1
buffer_load_dwordx4 v[52:55], v1, s[4:7], s40 offen offset:1024 sc1
buffer_load_dwordx4 v[56:59], v1, s[4:7], s40 offen offset:2048 sc1
buffer_load_dwordx4 v[60:63], v1, s[4:7], s40 offen offset:3072 sc1
s_add_u32 s13, s13, 1
s_cmp_gt_u32 s13, 200000
s_cbranch_scc1 L_FAIL
s_waitcnt vmcnt(0)
v_mfma_f32_16x16x32_bf16 v[64:67], v[38:41], v[48:51], 0
v_bitop3_b32 v44, v51, v55, s35 bitop3:0x7e
v_mfma_f32_16x16x32_bf16 v[64:67], v[38:41], v[52:55], v[64:67]
v_bitop3_b32 v45, v59, v63, s35 bitop3:0x7e
v_mfma_f32_16x16x32_bf16 v[64:67], v[38:41], v[56:59], v[64:67]
v_bitop3_b32 v44, v44, v45, 1 bitop3:0xa8
v_mfma_f32_16x16x32_bf16 v[64:67], v[38:41], v[60:63], v[64:67]
v_cmp_ne_u32 vcc, 0, v44
s_nop 0
s_cbranch_vccnz L_rs_18
s_nop 4
v_add_f32_dpp v68, v64, v64 row_ror:8 row_mask:0xf bank_mask:0xf
v_add_f32_dpp v69, v65, v65 row_ror:8 row_mask:0xf bank_mask:0xf
v_add_f32_dpp v70, v66, v66 row_ror:8 row_mask:0xf bank_mask:0xf
v_add_f32_dpp v71, v67, v67 row_ror:8 row_mask:0xf bank_mask:0xf
v_cvt_pk_bf16_f32 v72, v68, v69
v_cvt_pk_bf16_f32 v73, v70, v71
v_cndmask_b32_e64 v72, v72, v73, s[90:91]
s_mov_b64 exec, s[52:53]
buffer_store_dword v72, v8, s[4:7], s44 offen
s_mov_b64 exec, -1
s_add_u32 s44, s44, 9216
v_mov_b64 v[50:51], 0
v_mov_b64 v[52:53], 0
v_mov_b64 v[54:55], 0
v_mov_b64 v[56:57], 0
v_mov_b64 v[58:59], 0
v_mov_b64 v[60:61], 0
v_mov_b64 v[62:63], 0
v_mov_b64 v[64:65], 0
v_mov_b64 v[66:67], 0
v_mov_b64 v[68:69], 0
v_mov_b64 v[70:71], 0
v_mov_b64 v[72:73], 0
v_subrev_u32 v76, 147456, v1
v_and_b32 v78, 0x30, v76
v_bfe_u32 v75, v76, 7, 1
v_lshl_add_u32 v78, v75, 6, v78
v_lshrrev_b32 v76, 8, v76
v_lshl_add_u32 v78, v76, 7, v78
v_lshl_add_u32 v78, s20, 9, v78
s_lshl_b32 s3, s20, 9
v_add_u32 v79, s3, v3
v_add_u32 v77, s8, v1
s_nop 0
s_branch L_ch_top_p2
L_ch_end_p2:
s_nop 7
s_nop 7
s_waitcnt vmcnt(0)
s_mov_b32 s37, s38
s_mov_b64 exec, 1
v_mov_b32 v44, 1
buffer_atomic_add v44, off, s[4:7], s37 sc1
s_mov_b64 exec, -1
s_branch L_END
L_cls3p:
v_mov_b64 v[50:51], 0
v_mov_b64 v[52:53], 0
v_mov_b64 v[54:55], 0
v_mov_b64 v[56:57], 0
v_mov_b64 v[58:59], 0
v_mov_b64 v[60:61], 0
v_mov_b64 v[62:63], 0
v_mov_b64 v[64:65], 0
v_mov_b64 v[66:67], 0
v_mov_b64 v[68:69], 0
v_mov_b64 v[70:71], 0
v_mov_b64 v[72:73], 0
v_subrev_u32 v76, 147456, v1
v_and_b32 v78, 0x30, v76
v_bfe_u32 v75, v76, 7, 1
v_lshl_add_u32 v78, v75, 6, v78
v_lshrrev_b32 v76, 8, v76
v_lshl_add_u32 v78, v76, 7, v78
v_lshl_add_u32 v78, s20, 9, v78
s_lshl_b32 s3, s20, 9
v_add_u32 v79, s3, v3
v_add_u32 v77, s8, v1
ds_read_b128 v[10:13], v77 offset:0
ds_read_b128 v[14:17], v77 offset:1024
s_waitcnt lgkmcnt(0)
s_branch L_ch_b1_p3
L_ch_top_p3:
s_barrier
s_mov_b32 s67, 0
L_ag_20:
buffer_load_dwordx4 v[10:13], v1, s[4:7], s29 offen offset:0 sc1
buffer_load_dwordx4 v[14:17], v1, s[4:7], s29 offen offset:1024 sc1
s_add_u32 s67, s67, 1
s_cmp_gt_u32 s67, 200000
s_cbranch_scc1 L_FAIL
s_waitcnt vmcnt(1)
ds_write_b128 v77, v[10:13] offset:0
s_waitcnt vmcnt(0)
ds_write_b128 v77, v[14:17] offset:1024
v_max3_u32 v74, v10, v11, v12
v_max3_u32 v75, v13, v14, v15
v_max3_u32 v74, v74, v16, v17
v_max3_u32 v74, v74, v75, v75
v_cmp_eq_u32 vcc, -1, v74
s_nop 0
s_cbranch_vccnz L_ag_20
L_ch_b1_p3:
v_smfmac_f32_16x16x64_bf16 v[50:53], v[10:13], a[56:63], v0
v_smfmac_f32_16x16x64_bf16 v[54:57], v[10:13], a[128:135], v0
v_smfmac_f32_16x16x64_bf16 v[58:61], v[10:13], a[200:207], v0
v_smfmac_f32_16x16x64_bf16 v[62:65], v[10:13], v[96:103], v0
s_waitcnt lgkmcnt(0)
s_barrier
v_smfmac_f32_16x16x64_bf16 v[50:53], v[14:17], a[64:71], v0
ds_read_b128 v[38:41], v1 offset:0
v_smfmac_f32_16x16x64_bf16 v[54:57], v[14:17], a[136:143], v0
ds_read_b128 v[42:45], v1 offset:1024
v_smfmac_f32_16x16x64_bf16 v[58:61], v[14:17], a[208:215], v0
ds_read_b128 v[46:49], v1 offset:2048
v_smfmac_f32_16x16x64_bf16 v[62:65], v[14:17], v[104:111], v0
s_mov_b32 m0, s11
s_add_u32 s3, s32, s48
v_smfmac_f32_16x16x64_bf16 v[66:69], v[10:13], v[168:175], v0
v_smfmac_f32_16x16x64_bf16 v[70:73], v[10:13], v[240:247], v0
v_smfmac_f32_16x16x64_bf16 v[66:69], v[14:17], v[176:183], v0
buffer_load_dwordx4 v4, s[4:7], s3 offen sc1 lds
v_smfmac_f32_16x16x64_bf16 v[70:73], v[14:17], v[248:255], v0
s_waitcnt lgkmcnt(2)
v_smfmac_f32_16x16x64_bf16 v[50:53], v[38:41], a[0:7], v0
v_smfmac_f32_16x16x64_bf16 v[54:57], v[38:41], a[72:79], v0
buffer_load_dwordx4 v[22:25], v4, s[4:7], s33 offen offset:2048 sc1
v_smfmac_f32_16x16x64_bf16 v[58:61], v[38:41], a[144:151], v0
v_smfmac_f32_16x16x64_bf16 v[62:65], v[38:41], a[216:223], v0
ds_read_b128 v[38:41], v1 offset:3072
s_waitcnt lgkmcnt(2)
v_smfmac_f32_16x16x64_bf16 v[50:53], v[42:45], a[8:15], v0
buffer_load_dwordx4 v[26:29], v4, s[4:7], s33 offen offset:2176 sc1
v_smfmac_f32_16x16x64_bf16 v[54:57], v[42:45], a[80:87], v0
v_smfmac_f32_16x16x64_bf16 v[58:61], v[42:45], a[152:159], v0
v_smfmac_f32_16x16x64_bf16 v[62:65], v[42:45], a[224:231], v0
ds_read_b128 v[42:45], v1 offset:4096
buffer_load_dwordx4 v[18:21], v4, s[4:7], s33 offen offset:128 sc1
s_waitcnt lgkmcnt(2)
v_smfmac_f32_16x16x64_bf16 v[50:53], v[46:49], a[16:23], v0
v_smfmac_f32_16x16x64_bf16 v[54:57], v[46:49], a[88:95], v0
v_smfmac_f32_16x16x64_bf16 v[58:61], v[46:49], a[160:167], v0
buffer_load_dwordx4 v[10:13], v4, s[4:7], s32 offen offset:2176 sc1
v_smfmac_f32_16x16x64_bf16 v[62:65], v[46:49], a[232:239], v0
ds_read_b128 v[46:49], v1 offset:5120
s_waitcnt lgkmcnt(2)
v_smfmac_f32_16x16x64_bf16 v[50:53], v[38:41], a[24:31], v0
buffer_load_dwordx4 v[14:17], v4, s[4:7], s33 offen offset:0 sc1
v_smfmac_f32_16x16x64_bf16 v[54:57], v[38:41], a[96:103], v0
v_smfmac_f32_16x16x64_bf16 v[58:61], v[38:41], a[168:175], v0
buffer_load_dwordx4 v[30:33], v5, s[4:7], s32 offen offset:0 sc1
v_smfmac_f32_16x16x64_bf16 v[62:65], v[38:41], a[240:247], v0
ds_read_b128 v[38:41], v1 offset:6144
s_waitcnt lgkmcnt(2)
v_smfmac_f32_16x16x64_bf16 v[50:53], v[42:45], a[32:39], v0
buffer_load_dwordx4 v[34:37], v5, s[4:7], s32 offen offset:2048 sc1
v_smfmac_f32_16x16x64_bf16 v[54:57], v[42:45], a[104:111], v0
v_smfmac_f32_16x16x64_bf16 v[58:61], v[42:45], a[176:183], v0
v_smfmac_f32_16x16x64_bf16 v[62:65], v[42:45], a[248:255], v0
ds_read_b128 v[42:45], v1 offset:0
s_waitcnt lgkmcnt(2)
v_smfmac_f32_16x16x64_bf16 v[50:53], v[46:49], a[40:47], v0
v_smfmac_f32_16x16x64_bf16 v[54:57], v[46:49], a[112:119], v0
v_smfmac_f32_16x16x64_bf16 v[58:61], v[46:49], a[184:191], v0
v_smfmac_f32_16x16x64_bf16 v[62:65], v[46:49], v[80:87], v0
ds_read_b128 v[46:49], v1 offset:1024
s_waitcnt lgkmcnt(2)
v_smfmac_f32_16x16x64_bf16 v[50:53], v[38:41], a[48:55], v0
v_smfmac_f32_16x16x64_bf16 v[54:57], v[38:41], a[120:127], v0
v_smfmac_f32_16x16x64_bf16 v[58:61], v[38:41], a[192:199], v0
v_smfmac_f32_16x16x64_bf16 v[62:65], v[38:41], v[88:95], v0
ds_read_b128 v[38:41], v1 offset:2048
s_waitcnt lgkmcnt(2)
v_smfmac_f32_16x16x64_bf16 v[66:69], v[42:45], v[112:119], v0
v_smfmac_f32_16x16x64_bf16 v[70:73], v[42:45], v[184:191], v0
ds_read_b128 v[42:45], v1 offset:3072
v_add_f32 v50, v50, v52
v_add_f32 v51, v51, v53
v_add_f32 v54, v54, v56
v_add_f32 v55, v55, v57
v_cvt_pk_bf16_f32 v74, v50, v51
v_cvt_pk_bf16_f32 v75, v54, v55
ds_write2_b32 v2, v74, v75 offset0:0 offset1:128
v_add_f32 v58, v58, v60
v_add_f32 v59, v59, v61
v_add_f32 v62, v62, v64
v_add_f32 v63, v63, v65
v_cvt_pk_bf16_f32 v76, v58, v59
v_cvt_pk_bf16_f32 v77, v62, v63
ds_write_b32 v2, v76 offset:2048
ds_write_b32 v2, v77 offset:2560
s_waitcnt lgkmcnt(5)
v_smfmac_f32_16x16x64_bf16 v[66:69], v[46:49], v[120:127], v0
v_smfmac_f32_16x16x64_bf16 v[70:73], v[46:49], v[192:199], v0
ds_read_b128 v[46:49], v1 offset:4096
s_waitcnt lgkmcnt(5)
v_smfmac_f32_16x16x64_bf16 v[66:69], v[38:41], v[128:135], v0
v_smfmac_f32_16x16x64_bf16 v[70:73], v[38:41], v[200:207], v0
ds_read_b128 v[38:41], v1 offset:5120
s_waitcnt lgkmcnt(2)
s_waitcnt vmcnt(7)
s_barrier
ds_read_b64_tr_b16 v[50:51], v3 offset:1536
ds_read_b64_tr_b16 v[52:53], v3 offset:1664
ds_read_b64_tr_b16 v[54:55], v3 offset:3584
ds_read_b64_tr_b16 v[56:57], v3 offset:3712
s_waitcnt lgkmcnt(9)
v_smfmac_f32_16x16x64_bf16 v[66:69], v[42:45], v[136:143], v0
ds_read_b64_tr_b16 v[58:59], v3 offset:1024
ds_read_b64_tr_b16 v[60:61], v3 offset:1152
v_smfmac_f32_16x16x64_bf16 v[70:73], v[42:45], v[208:215], v0
ds_read_b128 v[42:45], v1 offset:6144
ds_read_b64_tr_b16 v[62:63], v3 offset:3072
ds_read_b64_tr_b16 v[64:65], v3 offset:3200
s_waitcnt lgkmcnt(10)
v_smfmac_f32_16x16x64_bf16 v[66:69], v[46:49], v[144:151], v0
ds_read_b64_tr_b16 v[74:75], v3 offset:512
ds_read_b64_tr_b16 v[76:77], v3 offset:640
v_smfmac_f32_16x16x64_bf16 v[70:73], v[46:49], v[216:223], v0
s_waitcnt lgkmcnt(11)
v_smfmac_f32_16x16x64_bf16 v[66:69], v[38:41], v[152:159], v0
v_smfmac_f32_16x16x64_bf16 v[70:73], v[38:41], v[224:231], v0
s_waitcnt lgkmcnt(4)
v_smfmac_f32_16x16x64_bf16 v[66:69], v[42:45], v[160:167], v0
v_smfmac_f32_16x16x64_bf16 v[70:73], v[42:45], v[232:239], v0
s_waitcnt lgkmcnt(7)
s_waitcnt vmcnt(5)
v_mfma_f32_16x16x32_bf16 v[42:45], v[22:25], v[50:53], 0
v_mfma_f32_16x16x32_bf16 v[46:49], v[26:29], v[50:53], 0
v_mfma_f32_16x16x32_bf16 v[38:41], v[54:57], v[50:53], 0
ds_read_b64_tr_b16 v[54:55], v3 offset:2560
ds_read_b64_tr_b16 v[56:57], v3 offset:2688
ds_read_b128 v[22:25], v1 offset:15360
ds_read_b64_tr_b16 v[50:51], v3 offset:0
ds_read_b64_tr_b16 v[52:53], v3 offset:128
ds_read_b128 v[26:29], v1 offset:13312
s_waitcnt lgkmcnt(8)
s_waitcnt vmcnt(2)
v_mfma_f32_16x16x32_bf16 v[42:45], v[14:17], v[58:61], v[42:45]
v_mfma_f32_16x16x32_bf16 v[46:49], v[18:21], v[58:61], v[46:49]
v_mfma_f32_16x16x32_bf16 v[38:41], v[62:65], v[58:61], v[38:41]
ds_read_b64_tr_b16 v[58:59], v3 offset:2048
ds_read_b64_tr_b16 v[60:61], v3 offset:2176
ds_read_b128 v[14:17], v1 offset:14336
ds_read_b64_tr_b16 v[62:63], v79 offset:2048
ds_read_b64_tr_b16 v[64:65], v79 offset:2176
s_waitcnt vmcnt(3)
s_waitcnt lgkmcnt(11)
v_mfma_f32_16x16x32_bf16 v[46:49], v[10:13], v[74:77], v[46:49]
v_add_f32 v70, v70, v72
v_add_f32 v71, v71, v73
s_waitcnt lgkmcnt(8)
v_mfma_f32_16x16x32_bf16 v[42:45], v[22:25], v[74:77], v[42:45]
v_add_f32 v66, v66, v68
v_add_f32 v67, v67, v69
s_waitcnt lgkmcnt(9)
v_mfma_f32_16x16x32_bf16 v[38:41], v[54:57], v[74:77], v[38:41]
v_cvt_pk_bf16_f32 v70, v70, v71
v_cvt_pk_bf16_f32 v72, v66, v67
s_waitcnt lgkmcnt(5)
v_mfma_f32_16x16x32_bf16 v[42:45], v[26:29], v[50:53], v[42:45]
v_mov_b32 v71, 0
v_mov_b32 v73, 0
s_waitcnt lgkmcnt(3)
v_mfma_f32_16x16x32_bf16 v[38:41], v[58:61], v[50:53], v[38:41]
v_mov_b64 v[74:75], s[78:79]
v_mov_b64 v[76:77], s[78:79]
s_waitcnt lgkmcnt(2)
v_mfma_f32_16x16x32_bf16 v[46:49], v[14:17], v[50:53], v[46:49]
s_add_u32 s3, s34, -154624
buffer_store_dword v72, v2, s[4:7], s3 offen sc1
buffer_store_dword v70, v2, s[4:7], s3 offen offset:512 sc1
s_waitcnt lgkmcnt(0)
buffer_store_dwordx4 v[62:65], v78, s[4:7], s34 offen sc1
s_cmp_eq_u32 s28, 63
s_cbranch_scc1 L_ch_end_p3
v_cndmask_b32_e64 v38, v38, v40, s[30:31]
v_cndmask_b32_e64 v39, v39, v41, s[30:31]
v_max3_f32 v50, v42, v43, v44
v_max3_f32 v51, v45, v46, v47
v_max3_f32 v52, v48, v49, v38
v_max3_f32 v50, v50, v51, v39
v_max_f32 v50, v50, v52
v_mov_b32 v51, v50
v_mov_b64 v[66:67], 0
v_mov_b32 v65, 0
v_permlane16_swap_b32 v50, v51
v_max_f32 v50, v50, v51
v_mov_b32 v51, v50
v_subrev_u32 v40, 147456, v1
s_nop 0
v_permlane32_swap_b32 v50, v51
v_max_f32 v50, v50, v51
v_mul_f32 v50, s49, v50
v_pk_fma_f32 v[42:43], v[42:43], s[50:51], v[50:51] op_sel_hi:[1,0,0]
v_pk_fma_f32 v[44:45], v[44:45], s[50:51], v[50:51] op_sel_hi:[1,0,0]
v_pk_fma_f32 v[46:47], v[46:47], s[50:51], v[50:51] op_sel_hi:[1,0,0]
v_pk_fma_f32 v[48:49], v[48:49], s[50:51], v[50:51] op_sel_hi:[1,0,0]
v_pk_fma_f32 v[38:39], v[38:39], s[50:51], v[50:51] op_sel_hi:[1,0,0]
v_exp_f32 v42, v42
v_exp_f32 v43, v43
v_exp_f32 v44, v44
v_exp_f32 v45, v45
v_exp_f32 v46, v46
v_exp_f32 v47, v47
v_exp_f32 v48, v48
v_exp_f32 v49, v49
v_cvt_pk_bf16_f32 v52, v42, v43
v_cvt_pk_bf16_f32 v53, v44, v45
v_cvt_pk_bf16_f32 v54, v46, v47
v_cvt_pk_bf16_f32 v55, v48, v49
s_waitcnt vmcnt(3)
s_nop 0
v_mfma_f32_16x16x32_bf16 v[42:45], v[74:77], v[52:55], 0
v_exp_f32 v38, v38
v_mfma_f32_16x16x32_bf16 v[56:59], v[30:33], v[52:55], 0
v_exp_f32 v39, v39
v_mfma_f32_16x16x32_bf16 v[60:63], v[34:37], v[52:55], 0
v_add_u32 v47, s68, v40
v_cvt_pk_bf16_f32 v64, v38, v39
v_add_u32 v46, 0x20000, v40
s_nop 0
v_mfma_f32_16x16x32_bf16 v[42:45], v[74:77], v[64:67], v[42:45]
v_mfma_f32_16x16x32_bf16 v[56:59], v[72:75], v[64:67], v[56:59]
v_mfma_f32_16x16x32_bf16 v[60:63], v[70:73], v[64:67], v[60:63]
ds_read_b128 v[10:13], v47 offset:0
ds_read_b128 v[14:17], v47 offset:1024
ds_read_b128 v[18:21], v47 offset:8192
ds_read_b128 v[22:25], v47 offset:9216
v_rcp_f32 v42, v42
s_nop 0
v_pk_mul_f32 v[56:57], v[56:57], v[42:43] op_sel_hi:[1,0]
v_pk_mul_f32 v[58:59], v[58:59], v[42:43] op_sel_hi:[1,0]
v_pk_mul_f32 v[60:61], v[60:61], v[42:43] op_sel_hi:[1,0]
v_pk_mul_f32 v[62:63], v[62:63], v[42:43] op_sel_hi:[1,0]
v_cvt_pk_bf16_f32 v56, v56, v60
v_cvt_pk_bf16_f32 v57, v57, v61
v_cvt_pk_bf16_f32 v58, v58, v62
v_cvt_pk_bf16_f32 v59, v59, v63
ds_write_b128 v6, v[56:59]
ds_read_b128 v[26:29], v47 offset:2048
ds_read_b128 v[30:33], v47 offset:3072
v_mov_b64 v[72:73], 0
v_mov_b64 v[74:75], 0
v_mov_b64 v[42:43], 0
v_mov_b64 v[44:45], 0
v_mov_b64 v[60:61], 0
v_mov_b64 v[62:63], 0
ds_read_b128 v[48:51], v47 offset:10240
ds_read_b128 v[52:55], v47 offset:11264
s_waitcnt lgkmcnt(4)
s_barrier
ds_read_b128 v[34:37], v1
ds_read_b128 v[38:41], v1 offset:1024
ds_read_b128 v[64:67], v47 offset:4096
ds_read_b128 v[68:71], v47 offset:5120
v_mov_b64 v[56:57], 0
v_mov_b64 v[58:59], 0
s_mul_i32 s3, s22, 589824
s_and_b32 s73, s28, 1
s_mul_i32 s73, s73, 294912
s_add_u32 s72, s3, s73
s_add_u32 s72, s72, 3145728
s_add_u32 s39, s72, s77
s_add_u32 s41, s39, 32768
s_bfe_u32 s35, s28, 0x10001
s_add_u32 s10, s72, s9
s_waitcnt lgkmcnt(3)
s_waitcnt lgkmcnt(9)
v_smfmac_f32_16x16x64_bf16 v[56:59], v[34:37], v[10:17], v0
ds_read_b128 v[10:13], v47 offset:12288
ds_read_b128 v[14:17], v47 offset:13312
v_smfmac_f32_16x16x64_bf16 v[60:63], v[34:37], v[18:25], v0
ds_read_b128 v[18:21], v47 offset:6144
ds_read_b128 v[22:25], v47 offset:7168
s_waitcnt lgkmcnt(6)
s_waitcnt lgkmcnt(8)
v_smfmac_f32_16x16x64_bf16 v[56:59], v[38:41], v[26:33], v0
ds_read_b128 v[26:29], v47 offset:14336
ds_read_b128 v[30:33], v47 offset:15360
v_smfmac_f32_16x16x64_bf16 v[60:63], v[38:41], v[48:55], v0
ds_read_b128 v[48:51], v47 offset:16384
ds_read_b128 v[52:55], v47 offset:17408
s_waitcnt lgkmcnt(6)
v_smfmac_f32_16x16x64_bf16 v[72:75], v[34:37], v[64:71], v0
ds_read_b128 v[64:67], v47 offset:24576
ds_read_b128 v[68:71], v47 offset:25600
v_smfmac_f32_16x16x64_bf16 v[42:45], v[34:37], v[10:17], v0
ds_read_b128 v[10:13], v47 offset:18432
ds_read_b128 v[14:17], v47 offset:19456
v_add_f32 v56, v56, v58
v_add_f32 v57, v57, v59
v_add_f32 v60, v60, v62
s_waitcnt lgkmcnt(6)
v_smfmac_f32_16x16x64_bf16 v[72:75], v[38:41], v[18:25], v0
ds_read_b128 v[18:21], v47 offset:26624
ds_read_b128 v[22:25], v47 offset:27648
v_add_f32 v61, v61, v63
v_cvt_pk_bf16_f32 v76, v56, v60
v_cvt_pk_bf16_f32 v77, v57, v61
v_smfmac_f32_16x16x64_bf16 v[42:45], v[38:41], v[26:33], v0
ds_read_b128 v[26:29], v47 offset:20480
ds_read_b128 v[30:33], v47 offset:21504
v_mov_b64 v[56:57], 0
v_mov_b64 v[58:59], 0
v_mov_b64 v[60:61], 0
v_mov_b64 v[62:63], 0
s_waitcnt lgkmcnt(6)
v_smfmac_f32_16x16x64_bf16 v[56:59], v[34:37], v[48:55], v0
ds_read_b128 v[48:51], v47 offset:28672
ds_read_b128 v[52:55], v47 offset:29696
v_smfmac_f32_16x16x64_bf16 v[60:63], v[34:37], v[64:71], v0
ds_read_b128 v[64:67], v47 offset:22528
ds_read_b128 v[68:71], v47 offset:23552
v_add_f32 v72, v72, v74
v_add_f32 v73, v73, v75
v_add_f32 v42, v42, v44
s_waitcnt lgkmcnt(6)
v_smfmac_f32_16x16x64_bf16 v[56:59], v[38:41], v[10:17], v0
ds_read_b128 v[10:13], v47 offset:30720
ds_read_b128 v[14:17], v47 offset:31744
v_add_f32 v43, v43, v45
v_cvt_pk_bf16_f32 v78, v72, v42
v_cvt_pk_bf16_f32 v79, v73, v43
v_smfmac_f32_16x16x64_bf16 v[60:63], v[38:41], v[18:25], v0
ds_read_b128 v[18:21], v46 offset:4096
ds_read_b128 v[22:25], v46 offset:5120
v_bfi_b32 v79, 1, s35, v79
buffer_store_dwordx4 v[76:79], v7, s[4:7], s39 offen
v_mov_b64 v[72:73], 0
v_mov_b64 v[74:75], 0
v_mov_b64 v[42:43], 0
v_mov_b64 v[44:45], 0
s_waitcnt lgkmcnt(6)
v_smfmac_f32_16x16x64_bf16 v[72:75], v[34:37], v[26:33], v0
ds_read_b128 v[26:29], v46 offset:12288
ds_read_b128 v[30:33], v46 offset:13312
v_smfmac_f32_16x16x64_bf16 v[42:45], v[34:37], v[48:55], v0
ds_read_b128 v[48:51], v46 offset:6144
ds_read_b128 v[52:55], v46 offset:7168
v_add_f32 v56, v56, v58
v_add_f32 v57, v57, v59
v_add_f32 v60, v60, v62
s_waitcnt lgkmcnt(6)
v_smfmac_f32_16x16x64_bf16 v[72:75], v[38:41], v[64:71], v0
ds_read_b128 v[64:67], v46 offset:14336
ds_read_b128 v[68:71], v46 offset:15360
v_add_f32 v61, v61, v63
v_cvt_pk_bf16_f32 v76, v56, v60
v_cvt_pk_bf16_f32 v77, v57, v61
v_smfmac_f32_16x16x64_bf16 v[42:45], v[38:41], v[10:17], v0
v_mov_b64 v[56:57], 0
v_mov_b64 v[58:59], 0
v_mov_b64 v[60:61], 0
v_mov_b64 v[62:63], 0
s_waitcnt lgkmcnt(4)
v_smfmac_f32_16x16x64_bf16 v[56:59], v[34:37], v[18:25], v0
v_smfmac_f32_16x16x64_bf16 v[60:63], v[34:37], v[26:33], v0
v_and_b32 v46, 0x70, v7
v_lshrrev_b32 v46, 1, v46
v_sub_u32 v46, v7, v46
s_waitcnt lgkmcnt(0)
v_smfmac_f32_16x16x64_bf16 v[56:59], v[38:41], v[48:55], v0
v_add_f32 v72, v72, v74
v_add_f32 v73, v73, v75
v_add_f32 v42, v42, v44
v_smfmac_f32_16x16x64_bf16 v[60:63], v[38:41], v[64:71], v0
v_add_f32 v43, v43, v45
v_cvt_pk_bf16_f32 v78, v72, v42
v_cvt_pk_bf16_f32 v79, v73, v43
v_bfi_b32 v79, 1, s35, v79
buffer_store_dwordx4 v[76:79], v7, s[4:7], s41 offen
v_add_f32 v56, v56, v58
v_add_f32 v57, v57, v59
s_nop 0
v_add_f32 v60, v60, v62
v_add_f32 v61, v61, v63
v_cvt_pk_bf16_f32 v76, v56, v60
v_cvt_pk_bf16_f32 v77, v57, v61
v_bfi_b32 v77, 1, s35, v77
buffer_store_dwordx2 v[76:77], v46, s[4:7], s10 offen
s_add_u32 s29, s29, 9216
s_add_u32 s75, s75, 9216
s_add_u32 s32, s32, 0x80000
s_add_u32 s33, s33, 0x80000
s_add_u32 s36, s36, 2048
s_mov_b32 s37, s38
s_add_u32 s38, s38, 2048
s_add_u32 s34, s34, 0x20000
s_add_u32 s28, s28, 1
s_cmp_ge_u32 s45, 72
s_cbranch_scc1 L_nors_21
s_add_u32 s40, s72, s46
v_mov_b32 v42, s64
v_mov_b32 v43, s65
v_cndmask_b32_e64 v42, v42, v43, s[62:63]
v_cndmask_b32_e64 v38, 0, v42, s[54:55]
v_cndmask_b32_e64 v39, 0, v42, s[56:57]
v_cndmask_b32_e64 v40, 0, v42, s[58:59]
v_cndmask_b32_e64 v41, 0, v42, s[60:61]
s_mov_b32 s90, 0xff00ff00
s_mov_b32 s91, 0xff00ff00
s_mov_b32 s13, 0
s_waitcnt vmcnt(0)
L_rs_22:
buffer_load_dwordx4 v[48:51], v1, s[4:7], s40 offen offset:0 sc1
buffer_load_dwordx4 v[52:55], v1, s[4:7], s40 offen offset:1024 sc1
buffer_load_dwordx4 v[56:59], v1, s[4:7], s40 offen offset:2048 sc1
buffer_load_dwordx4 v[60:63], v1, s[4:7], s40 offen offset:3072 sc1
s_add_u32 s13, s13, 1
s_cmp_gt_u32 s13, 200000
s_cbranch_scc1 L_FAIL
s_waitcnt vmcnt(0)
v_mfma_f32_16x16x32_bf16 v[64:67], v[38:41], v[48:51], 0
v_bitop3_b32 v44, v49, v51, s35 bitop3:0x7e
v_bitop3_b32 v45, v53, v55, s35 bitop3:0x7e
v_mfma_f32_16x16x32_bf16 v[64:67], v[38:41], v[52:55], v[64:67]
v_bitop3_b32 v46, v57, v59, s35 bitop3:0x7e
v_bitop3_b32 v47, v61, v63, s35 bitop3:0x7e
v_mfma_f32_16x16x32_bf16 v[64:67], v[38:41], v[56:59], v[64:67]
v_or3_b32 v44, v44, v46, v47
v_bitop3_b32 v44, v44, v45, 1 bitop3:0xa8
v_mfma_f32_16x16x32_bf16 v[64:67], v[38:41], v[60:63], v[64:67]
v_cmp_ne_u32 vcc, 0, v44
s_nop 0
s_cbranch_vccnz L_rs_22
s_nop 4
v_add_f32_dpp v68, v64, v64 row_ror:8 row_mask:0xf bank_mask:0xf
v_add_f32_dpp v69, v65, v65 row_ror:8 row_mask:0xf bank_mask:0xf
v_add_f32_dpp v70, v66, v66 row_ror:8 row_mask:0xf bank_mask:0xf
v_add_f32_dpp v71, v67, v67 row_ror:8 row_mask:0xf bank_mask:0xf
v_cvt_pk_bf16_f32 v72, v68, v69
v_cvt_pk_bf16_f32 v73, v70, v71
v_cndmask_b32_e64 v72, v72, v73, s[90:91]
s_mov_b64 exec, s[52:53]
buffer_store_dword v72, v8, s[4:7], s44 offen
s_mov_b64 exec, -1
s_add_u32 s44, s44, 9216
L_nors_21:
v_mov_b64 v[50:51], 0
v_mov_b64 v[52:53], 0
v_mov_b64 v[54:55], 0
v_mov_b64 v[56:57], 0
v_mov_b64 v[58:59], 0
v_mov_b64 v[60:61], 0
v_mov_b64 v[62:63], 0
v_mov_b64 v[64:65], 0
v_mov_b64 v[66:67], 0
v_mov_b64 v[68:69], 0
v_mov_b64 v[70:71], 0
v_mov_b64 v[72:73], 0
v_subrev_u32 v76, 147456, v1
v_and_b32 v78, 0x30, v76
v_bfe_u32 v75, v76, 7, 1
v_lshl_add_u32 v78, v75, 6, v78
v_lshrrev_b32 v76, 8, v76
v_lshl_add_u32 v78, v76, 7, v78
v_lshl_add_u32 v78, s20, 9, v78
s_lshl_b32 s3, s20, 9
v_add_u32 v79, s3, v3
v_add_u32 v77, s8, v1
s_nop 0
s_branch L_ch_top_p3
L_ch_end_p3:
s_nop 7
s_nop 7
s_waitcnt vmcnt(0)
s_mov_b32 s37, s38
s_mov_b64 exec, 1
v_mov_b32 v44, 1
buffer_atomic_add v44, off, s[4:7], s37 sc1
s_mov_b64 exec, -1
s_branch L_END
L_ch_slow:
s_cmp_eq_u32 s20, 0
s_cbranch_scc1 L_cls0s
s_cmp_eq_u32 s20, 2
s_cbranch_scc1 L_cls2s
s_cmp_eq_u32 s20, 3
s_cbranch_scc1 L_cls3s
v_mov_b64 v[50:51], 0
v_mov_b64 v[52:53], 0
v_mov_b64 v[54:55], 0
v_mov_b64 v[56:57], 0
v_mov_b64 v[58:59], 0
v_mov_b64 v[60:61], 0
v_mov_b64 v[62:63], 0
v_mov_b64 v[64:65], 0
v_mov_b64 v[66:67], 0
v_mov_b64 v[68:69], 0
v_mov_b64 v[70:71], 0
v_mov_b64 v[72:73], 0
v_subrev_u32 v76, 147456, v1
v_and_b32 v78, 0x30, v76
v_bfe_u32 v75, v76, 7, 1
v_lshl_add_u32 v78, v75, 6, v78
v_lshrrev_b32 v76, 8, v76
v_lshl_add_u32 v78, v76, 7, v78
v_lshl_add_u32 v78, s20, 9, v78
s_lshl_b32 s3, s20, 9
v_add_u32 v79, s3, v3
v_add_u32 v77, s8, v1
ds_read_b128 v[10:13], v77 offset:0
ds_read_b128 v[14:17], v77 offset:1024
s_waitcnt lgkmcnt(0)
s_branch L_ch_b1_s1
L_ch_top_s1:
s_barrier
s_mov_b32 s67, 0
L_ag_24:
buffer_load_dwordx4 v[10:13], v1, s[4:7], s29 offen offset:0 sc1
buffer_load_dwordx4 v[14:17], v1, s[4:7], s29 offen offset:1024 sc1
s_add_u32 s67, s67, 1
s_cmp_gt_u32 s67, 200000
s_cbranch_scc1 L_FAIL
s_waitcnt vmcnt(1)
ds_write_b128 v77, v[10:13] offset:0
s_waitcnt vmcnt(0)
ds_write_b128 v77, v[14:17] offset:1024
v_max3_u32 v74, v10, v11, v12
v_max3_u32 v75, v13, v14, v15
v_max3_u32 v74, v74, v16, v17
v_max3_u32 v74, v74, v75, v75
v_cmp_eq_u32 vcc, -1, v74
s_nop 0
s_cbranch_vccnz L_ag_24
L_ch_b1_s1:
v_smfmac_f32_16x16x64_bf16 v[50:53], v[10:13], a[24:31], v0
v_smfmac_f32_16x16x64_bf16 v[54:57], v[10:13], a[96:103], v0
v_smfmac_f32_16x16x64_bf16 v[58:61], v[10:13], a[168:175], v0
v_smfmac_f32_16x16x64_bf16 v[62:65], v[10:13], a[240:247], v0
s_waitcnt lgkmcnt(0)
s_barrier
v_smfmac_f32_16x16x64_bf16 v[50:53], v[14:17], a[32:39], v0
ds_read_b128 v[38:41], v1 offset:0
v_smfmac_f32_16x16x64_bf16 v[54:57], v[14:17], a[104:111], v0
ds_read_b128 v[42:45], v1 offset:1024
v_smfmac_f32_16x16x64_bf16 v[58:61], v[14:17], a[176:183], v0
ds_read_b128 v[46:49], v1 offset:2048
v_smfmac_f32_16x16x64_bf16 v[62:65], v[14:17], a[248:255], v0
s_mov_b32 m0, s11
s_add_u32 s3, s32, s48
v_smfmac_f32_16x16x64_bf16 v[66:69], v[10:13], v[136:143], v0
buffer_load_dwordx4 v4, s[4:7], s3 offen sc1 lds
v_smfmac_f32_16x16x64_bf16 v[70:73], v[10:13], v[208:215], v0
v_smfmac_f32_16x16x64_bf16 v[66:69], v[14:17], v[144:151], v0
v_smfmac_f32_16x16x64_bf16 v[70:73], v[14:17], v[216:223], v0
buffer_load_dwordx4 v[22:25], v4, s[4:7], s33 offen offset:2048 sc1
s_waitcnt lgkmcnt(2)
v_smfmac_f32_16x16x64_bf16 v[50:53], v[38:41], a[0:7], v0
v_smfmac_f32_16x16x64_bf16 v[54:57], v[38:41], a[72:79], v0
v_smfmac_f32_16x16x64_bf16 v[58:61], v[38:41], a[144:151], v0
buffer_load_dwordx4 v[26:29], v4, s[4:7], s33 offen offset:2176 sc1
v_smfmac_f32_16x16x64_bf16 v[62:65], v[38:41], a[216:223], v0
ds_read_b128 v[38:41], v1 offset:5120
s_waitcnt lgkmcnt(2)
v_smfmac_f32_16x16x64_bf16 v[50:53], v[42:45], a[8:15], v0
v_smfmac_f32_16x16x64_bf16 v[54:57], v[42:45], a[80:87], v0
buffer_load_dwordx4 v[18:21], v4, s[4:7], s33 offen offset:128 sc1
v_smfmac_f32_16x16x64_bf16 v[58:61], v[42:45], a[152:159], v0
v_smfmac_f32_16x16x64_bf16 v[62:65], v[42:45], a[224:231], v0
ds_read_b128 v[42:45], v1 offset:6144
s_waitcnt lgkmcnt(2)
v_smfmac_f32_16x16x64_bf16 v[50:53], v[46:49], a[16:23], v0
buffer_load_dwordx4 v[10:13], v4, s[4:7], s32 offen offset:2176 sc1
v_smfmac_f32_16x16x64_bf16 v[54:57], v[46:49], a[88:95], v0
v_smfmac_f32_16x16x64_bf16 v[58:61], v[46:49], a[160:167], v0
buffer_load_dwordx4 v[14:17], v4, s[4:7], s33 offen offset:0 sc1
v_smfmac_f32_16x16x64_bf16 v[62:65], v[46:49], a[232:239], v0
ds_read_b128 v[46:49], v1 offset:7168
s_waitcnt lgkmcnt(2)
v_smfmac_f32_16x16x64_bf16 v[50:53], v[38:41], a[40:47], v0
buffer_load_dwordx4 v[30:33], v5, s[4:7], s32 offen offset:0 sc1
v_smfmac_f32_16x16x64_bf16 v[54:57], v[38:41], a[112:119], v0
v_smfmac_f32_16x16x64_bf16 v[58:61], v[38:41], a[184:191], v0
buffer_load_dwordx4 v[34:37], v5, s[4:7], s32 offen offset:2048 sc1
v_smfmac_f32_16x16x64_bf16 v[62:65], v[38:41], v[80:87], v0
ds_read_b128 v[38:41], v1 offset:8192
s_waitcnt lgkmcnt(2)
v_smfmac_f32_16x16x64_bf16 v[50:53], v[42:45], a[48:55], v0
v_smfmac_f32_16x16x64_bf16 v[54:57], v[42:45], a[120:127], v0
v_smfmac_f32_16x16x64_bf16 v[58:61], v[42:45], a[192:199], v0
v_smfmac_f32_16x16x64_bf16 v[62:65], v[42:45], v[88:95], v0
ds_read_b128 v[42:45], v1 offset:0
s_waitcnt lgkmcnt(2)
v_smfmac_f32_16x16x64_bf16 v[50:53], v[46:49], a[56:63], v0
v_smfmac_f32_16x16x64_bf16 v[54:57], v[46:49], a[128:135], v0
v_smfmac_f32_16x16x64_bf16 v[58:61], v[46:49], a[200:207], v0
v_smfmac_f32_16x16x64_bf16 v[62:65], v[46:49], v[96:103], v0
ds_read_b128 v[46:49], v1 offset:1024
s_waitcnt lgkmcnt(2)
v_smfmac_f32_16x16x64_bf16 v[50:53], v[38:41], a[64:71], v0
v_smfmac_f32_16x16x64_bf16 v[54:57], v[38:41], a[136:143], v0
v_smfmac_f32_16x16x64_bf16 v[58:61], v[38:41], a[208:215], v0
v_smfmac_f32_16x16x64_bf16 v[62:65], v[38:41], v[104:111], v0
ds_read_b128 v[38:41], v1 offset:2048
s_waitcnt lgkmcnt(2)
v_smfmac_f32_16x16x64_bf16 v[66:69], v[42:45], v[112:119], v0
v_smfmac_f32_16x16x64_bf16 v[70:73], v[42:45], v[184:191], v0
ds_read_b128 v[42:45], v1 offset:5120
v_add_f32 v50, v50, v52
v_add_f32 v51, v51, v53
v_add_f32 v54, v54, v56
v_add_f32 v55, v55, v57
v_cvt_pk_bf16_f32 v74, v50, v51
v_cvt_pk_bf16_f32 v75, v54, v55
ds_write2_b32 v2, v74, v75 offset0:0 offset1:128
v_add_f32 v58, v58, v60
v_add_f32 v59, v59, v61
v_add_f32 v62, v62, v64
v_add_f32 v63, v63, v65
v_cvt_pk_bf16_f32 v76, v58, v59
v_cvt_pk_bf16_f32 v77, v62, v63
ds_write_b32 v2, v76 offset:2048
ds_write_b32 v2, v77 offset:2560
s_waitcnt lgkmcnt(5)
v_smfmac_f32_16x16x64_bf16 v[66:69], v[46:49], v[120:127], v0
v_smfmac_f32_16x16x64_bf16 v[70:73], v[46:49], v[192:199], v0
ds_read_b128 v[46:49], v1 offset:6144
s_waitcnt lgkmcnt(5)
v_smfmac_f32_16x16x64_bf16 v[66:69], v[38:41], v[128:135], v0
v_smfmac_f32_16x16x64_bf16 v[70:73], v[38:41], v[200:207], v0
ds_read_b128 v[38:41], v1 offset:7168
s_waitcnt lgkmcnt(2)
s_waitcnt vmcnt(7)
s_barrier
ds_read_b64_tr_b16 v[50:51], v3 offset:1536
ds_read_b64_tr_b16 v[52:53], v3 offset:1664
ds_read_b64_tr_b16 v[54:55], v3 offset:3584
ds_read_b64_tr_b16 v[56:57], v3 offset:3712
s_waitcnt lgkmcnt(9)
v_smfmac_f32_16x16x64_bf16 v[66:69], v[42:45], v[152:159], v0
ds_read_b64_tr_b16 v[58:59], v3 offset:1024
ds_read_b64_tr_b16 v[60:61], v3 offset:1152
v_smfmac_f32_16x16x64_bf16 v[70:73], v[42:45], v[224:231], v0
ds_read_b128 v[42:45], v1 offset:8192
ds_read_b64_tr_b16 v[62:63], v3 offset:3072
ds_read_b64_tr_b16 v[64:65], v3 offset:3200
s_waitcnt lgkmcnt(10)
v_smfmac_f32_16x16x64_bf16 v[66:69], v[46:49], v[160:167], v0
ds_read_b64_tr_b16 v[74:75], v3 offset:512
ds_read_b64_tr_b16 v[76:77], v3 offset:640
v_smfmac_f32_16x16x64_bf16 v[70:73], v[46:49], v[232:239], v0
s_waitcnt lgkmcnt(11)
v_smfmac_f32_16x16x64_bf16 v[66:69], v[38:41], v[168:175], v0
v_smfmac_f32_16x16x64_bf16 v[70:73], v[38:41], v[240:247], v0
s_waitcnt lgkmcnt(4)
v_smfmac_f32_16x16x64_bf16 v[66:69], v[42:45], v[176:183], v0
v_smfmac_f32_16x16x64_bf16 v[70:73], v[42:45], v[248:255], v0
s_waitcnt lgkmcnt(7)
s_waitcnt vmcnt(5)
v_mfma_f32_16x16x32_bf16 v[42:45], v[22:25], v[50:53], 0
v_mfma_f32_16x16x32_bf16 v[46:49], v[26:29], v[50:53], 0
v_mfma_f32_16x16x32_bf16 v[38:41], v[54:57], v[50:53], 0
ds_read_b64_tr_b16 v[54:55], v3 offset:2560
ds_read_b64_tr_b16 v[56:57], v3 offset:2688
ds_read_b128 v[22:25], v1 offset:15360
ds_read_b64_tr_b16 v[50:51], v3 offset:0
ds_read_b64_tr_b16 v[52:53], v3 offset:128
ds_read_b128 v[26:29], v1 offset:13312
s_waitcnt lgkmcnt(8)
s_waitcnt vmcnt(2)
v_mfma_f32_16x16x32_bf16 v[42:45], v[14:17], v[58:61], v[42:45]
v_mfma_f32_16x16x32_bf16 v[46:49], v[18:21], v[58:61], v[46:49]
v_mfma_f32_16x16x32_bf16 v[38:41], v[62:65], v[58:61], v[38:41]
ds_read_b64_tr_b16 v[58:59], v3 offset:2048
ds_read_b64_tr_b16 v[60:61], v3 offset:2176
ds_read_b128 v[14:17], v1 offset:14336
ds_read_b64_tr_b16 v[62:63], v79 offset:2048
ds_read_b64_tr_b16 v[64:65], v79 offset:2176
s_waitcnt vmcnt(3)
s_waitcnt lgkmcnt(11)
v_mfma_f32_16x16x32_bf16 v[46:49], v[10:13], v[74:77], v[46:49]
v_add_f32 v70, v70, v72
v_add_f32 v71, v71, v73
s_waitcnt lgkmcnt(8)
v_mfma_f32_16x16x32_bf16 v[42:45], v[22:25], v[74:77], v[42:45]
v_add_f32 v66, v66, v68
v_add_f32 v67, v67, v69
s_waitcnt lgkmcnt(9)
v_mfma_f32_16x16x32_bf16 v[38:41], v[54:57], v[74:77], v[38:41]
v_cvt_pk_bf16_f32 v70, v70, v71
v_cvt_pk_bf16_f32 v72, v66, v67
s_waitcnt lgkmcnt(5)
v_mfma_f32_16x16x32_bf16 v[42:45], v[26:29], v[50:53], v[42:45]
v_mov_b32 v71, 0
v_mov_b32 v73, 0
s_waitcnt lgkmcnt(3)
v_mfma_f32_16x16x32_bf16 v[38:41], v[58:61], v[50:53], v[38:41]
v_mov_b64 v[74:75], s[78:79]
v_mov_b64 v[76:77], s[78:79]
s_waitcnt lgkmcnt(2)
v_mfma_f32_16x16x32_bf16 v[46:49], v[14:17], v[50:53], v[46:49]
s_add_u32 s3, s34, -154624
buffer_store_dword v72, v2, s[4:7], s3 offen sc1
buffer_store_dword v70, v2, s[4:7], s3 offen offset:512 sc1
s_waitcnt lgkmcnt(0)
buffer_store_dwordx4 v[62:65], v78, s[4:7], s34 offen sc1
s_cmp_eq_u32 s28, 63
s_cbranch_scc1 L_ch_end_s1
v_cndmask_b32_e64 v38, v38, v40, s[30:31]
v_cndmask_b32_e64 v39, v39, v41, s[30:31]
v_max3_f32 v50, v42, v43, v44
v_max3_f32 v51, v45, v46, v47
v_max3_f32 v52, v48, v49, v38
v_max3_f32 v50, v50, v51, v39
v_max_f32 v50, v50, v52
v_mov_b32 v51, v50
v_mov_b64 v[66:67], 0
v_mov_b32 v65, 0
v_permlane16_swap_b32 v50, v51
v_max_f32 v50, v50, v51
v_mov_b32 v51, v50
v_subrev_u32 v40, 147456, v1
s_nop 0
v_permlane32_swap_b32 v50, v51
v_max_f32 v50, v50, v51
v_mul_f32 v50, s49, v50
v_pk_fma_f32 v[42:43], v[42:43], s[50:51], v[50:51] op_sel_hi:[1,0,0]
v_pk_fma_f32 v[44:45], v[44:45], s[50:51], v[50:51] op_sel_hi:[1,0,0]
v_pk_fma_f32 v[46:47], v[46:47], s[50:51], v[50:51] op_sel_hi:[1,0,0]
v_pk_fma_f32 v[48:49], v[48:49], s[50:51], v[50:51] op_sel_hi:[1,0,0]
v_pk_fma_f32 v[38:39], v[38:39], s[50:51], v[50:51] op_sel_hi:[1,0,0]
v_exp_f32 v42, v42
v_exp_f32 v43, v43
v_exp_f32 v44, v44
v_exp_f32 v45, v45
v_exp_f32 v46, v46
v_exp_f32 v47, v47
v_exp_f32 v48, v48
v_exp_f32 v49, v49
v_cvt_pk_bf16_f32 v52, v42, v43
v_cvt_pk_bf16_f32 v53, v44, v45
v_cvt_pk_bf16_f32 v54, v46, v47
v_cvt_pk_bf16_f32 v55, v48, v49
s_waitcnt vmcnt(3)
s_nop 0
v_mfma_f32_16x16x32_bf16 v[42:45], v[74:77], v[52:55], 0
v_exp_f32 v38, v38
v_mfma_f32_16x16x32_bf16 v[56:59], v[30:33], v[52:55], 0
v_exp_f32 v39, v39
v_mfma_f32_16x16x32_bf16 v[60:63], v[34:37], v[52:55], 0
v_add_u32 v47, s68, v40
v_cvt_pk_bf16_f32 v64, v38, v39
s_nop 1
v_mfma_f32_16x16x32_bf16 v[42:45], v[74:77], v[64:67], v[42:45]
v_mfma_f32_16x16x32_bf16 v[56:59], v[72:75], v[64:67], v[56:59]
v_mfma_f32_16x16x32_bf16 v[60:63], v[70:73], v[64:67], v[60:63]
ds_read_b128 v[10:13], v47 offset:0
ds_read_b128 v[14:17], v47 offset:1024
ds_read_b128 v[18:21], v47 offset:8192
ds_read_b128 v[22:25], v47 offset:9216
v_rcp_f32 v42, v42
s_nop 0
v_pk_mul_f32 v[56:57], v[56:57], v[42:43] op_sel_hi:[1,0]
v_pk_mul_f32 v[58:59], v[58:59], v[42:43] op_sel_hi:[1,0]
v_pk_mul_f32 v[60:61], v[60:61], v[42:43] op_sel_hi:[1,0]
v_pk_mul_f32 v[62:63], v[62:63], v[42:43] op_sel_hi:[1,0]
v_cvt_pk_bf16_f32 v56, v56, v60
v_cvt_pk_bf16_f32 v57, v57, v61
v_cvt_pk_bf16_f32 v58, v58, v62
v_cvt_pk_bf16_f32 v59, v59, v63
ds_write_b128 v6, v[56:59]
ds_read_b128 v[26:29], v47 offset:2048
ds_read_b128 v[30:33], v47 offset:3072
v_mov_b64 v[72:73], 0
v_mov_b64 v[74:75], 0
v_mov_b64 v[42:43], 0
v_mov_b64 v[44:45], 0
v_mov_b64 v[60:61], 0
v_mov_b64 v[62:63], 0
ds_read_b128 v[48:51], v47 offset:10240
ds_read_b128 v[52:55], v47 offset:11264
s_waitcnt lgkmcnt(4)
s_barrier
ds_read_b128 v[34:37], v1
ds_read_b128 v[38:41], v1 offset:1024
ds_read_b128 v[64:67], v47 offset:4096
ds_read_b128 v[68:71], v47 offset:5120
v_mov_b64 v[56:57], 0
v_mov_b64 v[58:59], 0
s_mul_i32 s3, s22, 589824
s_and_b32 s73, s28, 1
s_mul_i32 s73, s73, 294912
s_add_u32 s72, s3, s73
s_add_u32 s72, s72, 3145728
s_add_u32 s39, s72, s77
s_add_u32 s41, s39, 32768
s_bfe_u32 s35, s28, 0x10001
s_waitcnt lgkmcnt(3)
s_waitcnt lgkmcnt(9)
v_smfmac_f32_16x16x64_bf16 v[56:59], v[34:37], v[10:17], v0
ds_read_b128 v[10:13], v47 offset:12288
ds_read_b128 v[14:17], v47 offset:13312
v_smfmac_f32_16x16x64_bf16 v[60:63], v[34:37], v[18:25], v0
ds_read_b128 v[18:21], v47 offset:6144
ds_read_b128 v[22:25], v47 offset:7168
s_waitcnt lgkmcnt(6)
s_waitcnt lgkmcnt(8)
v_smfmac_f32_16x16x64_bf16 v[56:59], v[38:41], v[26:33], v0
ds_read_b128 v[26:29], v47 offset:14336
ds_read_b128 v[30:33], v47 offset:15360
v_smfmac_f32_16x16x64_bf16 v[60:63], v[38:41], v[48:55], v0
ds_read_b128 v[48:51], v47 offset:16384
ds_read_b128 v[52:55], v47 offset:17408
s_waitcnt lgkmcnt(6)
v_smfmac_f32_16x16x64_bf16 v[72:75], v[34:37], v[64:71], v0
ds_read_b128 v[64:67], v47 offset:24576
ds_read_b128 v[68:71], v47 offset:25600
v_smfmac_f32_16x16x64_bf16 v[42:45], v[34:37], v[10:17], v0
ds_read_b128 v[10:13], v47 offset:18432
ds_read_b128 v[14:17], v47 offset:19456
v_add_f32 v56, v56, v58
v_add_f32 v57, v57, v59
v_add_f32 v60, v60, v62
s_waitcnt lgkmcnt(6)
v_smfmac_f32_16x16x64_bf16 v[72:75], v[38:41], v[18:25], v0
ds_read_b128 v[18:21], v47 offset:26624
ds_read_b128 v[22:25], v47 offset:27648
v_add_f32 v61, v61, v63
v_cvt_pk_bf16_f32 v76, v56, v60
v_cvt_pk_bf16_f32 v77, v57, v61
v_smfmac_f32_16x16x64_bf16 v[42:45], v[38:41], v[26:33], v0
ds_read_b128 v[26:29], v47 offset:20480
ds_read_b128 v[30:33], v47 offset:21504
v_mov_b64 v[56:57], 0
v_mov_b64 v[58:59], 0
v_mov_b64 v[60:61], 0
v_mov_b64 v[62:63], 0
s_waitcnt lgkmcnt(6)
v_smfmac_f32_16x16x64_bf16 v[56:59], v[34:37], v[48:55], v0
ds_read_b128 v[48:51], v47 offset:28672
ds_read_b128 v[52:55], v47 offset:29696
v_smfmac_f32_16x16x64_bf16 v[60:63], v[34:37], v[64:71], v0
ds_read_b128 v[64:67], v47 offset:22528
ds_read_b128 v[68:71], v47 offset:23552
v_add_f32 v72, v72, v74
v_add_f32 v73, v73, v75
v_add_f32 v42, v42, v44
s_waitcnt lgkmcnt(6)
v_smfmac_f32_16x16x64_bf16 v[56:59], v[38:41], v[10:17], v0
ds_read_b128 v[10:13], v47 offset:30720
ds_read_b128 v[14:17], v47 offset:31744
v_add_f32 v43, v43, v45
v_cvt_pk_bf16_f32 v78, v72, v42
v_cvt_pk_bf16_f32 v79, v73, v43
v_smfmac_f32_16x16x64_bf16 v[60:63], v[38:41], v[18:25], v0
v_bfi_b32 v79, 1, s35, v79
buffer_store_dwordx4 v[76:79], v7, s[4:7], s39 offen sc1
v_mov_b64 v[72:73], 0
v_mov_b64 v[74:75], 0
v_mov_b64 v[42:43], 0
v_mov_b64 v[44:45], 0
s_waitcnt lgkmcnt(4)
v_smfmac_f32_16x16x64_bf16 v[72:75], v[34:37], v[26:33], v0
v_smfmac_f32_16x16x64_bf16 v[42:45], v[34:37], v[48:55], v0
v_add_f32 v56, v56, v58
v_add_f32 v57, v57, v59
v_add_f32 v60, v60, v62
s_waitcnt lgkmcnt(0)
v_smfmac_f32_16x16x64_bf16 v[72:75], v[38:41], v[64:71], v0
v_add_f32 v61, v61, v63
v_cvt_pk_bf16_f32 v76, v56, v60
v_cvt_pk_bf16_f32 v77, v57, v61
v_smfmac_f32_16x16x64_bf16 v[42:45], v[38:41], v[10:17], v0
s_nop 3
v_add_f32 v72, v72, v74
v_add_f32 v73, v73, v75
s_nop 1
v_add_f32 v42, v42, v44
v_add_f32 v43, v43, v45
v_cvt_pk_bf16_f32 v78, v72, v42
v_cvt_pk_bf16_f32 v79, v73, v43
v_bfi_b32 v79, 1, s35, v79
buffer_store_dwordx4 v[76:79], v7, s[4:7], s41 offen sc1
s_add_u32 s29, s29, 9216
s_add_u32 s75, s75, 9216
s_add_u32 s32, s32, 0x80000
s_add_u32 s33, s33, 0x80000
s_add_u32 s36, s36, 2048
s_mov_b32 s37, s38
s_add_u32 s38, s38, 2048
s_add_u32 s34, s34, 0x20000
s_add_u32 s28, s28, 1
s_add_u32 s40, s72, s46
v_mov_b32 v42, s64
v_mov_b32 v43, s65
v_cndmask_b32_e64 v42, v42, v43, s[62:63]
v_cndmask_b32_e64 v38, 0, v42, s[54:55]
v_cndmask_b32_e64 v39, 0, v42, s[56:57]
v_cndmask_b32_e64 v40, 0, v42, s[58:59]
v_cndmask_b32_e64 v41, 0, v42, s[60:61]
s_mov_b32 s90, 0xff00ff00
s_mov_b32 s91, 0xff00ff00
s_mov_b32 s13, 0
s_waitcnt vmcnt(0)
L_rs_26:
buffer_load_dwordx4 v[48:51], v1, s[4:7], s40 offen offset:0 sc1
buffer_load_dwordx4 v[52:55], v1, s[4:7], s40 offen offset:1024 sc1
buffer_load_dwordx4 v[56:59], v1, s[4:7], s40 offen offset:2048 sc1
buffer_load_dwordx4 v[60:63], v1, s[4:7], s40 offen offset:3072 sc1
s_add_u32 s13, s13, 1
s_cmp_gt_u32 s13, 200000
s_cbranch_scc1 L_FAIL
s_waitcnt vmcnt(0)
v_mfma_f32_16x16x32_bf16 v[64:67], v[38:41], v[48:51], 0
v_bitop3_b32 v44, v51, v55, s35 bitop3:0x7e
v_mfma_f32_16x16x32_bf16 v[64:67], v[38:41], v[52:55], v[64:67]
v_bitop3_b32 v45, v59, v63, s35 bitop3:0x7e
v_mfma_f32_16x16x32_bf16 v[64:67], v[38:41], v[56:59], v[64:67]
v_bitop3_b32 v44, v44, v45, 1 bitop3:0xa8
v_mfma_f32_16x16x32_bf16 v[64:67], v[38:41], v[60:63], v[64:67]
v_cmp_ne_u32 vcc, 0, v44
s_nop 0
s_cbranch_vccnz L_rs_26
s_nop 4
v_add_f32_dpp v68, v64, v64 row_ror:8 row_mask:0xf bank_mask:0xf
v_add_f32_dpp v69, v65, v65 row_ror:8 row_mask:0xf bank_mask:0xf
v_add_f32_dpp v70, v66, v66 row_ror:8 row_mask:0xf bank_mask:0xf
v_add_f32_dpp v71, v67, v67 row_ror:8 row_mask:0xf bank_mask:0xf
v_cvt_pk_bf16_f32 v72, v68, v69
v_cvt_pk_bf16_f32 v73, v70, v71
v_cndmask_b32_e64 v72, v72, v73, s[90:91]
s_mov_b64 exec, s[52:53]
buffer_store_dword v72, v8, s[4:7], s44 offen sc1
s_mov_b64 exec, -1
s_add_u32 s44, s44, 9216
v_mov_b64 v[50:51], 0
v_mov_b64 v[52:53], 0
v_mov_b64 v[54:55], 0
v_mov_b64 v[56:57], 0
v_mov_b64 v[58:59], 0
v_mov_b64 v[60:61], 0
v_mov_b64 v[62:63], 0
v_mov_b64 v[64:65], 0
v_mov_b64 v[66:67], 0
v_mov_b64 v[68:69], 0
v_mov_b64 v[70:71], 0
v_mov_b64 v[72:73], 0
v_subrev_u32 v76, 147456, v1
v_and_b32 v78, 0x30, v76
v_bfe_u32 v75, v76, 7, 1
v_lshl_add_u32 v78, v75, 6, v78
v_lshrrev_b32 v76, 8, v76
v_lshl_add_u32 v78, v76, 7, v78
v_lshl_add_u32 v78, s20, 9, v78
s_lshl_b32 s3, s20, 9
v_add_u32 v79, s3, v3
v_add_u32 v77, s8, v1
s_nop 0
s_branch L_ch_top_s1
L_ch_end_s1:
s_nop 7
s_nop 7
s_waitcnt vmcnt(0)
s_mov_b32 s37, s38
s_mov_b64 exec, 1
v_mov_b32 v44, 1
buffer_atomic_add v44, off, s[4:7], s37 sc1
s_mov_b64 exec, -1
s_branch L_END
L_cls0s:
v_subrev_u32 v75, 147456, v1
v_and_b32 v75, 256, v75
v_lshlrev_b32 v75, 3, v75
s_mov_b32 s67, 0
L_w0f_28:
buffer_load_dword v8, v75, s[4:7], s36 offen sc1
s_add_u32 s67, s67, 1
s_cmp_gt_u32 s67, 200000
s_cbranch_scc1 L_FAIL
s_waitcnt vmcnt(0)
v_readlane_b32 s3, v8, 0
s_nop 0
s_cmp_ge_u32 s3, 2
s_nop 1
s_cbranch_scc0 L_w0f_28
v_readlane_b32 s3, v8, 16
s_add_u32 s66, s32, 0x80000
s_cmp_ge_u32 s3, 2
s_cselect_b32 s66, s66, 0x7ffee000
v_mov_b64 v[50:51], 0
v_mov_b64 v[52:53], 0
v_mov_b64 v[54:55], 0
v_mov_b64 v[56:57], 0
v_mov_b64 v[58:59], 0
v_mov_b64 v[60:61], 0
v_mov_b64 v[62:63], 0
v_mov_b64 v[64:65], 0
v_mov_b64 v[66:67], 0
v_mov_b64 v[68:69], 0
v_mov_b64 v[70:71], 0
v_mov_b64 v[72:73], 0
v_subrev_u32 v76, 147456, v1
v_and_b32 v78, 0x30, v76
v_bfe_u32 v75, v76, 7, 1
v_lshl_add_u32 v78, v75, 6, v78
v_lshrrev_b32 v76, 8, v76
v_lshl_add_u32 v78, v76, 7, v78
v_lshl_add_u32 v78, s20, 9, v78
s_lshl_b32 s3, s20, 9
v_add_u32 v79, s3, v3
v_add_u32 v77, s8, v1
ds_read_b128 v[10:13], v77 offset:0
ds_read_b128 v[14:17], v77 offset:1024
ds_read_b128 v[18:21], v77 offset:2048
s_waitcnt lgkmcnt(0)
s_branch L_ch_b1_s0
L_ch_top_s0:
s_barrier
s_mov_b32 s67, 0
L_ag_29:
buffer_load_dwordx4 v[10:13], v1, s[4:7], s29 offen offset:0 sc1
buffer_load_dwordx4 v[14:17], v1, s[4:7], s29 offen offset:1024 sc1
buffer_load_dwordx4 v[18:21], v1, s[4:7], s29 offen offset:2048 sc1
s_add_u32 s67, s67, 1
s_cmp_gt_u32 s67, 200000
s_cbranch_scc1 L_FAIL
s_waitcnt vmcnt(2)
ds_write_b128 v77, v[10:13] offset:0
s_waitcnt vmcnt(1)
ds_write_b128 v77, v[14:17] offset:1024
s_waitcnt vmcnt(0)
ds_write_b128 v77, v[18:21] offset:2048
v_max3_u32 v74, v10, v11, v12
v_max3_u32 v75, v13, v14, v15
v_max3_u32 v76, v16, v17, v18
v_max3_u32 v74, v74, v19, v20
v_max3_u32 v75, v75, v76, v21
v_max_u32 v74, v74, v75
v_cmp_eq_u32 vcc, -1, v74
s_nop 0
s_cbranch_vccnz L_ag_29
L_ch_b1_s0:
v_smfmac_f32_16x16x64_bf16 v[50:53], v[10:13], a[0:7], v0
v_smfmac_f32_16x16x64_bf16 v[54:57], v[10:13], a[72:79], v0
v_smfmac_f32_16x16x64_bf16 v[58:61], v[10:13], a[144:151], v0
v_smfmac_f32_16x16x64_bf16 v[62:65], v[10:13], a[216:223], v0
s_waitcnt lgkmcnt(0)
s_barrier
v_smfmac_f32_16x16x64_bf16 v[50:53], v[14:17], a[8:15], v0
ds_read_b128 v[38:41], v1 offset:3072
v_smfmac_f32_16x16x64_bf16 v[54:57], v[14:17], a[80:87], v0
ds_read_b128 v[42:45], v1 offset:4096
v_smfmac_f32_16x16x64_bf16 v[58:61], v[14:17], a[152:159], v0
ds_read_b128 v[46:49], v1 offset:5120
v_smfmac_f32_16x16x64_bf16 v[62:65], v[14:17], a[224:231], v0
s_mov_b32 m0, s11
s_add_u32 s3, s32, s48
v_smfmac_f32_16x16x64_bf16 v[50:53], v[18:21], a[16:23], v0
buffer_load_dwordx4 v4, s[4:7], s3 offen sc1 lds
v_smfmac_f32_16x16x64_bf16 v[54:57], v[18:21], a[88:95], v0
v_subrev_u32 v76, 147456, v1
v_lshlrev_b32 v76, 3, v76
v_smfmac_f32_16x16x64_bf16 v[58:61], v[18:21], a[160:167], v0
v_and_b32 v74, 0x380, v76
v_and_b32 v75, 0x800, v76
v_smfmac_f32_16x16x64_bf16 v[62:65], v[18:21], a[232:239], v0
buffer_load_dwordx4 v[22:25], v4, s[4:7], s33 offen offset:2048 sc1
s_waitcnt lgkmcnt(2)
v_smfmac_f32_16x16x64_bf16 v[50:53], v[38:41], a[24:31], v0
v_smfmac_f32_16x16x64_bf16 v[54:57], v[38:41], a[96:103], v0
v_smfmac_f32_16x16x64_bf16 v[58:61], v[38:41], a[168:175], v0
buffer_load_dwordx4 v[26:29], v4, s[4:7], s33 offen offset:2176 sc1
v_smfmac_f32_16x16x64_bf16 v[62:65], v[38:41], a[240:247], v0
ds_read_b128 v[38:41], v1 offset:6144
s_waitcnt lgkmcnt(2)
v_smfmac_f32_16x16x64_bf16 v[50:53], v[42:45], a[32:39], v0
v_smfmac_f32_16x16x64_bf16 v[54:57], v[42:45], a[104:111], v0
buffer_load_dwordx4 v[10:13], v4, s[4:7], s32 offen offset:2176 sc1
v_smfmac_f32_16x16x64_bf16 v[58:61], v[42:45], a[176:183], v0
v_smfmac_f32_16x16x64_bf16 v[62:65], v[42:45], a[248:255], v0
ds_read_b128 v[42:45], v1 offset:7168
s_waitcnt lgkmcnt(2)
v_smfmac_f32_16x16x64_bf16 v[50:53], v[46:49], a[40:47], v0
buffer_load_dwordx4 v[14:17], v4, s[4:7], s33 offen offset:0 sc1
v_smfmac_f32_16x16x64_bf16 v[54:57], v[46:49], a[112:119], v0
v_smfmac_f32_16x16x64_bf16 v[58:61], v[46:49], a[184:191], v0
buffer_load_dwordx4 v[18:21], v4, s[4:7], s33 offen offset:128 sc1
v_smfmac_f32_16x16x64_bf16 v[62:65], v[46:49], v[80:87], v0
ds_read_b128 v[46:49], v1 offset:8192
s_waitcnt lgkmcnt(2)
v_smfmac_f32_16x16x64_bf16 v[50:53], v[38:41], a[48:55], v0
buffer_load_dwordx4 v[30:33], v5, s[4:7], s32 offen offset:0 sc1
v_smfmac_f32_16x16x64_bf16 v[54:57], v[38:41], a[120:127], v0
v_smfmac_f32_16x16x64_bf16 v[58:61], v[38:41], a[192:199], v0
buffer_load_dwordx4 v[34:37], v5, s[4:7], s32 offen offset:2048 sc1
v_smfmac_f32_16x16x64_bf16 v[62:65], v[38:41], v[88:95], v0
ds_read_b128 v[38:41], v1 offset:0
s_waitcnt lgkmcnt(2)
v_smfmac_f32_16x16x64_bf16 v[50:53], v[42:45], a[56:63], v0
v_smfmac_f32_16x16x64_bf16 v[54:57], v[42:45], a[128:135], v0
v_smfmac_f32_16x16x64_bf16 v[58:61], v[42:45], a[200:207], v0
v_smfmac_f32_16x16x64_bf16 v[62:65], v[42:45], v[96:103], v0
ds_read_b128 v[42:45], v1 offset:1024
buffer_load_dword v9, v76, s[4:7], s66 offen sc1
s_waitcnt lgkmcnt(2)
v_smfmac_f32_16x16x64_bf16 v[50:53], v[46:49], a[64:71], v0
s_add_u32 s3, s66, 8192
buffer_load_dword v9, v76, s[4:7], s3 offen sc1
v_smfmac_f32_16x16x64_bf16 v[54:57], v[46:49], a[136:143], v0
buffer_load_dword v9, v76, s[4:7], s75 offen sc1
v_smfmac_f32_16x16x64_bf16 v[58:61], v[46:49], a[208:215], v0
s_add_u32 s3, s75, 8192
buffer_load_dword v9, v74, s[4:7], s3 offen sc1
v_smfmac_f32_16x16x64_bf16 v[62:65], v[46:49], v[104:111], v0
ds_read_b128 v[46:49], v1 offset:2048
buffer_load_dword v8, v75, s[4:7], s36 offen offset:2048 sc1
s_mov_b64 exec, 1
v_mov_b32 v77, 4
buffer_atomic_add v77, off, s[4:7], s37 sc1
s_mov_b64 exec, -1
s_waitcnt lgkmcnt(2)
v_smfmac_f32_16x16x64_bf16 v[66:69], v[38:41], v[112:119], v0
v_smfmac_f32_16x16x64_bf16 v[70:73], v[38:41], v[184:191], v0
ds_read_b128 v[38:41], v1 offset:3072
v_add_f32 v50, v50, v52
v_add_f32 v51, v51, v53
v_add_f32 v54, v54, v56
v_add_f32 v55, v55, v57
v_cvt_pk_bf16_f32 v74, v50, v51
v_cvt_pk_bf16_f32 v75, v54, v55
ds_write2_b32 v2, v74, v75 offset0:0 offset1:128
v_add_f32 v58, v58, v60
v_add_f32 v59, v59, v61
v_add_f32 v62, v62, v64
v_add_f32 v63, v63, v65
v_cvt_pk_bf16_f32 v76, v58, v59
v_cvt_pk_bf16_f32 v77, v62, v63
ds_write_b32 v2, v76 offset:2048
ds_write_b32 v2, v77 offset:2560
s_waitcnt lgkmcnt(5)
v_smfmac_f32_16x16x64_bf16 v[66:69], v[42:45], v[120:127], v0
v_smfmac_f32_16x16x64_bf16 v[70:73], v[42:45], v[192:199], v0
ds_read_b128 v[42:45], v1 offset:4096
s_waitcnt lgkmcnt(5)
v_smfmac_f32_16x16x64_bf16 v[66:69], v[46:49], v[128:135], v0
v_smfmac_f32_16x16x64_bf16 v[70:73], v[46:49], v[200:207], v0
ds_read_b128 v[46:49], v1 offset:5120
s_waitcnt lgkmcnt(2)
s_waitcnt vmcnt(13)
s_barrier
ds_read_b64_tr_b16 v[50:51], v3 offset:1536
ds_read_b64_tr_b16 v[52:53], v3 offset:1664
ds_read_b64_tr_b16 v[54:55], v3 offset:3584
ds_read_b64_tr_b16 v[56:57], v3 offset:3712
s_waitcnt lgkmcnt(9)
v_smfmac_f32_16x16x64_bf16 v[66:69], v[38:41], v[136:143], v0
ds_read_b64_tr_b16 v[58:59], v3 offset:1024
ds_read_b64_tr_b16 v[60:61], v3 offset:1152
v_smfmac_f32_16x16x64_bf16 v[70:73], v[38:41], v[208:215], v0
ds_read_b128 v[38:41], v1 offset:6144
ds_read_b64_tr_b16 v[62:63], v3 offset:3072
ds_read_b64_tr_b16 v[64:65], v3 offset:3200
s_waitcnt lgkmcnt(10)
v_smfmac_f32_16x16x64_bf16 v[66:69], v[42:45], v[144:151], v0
ds_read_b64_tr_b16 v[74:75], v3 offset:512
ds_read_b64_tr_b16 v[76:77], v3 offset:640
v_smfmac_f32_16x16x64_bf16 v[70:73], v[42:45], v[216:223], v0
ds_read_b128 v[42:45], v1 offset:7168
s_waitcnt lgkmcnt(12)
v_smfmac_f32_16x16x64_bf16 v[66:69], v[46:49], v[152:159], v0
v_smfmac_f32_16x16x64_bf16 v[70:73], v[46:49], v[224:231], v0
ds_read_b128 v[46:49], v1 offset:8192
s_waitcnt lgkmcnt(6)
v_smfmac_f32_16x16x64_bf16 v[66:69], v[38:41], v[160:167], v0
v_smfmac_f32_16x16x64_bf16 v[70:73], v[38:41], v[232:239], v0
s_waitcnt lgkmcnt(1)
v_smfmac_f32_16x16x64_bf16 v[66:69], v[42:45], v[168:175], v0
v_smfmac_f32_16x16x64_bf16 v[70:73], v[42:45], v[240:247], v0
s_waitcnt lgkmcnt(0)
v_smfmac_f32_16x16x64_bf16 v[66:69], v[46:49], v[176:183], v0
v_smfmac_f32_16x16x64_bf16 v[70:73], v[46:49], v[248:255], v0
s_waitcnt lgkmcnt(9)
s_waitcnt vmcnt(11)
v_mfma_f32_16x16x32_bf16 v[42:45], v[22:25], v[50:53], 0
v_mfma_f32_16x16x32_bf16 v[46:49], v[26:29], v[50:53], 0
v_mfma_f32_16x16x32_bf16 v[38:41], v[54:57], v[50:53], 0
ds_read_b64_tr_b16 v[54:55], v3 offset:2560
ds_read_b64_tr_b16 v[56:57], v3 offset:2688
ds_read_b128 v[22:25], v1 offset:15360
ds_read_b64_tr_b16 v[50:51], v3 offset:0
ds_read_b64_tr_b16 v[52:53], v3 offset:128
ds_read_b128 v[26:29], v1 offset:13312
s_waitcnt lgkmcnt(10)
s_waitcnt vmcnt(8)
v_mfma_f32_16x16x32_bf16 v[42:45], v[14:17], v[58:61], v[42:45]
v_mfma_f32_16x16x32_bf16 v[46:49], v[18:21], v[58:61], v[46:49]
v_mfma_f32_16x16x32_bf16 v[38:41], v[62:65], v[58:61], v[38:41]
ds_read_b64_tr_b16 v[58:59], v3 offset:2048
ds_read_b64_tr_b16 v[60:61], v3 offset:2176
ds_read_b128 v[14:17], v1 offset:14336
ds_read_b64_tr_b16 v[62:63], v79 offset:2048
ds_read_b64_tr_b16 v[64:65], v79 offset:2176
s_waitcnt vmcnt(10)
s_waitcnt lgkmcnt(13)
v_mfma_f32_16x16x32_bf16 v[46:49], v[10:13], v[74:77], v[46:49]
v_add_f32 v70, v70, v72
v_add_f32 v71, v71, v73
s_waitcnt lgkmcnt(8)
v_mfma_f32_16x16x32_bf16 v[42:45], v[22:25], v[74:77], v[42:45]
v_add_f32 v66, v66, v68
v_add_f32 v67, v67, v69
s_waitcnt lgkmcnt(9)
v_mfma_f32_16x16x32_bf16 v[38:41], v[54:57], v[74:77], v[38:41]
v_cvt_pk_bf16_f32 v70, v70, v71
v_cvt_pk_bf16_f32 v72, v66, v67
s_waitcnt lgkmcnt(5)
v_mfma_f32_16x16x32_bf16 v[42:45], v[26:29], v[50:53], v[42:45]
v_mov_b32 v71, 0
v_mov_b32 v73, 0
s_waitcnt lgkmcnt(3)
v_mfma_f32_16x16x32_bf16 v[38:41], v[58:61], v[50:53], v[38:41]
v_mov_b64 v[74:75], s[78:79]
v_mov_b64 v[76:77], s[78:79]
s_waitcnt lgkmcnt(2)
v_mfma_f32_16x16x32_bf16 v[46:49], v[14:17], v[50:53], v[46:49]
s_add_u32 s3, s34, -154624
buffer_store_dword v72, v2, s[4:7], s3 offen sc1
buffer_store_dword v70, v2, s[4:7], s3 offen offset:512 sc1
s_waitcnt lgkmcnt(0)
buffer_store_dwordx4 v[62:65], v78, s[4:7], s34 offen sc1
s_cmp_eq_u32 s28, 63
s_cbranch_scc1 L_ch_end_s0
v_cndmask_b32_e64 v38, v38, v40, s[30:31]
v_cndmask_b32_e64 v39, v39, v41, s[30:31]
v_max3_f32 v50, v42, v43, v44
v_max3_f32 v51, v45, v46, v47
v_max3_f32 v52, v48, v49, v38
v_max3_f32 v50, v50, v51, v39
v_max_f32 v50, v50, v52
v_mov_b32 v51, v50
v_mov_b64 v[66:67], 0
v_mov_b32 v65, 0
v_permlane16_swap_b32 v50, v51
v_max_f32 v50, v50, v51
v_mov_b32 v51, v50
v_subrev_u32 v40, 147456, v1
s_nop 0
v_permlane32_swap_b32 v50, v51
v_max_f32 v50, v50, v51
v_mul_f32 v50, s49, v50
v_pk_fma_f32 v[42:43], v[42:43], s[50:51], v[50:51] op_sel_hi:[1,0,0]
v_pk_fma_f32 v[44:45], v[44:45], s[50:51], v[50:51] op_sel_hi:[1,0,0]
v_pk_fma_f32 v[46:47], v[46:47], s[50:51], v[50:51] op_sel_hi:[1,0,0]
v_pk_fma_f32 v[48:49], v[48:49], s[50:51], v[50:51] op_sel_hi:[1,0,0]
v_pk_fma_f32 v[38:39], v[38:39], s[50:51], v[50:51] op_sel_hi:[1,0,0]
v_exp_f32 v42, v42
v_exp_f32 v43, v43
v_exp_f32 v44, v44
v_exp_f32 v45, v45
v_exp_f32 v46, v46
v_exp_f32 v47, v47
v_exp_f32 v48, v48
v_exp_f32 v49, v49
v_cvt_pk_bf16_f32 v52, v42, v43
v_cvt_pk_bf16_f32 v53, v44, v45
v_cvt_pk_bf16_f32 v54, v46, v47
v_cvt_pk_bf16_f32 v55, v48, v49
s_waitcnt vmcnt(9)
s_nop 0
v_mfma_f32_16x16x32_bf16 v[42:45], v[74:77], v[52:55], 0
v_exp_f32 v38, v38
v_mfma_f32_16x16x32_bf16 v[56:59], v[30:33], v[52:55], 0
v_exp_f32 v39, v39
v_mfma_f32_16x16x32_bf16 v[60:63], v[34:37], v[52:55], 0
v_add_u32 v47, s68, v40
v_cvt_pk_bf16_f32 v64, v38, v39
v_add_u32 v46, 0x20000, v40
s_nop 0
v_mfma_f32_16x16x32_bf16 v[42:45], v[74:77], v[64:67], v[42:45]
v_mfma_f32_16x16x32_bf16 v[56:59], v[72:75], v[64:67], v[56:59]
v_mfma_f32_16x16x32_bf16 v[60:63], v[70:73], v[64:67], v[60:63]
ds_read_b128 v[10:13], v47 offset:0
ds_read_b128 v[14:17], v47 offset:1024
ds_read_b128 v[18:21], v47 offset:8192
ds_read_b128 v[22:25], v47 offset:9216
v_rcp_f32 v42, v42
s_nop 0
v_pk_mul_f32 v[56:57], v[56:57], v[42:43] op_sel_hi:[1,0]
v_pk_mul_f32 v[58:59], v[58:59], v[42:43] op_sel_hi:[1,0]
v_pk_mul_f32 v[60:61], v[60:61], v[42:43] op_sel_hi:[1,0]
v_pk_mul_f32 v[62:63], v[62:63], v[42:43] op_sel_hi:[1,0]
v_cvt_pk_bf16_f32 v56, v56, v60
v_cvt_pk_bf16_f32 v57, v57, v61
v_cvt_pk_bf16_f32 v58, v58, v62
v_cvt_pk_bf16_f32 v59, v59, v63
ds_write_b128 v6, v[56:59]
ds_read_b128 v[26:29], v47 offset:2048
ds_read_b128 v[30:33], v47 offset:3072
v_mov_b64 v[72:73], 0
v_mov_b64 v[74:75], 0
v_mov_b64 v[42:43], 0
v_mov_b64 v[44:45], 0
v_mov_b64 v[60:61], 0
v_mov_b64 v[62:63], 0
ds_read_b128 v[48:51], v47 offset:10240
ds_read_b128 v[52:55], v47 offset:11264
s_waitcnt lgkmcnt(4)
s_barrier
ds_read_b128 v[34:37], v1
ds_read_b128 v[38:41], v1 offset:1024
ds_read_b128 v[64:67], v47 offset:4096
ds_read_b128 v[68:71], v47 offset:5120
v_mov_b64 v[56:57], 0
v_mov_b64 v[58:59], 0
s_mul_i32 s3, s22, 589824
s_and_b32 s73, s28, 1
s_mul_i32 s73, s73, 294912
s_add_u32 s72, s3, s73
s_add_u32 s72, s72, 3145728
s_add_u32 s39, s72, s77
s_add_u32 s41, s39, 32768
s_bfe_u32 s35, s28, 0x10001
s_add_u32 s10, s72, s9
s_waitcnt lgkmcnt(3)
s_waitcnt lgkmcnt(9)
v_smfmac_f32_16x16x64_bf16 v[56:59], v[34:37], v[10:17], v0
ds_read_b128 v[10:13], v47 offset:12288
ds_read_b128 v[14:17], v47 offset:13312
v_smfmac_f32_16x16x64_bf16 v[60:63], v[34:37], v[18:25], v0
ds_read_b128 v[18:21], v47 offset:6144
ds_read_b128 v[22:25], v47 offset:7168
s_waitcnt lgkmcnt(6)
s_waitcnt lgkmcnt(8)
v_smfmac_f32_16x16x64_bf16 v[56:59], v[38:41], v[26:33], v0
ds_read_b128 v[26:29], v47 offset:14336
ds_read_b128 v[30:33], v47 offset:15360
v_smfmac_f32_16x16x64_bf16 v[60:63], v[38:41], v[48:55], v0
ds_read_b128 v[48:51], v47 offset:16384
ds_read_b128 v[52:55], v47 offset:17408
s_waitcnt lgkmcnt(6)
v_smfmac_f32_16x16x64_bf16 v[72:75], v[34:37], v[64:71], v0
ds_read_b128 v[64:67], v47 offset:24576
ds_read_b128 v[68:71], v47 offset:25600
v_smfmac_f32_16x16x64_bf16 v[42:45], v[34:37], v[10:17], v0
ds_read_b128 v[10:13], v47 offset:18432
ds_read_b128 v[14:17], v47 offset:19456
v_add_f32 v56, v56, v58
v_add_f32 v57, v57, v59
v_add_f32 v60, v60, v62
s_waitcnt lgkmcnt(6)
v_smfmac_f32_16x16x64_bf16 v[72:75], v[38:41], v[18:25], v0
ds_read_b128 v[18:21], v47 offset:26624
ds_read_b128 v[22:25], v47 offset:27648
v_add_f32 v61, v61, v63
v_cvt_pk_bf16_f32 v76, v56, v60
v_cvt_pk_bf16_f32 v77, v57, v61
v_smfmac_f32_16x16x64_bf16 v[42:45], v[38:41], v[26:33], v0
ds_read_b128 v[26:29], v47 offset:20480
ds_read_b128 v[30:33], v47 offset:21504
v_mov_b64 v[56:57], 0
v_mov_b64 v[58:59], 0
v_mov_b64 v[60:61], 0
v_mov_b64 v[62:63], 0
s_waitcnt lgkmcnt(6)
v_smfmac_f32_16x16x64_bf16 v[56:59], v[34:37], v[48:55], v0
ds_read_b128 v[48:51], v47 offset:28672
ds_read_b128 v[52:55], v47 offset:29696
v_smfmac_f32_16x16x64_bf16 v[60:63], v[34:37], v[64:71], v0
ds_read_b128 v[64:67], v47 offset:22528
ds_read_b128 v[68:71], v47 offset:23552
v_add_f32 v72, v72, v74
v_add_f32 v73, v73, v75
v_add_f32 v42, v42, v44
s_waitcnt lgkmcnt(6)
v_smfmac_f32_16x16x64_bf16 v[56:59], v[38:41], v[10:17], v0
ds_read_b128 v[10:13], v47 offset:30720
ds_read_b128 v[14:17], v47 offset:31744
v_add_f32 v43, v43, v45
v_cvt_pk_bf16_f32 v78, v72, v42
v_cvt_pk_bf16_f32 v79, v73, v43
v_smfmac_f32_16x16x64_bf16 v[60:63], v[38:41], v[18:25], v0
ds_read_b128 v[18:21], v46 offset:0
ds_read_b128 v[22:25], v46 offset:1024
v_bfi_b32 v79, 1, s35, v79
buffer_store_dwordx4 v[76:79], v7, s[4:7], s39 offen sc1
v_mov_b64 v[72:73], 0
v_mov_b64 v[74:75], 0
v_mov_b64 v[42:43], 0
v_mov_b64 v[44:45], 0
s_waitcnt lgkmcnt(6)
v_smfmac_f32_16x16x64_bf16 v[72:75], v[34:37], v[26:33], v0
ds_read_b128 v[26:29], v46 offset:8192
ds_read_b128 v[30:33], v46 offset:9216
v_smfmac_f32_16x16x64_bf16 v[42:45], v[34:37], v[48:55], v0
ds_read_b128 v[48:51], v46 offset:2048
ds_read_b128 v[52:55], v46 offset:3072
v_add_f32 v56, v56, v58
v_add_f32 v57, v57, v59
v_add_f32 v60, v60, v62
s_waitcnt lgkmcnt(6)
v_smfmac_f32_16x16x64_bf16 v[72:75], v[38:41], v[64:71], v0
ds_read_b128 v[64:67], v46 offset:10240
ds_read_b128 v[68:71], v46 offset:11264
v_add_f32 v61, v61, v63
v_cvt_pk_bf16_f32 v76, v56, v60
v_cvt_pk_bf16_f32 v77, v57, v61
v_smfmac_f32_16x16x64_bf16 v[42:45], v[38:41], v[10:17], v0
v_mov_b64 v[56:57], 0
v_mov_b64 v[58:59], 0
v_mov_b64 v[60:61], 0
v_mov_b64 v[62:63], 0
s_waitcnt lgkmcnt(4)
v_smfmac_f32_16x16x64_bf16 v[56:59], v[34:37], v[18:25], v0
v_smfmac_f32_16x16x64_bf16 v[60:63], v[34:37], v[26:33], v0
v_and_b32 v46, 0x70, v7
v_lshrrev_b32 v46, 1, v46
v_sub_u32 v46, v7, v46
s_waitcnt lgkmcnt(0)
v_smfmac_f32_16x16x64_bf16 v[56:59], v[38:41], v[48:55], v0
v_add_f32 v72, v72, v74
v_add_f32 v73, v73, v75
v_add_f32 v42, v42, v44
v_smfmac_f32_16x16x64_bf16 v[60:63], v[38:41], v[64:71], v0
v_add_f32 v43, v43, v45
v_cvt_pk_bf16_f32 v78, v72, v42
v_cvt_pk_bf16_f32 v79, v73, v43
v_bfi_b32 v79, 1, s35, v79
buffer_store_dwordx4 v[76:79], v7, s[4:7], s41 offen sc1
v_add_f32 v56, v56, v58
v_add_f32 v57, v57, v59
s_nop 0
v_add_f32 v60, v60, v62
v_add_f32 v61, v61, v63
v_cvt_pk_bf16_f32 v76, v56, v60
v_cvt_pk_bf16_f32 v77, v57, v61
v_bfi_b32 v77, 1, s35, v77
buffer_store_dwordx2 v[76:77], v46, s[4:7], s10 offen sc1
s_add_u32 s29, s29, 9216
s_add_u32 s75, s75, 9216
s_add_u32 s32, s32, 0x80000
s_add_u32 s33, s33, 0x80000
s_add_u32 s36, s36, 2048
s_mov_b32 s37, s38
s_add_u32 s38, s38, 2048
s_add_u32 s34, s34, 0x20000
s_add_u32 s28, s28, 1
s_waitcnt vmcnt(3)
v_readlane_b32 s3, v8, 0
s_nop 0
s_cmp_ge_u32 s3, 2
s_nop 1
s_cbranch_scc1 L_w0ok_31
v_subrev_u32 v75, 147456, v1
v_and_b32 v75, 256, v75
v_lshlrev_b32 v75, 3, v75
s_mov_b32 s67, 0
L_w0f_32:
buffer_load_dword v8, v75, s[4:7], s36 offen sc1
s_add_u32 s67, s67, 1
s_cmp_gt_u32 s67, 200000
s_cbranch_scc1 L_FAIL
s_waitcnt vmcnt(0)
v_readlane_b32 s3, v8, 0
s_nop 0
s_cmp_ge_u32 s3, 2
s_nop 1
s_cbranch_scc0 L_w0f_32
L_w0ok_31:
v_readlane_b32 s3, v8, 16
s_add_u32 s66, s32, 0x80000
s_cmp_ge_u32 s3, 2
s_cselect_b32 s66, s66, 0x7ffee000
v_mov_b64 v[50:51], 0
v_mov_b64 v[52:53], 0
v_mov_b64 v[54:55], 0
v_mov_b64 v[56:57], 0
v_mov_b64 v[58:59], 0
v_mov_b64 v[60:61], 0
v_mov_b64 v[62:63], 0
v_mov_b64 v[64:65], 0
v_mov_b64 v[66:67], 0
v_mov_b64 v[68:69], 0
v_mov_b64 v[70:71], 0
v_mov_b64 v[72:73], 0
v_subrev_u32 v76, 147456, v1
v_and_b32 v78, 0x30, v76
v_bfe_u32 v75, v76, 7, 1
v_lshl_add_u32 v78, v75, 6, v78
v_lshrrev_b32 v76, 8, v76
v_lshl_add_u32 v78, v76, 7, v78
v_lshl_add_u32 v78, s20, 9, v78
s_lshl_b32 s3, s20, 9
v_add_u32 v79, s3, v3
v_add_u32 v77, s8, v1
s_nop 0
s_branch L_ch_top_s0
L_ch_end_s0:
s_nop 7
s_nop 7
s_waitcnt vmcnt(0)
s_mov_b32 s37, s38
s_mov_b64 exec, 1
v_mov_b32 v44, 1
buffer_atomic_add v44, off, s[4:7], s37 sc1
s_mov_b64 exec, -1
s_branch L_END
L_cls2s:
v_mov_b64 v[50:51], 0
v_mov_b64 v[52:53], 0
v_mov_b64 v[54:55], 0
v_mov_b64 v[56:57], 0
v_mov_b64 v[58:59], 0
v_mov_b64 v[60:61], 0
v_mov_b64 v[62:63], 0
v_mov_b64 v[64:65], 0
v_mov_b64 v[66:67], 0
v_mov_b64 v[68:69], 0
v_mov_b64 v[70:71], 0
v_mov_b64 v[72:73], 0
v_subrev_u32 v76, 147456, v1
v_and_b32 v78, 0x30, v76
v_bfe_u32 v75, v76, 7, 1
v_lshl_add_u32 v78, v75, 6, v78
v_lshrrev_b32 v76, 8, v76
v_lshl_add_u32 v78, v76, 7, v78
v_lshl_add_u32 v78, s20, 9, v78
s_lshl_b32 s3, s20, 9
v_add_u32 v79, s3, v3
v_add_u32 v77, s8, v1
ds_read_b128 v[10:13], v77 offset:0
ds_read_b128 v[14:17], v77 offset:1024
s_waitcnt lgkmcnt(0)
s_branch L_ch_b1_s2
L_ch_top_s2:
s_barrier
s_mov_b32 s67, 0
L_ag_33:
buffer_load_dwordx4 v[10:13], v1, s[4:7], s29 offen offset:0 sc1
buffer_load_dwordx4 v[14:17], v1, s[4:7], s29 offen offset:1024 sc1
s_add_u32 s67, s67, 1
s_cmp_gt_u32 s67, 200000
s_cbranch_scc1 L_FAIL
s_waitcnt vmcnt(1)
ds_write_b128 v77, v[10:13] offset:0
s_waitcnt vmcnt(0)
ds_write_b128 v77, v[14:17] offset:1024
v_max3_u32 v74, v10, v11, v12
v_max3_u32 v75, v13, v14, v15
v_max3_u32 v74, v74, v16, v17
v_max3_u32 v74, v74, v75, v75
v_cmp_eq_u32 vcc, -1, v74
s_nop 0
s_cbranch_vccnz L_ag_33
L_ch_b1_s2:
v_smfmac_f32_16x16x64_bf16 v[50:53], v[10:13], a[40:47], v0
v_smfmac_f32_16x16x64_bf16 v[54:57], v[10:13], a[112:119], v0
v_smfmac_f32_16x16x64_bf16 v[58:61], v[10:13], a[184:191], v0
v_smfmac_f32_16x16x64_bf16 v[62:65], v[10:13], v[80:87], v0
s_waitcnt lgkmcnt(0)
s_barrier
v_smfmac_f32_16x16x64_bf16 v[50:53], v[14:17], a[48:55], v0
ds_read_b128 v[38:41], v1 offset:0
v_smfmac_f32_16x16x64_bf16 v[54:57], v[14:17], a[120:127], v0
ds_read_b128 v[42:45], v1 offset:1024
v_smfmac_f32_16x16x64_bf16 v[58:61], v[14:17], a[192:199], v0
ds_read_b128 v[46:49], v1 offset:2048
v_smfmac_f32_16x16x64_bf16 v[62:65], v[14:17], v[88:95], v0
s_mov_b32 m0, s11
s_add_u32 s3, s32, s48
v_smfmac_f32_16x16x64_bf16 v[66:69], v[10:13], v[152:159], v0
v_smfmac_f32_16x16x64_bf16 v[70:73], v[10:13], v[224:231], v0
buffer_load_dwordx4 v4, s[4:7], s3 offen sc1 lds
v_smfmac_f32_16x16x64_bf16 v[66:69], v[14:17], v[160:167], v0
v_smfmac_f32_16x16x64_bf16 v[70:73], v[14:17], v[232:239], v0
s_waitcnt lgkmcnt(2)
v_smfmac_f32_16x16x64_bf16 v[50:53], v[38:41], a[0:7], v0
buffer_load_dwordx4 v[22:25], v4, s[4:7], s33 offen offset:2048 sc1
v_smfmac_f32_16x16x64_bf16 v[54:57], v[38:41], a[72:79], v0
v_smfmac_f32_16x16x64_bf16 v[58:61], v[38:41], a[144:151], v0
v_smfmac_f32_16x16x64_bf16 v[62:65], v[38:41], a[216:223], v0
ds_read_b128 v[38:41], v1 offset:3072
buffer_load_dwordx4 v[26:29], v4, s[4:7], s33 offen offset:2176 sc1
s_waitcnt lgkmcnt(2)
v_smfmac_f32_16x16x64_bf16 v[50:53], v[42:45], a[8:15], v0
v_smfmac_f32_16x16x64_bf16 v[54:57], v[42:45], a[80:87], v0
v_smfmac_f32_16x16x64_bf16 v[58:61], v[42:45], a[152:159], v0
buffer_load_dwordx4 v[18:21], v4, s[4:7], s33 offen offset:128 sc1
v_smfmac_f32_16x16x64_bf16 v[62:65], v[42:45], a[224:231], v0
ds_read_b128 v[42:45], v1 offset:4096
s_waitcnt lgkmcnt(2)
v_smfmac_f32_16x16x64_bf16 v[50:53], v[46:49], a[16:23], v0
v_smfmac_f32_16x16x64_bf16 v[54:57], v[46:49], a[88:95], v0
buffer_load_dwordx4 v[10:13], v4, s[4:7], s32 offen offset:2176 sc1
v_smfmac_f32_16x16x64_bf16 v[58:61], v[46:49], a[160:167], v0
v_smfmac_f32_16x16x64_bf16 v[62:65], v[46:49], a[232:239], v0
ds_read_b128 v[46:49], v1 offset:7168
buffer_load_dwordx4 v[14:17], v4, s[4:7], s33 offen offset:0 sc1
s_waitcnt lgkmcnt(2)
v_smfmac_f32_16x16x64_bf16 v[50:53], v[38:41], a[24:31], v0
v_smfmac_f32_16x16x64_bf16 v[54:57], v[38:41], a[96:103], v0
buffer_load_dwordx4 v[30:33], v5, s[4:7], s32 offen offset:0 sc1
v_smfmac_f32_16x16x64_bf16 v[58:61], v[38:41], a[168:175], v0
v_smfmac_f32_16x16x64_bf16 v[62:65], v[38:41], a[240:247], v0
ds_read_b128 v[38:41], v1 offset:8192
buffer_load_dwordx4 v[34:37], v5, s[4:7], s32 offen offset:2048 sc1
s_waitcnt lgkmcnt(2)
v_smfmac_f32_16x16x64_bf16 v[50:53], v[42:45], a[32:39], v0
v_smfmac_f32_16x16x64_bf16 v[54:57], v[42:45], a[104:111], v0
v_smfmac_f32_16x16x64_bf16 v[58:61], v[42:45], a[176:183], v0
v_smfmac_f32_16x16x64_bf16 v[62:65], v[42:45], a[248:255], v0
ds_read_b128 v[42:45], v1 offset:0
s_waitcnt lgkmcnt(2)
v_smfmac_f32_16x16x64_bf16 v[50:53], v[46:49], a[56:63], v0
v_smfmac_f32_16x16x64_bf16 v[54:57], v[46:49], a[128:135], v0
v_smfmac_f32_16x16x64_bf16 v[58:61], v[46:49], a[200:207], v0
v_smfmac_f32_16x16x64_bf16 v[62:65], v[46:49], v[96:103], v0
ds_read_b128 v[46:49], v1 offset:1024
s_waitcnt lgkmcnt(2)
v_smfmac_f32_16x16x64_bf16 v[50:53], v[38:41], a[64:71], v0
v_smfmac_f32_16x16x64_bf16 v[54:57], v[38:41], a[136:143], v0
v_smfmac_f32_16x16x64_bf16 v[58:61], v[38:41], a[208:215], v0
v_smfmac_f32_16x16x64_bf16 v[62:65], v[38:41], v[104:111], v0
ds_read_b128 v[38:41], v1 offset:2048
s_waitcnt lgkmcnt(2)
v_smfmac_f32_16x16x64_bf16 v[66:69], v[42:45], v[112:119], v0
v_smfmac_f32_16x16x64_bf16 v[70:73], v[42:45], v[184:191], v0
ds_read_b128 v[42:45], v1 offset:3072
v_add_f32 v50, v50, v52
v_add_f32 v51, v51, v53
v_add_f32 v54, v54, v56
v_add_f32 v55, v55, v57
v_cvt_pk_bf16_f32 v74, v50, v51
v_cvt_pk_bf16_f32 v75, v54, v55
ds_write2_b32 v2, v74, v75 offset0:0 offset1:128
v_add_f32 v58, v58, v60
v_add_f32 v59, v59, v61
v_add_f32 v62, v62, v64
v_add_f32 v63, v63, v65
v_cvt_pk_bf16_f32 v76, v58, v59
v_cvt_pk_bf16_f32 v77, v62, v63
ds_write_b32 v2, v76 offset:2048
ds_write_b32 v2, v77 offset:2560
s_waitcnt lgkmcnt(5)
v_smfmac_f32_16x16x64_bf16 v[66:69], v[46:49], v[120:127], v0
v_smfmac_f32_16x16x64_bf16 v[70:73], v[46:49], v[192:199], v0
ds_read_b128 v[46:49], v1 offset:4096
s_waitcnt lgkmcnt(5)
v_smfmac_f32_16x16x64_bf16 v[66:69], v[38:41], v[128:135], v0
v_smfmac_f32_16x16x64_bf16 v[70:73], v[38:41], v[200:207], v0
ds_read_b128 v[38:41], v1 offset:7168
s_waitcnt lgkmcnt(2)
s_waitcnt vmcnt(7)
s_barrier
ds_read_b64_tr_b16 v[50:51], v3 offset:1536
ds_read_b64_tr_b16 v[52:53], v3 offset:1664
ds_read_b64_tr_b16 v[54:55], v3 offset:3584
ds_read_b64_tr_b16 v[56:57], v3 offset:3712
s_waitcnt lgkmcnt(9)
v_smfmac_f32_16x16x64_bf16 v[66:69], v[42:45], v[136:143], v0
ds_read_b64_tr_b16 v[58:59], v3 offset:1024
ds_read_b64_tr_b16 v[60:61], v3 offset:1152
v_smfmac_f32_16x16x64_bf16 v[70:73], v[42:45], v[208:215], v0
ds_read_b128 v[42:45], v1 offset:8192
ds_read_b64_tr_b16 v[62:63], v3 offset:3072
ds_read_b64_tr_b16 v[64:65], v3 offset:3200
s_waitcnt lgkmcnt(10)
v_smfmac_f32_16x16x64_bf16 v[66:69], v[46:49], v[144:151], v0
ds_read_b64_tr_b16 v[74:75], v3 offset:512
ds_read_b64_tr_b16 v[76:77], v3 offset:640
v_smfmac_f32_16x16x64_bf16 v[70:73], v[46:49], v[216:223], v0
s_waitcnt lgkmcnt(11)
v_smfmac_f32_16x16x64_bf16 v[66:69], v[38:41], v[168:175], v0
v_smfmac_f32_16x16x64_bf16 v[70:73], v[38:41], v[240:247], v0
s_waitcnt lgkmcnt(4)
v_smfmac_f32_16x16x64_bf16 v[66:69], v[42:45], v[176:183], v0
v_smfmac_f32_16x16x64_bf16 v[70:73], v[42:45], v[248:255], v0
s_waitcnt lgkmcnt(7)
s_waitcnt vmcnt(5)
v_mfma_f32_16x16x32_bf16 v[42:45], v[22:25], v[50:53], 0
v_mfma_f32_16x16x32_bf16 v[46:49], v[26:29], v[50:53], 0
v_mfma_f32_16x16x32_bf16 v[38:41], v[54:57], v[50:53], 0
ds_read_b64_tr_b16 v[54:55], v3 offset:2560
ds_read_b64_tr_b16 v[56:57], v3 offset:2688
ds_read_b128 v[22:25], v1 offset:15360
ds_read_b64_tr_b16 v[50:51], v3 offset:0
ds_read_b64_tr_b16 v[52:53], v3 offset:128
ds_read_b128 v[26:29], v1 offset:13312
s_waitcnt lgkmcnt(8)
s_waitcnt vmcnt(2)
v_mfma_f32_16x16x32_bf16 v[42:45], v[14:17], v[58:61], v[42:45]
v_mfma_f32_16x16x32_bf16 v[46:49], v[18:21], v[58:61], v[46:49]
v_mfma_f32_16x16x32_bf16 v[38:41], v[62:65], v[58:61], v[38:41]
ds_read_b64_tr_b16 v[58:59], v3 offset:2048
ds_read_b64_tr_b16 v[60:61], v3 offset:2176
ds_read_b128 v[14:17], v1 offset:14336
ds_read_b64_tr_b16 v[62:63], v79 offset:2048
ds_read_b64_tr_b16 v[64:65], v79 offset:2176
s_waitcnt vmcnt(3)
s_waitcnt lgkmcnt(11)
v_mfma_f32_16x16x32_bf16 v[46:49], v[10:13], v[74:77], v[46:49]
v_add_f32 v70, v70, v72
v_add_f32 v71, v71, v73
s_waitcnt lgkmcnt(8)
v_mfma_f32_16x16x32_bf16 v[42:45], v[22:25], v[74:77], v[42:45]
v_add_f32 v66, v66, v68
v_add_f32 v67, v67, v69
s_waitcnt lgkmcnt(9)
v_mfma_f32_16x16x32_bf16 v[38:41], v[54:57], v[74:77], v[38:41]
v_cvt_pk_bf16_f32 v70, v70, v71
v_cvt_pk_bf16_f32 v72, v66, v67
s_waitcnt lgkmcnt(5)
v_mfma_f32_16x16x32_bf16 v[42:45], v[26:29], v[50:53], v[42:45]
v_mov_b32 v71, 0
v_mov_b32 v73, 0
s_waitcnt lgkmcnt(3)
v_mfma_f32_16x16x32_bf16 v[38:41], v[58:61], v[50:53], v[38:41]
v_mov_b64 v[74:75], s[78:79]
v_mov_b64 v[76:77], s[78:79]
s_waitcnt lgkmcnt(2)
v_mfma_f32_16x16x32_bf16 v[46:49], v[14:17], v[50:53], v[46:49]
s_add_u32 s3, s34, -154624
buffer_store_dword v72, v2, s[4:7], s3 offen sc1
buffer_store_dword v70, v2, s[4:7], s3 offen offset:512 sc1
s_waitcnt lgkmcnt(0)
buffer_store_dwordx4 v[62:65], v78, s[4:7], s34 offen sc1
s_cmp_eq_u32 s28, 63
s_cbranch_scc1 L_ch_end_s2
v_cndmask_b32_e64 v38, v38, v40, s[30:31]
v_cndmask_b32_e64 v39, v39, v41, s[30:31]
v_max3_f32 v50, v42, v43, v44
v_max3_f32 v51, v45, v46, v47
v_max3_f32 v52, v48, v49, v38
v_max3_f32 v50, v50, v51, v39
v_max_f32 v50, v50, v52
v_mov_b32 v51, v50
v_mov_b64 v[66:67], 0
v_mov_b32 v65, 0
v_permlane16_swap_b32 v50, v51
v_max_f32 v50, v50, v51
v_mov_b32 v51, v50
v_subrev_u32 v40, 147456, v1
s_nop 0
v_permlane32_swap_b32 v50, v51
v_max_f32 v50, v50, v51
v_mul_f32 v50, s49, v50
v_pk_fma_f32 v[42:43], v[42:43], s[50:51], v[50:51] op_sel_hi:[1,0,0]
v_pk_fma_f32 v[44:45], v[44:45], s[50:51], v[50:51] op_sel_hi:[1,0,0]
v_pk_fma_f32 v[46:47], v[46:47], s[50:51], v[50:51] op_sel_hi:[1,0,0]
v_pk_fma_f32 v[48:49], v[48:49], s[50:51], v[50:51] op_sel_hi:[1,0,0]
v_pk_fma_f32 v[38:39], v[38:39], s[50:51], v[50:51] op_sel_hi:[1,0,0]
v_exp_f32 v42, v42
v_exp_f32 v43, v43
v_exp_f32 v44, v44
v_exp_f32 v45, v45
v_exp_f32 v46, v46
v_exp_f32 v47, v47
v_exp_f32 v48, v48
v_exp_f32 v49, v49
v_cvt_pk_bf16_f32 v52, v42, v43
v_cvt_pk_bf16_f32 v53, v44, v45
v_cvt_pk_bf16_f32 v54, v46, v47
v_cvt_pk_bf16_f32 v55, v48, v49
s_waitcnt vmcnt(3)
s_nop 0
v_mfma_f32_16x16x32_bf16 v[42:45], v[74:77], v[52:55], 0
v_exp_f32 v38, v38
v_mfma_f32_16x16x32_bf16 v[56:59], v[30:33], v[52:55], 0
v_exp_f32 v39, v39
v_mfma_f32_16x16x32_bf16 v[60:63], v[34:37], v[52:55], 0
v_add_u32 v47, s68, v40
v_cvt_pk_bf16_f32 v64, v38, v39
s_nop 1
v_mfma_f32_16x16x32_bf16 v[42:45], v[74:77], v[64:67], v[42:45]
v_mfma_f32_16x16x32_bf16 v[56:59], v[72:75], v[64:67], v[56:59]
v_mfma_f32_16x16x32_bf16 v[60:63], v[70:73], v[64:67], v[60:63]
ds_read_b128 v[10:13], v47 offset:0
ds_read_b128 v[14:17], v47 offset:1024
ds_read_b128 v[18:21], v47 offset:8192
ds_read_b128 v[22:25], v47 offset:9216
v_rcp_f32 v42, v42
s_nop 0
v_pk_mul_f32 v[56:57], v[56:57], v[42:43] op_sel_hi:[1,0]
v_pk_mul_f32 v[58:59], v[58:59], v[42:43] op_sel_hi:[1,0]
v_pk_mul_f32 v[60:61], v[60:61], v[42:43] op_sel_hi:[1,0]
v_pk_mul_f32 v[62:63], v[62:63], v[42:43] op_sel_hi:[1,0]
v_cvt_pk_bf16_f32 v56, v56, v60
v_cvt_pk_bf16_f32 v57, v57, v61
v_cvt_pk_bf16_f32 v58, v58, v62
v_cvt_pk_bf16_f32 v59, v59, v63
ds_write_b128 v6, v[56:59]
ds_read_b128 v[26:29], v47 offset:2048
ds_read_b128 v[30:33], v47 offset:3072
v_mov_b64 v[72:73], 0
v_mov_b64 v[74:75], 0
v_mov_b64 v[42:43], 0
v_mov_b64 v[44:45], 0
v_mov_b64 v[60:61], 0
v_mov_b64 v[62:63], 0
ds_read_b128 v[48:51], v47 offset:10240
ds_read_b128 v[52:55], v47 offset:11264
s_waitcnt lgkmcnt(4)
s_barrier
ds_read_b128 v[34:37], v1
ds_read_b128 v[38:41], v1 offset:1024
ds_read_b128 v[64:67], v47 offset:4096
ds_read_b128 v[68:71], v47 offset:5120
v_mov_b64 v[56:57], 0
v_mov_b64 v[58:59], 0
s_mul_i32 s3, s22, 589824
s_and_b32 s73, s28, 1
s_mul_i32 s73, s73, 294912
s_add_u32 s72, s3, s73
s_add_u32 s72, s72, 3145728
s_add_u32 s39, s72, s77
s_add_u32 s41, s39, 32768
s_bfe_u32 s35, s28, 0x10001
s_waitcnt lgkmcnt(3)
s_waitcnt lgkmcnt(9)
v_smfmac_f32_16x16x64_bf16 v[56:59], v[34:37], v[10:17], v0
ds_read_b128 v[10:13], v47 offset:12288
ds_read_b128 v[14:17], v47 offset:13312
v_smfmac_f32_16x16x64_bf16 v[60:63], v[34:37], v[18:25], v0
ds_read_b128 v[18:21], v47 offset:6144
ds_read_b128 v[22:25], v47 offset:7168
s_waitcnt lgkmcnt(6)
s_waitcnt lgkmcnt(8)
v_smfmac_f32_16x16x64_bf16 v[56:59], v[38:41], v[26:33], v0
ds_read_b128 v[26:29], v47 offset:14336
ds_read_b128 v[30:33], v47 offset:15360
v_smfmac_f32_16x16x64_bf16 v[60:63], v[38:41], v[48:55], v0
ds_read_b128 v[48:51], v47 offset:16384
ds_read_b128 v[52:55], v47 offset:17408
s_waitcnt lgkmcnt(6)
v_smfmac_f32_16x16x64_bf16 v[72:75], v[34:37], v[64:71], v0
ds_read_b128 v[64:67], v47 offset:24576
ds_read_b128 v[68:71], v47 offset:25600
v_smfmac_f32_16x16x64_bf16 v[42:45], v[34:37], v[10:17], v0
ds_read_b128 v[10:13], v47 offset:18432
ds_read_b128 v[14:17], v47 offset:19456
v_add_f32 v56, v56, v58
v_add_f32 v57, v57, v59
v_add_f32 v60, v60, v62
s_waitcnt lgkmcnt(6)
v_smfmac_f32_16x16x64_bf16 v[72:75], v[38:41], v[18:25], v0
ds_read_b128 v[18:21], v47 offset:26624
ds_read_b128 v[22:25], v47 offset:27648
v_add_f32 v61, v61, v63
v_cvt_pk_bf16_f32 v76, v56, v60
v_cvt_pk_bf16_f32 v77, v57, v61
v_smfmac_f32_16x16x64_bf16 v[42:45], v[38:41], v[26:33], v0
ds_read_b128 v[26:29], v47 offset:20480
ds_read_b128 v[30:33], v47 offset:21504
v_mov_b64 v[56:57], 0
v_mov_b64 v[58:59], 0
v_mov_b64 v[60:61], 0
v_mov_b64 v[62:63], 0
s_waitcnt lgkmcnt(6)
v_smfmac_f32_16x16x64_bf16 v[56:59], v[34:37], v[48:55], v0
ds_read_b128 v[48:51], v47 offset:28672
ds_read_b128 v[52:55], v47 offset:29696
v_smfmac_f32_16x16x64_bf16 v[60:63], v[34:37], v[64:71], v0
ds_read_b128 v[64:67], v47 offset:22528
ds_read_b128 v[68:71], v47 offset:23552
v_add_f32 v72, v72, v74
v_add_f32 v73, v73, v75
v_add_f32 v42, v42, v44
s_waitcnt lgkmcnt(6)
v_smfmac_f32_16x16x64_bf16 v[56:59], v[38:41], v[10:17], v0
ds_read_b128 v[10:13], v47 offset:30720
ds_read_b128 v[14:17], v47 offset:31744
v_add_f32 v43, v43, v45
v_cvt_pk_bf16_f32 v78, v72, v42
v_cvt_pk_bf16_f32 v79, v73, v43
v_smfmac_f32_16x16x64_bf16 v[60:63], v[38:41], v[18:25], v0
v_bfi_b32 v79, 1, s35, v79
buffer_store_dwordx4 v[76:79], v7, s[4:7], s39 offen sc1
v_mov_b64 v[72:73], 0
v_mov_b64 v[74:75], 0
v_mov_b64 v[42:43], 0
v_mov_b64 v[44:45], 0
s_waitcnt lgkmcnt(4)
v_smfmac_f32_16x16x64_bf16 v[72:75], v[34:37], v[26:33], v0
v_smfmac_f32_16x16x64_bf16 v[42:45], v[34:37], v[48:55], v0
v_add_f32 v56, v56, v58
v_add_f32 v57, v57, v59
v_add_f32 v60, v60, v62
s_waitcnt lgkmcnt(0)
v_smfmac_f32_16x16x64_bf16 v[72:75], v[38:41], v[64:71], v0
v_add_f32 v61, v61, v63
v_cvt_pk_bf16_f32 v76, v56, v60
v_cvt_pk_bf16_f32 v77, v57, v61
v_smfmac_f32_16x16x64_bf16 v[42:45], v[38:41], v[10:17], v0
s_nop 3
v_add_f32 v72, v72, v74
v_add_f32 v73, v73, v75
s_nop 1
v_add_f32 v42, v42, v44
v_add_f32 v43, v43, v45
v_cvt_pk_bf16_f32 v78, v72, v42
v_cvt_pk_bf16_f32 v79, v73, v43
v_bfi_b32 v79, 1, s35, v79
buffer_store_dwordx4 v[76:79], v7, s[4:7], s41 offen sc1
s_add_u32 s29, s29, 9216
s_add_u32 s75, s75, 9216
s_add_u32 s32, s32, 0x80000
s_add_u32 s33, s33, 0x80000
s_add_u32 s36, s36, 2048
s_mov_b32 s37, s38
s_add_u32 s38, s38, 2048
s_add_u32 s34, s34, 0x20000
s_add_u32 s28, s28, 1
s_add_u32 s40, s72, s46
v_mov_b32 v42, s64
v_mov_b32 v43, s65
v_cndmask_b32_e64 v42, v42, v43, s[62:63]
v_cndmask_b32_e64 v38, 0, v42, s[54:55]
v_cndmask_b32_e64 v39, 0, v42, s[56:57]
v_cndmask_b32_e64 v40, 0, v42, s[58:59]
v_cndmask_b32_e64 v41, 0, v42, s[60:61]
s_mov_b32 s90, 0xff00ff00
s_mov_b32 s91, 0xff00ff00
s_mov_b32 s13, 0
s_waitcnt vmcnt(0)
L_rs_35:
buffer_load_dwordx4 v[48:51], v1, s[4:7], s40 offen offset:0 sc1
buffer_load_dwordx4 v[52:55], v1, s[4:7], s40 offen offset:1024 sc1
buffer_load_dwordx4 v[56:59], v1, s[4:7], s40 offen offset:2048 sc1
buffer_load_dwordx4 v[60:63], v1, s[4:7], s40 offen offset:3072 sc1
s_add_u32 s13, s13, 1
s_cmp_gt_u32 s13, 200000
s_cbranch_scc1 L_FAIL
s_waitcnt vmcnt(0)
v_mfma_f32_16x16x32_bf16 v[64:67], v[38:41], v[48:51], 0
v_bitop3_b32 v44, v51, v55, s35 bitop3:0x7e
v_mfma_f32_16x16x32_bf16 v[64:67], v[38:41], v[52:55], v[64:67]
v_bitop3_b32 v45, v59, v63, s35 bitop3:0x7e
v_mfma_f32_16x16x32_bf16 v[64:67], v[38:41], v[56:59], v[64:67]
v_bitop3_b32 v44, v44, v45, 1 bitop3:0xa8
v_mfma_f32_16x16x32_bf16 v[64:67], v[38:41], v[60:63], v[64:67]
v_cmp_ne_u32 vcc, 0, v44
s_nop 0
s_cbranch_vccnz L_rs_35
s_nop 4
v_add_f32_dpp v68, v64, v64 row_ror:8 row_mask:0xf bank_mask:0xf
v_add_f32_dpp v69, v65, v65 row_ror:8 row_mask:0xf bank_mask:0xf
v_add_f32_dpp v70, v66, v66 row_ror:8 row_mask:0xf bank_mask:0xf
v_add_f32_dpp v71, v67, v67 row_ror:8 row_mask:0xf bank_mask:0xf
v_cvt_pk_bf16_f32 v72, v68, v69
v_cvt_pk_bf16_f32 v73, v70, v71
v_cndmask_b32_e64 v72, v72, v73, s[90:91]
s_mov_b64 exec, s[52:53]
buffer_store_dword v72, v8, s[4:7], s44 offen sc1
s_mov_b64 exec, -1
s_add_u32 s44, s44, 9216
v_mov_b64 v[50:51], 0
v_mov_b64 v[52:53], 0
v_mov_b64 v[54:55], 0
v_mov_b64 v[56:57], 0
v_mov_b64 v[58:59], 0
v_mov_b64 v[60:61], 0
v_mov_b64 v[62:63], 0
v_mov_b64 v[64:65], 0
v_mov_b64 v[66:67], 0
v_mov_b64 v[68:69], 0
v_mov_b64 v[70:71], 0
v_mov_b64 v[72:73], 0
v_subrev_u32 v76, 147456, v1
v_and_b32 v78, 0x30, v76
v_bfe_u32 v75, v76, 7, 1
v_lshl_add_u32 v78, v75, 6, v78
v_lshrrev_b32 v76, 8, v76
v_lshl_add_u32 v78, v76, 7, v78
v_lshl_add_u32 v78, s20, 9, v78
s_lshl_b32 s3, s20, 9
v_add_u32 v79, s3, v3
v_add_u32 v77, s8, v1
s_nop 0
s_branch L_ch_top_s2
L_ch_end_s2:
s_nop 7
s_nop 7
s_waitcnt vmcnt(0)
s_mov_b32 s37, s38
s_mov_b64 exec, 1
v_mov_b32 v44, 1
buffer_atomic_add v44, off, s[4:7], s37 sc1
s_mov_b64 exec, -1
s_branch L_END
L_cls3s:
v_mov_b64 v[50:51], 0
v_mov_b64 v[52:53], 0
v_mov_b64 v[54:55], 0
v_mov_b64 v[56:57], 0
v_mov_b64 v[58:59], 0
v_mov_b64 v[60:61], 0
v_mov_b64 v[62:63], 0
v_mov_b64 v[64:65], 0
v_mov_b64 v[66:67], 0
v_mov_b64 v[68:69], 0
v_mov_b64 v[70:71], 0
v_mov_b64 v[72:73], 0
v_subrev_u32 v76, 147456, v1
v_and_b32 v78, 0x30, v76
v_bfe_u32 v75, v76, 7, 1
v_lshl_add_u32 v78, v75, 6, v78
v_lshrrev_b32 v76, 8, v76
v_lshl_add_u32 v78, v76, 7, v78
v_lshl_add_u32 v78, s20, 9, v78
s_lshl_b32 s3, s20, 9
v_add_u32 v79, s3, v3
v_add_u32 v77, s8, v1
ds_read_b128 v[10:13], v77 offset:0
ds_read_b128 v[14:17], v77 offset:1024
s_waitcnt lgkmcnt(0)
s_branch L_ch_b1_s3
L_ch_top_s3:
s_barrier
s_mov_b32 s67, 0
L_ag_37:
buffer_load_dwordx4 v[10:13], v1, s[4:7], s29 offen offset:0 sc1
buffer_load_dwordx4 v[14:17], v1, s[4:7], s29 offen offset:1024 sc1
s_add_u32 s67, s67, 1
s_cmp_gt_u32 s67, 200000
s_cbranch_scc1 L_FAIL
s_waitcnt vmcnt(1)
ds_write_b128 v77, v[10:13] offset:0
s_waitcnt vmcnt(0)
ds_write_b128 v77, v[14:17] offset:1024
v_max3_u32 v74, v10, v11, v12
v_max3_u32 v75, v13, v14, v15
v_max3_u32 v74, v74, v16, v17
v_max3_u32 v74, v74, v75, v75
v_cmp_eq_u32 vcc, -1, v74
s_nop 0
s_cbranch_vccnz L_ag_37
L_ch_b1_s3:
v_smfmac_f32_16x16x64_bf16 v[50:53], v[10:13], a[56:63], v0
v_smfmac_f32_16x16x64_bf16 v[54:57], v[10:13], a[128:135], v0
v_smfmac_f32_16x16x64_bf16 v[58:61], v[10:13], a[200:207], v0
v_smfmac_f32_16x16x64_bf16 v[62:65], v[10:13], v[96:103], v0
s_waitcnt lgkmcnt(0)
s_barrier
v_smfmac_f32_16x16x64_bf16 v[50:53], v[14:17], a[64:71], v0
ds_read_b128 v[38:41], v1 offset:0
v_smfmac_f32_16x16x64_bf16 v[54:57], v[14:17], a[136:143], v0
ds_read_b128 v[42:45], v1 offset:1024
v_smfmac_f32_16x16x64_bf16 v[58:61], v[14:17], a[208:215], v0
ds_read_b128 v[46:49], v1 offset:2048
v_smfmac_f32_16x16x64_bf16 v[62:65], v[14:17], v[104:111], v0
s_mov_b32 m0, s11
s_add_u32 s3, s32, s48
v_smfmac_f32_16x16x64_bf16 v[66:69], v[10:13], v[168:175], v0
v_smfmac_f32_16x16x64_bf16 v[70:73], v[10:13], v[240:247], v0
v_smfmac_f32_16x16x64_bf16 v[66:69], v[14:17], v[176:183], v0
buffer_load_dwordx4 v4, s[4:7], s3 offen sc1 lds
v_smfmac_f32_16x16x64_bf16 v[70:73], v[14:17], v[248:255], v0
s_waitcnt lgkmcnt(2)
v_smfmac_f32_16x16x64_bf16 v[50:53], v[38:41], a[0:7], v0
v_smfmac_f32_16x16x64_bf16 v[54:57], v[38:41], a[72:79], v0
buffer_load_dwordx4 v[22:25], v4, s[4:7], s33 offen offset:2048 sc1
v_smfmac_f32_16x16x64_bf16 v[58:61], v[38:41], a[144:151], v0
v_smfmac_f32_16x16x64_bf16 v[62:65], v[38:41], a[216:223], v0
ds_read_b128 v[38:41], v1 offset:3072
s_waitcnt lgkmcnt(2)
v_smfmac_f32_16x16x64_bf16 v[50:53], v[42:45], a[8:15], v0
buffer_load_dwordx4 v[26:29], v4, s[4:7], s33 offen offset:2176 sc1
v_smfmac_f32_16x16x64_bf16 v[54:57], v[42:45], a[80:87], v0
v_smfmac_f32_16x16x64_bf16 v[58:61], v[42:45], a[152:159], v0
v_smfmac_f32_16x16x64_bf16 v[62:65], v[42:45], a[224:231], v0
ds_read_b128 v[42:45], v1 offset:4096
buffer_load_dwordx4 v[18:21], v4, s[4:7], s33 offen offset:128 sc1
s_waitcnt lgkmcnt(2)
v_smfmac_f32_16x16x64_bf16 v[50:53], v[46:49], a[16:23], v0
v_smfmac_f32_16x16x64_bf16 v[54:57], v[46:49], a[88:95], v0
v_smfmac_f32_16x16x64_bf16 v[58:61], v[46:49], a[160:167], v0
buffer_load_dwordx4 v[10:13], v4, s[4:7], s32 offen offset:2176 sc1
v_smfmac_f32_16x16x64_bf16 v[62:65], v[46:49], a[232:239], v0
ds_read_b128 v[46:49], v1 offset:5120
s_waitcnt lgkmcnt(2)
v_smfmac_f32_16x16x64_bf16 v[50:53], v[38:41], a[24:31], v0
buffer_load_dwordx4 v[14:17], v4, s[4:7], s33 offen offset:0 sc1
v_smfmac_f32_16x16x64_bf16 v[54:57], v[38:41], a[96:103], v0
v_smfmac_f32_16x16x64_bf16 v[58:61], v[38:41], a[168:175], v0
buffer_load_dwordx4 v[30:33], v5, s[4:7], s32 offen offset:0 sc1
v_smfmac_f32_16x16x64_bf16 v[62:65], v[38:41], a[240:247], v0
ds_read_b128 v[38:41], v1 offset:6144
s_waitcnt lgkmcnt(2)
v_smfmac_f32_16x16x64_bf16 v[50:53], v[42:45], a[32:39], v0
buffer_load_dwordx4 v[34:37], v5, s[4:7], s32 offen offset:2048 sc1
v_smfmac_f32_16x16x64_bf16 v[54:57], v[42:45], a[104:111], v0
v_smfmac_f32_16x16x64_bf16 v[58:61], v[42:45], a[176:183], v0
v_smfmac_f32_16x16x64_bf16 v[62:65], v[42:45], a[248:255], v0
ds_read_b128 v[42:45], v1 offset:0
s_waitcnt lgkmcnt(2)
v_smfmac_f32_16x16x64_bf16 v[50:53], v[46:49], a[40:47], v0
v_smfmac_f32_16x16x64_bf16 v[54:57], v[46:49], a[112:119], v0
v_smfmac_f32_16x16x64_bf16 v[58:61], v[46:49], a[184:191], v0
v_smfmac_f32_16x16x64_bf16 v[62:65], v[46:49], v[80:87], v0
ds_read_b128 v[46:49], v1 offset:1024
s_waitcnt lgkmcnt(2)
v_smfmac_f32_16x16x64_bf16 v[50:53], v[38:41], a[48:55], v0
v_smfmac_f32_16x16x64_bf16 v[54:57], v[38:41], a[120:127], v0
v_smfmac_f32_16x16x64_bf16 v[58:61], v[38:41], a[192:199], v0
v_smfmac_f32_16x16x64_bf16 v[62:65], v[38:41], v[88:95], v0
ds_read_b128 v[38:41], v1 offset:2048
s_waitcnt lgkmcnt(2)
v_smfmac_f32_16x16x64_bf16 v[66:69], v[42:45], v[112:119], v0
v_smfmac_f32_16x16x64_bf16 v[70:73], v[42:45], v[184:191], v0
ds_read_b128 v[42:45], v1 offset:3072
v_add_f32 v50, v50, v52
v_add_f32 v51, v51, v53
v_add_f32 v54, v54, v56
v_add_f32 v55, v55, v57
v_cvt_pk_bf16_f32 v74, v50, v51
v_cvt_pk_bf16_f32 v75, v54, v55
ds_write2_b32 v2, v74, v75 offset0:0 offset1:128
v_add_f32 v58, v58, v60
v_add_f32 v59, v59, v61
v_add_f32 v62, v62, v64
v_add_f32 v63, v63, v65
v_cvt_pk_bf16_f32 v76, v58, v59
v_cvt_pk_bf16_f32 v77, v62, v63
ds_write_b32 v2, v76 offset:2048
ds_write_b32 v2, v77 offset:2560
s_waitcnt lgkmcnt(5)
v_smfmac_f32_16x16x64_bf16 v[66:69], v[46:49], v[120:127], v0
v_smfmac_f32_16x16x64_bf16 v[70:73], v[46:49], v[192:199], v0
ds_read_b128 v[46:49], v1 offset:4096
s_waitcnt lgkmcnt(5)
v_smfmac_f32_16x16x64_bf16 v[66:69], v[38:41], v[128:135], v0
v_smfmac_f32_16x16x64_bf16 v[70:73], v[38:41], v[200:207], v0
ds_read_b128 v[38:41], v1 offset:5120
s_waitcnt lgkmcnt(2)
s_waitcnt vmcnt(7)
s_barrier
ds_read_b64_tr_b16 v[50:51], v3 offset:1536
ds_read_b64_tr_b16 v[52:53], v3 offset:1664
ds_read_b64_tr_b16 v[54:55], v3 offset:3584
ds_read_b64_tr_b16 v[56:57], v3 offset:3712
s_waitcnt lgkmcnt(9)
v_smfmac_f32_16x16x64_bf16 v[66:69], v[42:45], v[136:143], v0
ds_read_b64_tr_b16 v[58:59], v3 offset:1024
ds_read_b64_tr_b16 v[60:61], v3 offset:1152
v_smfmac_f32_16x16x64_bf16 v[70:73], v[42:45], v[208:215], v0
ds_read_b128 v[42:45], v1 offset:6144
ds_read_b64_tr_b16 v[62:63], v3 offset:3072
ds_read_b64_tr_b16 v[64:65], v3 offset:3200
s_waitcnt lgkmcnt(10)
v_smfmac_f32_16x16x64_bf16 v[66:69], v[46:49], v[144:151], v0
ds_read_b64_tr_b16 v[74:75], v3 offset:512
ds_read_b64_tr_b16 v[76:77], v3 offset:640
v_smfmac_f32_16x16x64_bf16 v[70:73], v[46:49], v[216:223], v0
s_waitcnt lgkmcnt(11)
v_smfmac_f32_16x16x64_bf16 v[66:69], v[38:41], v[152:159], v0
v_smfmac_f32_16x16x64_bf16 v[70:73], v[38:41], v[224:231], v0
s_waitcnt lgkmcnt(4)
v_smfmac_f32_16x16x64_bf16 v[66:69], v[42:45], v[160:167], v0
v_smfmac_f32_16x16x64_bf16 v[70:73], v[42:45], v[232:239], v0
s_waitcnt lgkmcnt(7)
s_waitcnt vmcnt(5)
v_mfma_f32_16x16x32_bf16 v[42:45], v[22:25], v[50:53], 0
v_mfma_f32_16x16x32_bf16 v[46:49], v[26:29], v[50:53], 0
v_mfma_f32_16x16x32_bf16 v[38:41], v[54:57], v[50:53], 0
ds_read_b64_tr_b16 v[54:55], v3 offset:2560
ds_read_b64_tr_b16 v[56:57], v3 offset:2688
ds_read_b128 v[22:25], v1 offset:15360
ds_read_b64_tr_b16 v[50:51], v3 offset:0
ds_read_b64_tr_b16 v[52:53], v3 offset:128
ds_read_b128 v[26:29], v1 offset:13312
s_waitcnt lgkmcnt(8)
s_waitcnt vmcnt(2)
v_mfma_f32_16x16x32_bf16 v[42:45], v[14:17], v[58:61], v[42:45]
v_mfma_f32_16x16x32_bf16 v[46:49], v[18:21], v[58:61], v[46:49]
v_mfma_f32_16x16x32_bf16 v[38:41], v[62:65], v[58:61], v[38:41]
ds_read_b64_tr_b16 v[58:59], v3 offset:2048
ds_read_b64_tr_b16 v[60:61], v3 offset:2176
ds_read_b128 v[14:17], v1 offset:14336
ds_read_b64_tr_b16 v[62:63], v79 offset:2048
ds_read_b64_tr_b16 v[64:65], v79 offset:2176
s_waitcnt vmcnt(3)
s_waitcnt lgkmcnt(11)
v_mfma_f32_16x16x32_bf16 v[46:49], v[10:13], v[74:77], v[46:49]
v_add_f32 v70, v70, v72
v_add_f32 v71, v71, v73
s_waitcnt lgkmcnt(8)
v_mfma_f32_16x16x32_bf16 v[42:45], v[22:25], v[74:77], v[42:45]
v_add_f32 v66, v66, v68
v_add_f32 v67, v67, v69
s_waitcnt lgkmcnt(9)
v_mfma_f32_16x16x32_bf16 v[38:41], v[54:57], v[74:77], v[38:41]
v_cvt_pk_bf16_f32 v70, v70, v71
v_cvt_pk_bf16_f32 v72, v66, v67
s_waitcnt lgkmcnt(5)
v_mfma_f32_16x16x32_bf16 v[42:45], v[26:29], v[50:53], v[42:45]
v_mov_b32 v71, 0
v_mov_b32 v73, 0
s_waitcnt lgkmcnt(3)
v_mfma_f32_16x16x32_bf16 v[38:41], v[58:61], v[50:53], v[38:41]
v_mov_b64 v[74:75], s[78:79]
v_mov_b64 v[76:77], s[78:79]
s_waitcnt lgkmcnt(2)
v_mfma_f32_16x16x32_bf16 v[46:49], v[14:17], v[50:53], v[46:49]
s_add_u32 s3, s34, -154624
buffer_store_dword v72, v2, s[4:7], s3 offen sc1
buffer_store_dword v70, v2, s[4:7], s3 offen offset:512 sc1
s_waitcnt lgkmcnt(0)
buffer_store_dwordx4 v[62:65], v78, s[4:7], s34 offen sc1
s_cmp_eq_u32 s28, 63
s_cbranch_scc1 L_ch_end_s3
v_cndmask_b32_e64 v38, v38, v40, s[30:31]
v_cndmask_b32_e64 v39, v39, v41, s[30:31]
v_max3_f32 v50, v42, v43, v44
v_max3_f32 v51, v45, v46, v47
v_max3_f32 v52, v48, v49, v38
v_max3_f32 v50, v50, v51, v39
v_max_f32 v50, v50, v52
v_mov_b32 v51, v50
v_mov_b64 v[66:67], 0
v_mov_b32 v65, 0
v_permlane16_swap_b32 v50, v51
v_max_f32 v50, v50, v51
v_mov_b32 v51, v50
v_subrev_u32 v40, 147456, v1
s_nop 0
v_permlane32_swap_b32 v50, v51
v_max_f32 v50, v50, v51
v_mul_f32 v50, s49, v50
v_pk_fma_f32 v[42:43], v[42:43], s[50:51], v[50:51] op_sel_hi:[1,0,0]
v_pk_fma_f32 v[44:45], v[44:45], s[50:51], v[50:51] op_sel_hi:[1,0,0]
v_pk_fma_f32 v[46:47], v[46:47], s[50:51], v[50:51] op_sel_hi:[1,0,0]
v_pk_fma_f32 v[48:49], v[48:49], s[50:51], v[50:51] op_sel_hi:[1,0,0]
v_pk_fma_f32 v[38:39], v[38:39], s[50:51], v[50:51] op_sel_hi:[1,0,0]
v_exp_f32 v42, v42
v_exp_f32 v43, v43
v_exp_f32 v44, v44
v_exp_f32 v45, v45
v_exp_f32 v46, v46
v_exp_f32 v47, v47
v_exp_f32 v48, v48
v_exp_f32 v49, v49
v_cvt_pk_bf16_f32 v52, v42, v43
v_cvt_pk_bf16_f32 v53, v44, v45
v_cvt_pk_bf16_f32 v54, v46, v47
v_cvt_pk_bf16_f32 v55, v48, v49
s_waitcnt vmcnt(3)
s_nop 0
v_mfma_f32_16x16x32_bf16 v[42:45], v[74:77], v[52:55], 0
v_exp_f32 v38, v38
v_mfma_f32_16x16x32_bf16 v[56:59], v[30:33], v[52:55], 0
v_exp_f32 v39, v39
v_mfma_f32_16x16x32_bf16 v[60:63], v[34:37], v[52:55], 0
v_add_u32 v47, s68, v40
v_cvt_pk_bf16_f32 v64, v38, v39
v_add_u32 v46, 0x20000, v40
s_nop 0
v_mfma_f32_16x16x32_bf16 v[42:45], v[74:77], v[64:67], v[42:45]
v_mfma_f32_16x16x32_bf16 v[56:59], v[72:75], v[64:67], v[56:59]
v_mfma_f32_16x16x32_bf16 v[60:63], v[70:73], v[64:67], v[60:63]
ds_read_b128 v[10:13], v47 offset:0
ds_read_b128 v[14:17], v47 offset:1024
ds_read_b128 v[18:21], v47 offset:8192
ds_read_b128 v[22:25], v47 offset:9216
v_rcp_f32 v42, v42
s_nop 0
v_pk_mul_f32 v[56:57], v[56:57], v[42:43] op_sel_hi:[1,0]
v_pk_mul_f32 v[58:59], v[58:59], v[42:43] op_sel_hi:[1,0]
v_pk_mul_f32 v[60:61], v[60:61], v[42:43] op_sel_hi:[1,0]
v_pk_mul_f32 v[62:63], v[62:63], v[42:43] op_sel_hi:[1,0]
v_cvt_pk_bf16_f32 v56, v56, v60
v_cvt_pk_bf16_f32 v57, v57, v61
v_cvt_pk_bf16_f32 v58, v58, v62
v_cvt_pk_bf16_f32 v59, v59, v63
ds_write_b128 v6, v[56:59]
ds_read_b128 v[26:29], v47 offset:2048
ds_read_b128 v[30:33], v47 offset:3072
v_mov_b64 v[72:73], 0
v_mov_b64 v[74:75], 0
v_mov_b64 v[42:43], 0
v_mov_b64 v[44:45], 0
v_mov_b64 v[60:61], 0
v_mov_b64 v[62:63], 0
ds_read_b128 v[48:51], v47 offset:10240
ds_read_b128 v[52:55], v47 offset:11264
s_waitcnt lgkmcnt(4)
s_barrier
ds_read_b128 v[34:37], v1
ds_read_b128 v[38:41], v1 offset:1024
ds_read_b128 v[64:67], v47 offset:4096
ds_read_b128 v[68:71], v47 offset:5120
v_mov_b64 v[56:57], 0
v_mov_b64 v[58:59], 0
s_mul_i32 s3, s22, 589824
s_and_b32 s73, s28, 1
s_mul_i32 s73, s73, 294912
s_add_u32 s72, s3, s73
s_add_u32 s72, s72, 3145728
s_add_u32 s39, s72, s77
s_add_u32 s41, s39, 32768
s_bfe_u32 s35, s28, 0x10001
s_add_u32 s10, s72, s9
s_waitcnt lgkmcnt(3)
s_waitcnt lgkmcnt(9)
v_smfmac_f32_16x16x64_bf16 v[56:59], v[34:37], v[10:17], v0
ds_read_b128 v[10:13], v47 offset:12288
ds_read_b128 v[14:17], v47 offset:13312
v_smfmac_f32_16x16x64_bf16 v[60:63], v[34:37], v[18:25], v0
ds_read_b128 v[18:21], v47 offset:6144
ds_read_b128 v[22:25], v47 offset:7168
s_waitcnt lgkmcnt(6)
s_waitcnt lgkmcnt(8)
v_smfmac_f32_16x16x64_bf16 v[56:59], v[38:41], v[26:33], v0
ds_read_b128 v[26:29], v47 offset:14336
ds_read_b128 v[30:33], v47 offset:15360
v_smfmac_f32_16x16x64_bf16 v[60:63], v[38:41], v[48:55], v0
ds_read_b128 v[48:51], v47 offset:16384
ds_read_b128 v[52:55], v47 offset:17408
s_waitcnt lgkmcnt(6)
v_smfmac_f32_16x16x64_bf16 v[72:75], v[34:37], v[64:71], v0
ds_read_b128 v[64:67], v47 offset:24576
ds_read_b128 v[68:71], v47 offset:25600
v_smfmac_f32_16x16x64_bf16 v[42:45], v[34:37], v[10:17], v0
ds_read_b128 v[10:13], v47 offset:18432
ds_read_b128 v[14:17], v47 offset:19456
v_add_f32 v56, v56, v58
v_add_f32 v57, v57, v59
v_add_f32 v60, v60, v62
s_waitcnt lgkmcnt(6)
v_smfmac_f32_16x16x64_bf16 v[72:75], v[38:41], v[18:25], v0
ds_read_b128 v[18:21], v47 offset:26624
ds_read_b128 v[22:25], v47 offset:27648
v_add_f32 v61, v61, v63
v_cvt_pk_bf16_f32 v76, v56, v60
v_cvt_pk_bf16_f32 v77, v57, v61
v_smfmac_f32_16x16x64_bf16 v[42:45], v[38:41], v[26:33], v0
ds_read_b128 v[26:29], v47 offset:20480
ds_read_b128 v[30:33], v47 offset:21504
v_mov_b64 v[56:57], 0
v_mov_b64 v[58:59], 0
v_mov_b64 v[60:61], 0
v_mov_b64 v[62:63], 0
s_waitcnt lgkmcnt(6)
v_smfmac_f32_16x16x64_bf16 v[56:59], v[34:37], v[48:55], v0
ds_read_b128 v[48:51], v47 offset:28672
ds_read_b128 v[52:55], v47 offset:29696
v_smfmac_f32_16x16x64_bf16 v[60:63], v[34:37], v[64:71], v0
ds_read_b128 v[64:67], v47 offset:22528
ds_read_b128 v[68:71], v47 offset:23552
v_add_f32 v72, v72, v74
v_add_f32 v73, v73, v75
v_add_f32 v42, v42, v44
s_waitcnt lgkmcnt(6)
v_smfmac_f32_16x16x64_bf16 v[56:59], v[38:41], v[10:17], v0
ds_read_b128 v[10:13], v47 offset:30720
ds_read_b128 v[14:17], v47 offset:31744
v_add_f32 v43, v43, v45
v_cvt_pk_bf16_f32 v78, v72, v42
v_cvt_pk_bf16_f32 v79, v73, v43
v_smfmac_f32_16x16x64_bf16 v[60:63], v[38:41], v[18:25], v0
ds_read_b128 v[18:21], v46 offset:4096
ds_read_b128 v[22:25], v46 offset:5120
v_bfi_b32 v79, 1, s35, v79
buffer_store_dwordx4 v[76:79], v7, s[4:7], s39 offen sc1
v_mov_b64 v[72:73], 0
v_mov_b64 v[74:75], 0
v_mov_b64 v[42:43], 0
v_mov_b64 v[44:45], 0
s_waitcnt lgkmcnt(6)
v_smfmac_f32_16x16x64_bf16 v[72:75], v[34:37], v[26:33], v0
ds_read_b128 v[26:29], v46 offset:12288
ds_read_b128 v[30:33], v46 offset:13312
v_smfmac_f32_16x16x64_bf16 v[42:45], v[34:37], v[48:55], v0
ds_read_b128 v[48:51], v46 offset:6144
ds_read_b128 v[52:55], v46 offset:7168
v_add_f32 v56, v56, v58
v_add_f32 v57, v57, v59
v_add_f32 v60, v60, v62
s_waitcnt lgkmcnt(6)
v_smfmac_f32_16x16x64_bf16 v[72:75], v[38:41], v[64:71], v0
ds_read_b128 v[64:67], v46 offset:14336
ds_read_b128 v[68:71], v46 offset:15360
v_add_f32 v61, v61, v63
v_cvt_pk_bf16_f32 v76, v56, v60
v_cvt_pk_bf16_f32 v77, v57, v61
v_smfmac_f32_16x16x64_bf16 v[42:45], v[38:41], v[10:17], v0
v_mov_b64 v[56:57], 0
v_mov_b64 v[58:59], 0
v_mov_b64 v[60:61], 0
v_mov_b64 v[62:63], 0
s_waitcnt lgkmcnt(4)
v_smfmac_f32_16x16x64_bf16 v[56:59], v[34:37], v[18:25], v0
v_smfmac_f32_16x16x64_bf16 v[60:63], v[34:37], v[26:33], v0
v_and_b32 v46, 0x70, v7
v_lshrrev_b32 v46, 1, v46
v_sub_u32 v46, v7, v46
s_waitcnt lgkmcnt(0)
v_smfmac_f32_16x16x64_bf16 v[56:59], v[38:41], v[48:55], v0
v_add_f32 v72, v72, v74
v_add_f32 v73, v73, v75
v_add_f32 v42, v42, v44
v_smfmac_f32_16x16x64_bf16 v[60:63], v[38:41], v[64:71], v0
v_add_f32 v43, v43, v45
v_cvt_pk_bf16_f32 v78, v72, v42
v_cvt_pk_bf16_f32 v79, v73, v43
v_bfi_b32 v79, 1, s35, v79
buffer_store_dwordx4 v[76:79], v7, s[4:7], s41 offen sc1
v_add_f32 v56, v56, v58
v_add_f32 v57, v57, v59
s_nop 0
v_add_f32 v60, v60, v62
v_add_f32 v61, v61, v63
v_cvt_pk_bf16_f32 v76, v56, v60
v_cvt_pk_bf16_f32 v77, v57, v61
v_bfi_b32 v77, 1, s35, v77
buffer_store_dwordx2 v[76:77], v46, s[4:7], s10 offen sc1
s_add_u32 s29, s29, 9216
s_add_u32 s75, s75, 9216
s_add_u32 s32, s32, 0x80000
s_add_u32 s33, s33, 0x80000
s_add_u32 s36, s36, 2048
s_mov_b32 s37, s38
s_add_u32 s38, s38, 2048
s_add_u32 s34, s34, 0x20000
s_add_u32 s28, s28, 1
s_cmp_ge_u32 s45, 72
s_cbranch_scc1 L_nors_38
s_add_u32 s40, s72, s46
v_mov_b32 v42, s64
v_mov_b32 v43, s65
v_cndmask_b32_e64 v42, v42, v43, s[62:63]
v_cndmask_b32_e64 v38, 0, v42, s[54:55]
v_cndmask_b32_e64 v39, 0, v42, s[56:57]
v_cndmask_b32_e64 v40, 0, v42, s[58:59]
v_cndmask_b32_e64 v41, 0, v42, s[60:61]
s_mov_b32 s90, 0xff00ff00
s_mov_b32 s91, 0xff00ff00
s_mov_b32 s13, 0
s_waitcnt vmcnt(0)
L_rs_39:
buffer_load_dwordx4 v[48:51], v1, s[4:7], s40 offen offset:0 sc1
buffer_load_dwordx4 v[52:55], v1, s[4:7], s40 offen offset:1024 sc1
buffer_load_dwordx4 v[56:59], v1, s[4:7], s40 offen offset:2048 sc1
buffer_load_dwordx4 v[60:63], v1, s[4:7], s40 offen offset:3072 sc1
s_add_u32 s13, s13, 1
s_cmp_gt_u32 s13, 200000
s_cbranch_scc1 L_FAIL
s_waitcnt vmcnt(0)
v_mfma_f32_16x16x32_bf16 v[64:67], v[38:41], v[48:51], 0
v_bitop3_b32 v44, v49, v51, s35 bitop3:0x7e
v_bitop3_b32 v45, v53, v55, s35 bitop3:0x7e
v_mfma_f32_16x16x32_bf16 v[64:67], v[38:41], v[52:55], v[64:67]
v_bitop3_b32 v46, v57, v59, s35 bitop3:0x7e
v_bitop3_b32 v47, v61, v63, s35 bitop3:0x7e
v_mfma_f32_16x16x32_bf16 v[64:67], v[38:41], v[56:59], v[64:67]
v_or3_b32 v44, v44, v46, v47
v_bitop3_b32 v44, v44, v45, 1 bitop3:0xa8
v_mfma_f32_16x16x32_bf16 v[64:67], v[38:41], v[60:63], v[64:67]
v_cmp_ne_u32 vcc, 0, v44
s_nop 0
s_cbranch_vccnz L_rs_39
s_nop 4
v_add_f32_dpp v68, v64, v64 row_ror:8 row_mask:0xf bank_mask:0xf
v_add_f32_dpp v69, v65, v65 row_ror:8 row_mask:0xf bank_mask:0xf
v_add_f32_dpp v70, v66, v66 row_ror:8 row_mask:0xf bank_mask:0xf
v_add_f32_dpp v71, v67, v67 row_ror:8 row_mask:0xf bank_mask:0xf
v_cvt_pk_bf16_f32 v72, v68, v69
v_cvt_pk_bf16_f32 v73, v70, v71
v_cndmask_b32_e64 v72, v72, v73, s[90:91]
s_mov_b64 exec, s[52:53]
buffer_store_dword v72, v8, s[4:7], s44 offen sc1
s_mov_b64 exec, -1
s_add_u32 s44, s44, 9216
L_nors_38:
v_mov_b64 v[50:51], 0
v_mov_b64 v[52:53], 0
v_mov_b64 v[54:55], 0
v_mov_b64 v[56:57], 0
v_mov_b64 v[58:59], 0
v_mov_b64 v[60:61], 0
v_mov_b64 v[62:63], 0
v_mov_b64 v[64:65], 0
v_mov_b64 v[66:67], 0
v_mov_b64 v[68:69], 0
v_mov_b64 v[70:71], 0
v_mov_b64 v[72:73], 0
v_subrev_u32 v76, 147456, v1
v_and_b32 v78, 0x30, v76
v_bfe_u32 v75, v76, 7, 1
v_lshl_add_u32 v78, v75, 6, v78
v_lshrrev_b32 v76, 8, v76
v_lshl_add_u32 v78, v76, 7, v78
v_lshl_add_u32 v78, s20, 9, v78
s_lshl_b32 s3, s20, 9
v_add_u32 v79, s3, v3
v_add_u32 v77, s8, v1
s_nop 0
s_branch L_ch_top_s3
L_ch_end_s3:
s_nop 7
s_nop 7
s_waitcnt vmcnt(0)
s_mov_b32 s37, s38
s_mov_b64 exec, 1
v_mov_b32 v44, 1
buffer_atomic_add v44, off, s[4:7], s37 sc1
s_mov_b64 exec, -1
s_branch L_END
s_endpgm
L_R_bk:
v_and_b32 v1, 63, v0
v_lshlrev_b32 v2, 4, v1
v_add_u32 v3, 61440, v2
v_add_u32 v4, 122880, v2
s_mov_b32 s32, 0x05040100
s_mov_b32 s33, 0x07060302
s_load_dwordx2 s[90:91], s[0:1], 48
s_waitcnt lgkmcnt(0)
s_mov_b32 s8, s90
s_and_b32 s9, s91, 0xffff
s_mov_b32 s10, 0x480000
s_mov_b32 s11, 0x20000
v_and_b32 v8, 31, v1
v_lshrrev_b32 v9, 5, v1
v_lshlrev_b32 v10, 16, v9
v_lshl_add_u32 v10, v8, 3, v10
s_lshl_b32 s3, s21, 8
v_add_u32 v10, s3, v10
s_mov_b32 s90, 0
L_w_41:
s_mul_i32 s34, s90, 36
s_add_u32 s34, s34, s20
s_mov_b32 s64, s34
s_mul_i32 s35, s34, 131072
s_add_u32 s36, s35, 0
buffer_load_dwordx2 v[16:17], v10, s[8:11], s36 offen
s_add_u32 s36, s35, 8192
buffer_load_dwordx2 v[18:19], v10, s[8:11], s36 offen
s_add_u32 s36, s35, 16384
buffer_load_dwordx2 v[20:21], v10, s[8:11], s36 offen
s_add_u32 s36, s35, 24576
buffer_load_dwordx2 v[22:23], v10, s[8:11], s36 offen
s_add_u32 s36, s35, 32768
buffer_load_dwordx2 v[24:25], v10, s[8:11], s36 offen
s_add_u32 s36, s35, 40960
buffer_load_dwordx2 v[26:27], v10, s[8:11], s36 offen
s_add_u32 s36, s35, 49152
buffer_load_dwordx2 v[28:29], v10, s[8:11], s36 offen
s_add_u32 s36, s35, 57344
buffer_load_dwordx2 v[30:31], v10, s[8:11], s36 offen
s_mul_i32 s34, s90, 36
s_add_u32 s34, s34, s20
s_add_u32 s34, s34, 4
s_mov_b32 s65, s34
s_mul_i32 s35, s34, 131072
s_add_u32 s36, s35, 0
buffer_load_dwordx2 v[32:33], v10, s[8:11], s36 offen
s_add_u32 s36, s35, 8192
buffer_load_dwordx2 v[34:35], v10, s[8:11], s36 offen
s_add_u32 s36, s35, 16384
buffer_load_dwordx2 v[36:37], v10, s[8:11], s36 offen
s_add_u32 s36, s35, 24576
buffer_load_dwordx2 v[38:39], v10, s[8:11], s36 offen
s_add_u32 s36, s35, 32768
buffer_load_dwordx2 v[40:41], v10, s[8:11], s36 offen
s_add_u32 s36, s35, 40960
buffer_load_dwordx2 v[42:43], v10, s[8:11], s36 offen
s_add_u32 s36, s35, 49152
buffer_load_dwordx2 v[44:45], v10, s[8:11], s36 offen
s_add_u32 s36, s35, 57344
buffer_load_dwordx2 v[46:47], v10, s[8:11], s36 offen
s_mul_i32 s34, s90, 36
s_add_u32 s34, s34, s20
s_add_u32 s34, s34, 8
s_mov_b32 s66, s34
s_mul_i32 s35, s34, 131072
s_add_u32 s36, s35, 0
buffer_load_dwordx2 v[48:49], v10, s[8:11], s36 offen
s_add_u32 s36, s35, 8192
buffer_load_dwordx2 v[50:51], v10, s[8:11], s36 offen
s_add_u32 s36, s35, 16384
buffer_load_dwordx2 v[52:53], v10, s[8:11], s36 offen
s_add_u32 s36, s35, 24576
buffer_load_dwordx2 v[54:55], v10, s[8:11], s36 offen
s_add_u32 s36, s35, 32768
buffer_load_dwordx2 v[56:57], v10, s[8:11], s36 offen
s_add_u32 s36, s35, 40960
buffer_load_dwordx2 v[58:59], v10, s[8:11], s36 offen
s_add_u32 s36, s35, 49152
buffer_load_dwordx2 v[60:61], v10, s[8:11], s36 offen
s_add_u32 s36, s35, 57344
buffer_load_dwordx2 v[62:63], v10, s[8:11], s36 offen
s_mul_i32 s34, s90, 36
s_add_u32 s34, s34, s20
s_add_u32 s34, s34, 12
s_mov_b32 s67, s34
s_mul_i32 s35, s34, 131072
s_add_u32 s36, s35, 0
buffer_load_dwordx2 v[64:65], v10, s[8:11], s36 offen
s_add_u32 s36, s35, 8192
buffer_load_dwordx2 v[66:67], v10, s[8:11], s36 offen
s_add_u32 s36, s35, 16384
buffer_load_dwordx2 v[68:69], v10, s[8:11], s36 offen
s_add_u32 s36, s35, 24576
buffer_load_dwordx2 v[70:71], v10, s[8:11], s36 offen
s_add_u32 s36, s35, 32768
buffer_load_dwordx2 v[72:73], v10, s[8:11], s36 offen
s_add_u32 s36, s35, 40960
buffer_load_dwordx2 v[74:75], v10, s[8:11], s36 offen
s_add_u32 s36, s35, 49152
buffer_load_dwordx2 v[76:77], v10, s[8:11], s36 offen
s_add_u32 s36, s35, 57344
buffer_load_dwordx2 v[78:79], v10, s[8:11], s36 offen
s_mul_i32 s34, s90, 36
s_add_u32 s34, s34, s20
s_add_u32 s34, s34, 16
s_mov_b32 s68, s34
s_mul_i32 s35, s34, 131072
s_add_u32 s36, s35, 0
buffer_load_dwordx2 v[80:81], v10, s[8:11], s36 offen
s_add_u32 s36, s35, 8192
buffer_load_dwordx2 v[82:83], v10, s[8:11], s36 offen
s_add_u32 s36, s35, 16384
buffer_load_dwordx2 v[84:85], v10, s[8:11], s36 offen
s_add_u32 s36, s35, 24576
buffer_load_dwordx2 v[86:87], v10, s[8:11], s36 offen
s_add_u32 s36, s35, 32768
buffer_load_dwordx2 v[88:89], v10, s[8:11], s36 offen
s_add_u32 s36, s35, 40960
buffer_load_dwordx2 v[90:91], v10, s[8:11], s36 offen
s_add_u32 s36, s35, 49152
buffer_load_dwordx2 v[92:93], v10, s[8:11], s36 offen
s_add_u32 s36, s35, 57344
buffer_load_dwordx2 v[94:95], v10, s[8:11], s36 offen
s_mul_i32 s34, s90, 36
s_add_u32 s34, s34, s20
s_add_u32 s34, s34, 20
s_mov_b32 s69, s34
s_mul_i32 s35, s34, 131072
s_add_u32 s36, s35, 0
buffer_load_dwordx2 v[96:97], v10, s[8:11], s36 offen
s_add_u32 s36, s35, 8192
buffer_load_dwordx2 v[98:99], v10, s[8:11], s36 offen
s_add_u32 s36, s35, 16384
buffer_load_dwordx2 v[100:101], v10, s[8:11], s36 offen
s_add_u32 s36, s35, 24576
buffer_load_dwordx2 v[102:103], v10, s[8:11], s36 offen
s_add_u32 s36, s35, 32768
buffer_load_dwordx2 v[104:105], v10, s[8:11], s36 offen
s_add_u32 s36, s35, 40960
buffer_load_dwordx2 v[106:107], v10, s[8:11], s36 offen
s_add_u32 s36, s35, 49152
buffer_load_dwordx2 v[108:109], v10, s[8:11], s36 offen
s_add_u32 s36, s35, 57344
buffer_load_dwordx2 v[110:111], v10, s[8:11], s36 offen
s_mul_i32 s34, s90, 36
s_add_u32 s34, s34, s20
s_add_u32 s34, s34, 24
s_mov_b32 s70, s34
s_mul_i32 s35, s34, 131072
s_add_u32 s36, s35, 0
buffer_load_dwordx2 v[112:113], v10, s[8:11], s36 offen
s_add_u32 s36, s35, 8192
buffer_load_dwordx2 v[114:115], v10, s[8:11], s36 offen
s_add_u32 s36, s35, 16384
buffer_load_dwordx2 v[116:117], v10, s[8:11], s36 offen
s_add_u32 s36, s35, 24576
buffer_load_dwordx2 v[118:119], v10, s[8:11], s36 offen
s_add_u32 s36, s35, 32768
buffer_load_dwordx2 v[120:121], v10, s[8:11], s36 offen
s_add_u32 s36, s35, 40960
buffer_load_dwordx2 v[122:123], v10, s[8:11], s36 offen
s_add_u32 s36, s35, 49152
buffer_load_dwordx2 v[124:125], v10, s[8:11], s36 offen
s_add_u32 s36, s35, 57344
buffer_load_dwordx2 v[126:127], v10, s[8:11], s36 offen
s_mul_i32 s34, s90, 36
s_add_u32 s34, s34, s20
s_add_u32 s34, s34, 28
s_mov_b32 s71, s34
s_mul_i32 s35, s34, 131072
s_add_u32 s36, s35, 0
buffer_load_dwordx2 v[128:129], v10, s[8:11], s36 offen
s_add_u32 s36, s35, 8192
buffer_load_dwordx2 v[130:131], v10, s[8:11], s36 offen
s_add_u32 s36, s35, 16384
buffer_load_dwordx2 v[132:133], v10, s[8:11], s36 offen
s_add_u32 s36, s35, 24576
buffer_load_dwordx2 v[134:135], v10, s[8:11], s36 offen
s_add_u32 s36, s35, 32768
buffer_load_dwordx2 v[136:137], v10, s[8:11], s36 offen
s_add_u32 s36, s35, 40960
buffer_load_dwordx2 v[138:139], v10, s[8:11], s36 offen
s_add_u32 s36, s35, 49152
buffer_load_dwordx2 v[140:141], v10, s[8:11], s36 offen
s_add_u32 s36, s35, 57344
buffer_load_dwordx2 v[142:143], v10, s[8:11], s36 offen
s_mul_i32 s34, s90, 36
s_add_u32 s34, s34, s20
s_add_u32 s34, s34, 32
s_mov_b32 s72, s34
s_mul_i32 s35, s34, 131072
s_add_u32 s36, s35, 0
buffer_load_dwordx2 v[144:145], v10, s[8:11], s36 offen
s_add_u32 s36, s35, 8192
buffer_load_dwordx2 v[146:147], v10, s[8:11], s36 offen
s_add_u32 s36, s35, 16384
buffer_load_dwordx2 v[148:149], v10, s[8:11], s36 offen
s_add_u32 s36, s35, 24576
buffer_load_dwordx2 v[150:151], v10, s[8:11], s36 offen
s_add_u32 s36, s35, 32768
buffer_load_dwordx2 v[152:153], v10, s[8:11], s36 offen
s_add_u32 s36, s35, 40960
buffer_load_dwordx2 v[154:155], v10, s[8:11], s36 offen
s_add_u32 s36, s35, 49152
buffer_load_dwordx2 v[156:157], v10, s[8:11], s36 offen
s_add_u32 s36, s35, 57344
buffer_load_dwordx2 v[158:159], v10, s[8:11], s36 offen
s_waitcnt vmcnt(63)
s_mul_i32 s3, s64, 4096
v_add_u32 v15, s3, v2
v_perm_b32 v160, v18, v16, s32
v_perm_b32 v161, v22, v20, s32
v_perm_b32 v162, v26, v24, s32
v_perm_b32 v163, v30, v28, s32
ds_write_b128 v15, v[160:163] offset:0
v_perm_b32 v164, v18, v16, s33
v_perm_b32 v165, v22, v20, s33
v_perm_b32 v166, v26, v24, s33
v_perm_b32 v167, v30, v28, s33
ds_write_b128 v15, v[164:167] offset:1024
v_perm_b32 v168, v19, v17, s32
v_perm_b32 v169, v23, v21, s32
v_perm_b32 v170, v27, v25, s32
v_perm_b32 v171, v31, v29, s32
ds_write_b128 v15, v[168:171] offset:2048
v_perm_b32 v172, v19, v17, s33
v_perm_b32 v173, v23, v21, s33
v_perm_b32 v174, v27, v25, s33
v_perm_b32 v175, v31, v29, s33
ds_write_b128 v15, v[172:175] offset:3072
s_waitcnt lgkmcnt(0)
s_waitcnt vmcnt(56)
s_mul_i32 s3, s65, 4096
v_add_u32 v15, s3, v2
v_perm_b32 v160, v34, v32, s32
v_perm_b32 v161, v38, v36, s32
v_perm_b32 v162, v42, v40, s32
v_perm_b32 v163, v46, v44, s32
ds_write_b128 v15, v[160:163] offset:0
v_perm_b32 v164, v34, v32, s33
v_perm_b32 v165, v38, v36, s33
v_perm_b32 v166, v42, v40, s33
v_perm_b32 v167, v46, v44, s33
ds_write_b128 v15, v[164:167] offset:1024
v_perm_b32 v168, v35, v33, s32
v_perm_b32 v169, v39, v37, s32
v_perm_b32 v170, v43, v41, s32
v_perm_b32 v171, v47, v45, s32
ds_write_b128 v15, v[168:171] offset:2048
v_perm_b32 v172, v35, v33, s33
v_perm_b32 v173, v39, v37, s33
v_perm_b32 v174, v43, v41, s33
v_perm_b32 v175, v47, v45, s33
ds_write_b128 v15, v[172:175] offset:3072
s_waitcnt lgkmcnt(0)
s_waitcnt vmcnt(48)
s_mul_i32 s3, s66, 4096
v_add_u32 v15, s3, v2
v_perm_b32 v160, v50, v48, s32
v_perm_b32 v161, v54, v52, s32
v_perm_b32 v162, v58, v56, s32
v_perm_b32 v163, v62, v60, s32
ds_write_b128 v15, v[160:163] offset:0
v_perm_b32 v164, v50, v48, s33
v_perm_b32 v165, v54, v52, s33
v_perm_b32 v166, v58, v56, s33
v_perm_b32 v167, v62, v60, s33
ds_write_b128 v15, v[164:167] offset:1024
v_perm_b32 v168, v51, v49, s32
v_perm_b32 v169, v55, v53, s32
v_perm_b32 v170, v59, v57, s32
v_perm_b32 v171, v63, v61, s32
ds_write_b128 v15, v[168:171] offset:2048
v_perm_b32 v172, v51, v49, s33
v_perm_b32 v173, v55, v53, s33
v_perm_b32 v174, v59, v57, s33
v_perm_b32 v175, v63, v61, s33
ds_write_b128 v15, v[172:175] offset:3072
s_waitcnt lgkmcnt(0)
s_waitcnt vmcnt(40)
s_mul_i32 s3, s67, 4096
v_add_u32 v15, s3, v2
v_perm_b32 v160, v66, v64, s32
v_perm_b32 v161, v70, v68, s32
v_perm_b32 v162, v74, v72, s32
v_perm_b32 v163, v78, v76, s32
ds_write_b128 v15, v[160:163] offset:0
v_perm_b32 v164, v66, v64, s33
v_perm_b32 v165, v70, v68, s33
v_perm_b32 v166, v74, v72, s33
v_perm_b32 v167, v78, v76, s33
ds_write_b128 v15, v[164:167] offset:1024
v_perm_b32 v168, v67, v65, s32
v_perm_b32 v169, v71, v69, s32
v_perm_b32 v170, v75, v73, s32
v_perm_b32 v171, v79, v77, s32
ds_write_b128 v15, v[168:171] offset:2048
v_perm_b32 v172, v67, v65, s33
v_perm_b32 v173, v71, v69, s33
v_perm_b32 v174, v75, v73, s33
v_perm_b32 v175, v79, v77, s33
ds_write_b128 v15, v[172:175] offset:3072
s_waitcnt lgkmcnt(0)
s_waitcnt vmcnt(32)
s_mul_i32 s3, s68, 4096
v_add_u32 v15, s3, v2
v_perm_b32 v160, v82, v80, s32
v_perm_b32 v161, v86, v84, s32
v_perm_b32 v162, v90, v88, s32
v_perm_b32 v163, v94, v92, s32
ds_write_b128 v15, v[160:163] offset:0
v_perm_b32 v164, v82, v80, s33
v_perm_b32 v165, v86, v84, s33
v_perm_b32 v166, v90, v88, s33
v_perm_b32 v167, v94, v92, s33
ds_write_b128 v15, v[164:167] offset:1024
v_perm_b32 v168, v83, v81, s32
v_perm_b32 v169, v87, v85, s32
v_perm_b32 v170, v91, v89, s32
v_perm_b32 v171, v95, v93, s32
ds_write_b128 v15, v[168:171] offset:2048
v_perm_b32 v172, v83, v81, s33
v_perm_b32 v173, v87, v85, s33
v_perm_b32 v174, v91, v89, s33
v_perm_b32 v175, v95, v93, s33
ds_write_b128 v15, v[172:175] offset:3072
s_waitcnt lgkmcnt(0)
s_waitcnt vmcnt(24)
s_mul_i32 s3, s69, 4096
v_add_u32 v15, s3, v2
v_perm_b32 v160, v98, v96, s32
v_perm_b32 v161, v102, v100, s32
v_perm_b32 v162, v106, v104, s32
v_perm_b32 v163, v110, v108, s32
ds_write_b128 v15, v[160:163] offset:0
v_perm_b32 v164, v98, v96, s33
v_perm_b32 v165, v102, v100, s33
v_perm_b32 v166, v106, v104, s33
v_perm_b32 v167, v110, v108, s33
ds_write_b128 v15, v[164:167] offset:1024
v_perm_b32 v168, v99, v97, s32
v_perm_b32 v169, v103, v101, s32
v_perm_b32 v170, v107, v105, s32
v_perm_b32 v171, v111, v109, s32
ds_write_b128 v15, v[168:171] offset:2048
v_perm_b32 v172, v99, v97, s33
v_perm_b32 v173, v103, v101, s33
v_perm_b32 v174, v107, v105, s33
v_perm_b32 v175, v111, v109, s33
ds_write_b128 v15, v[172:175] offset:3072
s_waitcnt lgkmcnt(0)
s_waitcnt vmcnt(16)
s_mul_i32 s3, s70, 4096
v_add_u32 v15, s3, v2
v_perm_b32 v160, v114, v112, s32
v_perm_b32 v161, v118, v116, s32
v_perm_b32 v162, v122, v120, s32
v_perm_b32 v163, v126, v124, s32
ds_write_b128 v15, v[160:163] offset:0
v_perm_b32 v164, v114, v112, s33
v_perm_b32 v165, v118, v116, s33
v_perm_b32 v166, v122, v120, s33
v_perm_b32 v167, v126, v124, s33
ds_write_b128 v15, v[164:167] offset:1024
v_perm_b32 v168, v115, v113, s32
v_perm_b32 v169, v119, v117, s32
v_perm_b32 v170, v123, v121, s32
v_perm_b32 v171, v127, v125, s32
ds_write_b128 v15, v[168:171] offset:2048
v_perm_b32 v172, v115, v113, s33
v_perm_b32 v173, v119, v117, s33
v_perm_b32 v174, v123, v121, s33
v_perm_b32 v175, v127, v125, s33
ds_write_b128 v15, v[172:175] offset:3072
s_waitcnt lgkmcnt(0)
s_waitcnt vmcnt(8)
s_mul_i32 s3, s71, 4096
v_add_u32 v15, s3, v2
v_perm_b32 v160, v130, v128, s32
v_perm_b32 v161, v134, v132, s32
v_perm_b32 v162, v138, v136, s32
v_perm_b32 v163, v142, v140, s32
ds_write_b128 v15, v[160:163] offset:0
v_perm_b32 v164, v130, v128, s33
v_perm_b32 v165, v134, v132, s33
v_perm_b32 v166, v138, v136, s33
v_perm_b32 v167, v142, v140, s33
ds_write_b128 v15, v[164:167] offset:1024
v_perm_b32 v168, v131, v129, s32
v_perm_b32 v169, v135, v133, s32
v_perm_b32 v170, v139, v137, s32
v_perm_b32 v171, v143, v141, s32
ds_write_b128 v15, v[168:171] offset:2048
v_perm_b32 v172, v131, v129, s33
v_perm_b32 v173, v135, v133, s33
v_perm_b32 v174, v139, v137, s33
v_perm_b32 v175, v143, v141, s33
ds_write_b128 v15, v[172:175] offset:3072
s_waitcnt lgkmcnt(0)
s_waitcnt vmcnt(0)
s_mul_i32 s3, s72, 4096
v_add_u32 v15, s3, v2
v_perm_b32 v160, v146, v144, s32
v_perm_b32 v161, v150, v148, s32
v_perm_b32 v162, v154, v152, s32
v_perm_b32 v163, v158, v156, s32
ds_write_b128 v15, v[160:163] offset:0
v_perm_b32 v164, v146, v144, s33
v_perm_b32 v165, v150, v148, s33
v_perm_b32 v166, v154, v152, s33
v_perm_b32 v167, v158, v156, s33
ds_write_b128 v15, v[164:167] offset:1024
v_perm_b32 v168, v147, v145, s32
v_perm_b32 v169, v151, v149, s32
v_perm_b32 v170, v155, v153, s32
v_perm_b32 v171, v159, v157, s32
ds_write_b128 v15, v[168:171] offset:2048
v_perm_b32 v172, v147, v145, s33
v_perm_b32 v173, v151, v149, s33
v_perm_b32 v174, v155, v153, s33
v_perm_b32 v175, v159, v157, s33
ds_write_b128 v15, v[172:175] offset:3072
s_waitcnt lgkmcnt(0)
s_add_u32 s90, s90, 1
s_cmp_lt_u32 s90, 1
s_cbranch_scc1 L_w_41
s_lshr_b32 s22, s20, 1
s_and_b32 s23, s20, 1
s_mov_b32 s28, 0x1000
s_mul_i32 s3, s22, 0x2000
s_add_u32 s28, s28, s3
s_mul_i32 s3, s23, 0x40
s_add_u32 s28, s28, s3
s_mov_b32 s29, 0x20000
s_mul_i32 s3, s22, 0x20000
s_add_u32 s29, s29, s3
s_mul_i32 s3, s23, 0x800
s_add_u32 s29, s29, s3
s_mul_i32 s3, s21, 0x40
s_add_u32 s29, s29, s3
s_mov_b32 s30, 0x740000
s_mul_i32 s3, s22, 0x480000
s_add_u32 s30, s30, s3
s_mul_i32 s3, s23, 0x9000
s_add_u32 s30, s30, s3
s_mov_b32 s31, 0x5400000
s_mul_i32 s3, s22, 0x2000000
s_add_u32 s31, s31, s3
s_mul_i32 s3, s23, 0x80000
s_add_u32 s31, s31, s3
s_mul_i32 s3, s21, 0x4000
s_add_u32 s31, s31, s3
s_mov_b32 s39, 0x7fff0000
s_mov_b32 s85, 0
s_waitcnt vmcnt(0) lgkmcnt(0)
s_cmp_lg_u32 s20, 0
s_cbranch_scc1 L_walld_43
s_mov_b32 s91, 0
L_wall_42:
buffer_load_dword v15, off, s[16:19], 0 sc1
s_add_u32 s91, s91, 1
s_cmp_gt_u32 s91, 200000
s_cbranch_scc1 L_FAIL
s_waitcnt vmcnt(0)
v_cmp_gt_u32 vcc, 32, v15
s_nop 0
s_nop 2
s_cbranch_vccz L_walld_43
s_sleep 4
s_branch L_wall_42
L_walld_43:
s_barrier
L_bk_top:
s_cmp_lg_u32 s85, 0
s_cbranch_scc1 L_warm_44
buffer_load_dword v15, off, s[4:7], s28 sc1
s_mov_b32 s91, 0
s_waitcnt vmcnt(0)
s_mov_b64 exec, 1
v_mov_b32 v13, 1
buffer_atomic_add v13, off, s[4:7], s39 sc1
s_mov_b64 exec, -1
v_cmp_gt_u32 vcc, 4, v15
s_nop 0
s_nop 2
s_cbranch_vccz L_spd_46
L_sp_45:
buffer_load_dword v15, off, s[4:7], s28 sc1
s_add_u32 s91, s91, 1
s_cmp_gt_u32 s91, 200000
s_cbranch_scc1 L_FAIL
s_waitcnt vmcnt(0)
v_cmp_gt_u32 vcc, 4, v15
s_nop 0
s_nop 2
s_cbranch_vccnz L_sp_45
L_spd_46:
s_mov_b32 s39, 0x7fff0000
s_add_u32 s27, s30, 0x0
buffer_load_dwordx4 a[0:3], v2, s[4:7], s27 offen offset:0
buffer_load_dwordx4 a[4:7], v2, s[4:7], s27 offen offset:1024
buffer_load_dwordx4 a[8:11], v2, s[4:7], s27 offen offset:2048
buffer_load_dwordx4 a[12:15], v2, s[4:7], s27 offen offset:3072
s_add_u32 s27, s30, 0x1000
buffer_load_dwordx4 a[16:19], v2, s[4:7], s27 offen offset:0
buffer_load_dwordx4 a[20:23], v2, s[4:7], s27 offen offset:1024
buffer_load_dwordx4 a[24:27], v2, s[4:7], s27 offen offset:2048
buffer_load_dwordx4 a[28:31], v2, s[4:7], s27 offen offset:3072
s_waitcnt vmcnt(0)
L_warm_44:
ds_read_b128 v[128:131], v2 offset:0
ds_read_b128 v[132:135], v2 offset:1024
ds_read_b128 v[136:139], v2 offset:2048
ds_read_b128 v[140:143], v2 offset:3072
ds_read_b128 v[144:147], v2 offset:4096
ds_read_b128 v[148:151], v2 offset:5120
ds_read_b128 v[152:155], v2 offset:6144
ds_read_b128 v[156:159], v2 offset:7168
s_waitcnt lgkmcnt(4)
v_mfma_f32_32x32x16_bf16 v[64:79], v[128:131], a[0:3], 0
ds_read_b128 v[160:163], v2 offset:8192
s_add_u32 s27, s30, 8192
buffer_load_dwordx4 a[32:35], v2, s[4:7], s27 offen offset:0
v_mfma_f32_32x32x16_bf16 v[80:95], v[132:135], a[0:3], 0
ds_read_b128 v[164:167], v2 offset:9216
buffer_load_dwordx4 a[36:39], v2, s[4:7], s27 offen offset:1024
v_mfma_f32_32x32x16_bf16 v[96:111], v[136:139], a[0:3], 0
ds_read_b128 v[168:171], v2 offset:10240
v_mfma_f32_32x32x16_bf16 v[112:127], v[140:143], a[0:3], 0
ds_read_b128 v[172:175], v2 offset:11264
s_waitcnt lgkmcnt(4)
v_mfma_f32_32x32x16_bf16 v[64:79], v[144:147], a[4:7], v[64:79]
ds_read_b128 v[128:131], v2 offset:12288
buffer_load_dwordx4 a[40:43], v2, s[4:7], s27 offen offset:2048
v_mfma_f32_32x32x16_bf16 v[80:95], v[148:151], a[4:7], v[80:95]
ds_read_b128 v[132:135], v2 offset:13312
buffer_load_dwordx4 a[44:47], v2, s[4:7], s27 offen offset:3072
v_mfma_f32_32x32x16_bf16 v[96:111], v[152:155], a[4:7], v[96:111]
ds_read_b128 v[136:139], v2 offset:14336
v_mfma_f32_32x32x16_bf16 v[112:127], v[156:159], a[4:7], v[112:127]
ds_read_b128 v[140:143], v2 offset:15360
s_waitcnt lgkmcnt(4)
v_mfma_f32_32x32x16_bf16 v[64:79], v[160:163], a[8:11], v[64:79]
ds_read_b128 v[144:147], v2 offset:16384
s_add_u32 s27, s30, 12288
buffer_load_dwordx4 a[48:51], v2, s[4:7], s27 offen offset:0
v_mfma_f32_32x32x16_bf16 v[80:95], v[164:167], a[8:11], v[80:95]
ds_read_b128 v[148:151], v2 offset:17408
buffer_load_dwordx4 a[52:55], v2, s[4:7], s27 offen offset:1024
v_mfma_f32_32x32x16_bf16 v[96:111], v[168:171], a[8:11], v[96:111]
ds_read_b128 v[152:155], v2 offset:18432
v_mfma_f32_32x32x16_bf16 v[112:127], v[172:175], a[8:11], v[112:127]
ds_read_b128 v[156:159], v2 offset:19456
s_waitcnt lgkmcnt(4)
v_mfma_f32_32x32x16_bf16 v[64:79], v[128:131], a[12:15], v[64:79]
ds_read_b128 v[160:163], v2 offset:20480
buffer_load_dwordx4 a[56:59], v2, s[4:7], s27 offen offset:2048
v_mfma_f32_32x32x16_bf16 v[80:95], v[132:135], a[12:15], v[80:95]
ds_read_b128 v[164:167], v2 offset:21504
buffer_load_dwordx4 a[60:63], v2, s[4:7], s27 offen offset:3072
v_mfma_f32_32x32x16_bf16 v[96:111], v[136:139], a[12:15], v[96:111]
ds_read_b128 v[168:171], v2 offset:22528
v_mfma_f32_32x32x16_bf16 v[112:127], v[140:143], a[12:15], v[112:127]
ds_read_b128 v[172:175], v2 offset:23552
s_waitcnt lgkmcnt(4)
v_mfma_f32_32x32x16_bf16 v[64:79], v[144:147], a[16:19], v[64:79]
ds_read_b128 v[128:131], v2 offset:24576
s_add_u32 s27, s30, 16384
buffer_load_dwordx4 a[64:67], v2, s[4:7], s27 offen offset:0
v_mfma_f32_32x32x16_bf16 v[80:95], v[148:151], a[16:19], v[80:95]
ds_read_b128 v[132:135], v2 offset:25600
buffer_load_dwordx4 a[68:71], v2, s[4:7], s27 offen offset:1024
v_mfma_f32_32x32x16_bf16 v[96:111], v[152:155], a[16:19], v[96:111]
ds_read_b128 v[136:139], v2 offset:26624
v_mfma_f32_32x32x16_bf16 v[112:127], v[156:159], a[16:19], v[112:127]
ds_read_b128 v[140:143], v2 offset:27648
s_waitcnt lgkmcnt(4)
v_mfma_f32_32x32x16_bf16 v[64:79], v[160:163], a[20:23], v[64:79]
ds_read_b128 v[144:147], v2 offset:28672
buffer_load_dwordx4 a[72:75], v2, s[4:7], s27 offen offset:2048
v_mfma_f32_32x32x16_bf16 v[80:95], v[164:167], a[20:23], v[80:95]
ds_read_b128 v[148:151], v2 offset:29696
buffer_load_dwordx4 a[76:79], v2, s[4:7], s27 offen offset:3072
v_mfma_f32_32x32x16_bf16 v[96:111], v[168:171], a[20:23], v[96:111]
ds_read_b128 v[152:155], v2 offset:30720
v_mfma_f32_32x32x16_bf16 v[112:127], v[172:175], a[20:23], v[112:127]
ds_read_b128 v[156:159], v2 offset:31744
s_waitcnt lgkmcnt(4)
v_mfma_f32_32x32x16_bf16 v[64:79], v[128:131], a[24:27], v[64:79]
ds_read_b128 v[160:163], v2 offset:32768
s_add_u32 s27, s30, 20480
buffer_load_dwordx4 a[80:83], v2, s[4:7], s27 offen offset:0
v_mfma_f32_32x32x16_bf16 v[80:95], v[132:135], a[24:27], v[80:95]
ds_read_b128 v[164:167], v2 offset:33792
buffer_load_dwordx4 a[84:87], v2, s[4:7], s27 offen offset:1024
v_mfma_f32_32x32x16_bf16 v[96:111], v[136:139], a[24:27], v[96:111]
ds_read_b128 v[168:171], v2 offset:34816
v_mfma_f32_32x32x16_bf16 v[112:127], v[140:143], a[24:27], v[112:127]
ds_read_b128 v[172:175], v2 offset:35840
s_waitcnt lgkmcnt(4)
v_mfma_f32_32x32x16_bf16 v[64:79], v[144:147], a[28:31], v[64:79]
ds_read_b128 v[128:131], v2 offset:36864
buffer_load_dwordx4 a[88:91], v2, s[4:7], s27 offen offset:2048
v_mfma_f32_32x32x16_bf16 v[80:95], v[148:151], a[28:31], v[80:95]
ds_read_b128 v[132:135], v2 offset:37888
buffer_load_dwordx4 a[92:95], v2, s[4:7], s27 offen offset:3072
v_mfma_f32_32x32x16_bf16 v[96:111], v[152:155], a[28:31], v[96:111]
ds_read_b128 v[136:139], v2 offset:38912
v_mfma_f32_32x32x16_bf16 v[112:127], v[156:159], a[28:31], v[112:127]
ds_read_b128 v[140:143], v2 offset:39936
s_waitcnt vmcnt(15) lgkmcnt(4)
v_mfma_f32_32x32x16_bf16 v[64:79], v[160:163], a[32:35], v[64:79]
ds_read_b128 v[144:147], v2 offset:40960
s_add_u32 s27, s30, 24576
buffer_load_dwordx4 a[96:99], v2, s[4:7], s27 offen offset:0
s_mov_b64 exec, 1
v_mov_b32 v13, 1
buffer_atomic_add v13, off, s[4:7], s39 sc1
s_mov_b64 exec, -1
v_mfma_f32_32x32x16_bf16 v[80:95], v[164:167], a[32:35], v[80:95]
ds_read_b128 v[148:151], v2 offset:41984
buffer_load_dwordx4 a[100:103], v2, s[4:7], s27 offen offset:1024
v_mfma_f32_32x32x16_bf16 v[96:111], v[168:171], a[32:35], v[96:111]
ds_read_b128 v[152:155], v2 offset:43008
v_mfma_f32_32x32x16_bf16 v[112:127], v[172:175], a[32:35], v[112:127]
ds_read_b128 v[156:159], v2 offset:44032
s_waitcnt vmcnt(17) lgkmcnt(4)
v_mfma_f32_32x32x16_bf16 v[64:79], v[128:131], a[36:39], v[64:79]
ds_read_b128 v[160:163], v2 offset:45056
buffer_load_dwordx4 a[104:107], v2, s[4:7], s27 offen offset:2048
v_mfma_f32_32x32x16_bf16 v[80:95], v[132:135], a[36:39], v[80:95]
ds_read_b128 v[164:167], v2 offset:46080
buffer_load_dwordx4 a[108:111], v2, s[4:7], s27 offen offset:3072
v_mfma_f32_32x32x16_bf16 v[96:111], v[136:139], a[36:39], v[96:111]
ds_read_b128 v[168:171], v2 offset:47104
v_mfma_f32_32x32x16_bf16 v[112:127], v[140:143], a[36:39], v[112:127]
ds_read_b128 v[172:175], v2 offset:48128
s_waitcnt vmcnt(18) lgkmcnt(4)
v_mfma_f32_32x32x16_bf16 v[64:79], v[144:147], a[40:43], v[64:79]
ds_read_b128 v[128:131], v2 offset:49152
s_add_u32 s27, s30, 28672
buffer_load_dwordx4 a[112:115], v2, s[4:7], s27 offen offset:0
v_mfma_f32_32x32x16_bf16 v[80:95], v[148:151], a[40:43], v[80:95]
ds_read_b128 v[132:135], v2 offset:50176
buffer_load_dwordx4 a[116:119], v2, s[4:7], s27 offen offset:1024
v_mfma_f32_32x32x16_bf16 v[96:111], v[152:155], a[40:43], v[96:111]
ds_read_b128 v[136:139], v2 offset:51200
v_mfma_f32_32x32x16_bf16 v[112:127], v[156:159], a[40:43], v[112:127]
ds_read_b128 v[140:143], v2 offset:52224
s_waitcnt vmcnt(19) lgkmcnt(4)
v_mfma_f32_32x32x16_bf16 v[64:79], v[160:163], a[44:47], v[64:79]
ds_read_b128 v[144:147], v2 offset:53248
buffer_load_dwordx4 a[120:123], v2, s[4:7], s27 offen offset:2048
v_mfma_f32_32x32x16_bf16 v[80:95], v[164:167], a[44:47], v[80:95]
ds_read_b128 v[148:151], v2 offset:54272
buffer_load_dwordx4 a[124:127], v2, s[4:7], s27 offen offset:3072
v_mfma_f32_32x32x16_bf16 v[96:111], v[168:171], a[44:47], v[96:111]
ds_read_b128 v[152:155], v2 offset:55296
v_mfma_f32_32x32x16_bf16 v[112:127], v[172:175], a[44:47], v[112:127]
ds_read_b128 v[156:159], v2 offset:56320
s_waitcnt vmcnt(20) lgkmcnt(4)
v_mfma_f32_32x32x16_bf16 v[64:79], v[128:131], a[48:51], v[64:79]
ds_read_b128 v[160:163], v2 offset:57344
s_add_u32 s27, s30, 32768
buffer_load_dwordx4 a[128:131], v2, s[4:7], s27 offen offset:0
v_mfma_f32_32x32x16_bf16 v[80:95], v[132:135], a[48:51], v[80:95]
ds_read_b128 v[164:167], v2 offset:58368
buffer_load_dwordx4 a[132:135], v2, s[4:7], s27 offen offset:1024
v_mfma_f32_32x32x16_bf16 v[96:111], v[136:139], a[48:51], v[96:111]
ds_read_b128 v[168:171], v2 offset:59392
v_mfma_f32_32x32x16_bf16 v[112:127], v[140:143], a[48:51], v[112:127]
ds_read_b128 v[172:175], v2 offset:60416
s_waitcnt vmcnt(21) lgkmcnt(4)
v_mfma_f32_32x32x16_bf16 v[64:79], v[144:147], a[52:55], v[64:79]
ds_read_b128 v[128:131], v3 offset:0
buffer_load_dwordx4 a[136:139], v2, s[4:7], s27 offen offset:2048
v_mfma_f32_32x32x16_bf16 v[80:95], v[148:151], a[52:55], v[80:95]
ds_read_b128 v[132:135], v3 offset:1024
buffer_load_dwordx4 a[140:143], v2, s[4:7], s27 offen offset:3072
v_mfma_f32_32x32x16_bf16 v[96:111], v[152:155], a[52:55], v[96:111]
ds_read_b128 v[136:139], v3 offset:2048
v_mfma_f32_32x32x16_bf16 v[112:127], v[156:159], a[52:55], v[112:127]
ds_read_b128 v[140:143], v3 offset:3072
s_waitcnt vmcnt(22) lgkmcnt(4)
v_mfma_f32_32x32x16_bf16 v[64:79], v[160:163], a[56:59], v[64:79]
ds_read_b128 v[144:147], v3 offset:4096
v_mfma_f32_32x32x16_bf16 v[80:95], v[164:167], a[56:59], v[80:95]
ds_read_b128 v[148:151], v3 offset:5120
v_mfma_f32_32x32x16_bf16 v[96:111], v[168:171], a[56:59], v[96:111]
ds_read_b128 v[152:155], v3 offset:6144
v_mfma_f32_32x32x16_bf16 v[112:127], v[172:175], a[56:59], v[112:127]
ds_read_b128 v[156:159], v3 offset:7168
s_waitcnt vmcnt(21) lgkmcnt(4)
v_mfma_f32_32x32x16_bf16 v[64:79], v[128:131], a[60:63], v[64:79]
ds_read_b128 v[160:163], v3 offset:8192
v_mfma_f32_32x32x16_bf16 v[80:95], v[132:135], a[60:63], v[80:95]
ds_read_b128 v[164:167], v3 offset:9216
v_mfma_f32_32x32x16_bf16 v[96:111], v[136:139], a[60:63], v[96:111]
ds_read_b128 v[168:171], v3 offset:10240
v_mfma_f32_32x32x16_bf16 v[112:127], v[140:143], a[60:63], v[112:127]
ds_read_b128 v[172:175], v3 offset:11264
s_waitcnt vmcnt(20) lgkmcnt(4)
v_mfma_f32_32x32x16_bf16 v[64:79], v[144:147], a[64:67], v[64:79]
ds_read_b128 v[128:131], v3 offset:12288
v_mfma_f32_32x32x16_bf16 v[80:95], v[148:151], a[64:67], v[80:95]
ds_read_b128 v[132:135], v3 offset:13312
v_mfma_f32_32x32x16_bf16 v[96:111], v[152:155], a[64:67], v[96:111]
ds_read_b128 v[136:139], v3 offset:14336
v_mfma_f32_32x32x16_bf16 v[112:127], v[156:159], a[64:67], v[112:127]
ds_read_b128 v[140:143], v3 offset:15360
s_add_u32 s3, s28, 0x80
buffer_load_dword v14, off, s[4:7], s3 sc1
s_waitcnt vmcnt(20) lgkmcnt(4)
v_mfma_f32_32x32x16_bf16 v[64:79], v[160:163], a[68:71], v[64:79]
ds_read_b128 v[144:147], v3 offset:16384
v_mfma_f32_32x32x16_bf16 v[80:95], v[164:167], a[68:71], v[80:95]
ds_read_b128 v[148:151], v3 offset:17408
v_mfma_f32_32x32x16_bf16 v[96:111], v[168:171], a[68:71], v[96:111]
ds_read_b128 v[152:155], v3 offset:18432
v_mfma_f32_32x32x16_bf16 v[112:127], v[172:175], a[68:71], v[112:127]
ds_read_b128 v[156:159], v3 offset:19456
s_waitcnt vmcnt(19) lgkmcnt(4)
v_mfma_f32_32x32x16_bf16 v[64:79], v[128:131], a[72:75], v[64:79]
ds_read_b128 v[160:163], v3 offset:20480
v_mfma_f32_32x32x16_bf16 v[80:95], v[132:135], a[72:75], v[80:95]
ds_read_b128 v[164:167], v3 offset:21504
v_mfma_f32_32x32x16_bf16 v[96:111], v[136:139], a[72:75], v[96:111]
ds_read_b128 v[168:171], v3 offset:22528
v_mfma_f32_32x32x16_bf16 v[112:127], v[140:143], a[72:75], v[112:127]
ds_read_b128 v[172:175], v3 offset:23552
s_waitcnt vmcnt(18) lgkmcnt(4)
v_mfma_f32_32x32x16_bf16 v[64:79], v[144:147], a[76:79], v[64:79]
ds_read_b128 v[128:131], v3 offset:24576
v_mfma_f32_32x32x16_bf16 v[80:95], v[148:151], a[76:79], v[80:95]
ds_read_b128 v[132:135], v3 offset:25600
v_mfma_f32_32x32x16_bf16 v[96:111], v[152:155], a[76:79], v[96:111]
ds_read_b128 v[136:139], v3 offset:26624
v_mfma_f32_32x32x16_bf16 v[112:127], v[156:159], a[76:79], v[112:127]
ds_read_b128 v[140:143], v3 offset:27648
s_waitcnt vmcnt(17) lgkmcnt(4)
v_mfma_f32_32x32x16_bf16 v[64:79], v[160:163], a[80:83], v[64:79]
ds_read_b128 v[144:147], v3 offset:28672
v_mfma_f32_32x32x16_bf16 v[80:95], v[164:167], a[80:83], v[80:95]
ds_read_b128 v[148:151], v3 offset:29696
v_mfma_f32_32x32x16_bf16 v[96:111], v[168:171], a[80:83], v[96:111]
ds_read_b128 v[152:155], v3 offset:30720
v_mfma_f32_32x32x16_bf16 v[112:127], v[172:175], a[80:83], v[112:127]
ds_read_b128 v[156:159], v3 offset:31744
s_waitcnt vmcnt(16) lgkmcnt(4)
v_mfma_f32_32x32x16_bf16 v[64:79], v[128:131], a[84:87], v[64:79]
ds_read_b128 v[160:163], v3 offset:32768
v_mfma_f32_32x32x16_bf16 v[80:95], v[132:135], a[84:87], v[80:95]
ds_read_b128 v[164:167], v3 offset:33792
v_mfma_f32_32x32x16_bf16 v[96:111], v[136:139], a[84:87], v[96:111]
ds_read_b128 v[168:171], v3 offset:34816
v_mfma_f32_32x32x16_bf16 v[112:127], v[140:143], a[84:87], v[112:127]
ds_read_b128 v[172:175], v3 offset:35840
s_waitcnt vmcnt(15) lgkmcnt(4)
v_mfma_f32_32x32x16_bf16 v[64:79], v[144:147], a[88:91], v[64:79]
ds_read_b128 v[128:131], v3 offset:36864
v_mfma_f32_32x32x16_bf16 v[80:95], v[148:151], a[88:91], v[80:95]
ds_read_b128 v[132:135], v3 offset:37888
v_mfma_f32_32x32x16_bf16 v[96:111], v[152:155], a[88:91], v[96:111]
ds_read_b128 v[136:139], v3 offset:38912
v_mfma_f32_32x32x16_bf16 v[112:127], v[156:159], a[88:91], v[112:127]
ds_read_b128 v[140:143], v3 offset:39936
s_waitcnt vmcnt(14) lgkmcnt(4)
v_mfma_f32_32x32x16_bf16 v[64:79], v[160:163], a[92:95], v[64:79]
ds_read_b128 v[144:147], v3 offset:40960
v_mfma_f32_32x32x16_bf16 v[80:95], v[164:167], a[92:95], v[80:95]
ds_read_b128 v[148:151], v3 offset:41984
v_mfma_f32_32x32x16_bf16 v[96:111], v[168:171], a[92:95], v[96:111]
ds_read_b128 v[152:155], v3 offset:43008
v_mfma_f32_32x32x16_bf16 v[112:127], v[172:175], a[92:95], v[112:127]
ds_read_b128 v[156:159], v3 offset:44032
s_waitcnt vmcnt(13) lgkmcnt(4)
v_mfma_f32_32x32x16_bf16 v[64:79], v[128:131], a[96:99], v[64:79]
ds_read_b128 v[160:163], v3 offset:45056
v_mfma_f32_32x32x16_bf16 v[80:95], v[132:135], a[96:99], v[80:95]
ds_read_b128 v[164:167], v3 offset:46080
v_mfma_f32_32x32x16_bf16 v[96:111], v[136:139], a[96:99], v[96:111]
ds_read_b128 v[168:171], v3 offset:47104
v_mfma_f32_32x32x16_bf16 v[112:127], v[140:143], a[96:99], v[112:127]
ds_read_b128 v[172:175], v3 offset:48128
s_waitcnt vmcnt(11) lgkmcnt(4)
v_mfma_f32_32x32x16_bf16 v[64:79], v[144:147], a[100:103], v[64:79]
ds_read_b128 v[128:131], v3 offset:49152
v_mfma_f32_32x32x16_bf16 v[80:95], v[148:151], a[100:103], v[80:95]
ds_read_b128 v[132:135], v3 offset:50176
v_mfma_f32_32x32x16_bf16 v[96:111], v[152:155], a[100:103], v[96:111]
ds_read_b128 v[136:139], v3 offset:51200
v_mfma_f32_32x32x16_bf16 v[112:127], v[156:159], a[100:103], v[112:127]
ds_read_b128 v[140:143], v3 offset:52224
s_waitcnt vmcnt(0)
v_cmp_le_u32 vcc, 4, v14
s_nop 3
s_and_b32 s85, vcc_lo, 1
s_cmp_lt_u32 s23, 62
s_cselect_b32 s85, s85, 0
s_add_u32 s86, s30, 0x12000
s_cmp_lg_u32 s85, 0
s_cselect_b32 s86, s86, 0x7fff0000
s_add_u32 s87, s86, 4096
s_waitcnt vmcnt(10) lgkmcnt(4)
v_mfma_f32_32x32x16_bf16 v[64:79], v[160:163], a[104:107], v[64:79]
ds_read_b128 v[144:147], v3 offset:53248
buffer_load_dwordx4 a[0:3], v2, s[4:7], s86 offen offset:0
v_mfma_f32_32x32x16_bf16 v[80:95], v[164:167], a[104:107], v[80:95]
ds_read_b128 v[148:151], v3 offset:54272
buffer_load_dwordx4 a[4:7], v2, s[4:7], s86 offen offset:1024
v_mfma_f32_32x32x16_bf16 v[96:111], v[168:171], a[104:107], v[96:111]
ds_read_b128 v[152:155], v3 offset:55296
buffer_load_dwordx4 a[8:11], v2, s[4:7], s86 offen offset:2048
v_mfma_f32_32x32x16_bf16 v[112:127], v[172:175], a[104:107], v[112:127]
ds_read_b128 v[156:159], v3 offset:56320
buffer_load_dwordx4 a[12:15], v2, s[4:7], s86 offen offset:3072
s_waitcnt vmcnt(13) lgkmcnt(4)
v_mfma_f32_32x32x16_bf16 v[64:79], v[128:131], a[108:111], v[64:79]
ds_read_b128 v[160:163], v3 offset:57344
buffer_load_dwordx4 a[16:19], v2, s[4:7], s87 offen offset:0
v_mfma_f32_32x32x16_bf16 v[80:95], v[132:135], a[108:111], v[80:95]
ds_read_b128 v[164:167], v3 offset:58368
buffer_load_dwordx4 a[20:23], v2, s[4:7], s87 offen offset:1024
v_mfma_f32_32x32x16_bf16 v[96:111], v[136:139], a[108:111], v[96:111]
ds_read_b128 v[168:171], v3 offset:59392
buffer_load_dwordx4 a[24:27], v2, s[4:7], s87 offen offset:2048
v_mfma_f32_32x32x16_bf16 v[112:127], v[140:143], a[108:111], v[112:127]
ds_read_b128 v[172:175], v3 offset:60416
buffer_load_dwordx4 a[28:31], v2, s[4:7], s87 offen offset:3072
s_waitcnt vmcnt(16) lgkmcnt(4)
v_mfma_f32_32x32x16_bf16 v[64:79], v[144:147], a[112:115], v[64:79]
ds_read_b128 v[128:131], v4 offset:0
v_mfma_f32_32x32x16_bf16 v[80:95], v[148:151], a[112:115], v[80:95]
ds_read_b128 v[132:135], v4 offset:1024
v_mfma_f32_32x32x16_bf16 v[96:111], v[152:155], a[112:115], v[96:111]
ds_read_b128 v[136:139], v4 offset:2048
v_mfma_f32_32x32x16_bf16 v[112:127], v[156:159], a[112:115], v[112:127]
ds_read_b128 v[140:143], v4 offset:3072
s_waitcnt vmcnt(15) lgkmcnt(4)
v_mfma_f32_32x32x16_bf16 v[64:79], v[160:163], a[116:119], v[64:79]
ds_read_b128 v[144:147], v4 offset:4096
v_mfma_f32_32x32x16_bf16 v[80:95], v[164:167], a[116:119], v[80:95]
ds_read_b128 v[148:151], v4 offset:5120
v_mfma_f32_32x32x16_bf16 v[96:111], v[168:171], a[116:119], v[96:111]
ds_read_b128 v[152:155], v4 offset:6144
v_mfma_f32_32x32x16_bf16 v[112:127], v[172:175], a[116:119], v[112:127]
ds_read_b128 v[156:159], v4 offset:7168
s_waitcnt vmcnt(14) lgkmcnt(4)
v_mfma_f32_32x32x16_bf16 v[64:79], v[128:131], a[120:123], v[64:79]
ds_read_b128 v[160:163], v4 offset:8192
v_mfma_f32_32x32x16_bf16 v[80:95], v[132:135], a[120:123], v[80:95]
ds_read_b128 v[164:167], v4 offset:9216
v_mfma_f32_32x32x16_bf16 v[96:111], v[136:139], a[120:123], v[96:111]
ds_read_b128 v[168:171], v4 offset:10240
v_mfma_f32_32x32x16_bf16 v[112:127], v[140:143], a[120:123], v[112:127]
ds_read_b128 v[172:175], v4 offset:11264
s_waitcnt vmcnt(13) lgkmcnt(4)
v_mfma_f32_32x32x16_bf16 v[64:79], v[144:147], a[124:127], v[64:79]
ds_read_b128 v[128:131], v4 offset:12288
v_mfma_f32_32x32x16_bf16 v[80:95], v[148:151], a[124:127], v[80:95]
ds_read_b128 v[132:135], v4 offset:13312
v_mfma_f32_32x32x16_bf16 v[96:111], v[152:155], a[124:127], v[96:111]
ds_read_b128 v[136:139], v4 offset:14336
v_mfma_f32_32x32x16_bf16 v[112:127], v[156:159], a[124:127], v[112:127]
ds_read_b128 v[140:143], v4 offset:15360
s_waitcnt vmcnt(12) lgkmcnt(4)
v_mfma_f32_32x32x16_bf16 v[64:79], v[160:163], a[128:131], v[64:79]
ds_read_b128 v[144:147], v4 offset:16384
v_mfma_f32_32x32x16_bf16 v[80:95], v[164:167], a[128:131], v[80:95]
ds_read_b128 v[148:151], v4 offset:17408
v_mfma_f32_32x32x16_bf16 v[96:111], v[168:171], a[128:131], v[96:111]
ds_read_b128 v[152:155], v4 offset:18432
v_mfma_f32_32x32x16_bf16 v[112:127], v[172:175], a[128:131], v[112:127]
ds_read_b128 v[156:159], v4 offset:19456
s_waitcnt vmcnt(11) lgkmcnt(4)
v_mfma_f32_32x32x16_bf16 v[64:79], v[128:131], a[132:135], v[64:79]
ds_read_b128 v[160:163], v4 offset:20480
v_mfma_f32_32x32x16_bf16 v[80:95], v[132:135], a[132:135], v[80:95]
ds_read_b128 v[164:167], v4 offset:21504
v_mfma_f32_32x32x16_bf16 v[96:111], v[136:139], a[132:135], v[96:111]
ds_read_b128 v[168:171], v4 offset:22528
v_mfma_f32_32x32x16_bf16 v[112:127], v[140:143], a[132:135], v[112:127]
ds_read_b128 v[172:175], v4 offset:23552
s_waitcnt vmcnt(10) lgkmcnt(4)
v_mfma_f32_32x32x16_bf16 v[64:79], v[144:147], a[136:139], v[64:79]
v_mfma_f32_32x32x16_bf16 v[80:95], v[148:151], a[136:139], v[80:95]
v_mfma_f32_32x32x16_bf16 v[96:111], v[152:155], a[136:139], v[96:111]
v_mfma_f32_32x32x16_bf16 v[112:127], v[156:159], a[136:139], v[112:127]
s_waitcnt vmcnt(9) lgkmcnt(0)
v_mfma_f32_32x32x16_bf16 v[64:79], v[160:163], a[140:143], v[64:79]
v_mfma_f32_32x32x16_bf16 v[80:95], v[164:167], a[140:143], v[80:95]
v_mfma_f32_32x32x16_bf16 v[96:111], v[168:171], a[140:143], v[96:111]
v_mfma_f32_32x32x16_bf16 v[112:127], v[172:175], a[140:143], v[112:127]
v_cvt_pk_bf16_f32 v16, v64, v65
v_cvt_pk_bf16_f32 v17, v66, v67
v_cvt_pk_bf16_f32 v18, v68, v69
v_cvt_pk_bf16_f32 v19, v70, v71
buffer_store_dwordx4 v[16:19], v2, s[4:7], s31 offen offset:0 sc1
v_cvt_pk_bf16_f32 v20, v72, v73
v_cvt_pk_bf16_f32 v21, v74, v75
v_cvt_pk_bf16_f32 v22, v76, v77
v_cvt_pk_bf16_f32 v23, v78, v79
buffer_store_dwordx4 v[20:23], v2, s[4:7], s31 offen offset:1024 sc1
v_cvt_pk_bf16_f32 v24, v80, v81
v_cvt_pk_bf16_f32 v25, v82, v83
v_cvt_pk_bf16_f32 v26, v84, v85
v_cvt_pk_bf16_f32 v27, v86, v87
buffer_store_dwordx4 v[24:27], v2, s[4:7], s31 offen offset:2048 sc1
v_cvt_pk_bf16_f32 v28, v88, v89
v_cvt_pk_bf16_f32 v29, v90, v91
v_cvt_pk_bf16_f32 v30, v92, v93
v_cvt_pk_bf16_f32 v31, v94, v95
buffer_store_dwordx4 v[28:31], v2, s[4:7], s31 offen offset:3072 sc1
v_cvt_pk_bf16_f32 v16, v96, v97
v_cvt_pk_bf16_f32 v17, v98, v99
v_cvt_pk_bf16_f32 v18, v100, v101
v_cvt_pk_bf16_f32 v19, v102, v103
s_add_u32 s37, s31, 4096
buffer_store_dwordx4 v[16:19], v2, s[4:7], s37 offen offset:0 sc1
v_cvt_pk_bf16_f32 v20, v104, v105
v_cvt_pk_bf16_f32 v21, v106, v107
v_cvt_pk_bf16_f32 v22, v108, v109
v_cvt_pk_bf16_f32 v23, v110, v111
buffer_store_dwordx4 v[20:23], v2, s[4:7], s37 offen offset:1024 sc1
v_cvt_pk_bf16_f32 v24, v112, v113
v_cvt_pk_bf16_f32 v25, v114, v115
v_cvt_pk_bf16_f32 v26, v116, v117
v_cvt_pk_bf16_f32 v27, v118, v119
buffer_store_dwordx4 v[24:27], v2, s[4:7], s37 offen offset:2048 sc1
v_cvt_pk_bf16_f32 v28, v120, v121
v_cvt_pk_bf16_f32 v29, v122, v123
v_cvt_pk_bf16_f32 v30, v124, v125
v_cvt_pk_bf16_f32 v31, v126, v127
buffer_store_dwordx4 v[28:31], v2, s[4:7], s37 offen offset:3072 sc1
s_waitcnt vmcnt(8)
s_mov_b32 s39, s29
s_add_u32 s28, s28, 0x80
s_add_u32 s29, s29, 0x1000
s_add_u32 s30, s30, 0x12000
s_add_u32 s31, s31, 0x100000
s_add_u32 s23, s23, 2
s_cmp_lt_u32 s23, 64
s_cbranch_scc1 L_bk_top
s_waitcnt vmcnt(0)
s_mov_b64 exec, 1
v_mov_b32 v13, 1
buffer_atomic_add v13, off, s[4:7], s39 sc1
s_mov_b64 exec, -1
s_waitcnt vmcnt(0)
s_branch L_END
s_endpgm
L_R_bv:
v_and_b32 v1, 63, v0
v_lshlrev_b32 v2, 4, v1
v_add_u32 v3, 61440, v2
v_add_u32 v4, 122880, v2
s_mov_b32 s32, 0x05040100
s_mov_b32 s33, 0x07060302
s_load_dwordx2 s[90:91], s[0:1], 56
s_waitcnt lgkmcnt(0)
s_mov_b32 s8, s90
s_and_b32 s9, s91, 0xffff
s_mov_b32 s10, 0x480000
s_mov_b32 s11, 0x20000
v_and_b32 v8, 31, v1
v_lshrrev_b32 v9, 5, v1
v_lshlrev_b32 v10, 16, v9
v_lshl_add_u32 v10, v8, 3, v10
s_lshl_b32 s3, s21, 8
v_add_u32 v10, s3, v10
s_mov_b32 s90, 0
L_w_47:
s_mul_i32 s34, s90, 36
s_add_u32 s34, s34, s20
s_mov_b32 s64, s34
s_mul_i32 s35, s34, 131072
s_add_u32 s36, s35, 0
buffer_load_dwordx2 v[16:17], v10, s[8:11], s36 offen
s_add_u32 s36, s35, 8192
buffer_load_dwordx2 v[18:19], v10, s[8:11], s36 offen
s_add_u32 s36, s35, 16384
buffer_load_dwordx2 v[20:21], v10, s[8:11], s36 offen
s_add_u32 s36, s35, 24576
buffer_load_dwordx2 v[22:23], v10, s[8:11], s36 offen
s_add_u32 s36, s35, 32768
buffer_load_dwordx2 v[24:25], v10, s[8:11], s36 offen
s_add_u32 s36, s35, 40960
buffer_load_dwordx2 v[26:27], v10, s[8:11], s36 offen
s_add_u32 s36, s35, 49152
buffer_load_dwordx2 v[28:29], v10, s[8:11], s36 offen
s_add_u32 s36, s35, 57344
buffer_load_dwordx2 v[30:31], v10, s[8:11], s36 offen
s_mul_i32 s34, s90, 36
s_add_u32 s34, s34, s20
s_add_u32 s34, s34, 4
s_mov_b32 s65, s34
s_mul_i32 s35, s34, 131072
s_add_u32 s36, s35, 0
buffer_load_dwordx2 v[32:33], v10, s[8:11], s36 offen
s_add_u32 s36, s35, 8192
buffer_load_dwordx2 v[34:35], v10, s[8:11], s36 offen
s_add_u32 s36, s35, 16384
buffer_load_dwordx2 v[36:37], v10, s[8:11], s36 offen
s_add_u32 s36, s35, 24576
buffer_load_dwordx2 v[38:39], v10, s[8:11], s36 offen
s_add_u32 s36, s35, 32768
buffer_load_dwordx2 v[40:41], v10, s[8:11], s36 offen
s_add_u32 s36, s35, 40960
buffer_load_dwordx2 v[42:43], v10, s[8:11], s36 offen
s_add_u32 s36, s35, 49152
buffer_load_dwordx2 v[44:45], v10, s[8:11], s36 offen
s_add_u32 s36, s35, 57344
buffer_load_dwordx2 v[46:47], v10, s[8:11], s36 offen
s_mul_i32 s34, s90, 36
s_add_u32 s34, s34, s20
s_add_u32 s34, s34, 8
s_mov_b32 s66, s34
s_mul_i32 s35, s34, 131072
s_add_u32 s36, s35, 0
buffer_load_dwordx2 v[48:49], v10, s[8:11], s36 offen
s_add_u32 s36, s35, 8192
buffer_load_dwordx2 v[50:51], v10, s[8:11], s36 offen
s_add_u32 s36, s35, 16384
buffer_load_dwordx2 v[52:53], v10, s[8:11], s36 offen
s_add_u32 s36, s35, 24576
buffer_load_dwordx2 v[54:55], v10, s[8:11], s36 offen
s_add_u32 s36, s35, 32768
buffer_load_dwordx2 v[56:57], v10, s[8:11], s36 offen
s_add_u32 s36, s35, 40960
buffer_load_dwordx2 v[58:59], v10, s[8:11], s36 offen
s_add_u32 s36, s35, 49152
buffer_load_dwordx2 v[60:61], v10, s[8:11], s36 offen
s_add_u32 s36, s35, 57344
buffer_load_dwordx2 v[62:63], v10, s[8:11], s36 offen
s_mul_i32 s34, s90, 36
s_add_u32 s34, s34, s20
s_add_u32 s34, s34, 12
s_mov_b32 s67, s34
s_mul_i32 s35, s34, 131072
s_add_u32 s36, s35, 0
buffer_load_dwordx2 v[64:65], v10, s[8:11], s36 offen
s_add_u32 s36, s35, 8192
buffer_load_dwordx2 v[66:67], v10, s[8:11], s36 offen
s_add_u32 s36, s35, 16384
buffer_load_dwordx2 v[68:69], v10, s[8:11], s36 offen
s_add_u32 s36, s35, 24576
buffer_load_dwordx2 v[70:71], v10, s[8:11], s36 offen
s_add_u32 s36, s35, 32768
buffer_load_dwordx2 v[72:73], v10, s[8:11], s36 offen
s_add_u32 s36, s35, 40960
buffer_load_dwordx2 v[74:75], v10, s[8:11], s36 offen
s_add_u32 s36, s35, 49152
buffer_load_dwordx2 v[76:77], v10, s[8:11], s36 offen
s_add_u32 s36, s35, 57344
buffer_load_dwordx2 v[78:79], v10, s[8:11], s36 offen
s_mul_i32 s34, s90, 36
s_add_u32 s34, s34, s20
s_add_u32 s34, s34, 16
s_mov_b32 s68, s34
s_mul_i32 s35, s34, 131072
s_add_u32 s36, s35, 0
buffer_load_dwordx2 v[80:81], v10, s[8:11], s36 offen
s_add_u32 s36, s35, 8192
buffer_load_dwordx2 v[82:83], v10, s[8:11], s36 offen
s_add_u32 s36, s35, 16384
buffer_load_dwordx2 v[84:85], v10, s[8:11], s36 offen
s_add_u32 s36, s35, 24576
buffer_load_dwordx2 v[86:87], v10, s[8:11], s36 offen
s_add_u32 s36, s35, 32768
buffer_load_dwordx2 v[88:89], v10, s[8:11], s36 offen
s_add_u32 s36, s35, 40960
buffer_load_dwordx2 v[90:91], v10, s[8:11], s36 offen
s_add_u32 s36, s35, 49152
buffer_load_dwordx2 v[92:93], v10, s[8:11], s36 offen
s_add_u32 s36, s35, 57344
buffer_load_dwordx2 v[94:95], v10, s[8:11], s36 offen
s_mul_i32 s34, s90, 36
s_add_u32 s34, s34, s20
s_add_u32 s34, s34, 20
s_mov_b32 s69, s34
s_mul_i32 s35, s34, 131072
s_add_u32 s36, s35, 0
buffer_load_dwordx2 v[96:97], v10, s[8:11], s36 offen
s_add_u32 s36, s35, 8192
buffer_load_dwordx2 v[98:99], v10, s[8:11], s36 offen
s_add_u32 s36, s35, 16384
buffer_load_dwordx2 v[100:101], v10, s[8:11], s36 offen
s_add_u32 s36, s35, 24576
buffer_load_dwordx2 v[102:103], v10, s[8:11], s36 offen
s_add_u32 s36, s35, 32768
buffer_load_dwordx2 v[104:105], v10, s[8:11], s36 offen
s_add_u32 s36, s35, 40960
buffer_load_dwordx2 v[106:107], v10, s[8:11], s36 offen
s_add_u32 s36, s35, 49152
buffer_load_dwordx2 v[108:109], v10, s[8:11], s36 offen
s_add_u32 s36, s35, 57344
buffer_load_dwordx2 v[110:111], v10, s[8:11], s36 offen
s_mul_i32 s34, s90, 36
s_add_u32 s34, s34, s20
s_add_u32 s34, s34, 24
s_mov_b32 s70, s34
s_mul_i32 s35, s34, 131072
s_add_u32 s36, s35, 0
buffer_load_dwordx2 v[112:113], v10, s[8:11], s36 offen
s_add_u32 s36, s35, 8192
buffer_load_dwordx2 v[114:115], v10, s[8:11], s36 offen
s_add_u32 s36, s35, 16384
buffer_load_dwordx2 v[116:117], v10, s[8:11], s36 offen
s_add_u32 s36, s35, 24576
buffer_load_dwordx2 v[118:119], v10, s[8:11], s36 offen
s_add_u32 s36, s35, 32768
buffer_load_dwordx2 v[120:121], v10, s[8:11], s36 offen
s_add_u32 s36, s35, 40960
buffer_load_dwordx2 v[122:123], v10, s[8:11], s36 offen
s_add_u32 s36, s35, 49152
buffer_load_dwordx2 v[124:125], v10, s[8:11], s36 offen
s_add_u32 s36, s35, 57344
buffer_load_dwordx2 v[126:127], v10, s[8:11], s36 offen
s_mul_i32 s34, s90, 36
s_add_u32 s34, s34, s20
s_add_u32 s34, s34, 28
s_mov_b32 s71, s34
s_mul_i32 s35, s34, 131072
s_add_u32 s36, s35, 0
buffer_load_dwordx2 v[128:129], v10, s[8:11], s36 offen
s_add_u32 s36, s35, 8192
buffer_load_dwordx2 v[130:131], v10, s[8:11], s36 offen
s_add_u32 s36, s35, 16384
buffer_load_dwordx2 v[132:133], v10, s[8:11], s36 offen
s_add_u32 s36, s35, 24576
buffer_load_dwordx2 v[134:135], v10, s[8:11], s36 offen
s_add_u32 s36, s35, 32768
buffer_load_dwordx2 v[136:137], v10, s[8:11], s36 offen
s_add_u32 s36, s35, 40960
buffer_load_dwordx2 v[138:139], v10, s[8:11], s36 offen
s_add_u32 s36, s35, 49152
buffer_load_dwordx2 v[140:141], v10, s[8:11], s36 offen
s_add_u32 s36, s35, 57344
buffer_load_dwordx2 v[142:143], v10, s[8:11], s36 offen
s_mul_i32 s34, s90, 36
s_add_u32 s34, s34, s20
s_add_u32 s34, s34, 32
s_mov_b32 s72, s34
s_mul_i32 s35, s34, 131072
s_add_u32 s36, s35, 0
buffer_load_dwordx2 v[144:145], v10, s[8:11], s36 offen
s_add_u32 s36, s35, 8192
buffer_load_dwordx2 v[146:147], v10, s[8:11], s36 offen
s_add_u32 s36, s35, 16384
buffer_load_dwordx2 v[148:149], v10, s[8:11], s36 offen
s_add_u32 s36, s35, 24576
buffer_load_dwordx2 v[150:151], v10, s[8:11], s36 offen
s_add_u32 s36, s35, 32768
buffer_load_dwordx2 v[152:153], v10, s[8:11], s36 offen
s_add_u32 s36, s35, 40960
buffer_load_dwordx2 v[154:155], v10, s[8:11], s36 offen
s_add_u32 s36, s35, 49152
buffer_load_dwordx2 v[156:157], v10, s[8:11], s36 offen
s_add_u32 s36, s35, 57344
buffer_load_dwordx2 v[158:159], v10, s[8:11], s36 offen
s_waitcnt vmcnt(63)
s_mul_i32 s3, s64, 4096
v_add_u32 v15, s3, v2
v_perm_b32 v160, v18, v16, s32
v_perm_b32 v161, v22, v20, s32
v_perm_b32 v162, v26, v24, s32
v_perm_b32 v163, v30, v28, s32
ds_write_b128 v15, v[160:163] offset:0
v_perm_b32 v164, v18, v16, s33
v_perm_b32 v165, v22, v20, s33
v_perm_b32 v166, v26, v24, s33
v_perm_b32 v167, v30, v28, s33
ds_write_b128 v15, v[164:167] offset:1024
v_perm_b32 v168, v19, v17, s32
v_perm_b32 v169, v23, v21, s32
v_perm_b32 v170, v27, v25, s32
v_perm_b32 v171, v31, v29, s32
ds_write_b128 v15, v[168:171] offset:2048
v_perm_b32 v172, v19, v17, s33
v_perm_b32 v173, v23, v21, s33
v_perm_b32 v174, v27, v25, s33
v_perm_b32 v175, v31, v29, s33
ds_write_b128 v15, v[172:175] offset:3072
s_waitcnt lgkmcnt(0)
s_waitcnt vmcnt(56)
s_mul_i32 s3, s65, 4096
v_add_u32 v15, s3, v2
v_perm_b32 v160, v34, v32, s32
v_perm_b32 v161, v38, v36, s32
v_perm_b32 v162, v42, v40, s32
v_perm_b32 v163, v46, v44, s32
ds_write_b128 v15, v[160:163] offset:0
v_perm_b32 v164, v34, v32, s33
v_perm_b32 v165, v38, v36, s33
v_perm_b32 v166, v42, v40, s33
v_perm_b32 v167, v46, v44, s33
ds_write_b128 v15, v[164:167] offset:1024
v_perm_b32 v168, v35, v33, s32
v_perm_b32 v169, v39, v37, s32
v_perm_b32 v170, v43, v41, s32
v_perm_b32 v171, v47, v45, s32
ds_write_b128 v15, v[168:171] offset:2048
v_perm_b32 v172, v35, v33, s33
v_perm_b32 v173, v39, v37, s33
v_perm_b32 v174, v43, v41, s33
v_perm_b32 v175, v47, v45, s33
ds_write_b128 v15, v[172:175] offset:3072
s_waitcnt lgkmcnt(0)
s_waitcnt vmcnt(48)
s_mul_i32 s3, s66, 4096
v_add_u32 v15, s3, v2
v_perm_b32 v160, v50, v48, s32
v_perm_b32 v161, v54, v52, s32
v_perm_b32 v162, v58, v56, s32
v_perm_b32 v163, v62, v60, s32
ds_write_b128 v15, v[160:163] offset:0
v_perm_b32 v164, v50, v48, s33
v_perm_b32 v165, v54, v52, s33
v_perm_b32 v166, v58, v56, s33
v_perm_b32 v167, v62, v60, s33
ds_write_b128 v15, v[164:167] offset:1024
v_perm_b32 v168, v51, v49, s32
v_perm_b32 v169, v55, v53, s32
v_perm_b32 v170, v59, v57, s32
v_perm_b32 v171, v63, v61, s32
ds_write_b128 v15, v[168:171] offset:2048
v_perm_b32 v172, v51, v49, s33
v_perm_b32 v173, v55, v53, s33
v_perm_b32 v174, v59, v57, s33
v_perm_b32 v175, v63, v61, s33
ds_write_b128 v15, v[172:175] offset:3072
s_waitcnt lgkmcnt(0)
s_waitcnt vmcnt(40)
s_mul_i32 s3, s67, 4096
v_add_u32 v15, s3, v2
v_perm_b32 v160, v66, v64, s32
v_perm_b32 v161, v70, v68, s32
v_perm_b32 v162, v74, v72, s32
v_perm_b32 v163, v78, v76, s32
ds_write_b128 v15, v[160:163] offset:0
v_perm_b32 v164, v66, v64, s33
v_perm_b32 v165, v70, v68, s33
v_perm_b32 v166, v74, v72, s33
v_perm_b32 v167, v78, v76, s33
ds_write_b128 v15, v[164:167] offset:1024
v_perm_b32 v168, v67, v65, s32
v_perm_b32 v169, v71, v69, s32
v_perm_b32 v170, v75, v73, s32
v_perm_b32 v171, v79, v77, s32
ds_write_b128 v15, v[168:171] offset:2048
v_perm_b32 v172, v67, v65, s33
v_perm_b32 v173, v71, v69, s33
v_perm_b32 v174, v75, v73, s33
v_perm_b32 v175, v79, v77, s33
ds_write_b128 v15, v[172:175] offset:3072
s_waitcnt lgkmcnt(0)
s_waitcnt vmcnt(32)
s_mul_i32 s3, s68, 4096
v_add_u32 v15, s3, v2
v_perm_b32 v160, v82, v80, s32
v_perm_b32 v161, v86, v84, s32
v_perm_b32 v162, v90, v88, s32
v_perm_b32 v163, v94, v92, s32
ds_write_b128 v15, v[160:163] offset:0
v_perm_b32 v164, v82, v80, s33
v_perm_b32 v165, v86, v84, s33
v_perm_b32 v166, v90, v88, s33
v_perm_b32 v167, v94, v92, s33
ds_write_b128 v15, v[164:167] offset:1024
v_perm_b32 v168, v83, v81, s32
v_perm_b32 v169, v87, v85, s32
v_perm_b32 v170, v91, v89, s32
v_perm_b32 v171, v95, v93, s32
ds_write_b128 v15, v[168:171] offset:2048
v_perm_b32 v172, v83, v81, s33
v_perm_b32 v173, v87, v85, s33
v_perm_b32 v174, v91, v89, s33
v_perm_b32 v175, v95, v93, s33
ds_write_b128 v15, v[172:175] offset:3072
s_waitcnt lgkmcnt(0)
s_waitcnt vmcnt(24)
s_mul_i32 s3, s69, 4096
v_add_u32 v15, s3, v2
v_perm_b32 v160, v98, v96, s32
v_perm_b32 v161, v102, v100, s32
v_perm_b32 v162, v106, v104, s32
v_perm_b32 v163, v110, v108, s32
ds_write_b128 v15, v[160:163] offset:0
v_perm_b32 v164, v98, v96, s33
v_perm_b32 v165, v102, v100, s33
v_perm_b32 v166, v106, v104, s33
v_perm_b32 v167, v110, v108, s33
ds_write_b128 v15, v[164:167] offset:1024
v_perm_b32 v168, v99, v97, s32
v_perm_b32 v169, v103, v101, s32
v_perm_b32 v170, v107, v105, s32
v_perm_b32 v171, v111, v109, s32
ds_write_b128 v15, v[168:171] offset:2048
v_perm_b32 v172, v99, v97, s33
v_perm_b32 v173, v103, v101, s33
v_perm_b32 v174, v107, v105, s33
v_perm_b32 v175, v111, v109, s33
ds_write_b128 v15, v[172:175] offset:3072
s_waitcnt lgkmcnt(0)
s_waitcnt vmcnt(16)
s_mul_i32 s3, s70, 4096
v_add_u32 v15, s3, v2
v_perm_b32 v160, v114, v112, s32
v_perm_b32 v161, v118, v116, s32
v_perm_b32 v162, v122, v120, s32
v_perm_b32 v163, v126, v124, s32
ds_write_b128 v15, v[160:163] offset:0
v_perm_b32 v164, v114, v112, s33
v_perm_b32 v165, v118, v116, s33
v_perm_b32 v166, v122, v120, s33
v_perm_b32 v167, v126, v124, s33
ds_write_b128 v15, v[164:167] offset:1024
v_perm_b32 v168, v115, v113, s32
v_perm_b32 v169, v119, v117, s32
v_perm_b32 v170, v123, v121, s32
v_perm_b32 v171, v127, v125, s32
ds_write_b128 v15, v[168:171] offset:2048
v_perm_b32 v172, v115, v113, s33
v_perm_b32 v173, v119, v117, s33
v_perm_b32 v174, v123, v121, s33
v_perm_b32 v175, v127, v125, s33
ds_write_b128 v15, v[172:175] offset:3072
s_waitcnt lgkmcnt(0)
s_waitcnt vmcnt(8)
s_mul_i32 s3, s71, 4096
v_add_u32 v15, s3, v2
v_perm_b32 v160, v130, v128, s32
v_perm_b32 v161, v134, v132, s32
v_perm_b32 v162, v138, v136, s32
v_perm_b32 v163, v142, v140, s32
ds_write_b128 v15, v[160:163] offset:0
v_perm_b32 v164, v130, v128, s33
v_perm_b32 v165, v134, v132, s33
v_perm_b32 v166, v138, v136, s33
v_perm_b32 v167, v142, v140, s33
ds_write_b128 v15, v[164:167] offset:1024
v_perm_b32 v168, v131, v129, s32
v_perm_b32 v169, v135, v133, s32
v_perm_b32 v170, v139, v137, s32
v_perm_b32 v171, v143, v141, s32
ds_write_b128 v15, v[168:171] offset:2048
v_perm_b32 v172, v131, v129, s33
v_perm_b32 v173, v135, v133, s33
v_perm_b32 v174, v139, v137, s33
v_perm_b32 v175, v143, v141, s33
ds_write_b128 v15, v[172:175] offset:3072
s_waitcnt lgkmcnt(0)
s_waitcnt vmcnt(0)
s_mul_i32 s3, s72, 4096
v_add_u32 v15, s3, v2
v_perm_b32 v160, v146, v144, s32
v_perm_b32 v161, v150, v148, s32
v_perm_b32 v162, v154, v152, s32
v_perm_b32 v163, v158, v156, s32
ds_write_b128 v15, v[160:163] offset:0
v_perm_b32 v164, v146, v144, s33
v_perm_b32 v165, v150, v148, s33
v_perm_b32 v166, v154, v152, s33
v_perm_b32 v167, v158, v156, s33
ds_write_b128 v15, v[164:167] offset:1024
v_perm_b32 v168, v147, v145, s32
v_perm_b32 v169, v151, v149, s32
v_perm_b32 v170, v155, v153, s32
v_perm_b32 v171, v159, v157, s32
ds_write_b128 v15, v[168:171] offset:2048
v_perm_b32 v172, v147, v145, s33
v_perm_b32 v173, v151, v149, s33
v_perm_b32 v174, v155, v153, s33
v_perm_b32 v175, v159, v157, s33
ds_write_b128 v15, v[172:175] offset:3072
s_waitcnt lgkmcnt(0)
s_add_u32 s90, s90, 1
s_cmp_lt_u32 s90, 1
s_cbranch_scc1 L_w_47
s_lshr_b32 s22, s20, 1
s_and_b32 s23, s20, 1
s_mov_b32 s28, 0x1000
s_mul_i32 s3, s22, 0x2000
s_add_u32 s28, s28, s3
s_mul_i32 s3, s23, 0x40
s_add_u32 s28, s28, s3
s_mov_b32 s29, 0x20000
s_mul_i32 s3, s22, 0x20000
s_add_u32 s29, s29, s3
s_mul_i32 s3, s23, 0x800
s_add_u32 s29, s29, s3
s_mul_i32 s3, s21, 0x40
s_add_u32 s29, s29, s3
s_mov_b32 s30, 0x740000
s_mul_i32 s3, s22, 0x480000
s_add_u32 s30, s30, s3
s_mul_i32 s3, s23, 0x9000
s_add_u32 s30, s30, s3
s_mov_b32 s31, 0x5402000
s_mul_i32 s3, s22, 0x2000000
s_add_u32 s31, s31, s3
s_mul_i32 s3, s23, 0x80000
s_add_u32 s31, s31, s3
s_mul_i32 s3, s21, 0x4000
s_add_u32 s31, s31, s3
s_mov_b32 s39, 0x7fff0000
s_mov_b32 s85, 0
s_waitcnt vmcnt(0) lgkmcnt(0)
s_cmp_lg_u32 s20, 0
s_cbranch_scc1 L_walld_49
s_mov_b32 s91, 0
L_wall_48:
buffer_load_dword v15, off, s[16:19], 0 sc1
s_add_u32 s91, s91, 1
s_cmp_gt_u32 s91, 200000
s_cbranch_scc1 L_FAIL
s_waitcnt vmcnt(0)
v_cmp_gt_u32 vcc, 32, v15
s_nop 0
s_nop 2
s_cbranch_vccz L_walld_49
s_sleep 4
s_branch L_wall_48
L_walld_49:
s_barrier
L_bv_top:
s_cmp_lg_u32 s85, 0
s_cbranch_scc1 L_warm_50
buffer_load_dword v15, off, s[4:7], s28 sc1
s_mov_b32 s91, 0
s_waitcnt vmcnt(0)
s_mov_b64 exec, 1
v_mov_b32 v13, 1
buffer_atomic_add v13, off, s[4:7], s39 sc1
s_mov_b64 exec, -1
v_cmp_gt_u32 vcc, 4, v15
s_nop 0
s_nop 2
s_cbranch_vccz L_spd_52
L_sp_51:
buffer_load_dword v15, off, s[4:7], s28 sc1
s_add_u32 s91, s91, 1
s_cmp_gt_u32 s91, 200000
s_cbranch_scc1 L_FAIL
s_waitcnt vmcnt(0)
v_cmp_gt_u32 vcc, 4, v15
s_nop 0
s_nop 2
s_cbranch_vccnz L_sp_51
L_spd_52:
s_mov_b32 s39, 0x7fff0000
s_add_u32 s27, s30, 0x0
buffer_load_dwordx4 a[0:3], v2, s[4:7], s27 offen offset:0
buffer_load_dwordx4 a[4:7], v2, s[4:7], s27 offen offset:1024
buffer_load_dwordx4 a[8:11], v2, s[4:7], s27 offen offset:2048
buffer_load_dwordx4 a[12:15], v2, s[4:7], s27 offen offset:3072
s_add_u32 s27, s30, 0x1000
buffer_load_dwordx4 a[16:19], v2, s[4:7], s27 offen offset:0
buffer_load_dwordx4 a[20:23], v2, s[4:7], s27 offen offset:1024
buffer_load_dwordx4 a[24:27], v2, s[4:7], s27 offen offset:2048
buffer_load_dwordx4 a[28:31], v2, s[4:7], s27 offen offset:3072
s_waitcnt vmcnt(0)
L_warm_50:
ds_read_b128 v[128:131], v2 offset:0
ds_read_b128 v[132:135], v2 offset:1024
ds_read_b128 v[136:139], v2 offset:2048
ds_read_b128 v[140:143], v2 offset:3072
ds_read_b128 v[144:147], v2 offset:4096
ds_read_b128 v[148:151], v2 offset:5120
ds_read_b128 v[152:155], v2 offset:6144
ds_read_b128 v[156:159], v2 offset:7168
s_waitcnt lgkmcnt(4)
v_mfma_f32_32x32x16_bf16 v[64:79], a[0:3], v[128:131], 0
ds_read_b128 v[160:163], v2 offset:8192
s_add_u32 s27, s30, 8192
buffer_load_dwordx4 a[32:35], v2, s[4:7], s27 offen offset:0
v_mfma_f32_32x32x16_bf16 v[80:95], a[0:3], v[132:135], 0
ds_read_b128 v[164:167], v2 offset:9216
buffer_load_dwordx4 a[36:39], v2, s[4:7], s27 offen offset:1024
v_mfma_f32_32x32x16_bf16 v[96:111], a[0:3], v[136:139], 0
ds_read_b128 v[168:171], v2 offset:10240
v_mfma_f32_32x32x16_bf16 v[112:127], a[0:3], v[140:143], 0
ds_read_b128 v[172:175], v2 offset:11264
s_waitcnt lgkmcnt(4)
v_mfma_f32_32x32x16_bf16 v[64:79], a[4:7], v[144:147], v[64:79]
ds_read_b128 v[128:131], v2 offset:12288
buffer_load_dwordx4 a[40:43], v2, s[4:7], s27 offen offset:2048
v_mfma_f32_32x32x16_bf16 v[80:95], a[4:7], v[148:151], v[80:95]
ds_read_b128 v[132:135], v2 offset:13312
buffer_load_dwordx4 a[44:47], v2, s[4:7], s27 offen offset:3072
v_mfma_f32_32x32x16_bf16 v[96:111], a[4:7], v[152:155], v[96:111]
ds_read_b128 v[136:139], v2 offset:14336
v_mfma_f32_32x32x16_bf16 v[112:127], a[4:7], v[156:159], v[112:127]
ds_read_b128 v[140:143], v2 offset:15360
s_waitcnt lgkmcnt(4)
v_mfma_f32_32x32x16_bf16 v[64:79], a[8:11], v[160:163], v[64:79]
ds_read_b128 v[144:147], v2 offset:16384
s_add_u32 s27, s30, 12288
buffer_load_dwordx4 a[48:51], v2, s[4:7], s27 offen offset:0
v_mfma_f32_32x32x16_bf16 v[80:95], a[8:11], v[164:167], v[80:95]
ds_read_b128 v[148:151], v2 offset:17408
buffer_load_dwordx4 a[52:55], v2, s[4:7], s27 offen offset:1024
v_mfma_f32_32x32x16_bf16 v[96:111], a[8:11], v[168:171], v[96:111]
ds_read_b128 v[152:155], v2 offset:18432
v_mfma_f32_32x32x16_bf16 v[112:127], a[8:11], v[172:175], v[112:127]
ds_read_b128 v[156:159], v2 offset:19456
s_waitcnt lgkmcnt(4)
v_mfma_f32_32x32x16_bf16 v[64:79], a[12:15], v[128:131], v[64:79]
ds_read_b128 v[160:163], v2 offset:20480
buffer_load_dwordx4 a[56:59], v2, s[4:7], s27 offen offset:2048
v_mfma_f32_32x32x16_bf16 v[80:95], a[12:15], v[132:135], v[80:95]
ds_read_b128 v[164:167], v2 offset:21504
buffer_load_dwordx4 a[60:63], v2, s[4:7], s27 offen offset:3072
v_mfma_f32_32x32x16_bf16 v[96:111], a[12:15], v[136:139], v[96:111]
ds_read_b128 v[168:171], v2 offset:22528
v_mfma_f32_32x32x16_bf16 v[112:127], a[12:15], v[140:143], v[112:127]
ds_read_b128 v[172:175], v2 offset:23552
s_waitcnt lgkmcnt(4)
v_mfma_f32_32x32x16_bf16 v[64:79], a[16:19], v[144:147], v[64:79]
ds_read_b128 v[128:131], v2 offset:24576
s_add_u32 s27, s30, 16384
buffer_load_dwordx4 a[64:67], v2, s[4:7], s27 offen offset:0
v_mfma_f32_32x32x16_bf16 v[80:95], a[16:19], v[148:151], v[80:95]
ds_read_b128 v[132:135], v2 offset:25600
buffer_load_dwordx4 a[68:71], v2, s[4:7], s27 offen offset:1024
v_mfma_f32_32x32x16_bf16 v[96:111], a[16:19], v[152:155], v[96:111]
ds_read_b128 v[136:139], v2 offset:26624
v_mfma_f32_32x32x16_bf16 v[112:127], a[16:19], v[156:159], v[112:127]
ds_read_b128 v[140:143], v2 offset:27648
s_waitcnt lgkmcnt(4)
v_mfma_f32_32x32x16_bf16 v[64:79], a[20:23], v[160:163], v[64:79]
ds_read_b128 v[144:147], v2 offset:28672
buffer_load_dwordx4 a[72:75], v2, s[4:7], s27 offen offset:2048
v_mfma_f32_32x32x16_bf16 v[80:95], a[20:23], v[164:167], v[80:95]
ds_read_b128 v[148:151], v2 offset:29696
buffer_load_dwordx4 a[76:79], v2, s[4:7], s27 offen offset:3072
v_mfma_f32_32x32x16_bf16 v[96:111], a[20:23], v[168:171], v[96:111]
ds_read_b128 v[152:155], v2 offset:30720
v_mfma_f32_32x32x16_bf16 v[112:127], a[20:23], v[172:175], v[112:127]
ds_read_b128 v[156:159], v2 offset:31744
s_waitcnt lgkmcnt(4)
v_mfma_f32_32x32x16_bf16 v[64:79], a[24:27], v[128:131], v[64:79]
ds_read_b128 v[160:163], v2 offset:32768
s_add_u32 s27, s30, 20480
buffer_load_dwordx4 a[80:83], v2, s[4:7], s27 offen offset:0
v_mfma_f32_32x32x16_bf16 v[80:95], a[24:27], v[132:135], v[80:95]
ds_read_b128 v[164:167], v2 offset:33792
buffer_load_dwordx4 a[84:87], v2, s[4:7], s27 offen offset:1024
v_mfma_f32_32x32x16_bf16 v[96:111], a[24:27], v[136:139], v[96:111]
ds_read_b128 v[168:171], v2 offset:34816
v_mfma_f32_32x32x16_bf16 v[112:127], a[24:27], v[140:143], v[112:127]
ds_read_b128 v[172:175], v2 offset:35840
s_waitcnt lgkmcnt(4)
v_mfma_f32_32x32x16_bf16 v[64:79], a[28:31], v[144:147], v[64:79]
ds_read_b128 v[128:131], v2 offset:36864
buffer_load_dwordx4 a[88:91], v2, s[4:7], s27 offen offset:2048
v_mfma_f32_32x32x16_bf16 v[80:95], a[28:31], v[148:151], v[80:95]
ds_read_b128 v[132:135], v2 offset:37888
buffer_load_dwordx4 a[92:95], v2, s[4:7], s27 offen offset:3072
v_mfma_f32_32x32x16_bf16 v[96:111], a[28:31], v[152:155], v[96:111]
ds_read_b128 v[136:139], v2 offset:38912
v_mfma_f32_32x32x16_bf16 v[112:127], a[28:31], v[156:159], v[112:127]
ds_read_b128 v[140:143], v2 offset:39936
s_waitcnt vmcnt(15) lgkmcnt(4)
v_mfma_f32_32x32x16_bf16 v[64:79], a[32:35], v[160:163], v[64:79]
ds_read_b128 v[144:147], v2 offset:40960
s_add_u32 s27, s30, 24576
buffer_load_dwordx4 a[96:99], v2, s[4:7], s27 offen offset:0
s_mov_b64 exec, 1
v_mov_b32 v13, 1
buffer_atomic_add v13, off, s[4:7], s39 sc1
s_mov_b64 exec, -1
v_mfma_f32_32x32x16_bf16 v[80:95], a[32:35], v[164:167], v[80:95]
ds_read_b128 v[148:151], v2 offset:41984
buffer_load_dwordx4 a[100:103], v2, s[4:7], s27 offen offset:1024
v_mfma_f32_32x32x16_bf16 v[96:111], a[32:35], v[168:171], v[96:111]
ds_read_b128 v[152:155], v2 offset:43008
v_mfma_f32_32x32x16_bf16 v[112:127], a[32:35], v[172:175], v[112:127]
ds_read_b128 v[156:159], v2 offset:44032
s_waitcnt vmcnt(17) lgkmcnt(4)
v_mfma_f32_32x32x16_bf16 v[64:79], a[36:39], v[128:131], v[64:79]
ds_read_b128 v[160:163], v2 offset:45056
buffer_load_dwordx4 a[104:107], v2, s[4:7], s27 offen offset:2048
v_mfma_f32_32x32x16_bf16 v[80:95], a[36:39], v[132:135], v[80:95]
ds_read_b128 v[164:167], v2 offset:46080
buffer_load_dwordx4 a[108:111], v2, s[4:7], s27 offen offset:3072
v_mfma_f32_32x32x16_bf16 v[96:111], a[36:39], v[136:139], v[96:111]
ds_read_b128 v[168:171], v2 offset:47104
v_mfma_f32_32x32x16_bf16 v[112:127], a[36:39], v[140:143], v[112:127]
ds_read_b128 v[172:175], v2 offset:48128
s_waitcnt vmcnt(18) lgkmcnt(4)
v_mfma_f32_32x32x16_bf16 v[64:79], a[40:43], v[144:147], v[64:79]
ds_read_b128 v[128:131], v2 offset:49152
s_add_u32 s27, s30, 28672
buffer_load_dwordx4 a[112:115], v2, s[4:7], s27 offen offset:0
v_mfma_f32_32x32x16_bf16 v[80:95], a[40:43], v[148:151], v[80:95]
ds_read_b128 v[132:135], v2 offset:50176
buffer_load_dwordx4 a[116:119], v2, s[4:7], s27 offen offset:1024
v_mfma_f32_32x32x16_bf16 v[96:111], a[40:43], v[152:155], v[96:111]
ds_read_b128 v[136:139], v2 offset:51200
v_mfma_f32_32x32x16_bf16 v[112:127], a[40:43], v[156:159], v[112:127]
ds_read_b128 v[140:143], v2 offset:52224
s_waitcnt vmcnt(19) lgkmcnt(4)
v_mfma_f32_32x32x16_bf16 v[64:79], a[44:47], v[160:163], v[64:79]
ds_read_b128 v[144:147], v2 offset:53248
buffer_load_dwordx4 a[120:123], v2, s[4:7], s27 offen offset:2048
v_mfma_f32_32x32x16_bf16 v[80:95], a[44:47], v[164:167], v[80:95]
ds_read_b128 v[148:151], v2 offset:54272
buffer_load_dwordx4 a[124:127], v2, s[4:7], s27 offen offset:3072
v_mfma_f32_32x32x16_bf16 v[96:111], a[44:47], v[168:171], v[96:111]
ds_read_b128 v[152:155], v2 offset:55296
v_mfma_f32_32x32x16_bf16 v[112:127], a[44:47], v[172:175], v[112:127]
ds_read_b128 v[156:159], v2 offset:56320
s_waitcnt vmcnt(20) lgkmcnt(4)
v_mfma_f32_32x32x16_bf16 v[64:79], a[48:51], v[128:131], v[64:79]
ds_read_b128 v[160:163], v2 offset:57344
s_add_u32 s27, s30, 32768
buffer_load_dwordx4 a[128:131], v2, s[4:7], s27 offen offset:0
v_mfma_f32_32x32x16_bf16 v[80:95], a[48:51], v[132:135], v[80:95]
ds_read_b128 v[164:167], v2 offset:58368
buffer_load_dwordx4 a[132:135], v2, s[4:7], s27 offen offset:1024
v_mfma_f32_32x32x16_bf16 v[96:111], a[48:51], v[136:139], v[96:111]
ds_read_b128 v[168:171], v2 offset:59392
v_mfma_f32_32x32x16_bf16 v[112:127], a[48:51], v[140:143], v[112:127]
ds_read_b128 v[172:175], v2 offset:60416
s_waitcnt vmcnt(21) lgkmcnt(4)
v_mfma_f32_32x32x16_bf16 v[64:79], a[52:55], v[144:147], v[64:79]
ds_read_b128 v[128:131], v3 offset:0
buffer_load_dwordx4 a[136:139], v2, s[4:7], s27 offen offset:2048
v_mfma_f32_32x32x16_bf16 v[80:95], a[52:55], v[148:151], v[80:95]
ds_read_b128 v[132:135], v3 offset:1024
buffer_load_dwordx4 a[140:143], v2, s[4:7], s27 offen offset:3072
v_mfma_f32_32x32x16_bf16 v[96:111], a[52:55], v[152:155], v[96:111]
ds_read_b128 v[136:139], v3 offset:2048
v_mfma_f32_32x32x16_bf16 v[112:127], a[52:55], v[156:159], v[112:127]
ds_read_b128 v[140:143], v3 offset:3072
s_waitcnt vmcnt(22) lgkmcnt(4)
v_mfma_f32_32x32x16_bf16 v[64:79], a[56:59], v[160:163], v[64:79]
ds_read_b128 v[144:147], v3 offset:4096
v_mfma_f32_32x32x16_bf16 v[80:95], a[56:59], v[164:167], v[80:95]
ds_read_b128 v[148:151], v3 offset:5120
v_mfma_f32_32x32x16_bf16 v[96:111], a[56:59], v[168:171], v[96:111]
ds_read_b128 v[152:155], v3 offset:6144
v_mfma_f32_32x32x16_bf16 v[112:127], a[56:59], v[172:175], v[112:127]
ds_read_b128 v[156:159], v3 offset:7168
s_waitcnt vmcnt(21) lgkmcnt(4)
v_mfma_f32_32x32x16_bf16 v[64:79], a[60:63], v[128:131], v[64:79]
ds_read_b128 v[160:163], v3 offset:8192
v_mfma_f32_32x32x16_bf16 v[80:95], a[60:63], v[132:135], v[80:95]
ds_read_b128 v[164:167], v3 offset:9216
v_mfma_f32_32x32x16_bf16 v[96:111], a[60:63], v[136:139], v[96:111]
ds_read_b128 v[168:171], v3 offset:10240
v_mfma_f32_32x32x16_bf16 v[112:127], a[60:63], v[140:143], v[112:127]
ds_read_b128 v[172:175], v3 offset:11264
s_waitcnt vmcnt(20) lgkmcnt(4)
v_mfma_f32_32x32x16_bf16 v[64:79], a[64:67], v[144:147], v[64:79]
ds_read_b128 v[128:131], v3 offset:12288
v_mfma_f32_32x32x16_bf16 v[80:95], a[64:67], v[148:151], v[80:95]
ds_read_b128 v[132:135], v3 offset:13312
v_mfma_f32_32x32x16_bf16 v[96:111], a[64:67], v[152:155], v[96:111]
ds_read_b128 v[136:139], v3 offset:14336
v_mfma_f32_32x32x16_bf16 v[112:127], a[64:67], v[156:159], v[112:127]
ds_read_b128 v[140:143], v3 offset:15360
s_add_u32 s3, s28, 0x80
buffer_load_dword v14, off, s[4:7], s3 sc1
s_waitcnt vmcnt(20) lgkmcnt(4)
v_mfma_f32_32x32x16_bf16 v[64:79], a[68:71], v[160:163], v[64:79]
ds_read_b128 v[144:147], v3 offset:16384
v_mfma_f32_32x32x16_bf16 v[80:95], a[68:71], v[164:167], v[80:95]
ds_read_b128 v[148:151], v3 offset:17408
v_mfma_f32_32x32x16_bf16 v[96:111], a[68:71], v[168:171], v[96:111]
ds_read_b128 v[152:155], v3 offset:18432
v_mfma_f32_32x32x16_bf16 v[112:127], a[68:71], v[172:175], v[112:127]
ds_read_b128 v[156:159], v3 offset:19456
s_waitcnt vmcnt(19) lgkmcnt(4)
v_mfma_f32_32x32x16_bf16 v[64:79], a[72:75], v[128:131], v[64:79]
ds_read_b128 v[160:163], v3 offset:20480
v_mfma_f32_32x32x16_bf16 v[80:95], a[72:75], v[132:135], v[80:95]
ds_read_b128 v[164:167], v3 offset:21504
v_mfma_f32_32x32x16_bf16 v[96:111], a[72:75], v[136:139], v[96:111]
ds_read_b128 v[168:171], v3 offset:22528
v_mfma_f32_32x32x16_bf16 v[112:127], a[72:75], v[140:143], v[112:127]
ds_read_b128 v[172:175], v3 offset:23552
s_waitcnt vmcnt(18) lgkmcnt(4)
v_mfma_f32_32x32x16_bf16 v[64:79], a[76:79], v[144:147], v[64:79]
ds_read_b128 v[128:131], v3 offset:24576
v_mfma_f32_32x32x16_bf16 v[80:95], a[76:79], v[148:151], v[80:95]
ds_read_b128 v[132:135], v3 offset:25600
v_mfma_f32_32x32x16_bf16 v[96:111], a[76:79], v[152:155], v[96:111]
ds_read_b128 v[136:139], v3 offset:26624
v_mfma_f32_32x32x16_bf16 v[112:127], a[76:79], v[156:159], v[112:127]
ds_read_b128 v[140:143], v3 offset:27648
s_waitcnt vmcnt(17) lgkmcnt(4)
v_mfma_f32_32x32x16_bf16 v[64:79], a[80:83], v[160:163], v[64:79]
ds_read_b128 v[144:147], v3 offset:28672
v_mfma_f32_32x32x16_bf16 v[80:95], a[80:83], v[164:167], v[80:95]
ds_read_b128 v[148:151], v3 offset:29696
v_mfma_f32_32x32x16_bf16 v[96:111], a[80:83], v[168:171], v[96:111]
ds_read_b128 v[152:155], v3 offset:30720
v_mfma_f32_32x32x16_bf16 v[112:127], a[80:83], v[172:175], v[112:127]
ds_read_b128 v[156:159], v3 offset:31744
s_waitcnt vmcnt(16) lgkmcnt(4)
v_mfma_f32_32x32x16_bf16 v[64:79], a[84:87], v[128:131], v[64:79]
ds_read_b128 v[160:163], v3 offset:32768
v_mfma_f32_32x32x16_bf16 v[80:95], a[84:87], v[132:135], v[80:95]
ds_read_b128 v[164:167], v3 offset:33792
v_mfma_f32_32x32x16_bf16 v[96:111], a[84:87], v[136:139], v[96:111]
ds_read_b128 v[168:171], v3 offset:34816
v_mfma_f32_32x32x16_bf16 v[112:127], a[84:87], v[140:143], v[112:127]
ds_read_b128 v[172:175], v3 offset:35840
s_waitcnt vmcnt(15) lgkmcnt(4)
v_mfma_f32_32x32x16_bf16 v[64:79], a[88:91], v[144:147], v[64:79]
ds_read_b128 v[128:131], v3 offset:36864
v_mfma_f32_32x32x16_bf16 v[80:95], a[88:91], v[148:151], v[80:95]
ds_read_b128 v[132:135], v3 offset:37888
v_mfma_f32_32x32x16_bf16 v[96:111], a[88:91], v[152:155], v[96:111]
ds_read_b128 v[136:139], v3 offset:38912
v_mfma_f32_32x32x16_bf16 v[112:127], a[88:91], v[156:159], v[112:127]
ds_read_b128 v[140:143], v3 offset:39936
s_waitcnt vmcnt(14) lgkmcnt(4)
v_mfma_f32_32x32x16_bf16 v[64:79], a[92:95], v[160:163], v[64:79]
ds_read_b128 v[144:147], v3 offset:40960
v_mfma_f32_32x32x16_bf16 v[80:95], a[92:95], v[164:167], v[80:95]
ds_read_b128 v[148:151], v3 offset:41984
v_mfma_f32_32x32x16_bf16 v[96:111], a[92:95], v[168:171], v[96:111]
ds_read_b128 v[152:155], v3 offset:43008
v_mfma_f32_32x32x16_bf16 v[112:127], a[92:95], v[172:175], v[112:127]
ds_read_b128 v[156:159], v3 offset:44032
s_waitcnt vmcnt(13) lgkmcnt(4)
v_mfma_f32_32x32x16_bf16 v[64:79], a[96:99], v[128:131], v[64:79]
ds_read_b128 v[160:163], v3 offset:45056
v_mfma_f32_32x32x16_bf16 v[80:95], a[96:99], v[132:135], v[80:95]
ds_read_b128 v[164:167], v3 offset:46080
v_mfma_f32_32x32x16_bf16 v[96:111], a[96:99], v[136:139], v[96:111]
ds_read_b128 v[168:171], v3 offset:47104
v_mfma_f32_32x32x16_bf16 v[112:127], a[96:99], v[140:143], v[112:127]
ds_read_b128 v[172:175], v3 offset:48128
s_waitcnt vmcnt(11) lgkmcnt(4)
v_mfma_f32_32x32x16_bf16 v[64:79], a[100:103], v[144:147], v[64:79]
ds_read_b128 v[128:131], v3 offset:49152
v_mfma_f32_32x32x16_bf16 v[80:95], a[100:103], v[148:151], v[80:95]
ds_read_b128 v[132:135], v3 offset:50176
v_mfma_f32_32x32x16_bf16 v[96:111], a[100:103], v[152:155], v[96:111]
ds_read_b128 v[136:139], v3 offset:51200
v_mfma_f32_32x32x16_bf16 v[112:127], a[100:103], v[156:159], v[112:127]
ds_read_b128 v[140:143], v3 offset:52224
s_waitcnt vmcnt(0)
v_cmp_le_u32 vcc, 4, v14
s_nop 3
s_and_b32 s85, vcc_lo, 1
s_cmp_lt_u32 s23, 62
s_cselect_b32 s85, s85, 0
s_add_u32 s86, s30, 0x12000
s_cmp_lg_u32 s85, 0
s_cselect_b32 s86, s86, 0x7fff0000
s_add_u32 s87, s86, 4096
s_waitcnt vmcnt(10) lgkmcnt(4)
v_mfma_f32_32x32x16_bf16 v[64:79], a[104:107], v[160:163], v[64:79]
ds_read_b128 v[144:147], v3 offset:53248
buffer_load_dwordx4 a[0:3], v2, s[4:7], s86 offen offset:0
v_mfma_f32_32x32x16_bf16 v[80:95], a[104:107], v[164:167], v[80:95]
ds_read_b128 v[148:151], v3 offset:54272
buffer_load_dwordx4 a[4:7], v2, s[4:7], s86 offen offset:1024
v_mfma_f32_32x32x16_bf16 v[96:111], a[104:107], v[168:171], v[96:111]
ds_read_b128 v[152:155], v3 offset:55296
buffer_load_dwordx4 a[8:11], v2, s[4:7], s86 offen offset:2048
v_mfma_f32_32x32x16_bf16 v[112:127], a[104:107], v[172:175], v[112:127]
ds_read_b128 v[156:159], v3 offset:56320
buffer_load_dwordx4 a[12:15], v2, s[4:7], s86 offen offset:3072
s_waitcnt vmcnt(13) lgkmcnt(4)
v_mfma_f32_32x32x16_bf16 v[64:79], a[108:111], v[128:131], v[64:79]
ds_read_b128 v[160:163], v3 offset:57344
buffer_load_dwordx4 a[16:19], v2, s[4:7], s87 offen offset:0
v_mfma_f32_32x32x16_bf16 v[80:95], a[108:111], v[132:135], v[80:95]
ds_read_b128 v[164:167], v3 offset:58368
buffer_load_dwordx4 a[20:23], v2, s[4:7], s87 offen offset:1024
v_mfma_f32_32x32x16_bf16 v[96:111], a[108:111], v[136:139], v[96:111]
ds_read_b128 v[168:171], v3 offset:59392
buffer_load_dwordx4 a[24:27], v2, s[4:7], s87 offen offset:2048
v_mfma_f32_32x32x16_bf16 v[112:127], a[108:111], v[140:143], v[112:127]
ds_read_b128 v[172:175], v3 offset:60416
buffer_load_dwordx4 a[28:31], v2, s[4:7], s87 offen offset:3072
s_waitcnt vmcnt(16) lgkmcnt(4)
v_mfma_f32_32x32x16_bf16 v[64:79], a[112:115], v[144:147], v[64:79]
ds_read_b128 v[128:131], v4 offset:0
v_mfma_f32_32x32x16_bf16 v[80:95], a[112:115], v[148:151], v[80:95]
ds_read_b128 v[132:135], v4 offset:1024
v_mfma_f32_32x32x16_bf16 v[96:111], a[112:115], v[152:155], v[96:111]
ds_read_b128 v[136:139], v4 offset:2048
v_mfma_f32_32x32x16_bf16 v[112:127], a[112:115], v[156:159], v[112:127]
ds_read_b128 v[140:143], v4 offset:3072
s_waitcnt vmcnt(15) lgkmcnt(4)
v_mfma_f32_32x32x16_bf16 v[64:79], a[116:119], v[160:163], v[64:79]
ds_read_b128 v[144:147], v4 offset:4096
v_mfma_f32_32x32x16_bf16 v[80:95], a[116:119], v[164:167], v[80:95]
ds_read_b128 v[148:151], v4 offset:5120
v_mfma_f32_32x32x16_bf16 v[96:111], a[116:119], v[168:171], v[96:111]
ds_read_b128 v[152:155], v4 offset:6144
v_mfma_f32_32x32x16_bf16 v[112:127], a[116:119], v[172:175], v[112:127]
ds_read_b128 v[156:159], v4 offset:7168
s_waitcnt vmcnt(14) lgkmcnt(4)
v_mfma_f32_32x32x16_bf16 v[64:79], a[120:123], v[128:131], v[64:79]
ds_read_b128 v[160:163], v4 offset:8192
v_mfma_f32_32x32x16_bf16 v[80:95], a[120:123], v[132:135], v[80:95]
ds_read_b128 v[164:167], v4 offset:9216
v_mfma_f32_32x32x16_bf16 v[96:111], a[120:123], v[136:139], v[96:111]
ds_read_b128 v[168:171], v4 offset:10240
v_mfma_f32_32x32x16_bf16 v[112:127], a[120:123], v[140:143], v[112:127]
ds_read_b128 v[172:175], v4 offset:11264
s_waitcnt vmcnt(13) lgkmcnt(4)
v_mfma_f32_32x32x16_bf16 v[64:79], a[124:127], v[144:147], v[64:79]
ds_read_b128 v[128:131], v4 offset:12288
v_mfma_f32_32x32x16_bf16 v[80:95], a[124:127], v[148:151], v[80:95]
ds_read_b128 v[132:135], v4 offset:13312
v_mfma_f32_32x32x16_bf16 v[96:111], a[124:127], v[152:155], v[96:111]
ds_read_b128 v[136:139], v4 offset:14336
v_mfma_f32_32x32x16_bf16 v[112:127], a[124:127], v[156:159], v[112:127]
ds_read_b128 v[140:143], v4 offset:15360
s_waitcnt vmcnt(12) lgkmcnt(4)
v_mfma_f32_32x32x16_bf16 v[64:79], a[128:131], v[160:163], v[64:79]
ds_read_b128 v[144:147], v4 offset:16384
v_mfma_f32_32x32x16_bf16 v[80:95], a[128:131], v[164:167], v[80:95]
ds_read_b128 v[148:151], v4 offset:17408
v_mfma_f32_32x32x16_bf16 v[96:111], a[128:131], v[168:171], v[96:111]
ds_read_b128 v[152:155], v4 offset:18432
v_mfma_f32_32x32x16_bf16 v[112:127], a[128:131], v[172:175], v[112:127]
ds_read_b128 v[156:159], v4 offset:19456
s_waitcnt vmcnt(11) lgkmcnt(4)
v_mfma_f32_32x32x16_bf16 v[64:79], a[132:135], v[128:131], v[64:79]
ds_read_b128 v[160:163], v4 offset:20480
v_mfma_f32_32x32x16_bf16 v[80:95], a[132:135], v[132:135], v[80:95]
ds_read_b128 v[164:167], v4 offset:21504
v_mfma_f32_32x32x16_bf16 v[96:111], a[132:135], v[136:139], v[96:111]
ds_read_b128 v[168:171], v4 offset:22528
v_mfma_f32_32x32x16_bf16 v[112:127], a[132:135], v[140:143], v[112:127]
ds_read_b128 v[172:175], v4 offset:23552
s_waitcnt vmcnt(10) lgkmcnt(4)
v_mfma_f32_32x32x16_bf16 v[64:79], a[136:139], v[144:147], v[64:79]
v_mfma_f32_32x32x16_bf16 v[80:95], a[136:139], v[148:151], v[80:95]
v_mfma_f32_32x32x16_bf16 v[96:111], a[136:139], v[152:155], v[96:111]
v_mfma_f32_32x32x16_bf16 v[112:127], a[136:139], v[156:159], v[112:127]
s_waitcnt vmcnt(9) lgkmcnt(0)
v_mfma_f32_32x32x16_bf16 v[64:79], a[140:143], v[160:163], v[64:79]
v_mfma_f32_32x32x16_bf16 v[80:95], a[140:143], v[164:167], v[80:95]
v_mfma_f32_32x32x16_bf16 v[96:111], a[140:143], v[168:171], v[96:111]
v_mfma_f32_32x32x16_bf16 v[112:127], a[140:143], v[172:175], v[112:127]
v_cvt_pk_bf16_f32 v16, v64, v65
v_cvt_pk_bf16_f32 v17, v66, v67
v_cvt_pk_bf16_f32 v18, v68, v69
v_cvt_pk_bf16_f32 v19, v70, v71
buffer_store_dwordx4 v[16:19], v2, s[4:7], s31 offen offset:0 sc1
v_cvt_pk_bf16_f32 v20, v72, v73
v_cvt_pk_bf16_f32 v21, v74, v75
v_cvt_pk_bf16_f32 v22, v76, v77
v_cvt_pk_bf16_f32 v23, v78, v79
buffer_store_dwordx4 v[20:23], v2, s[4:7], s31 offen offset:1024 sc1
v_cvt_pk_bf16_f32 v24, v80, v81
v_cvt_pk_bf16_f32 v25, v82, v83
v_cvt_pk_bf16_f32 v26, v84, v85
v_cvt_pk_bf16_f32 v27, v86, v87
buffer_store_dwordx4 v[24:27], v2, s[4:7], s31 offen offset:2048 sc1
v_cvt_pk_bf16_f32 v28, v88, v89
v_cvt_pk_bf16_f32 v29, v90, v91
v_cvt_pk_bf16_f32 v30, v92, v93
v_cvt_pk_bf16_f32 v31, v94, v95
buffer_store_dwordx4 v[28:31], v2, s[4:7], s31 offen offset:3072 sc1
v_cvt_pk_bf16_f32 v16, v96, v97
v_cvt_pk_bf16_f32 v17, v98, v99
v_cvt_pk_bf16_f32 v18, v100, v101
v_cvt_pk_bf16_f32 v19, v102, v103
s_add_u32 s37, s31, 4096
buffer_store_dwordx4 v[16:19], v2, s[4:7], s37 offen offset:0 sc1
v_cvt_pk_bf16_f32 v20, v104, v105
v_cvt_pk_bf16_f32 v21, v106, v107
v_cvt_pk_bf16_f32 v22, v108, v109
v_cvt_pk_bf16_f32 v23, v110, v111
buffer_store_dwordx4 v[20:23], v2, s[4:7], s37 offen offset:1024 sc1
v_cvt_pk_bf16_f32 v24, v112, v113
v_cvt_pk_bf16_f32 v25, v114, v115
v_cvt_pk_bf16_f32 v26, v116, v117
v_cvt_pk_bf16_f32 v27, v118, v119
buffer_store_dwordx4 v[24:27], v2, s[4:7], s37 offen offset:2048 sc1
v_cvt_pk_bf16_f32 v28, v120, v121
v_cvt_pk_bf16_f32 v29, v122, v123
v_cvt_pk_bf16_f32 v30, v124, v125
v_cvt_pk_bf16_f32 v31, v126, v127
buffer_store_dwordx4 v[28:31], v2, s[4:7], s37 offen offset:3072 sc1
s_waitcnt vmcnt(8)
s_mov_b32 s39, s29
s_add_u32 s28, s28, 0x80
s_add_u32 s29, s29, 0x1000
s_add_u32 s30, s30, 0x12000
s_add_u32 s31, s31, 0x100000
s_add_u32 s23, s23, 2
s_cmp_lt_u32 s23, 64
s_cbranch_scc1 L_bv_top
s_waitcnt vmcnt(0)
s_mov_b64 exec, 1
v_mov_b32 v13, 1
buffer_atomic_add v13, off, s[4:7], s39 sc1
s_mov_b64 exec, -1
s_waitcnt vmcnt(0)
s_branch L_END
s_endpgm
L_R_qa:
v_and_b32 v1, 63, v0
v_lshlrev_b32 v2, 4, v1
v_add_u32 v3, 61440, v2
v_add_u32 v4, 122880, v2
s_mov_b32 s32, 0x05040100
s_mov_b32 s33, 0x07060302
s_load_dwordx2 s[90:91], s[0:1], 40
s_waitcnt lgkmcnt(0)
s_mov_b32 s8, s90
s_and_b32 s9, s91, 0xffff
s_mov_b32 s10, 0x480000
s_mov_b32 s11, 0x20000
v_and_b32 v8, 31, v1
v_lshrrev_b32 v9, 5, v1
v_lshlrev_b32 v10, 16, v9
v_lshl_add_u32 v10, v8, 3, v10
s_lshl_b32 s3, s21, 8
v_add_u32 v10, s3, v10
s_mov_b32 s90, 0
L_w_53:
s_mul_i32 s34, s90, 36
s_add_u32 s34, s34, s20
s_mov_b32 s64, s34
s_mul_i32 s35, s34, 131072
s_add_u32 s36, s35, 0
buffer_load_dwordx2 v[16:17], v10, s[8:11], s36 offen
s_add_u32 s36, s35, 8192
buffer_load_dwordx2 v[18:19], v10, s[8:11], s36 offen
s_add_u32 s36, s35, 16384
buffer_load_dwordx2 v[20:21], v10, s[8:11], s36 offen
s_add_u32 s36, s35, 24576
buffer_load_dwordx2 v[22:23], v10, s[8:11], s36 offen
s_add_u32 s36, s35, 32768
buffer_load_dwordx2 v[24:25], v10, s[8:11], s36 offen
s_add_u32 s36, s35, 40960
buffer_load_dwordx2 v[26:27], v10, s[8:11], s36 offen
s_add_u32 s36, s35, 49152
buffer_load_dwordx2 v[28:29], v10, s[8:11], s36 offen
s_add_u32 s36, s35, 57344
buffer_load_dwordx2 v[30:31], v10, s[8:11], s36 offen
s_mul_i32 s34, s90, 36
s_add_u32 s34, s34, s20
s_add_u32 s34, s34, 4
s_mov_b32 s65, s34
s_mul_i32 s35, s34, 131072
s_add_u32 s36, s35, 0
buffer_load_dwordx2 v[32:33], v10, s[8:11], s36 offen
s_add_u32 s36, s35, 8192
buffer_load_dwordx2 v[34:35], v10, s[8:11], s36 offen
s_add_u32 s36, s35, 16384
buffer_load_dwordx2 v[36:37], v10, s[8:11], s36 offen
s_add_u32 s36, s35, 24576
buffer_load_dwordx2 v[38:39], v10, s[8:11], s36 offen
s_add_u32 s36, s35, 32768
buffer_load_dwordx2 v[40:41], v10, s[8:11], s36 offen
s_add_u32 s36, s35, 40960
buffer_load_dwordx2 v[42:43], v10, s[8:11], s36 offen
s_add_u32 s36, s35, 49152
buffer_load_dwordx2 v[44:45], v10, s[8:11], s36 offen
s_add_u32 s36, s35, 57344
buffer_load_dwordx2 v[46:47], v10, s[8:11], s36 offen
s_mul_i32 s34, s90, 36
s_add_u32 s34, s34, s20
s_add_u32 s34, s34, 8
s_mov_b32 s66, s34
s_mul_i32 s35, s34, 131072
s_add_u32 s36, s35, 0
buffer_load_dwordx2 v[48:49], v10, s[8:11], s36 offen
s_add_u32 s36, s35, 8192
buffer_load_dwordx2 v[50:51], v10, s[8:11], s36 offen
s_add_u32 s36, s35, 16384
buffer_load_dwordx2 v[52:53], v10, s[8:11], s36 offen
s_add_u32 s36, s35, 24576
buffer_load_dwordx2 v[54:55], v10, s[8:11], s36 offen
s_add_u32 s36, s35, 32768
buffer_load_dwordx2 v[56:57], v10, s[8:11], s36 offen
s_add_u32 s36, s35, 40960
buffer_load_dwordx2 v[58:59], v10, s[8:11], s36 offen
s_add_u32 s36, s35, 49152
buffer_load_dwordx2 v[60:61], v10, s[8:11], s36 offen
s_add_u32 s36, s35, 57344
buffer_load_dwordx2 v[62:63], v10, s[8:11], s36 offen
s_mul_i32 s34, s90, 36
s_add_u32 s34, s34, s20
s_add_u32 s34, s34, 12
s_mov_b32 s67, s34
s_mul_i32 s35, s34, 131072
s_add_u32 s36, s35, 0
buffer_load_dwordx2 v[64:65], v10, s[8:11], s36 offen
s_add_u32 s36, s35, 8192
buffer_load_dwordx2 v[66:67], v10, s[8:11], s36 offen
s_add_u32 s36, s35, 16384
buffer_load_dwordx2 v[68:69], v10, s[8:11], s36 offen
s_add_u32 s36, s35, 24576
buffer_load_dwordx2 v[70:71], v10, s[8:11], s36 offen
s_add_u32 s36, s35, 32768
buffer_load_dwordx2 v[72:73], v10, s[8:11], s36 offen
s_add_u32 s36, s35, 40960
buffer_load_dwordx2 v[74:75], v10, s[8:11], s36 offen
s_add_u32 s36, s35, 49152
buffer_load_dwordx2 v[76:77], v10, s[8:11], s36 offen
s_add_u32 s36, s35, 57344
buffer_load_dwordx2 v[78:79], v10, s[8:11], s36 offen
s_mul_i32 s34, s90, 36
s_add_u32 s34, s34, s20
s_add_u32 s34, s34, 16
s_mov_b32 s68, s34
s_mul_i32 s35, s34, 131072
s_add_u32 s36, s35, 0
buffer_load_dwordx2 v[80:81], v10, s[8:11], s36 offen
s_add_u32 s36, s35, 8192
buffer_load_dwordx2 v[82:83], v10, s[8:11], s36 offen
s_add_u32 s36, s35, 16384
buffer_load_dwordx2 v[84:85], v10, s[8:11], s36 offen
s_add_u32 s36, s35, 24576
buffer_load_dwordx2 v[86:87], v10, s[8:11], s36 offen
s_add_u32 s36, s35, 32768
buffer_load_dwordx2 v[88:89], v10, s[8:11], s36 offen
s_add_u32 s36, s35, 40960
buffer_load_dwordx2 v[90:91], v10, s[8:11], s36 offen
s_add_u32 s36, s35, 49152
buffer_load_dwordx2 v[92:93], v10, s[8:11], s36 offen
s_add_u32 s36, s35, 57344
buffer_load_dwordx2 v[94:95], v10, s[8:11], s36 offen
s_mul_i32 s34, s90, 36
s_add_u32 s34, s34, s20
s_add_u32 s34, s34, 20
s_mov_b32 s69, s34
s_mul_i32 s35, s34, 131072
s_add_u32 s36, s35, 0
buffer_load_dwordx2 v[96:97], v10, s[8:11], s36 offen
s_add_u32 s36, s35, 8192
buffer_load_dwordx2 v[98:99], v10, s[8:11], s36 offen
s_add_u32 s36, s35, 16384
buffer_load_dwordx2 v[100:101], v10, s[8:11], s36 offen
s_add_u32 s36, s35, 24576
buffer_load_dwordx2 v[102:103], v10, s[8:11], s36 offen
s_add_u32 s36, s35, 32768
buffer_load_dwordx2 v[104:105], v10, s[8:11], s36 offen
s_add_u32 s36, s35, 40960
buffer_load_dwordx2 v[106:107], v10, s[8:11], s36 offen
s_add_u32 s36, s35, 49152
buffer_load_dwordx2 v[108:109], v10, s[8:11], s36 offen
s_add_u32 s36, s35, 57344
buffer_load_dwordx2 v[110:111], v10, s[8:11], s36 offen
s_mul_i32 s34, s90, 36
s_add_u32 s34, s34, s20
s_add_u32 s34, s34, 24
s_mov_b32 s70, s34
s_mul_i32 s35, s34, 131072
s_add_u32 s36, s35, 0
buffer_load_dwordx2 v[112:113], v10, s[8:11], s36 offen
s_add_u32 s36, s35, 8192
buffer_load_dwordx2 v[114:115], v10, s[8:11], s36 offen
s_add_u32 s36, s35, 16384
buffer_load_dwordx2 v[116:117], v10, s[8:11], s36 offen
s_add_u32 s36, s35, 24576
buffer_load_dwordx2 v[118:119], v10, s[8:11], s36 offen
s_add_u32 s36, s35, 32768
buffer_load_dwordx2 v[120:121], v10, s[8:11], s36 offen
s_add_u32 s36, s35, 40960
buffer_load_dwordx2 v[122:123], v10, s[8:11], s36 offen
s_add_u32 s36, s35, 49152
buffer_load_dwordx2 v[124:125], v10, s[8:11], s36 offen
s_add_u32 s36, s35, 57344
buffer_load_dwordx2 v[126:127], v10, s[8:11], s36 offen
s_mul_i32 s34, s90, 36
s_add_u32 s34, s34, s20
s_add_u32 s34, s34, 28
s_mov_b32 s71, s34
s_mul_i32 s35, s34, 131072
s_add_u32 s36, s35, 0
buffer_load_dwordx2 v[128:129], v10, s[8:11], s36 offen
s_add_u32 s36, s35, 8192
buffer_load_dwordx2 v[130:131], v10, s[8:11], s36 offen
s_add_u32 s36, s35, 16384
buffer_load_dwordx2 v[132:133], v10, s[8:11], s36 offen
s_add_u32 s36, s35, 24576
buffer_load_dwordx2 v[134:135], v10, s[8:11], s36 offen
s_add_u32 s36, s35, 32768
buffer_load_dwordx2 v[136:137], v10, s[8:11], s36 offen
s_add_u32 s36, s35, 40960
buffer_load_dwordx2 v[138:139], v10, s[8:11], s36 offen
s_add_u32 s36, s35, 49152
buffer_load_dwordx2 v[140:141], v10, s[8:11], s36 offen
s_add_u32 s36, s35, 57344
buffer_load_dwordx2 v[142:143], v10, s[8:11], s36 offen
s_mul_i32 s34, s90, 36
s_add_u32 s34, s34, s20
s_add_u32 s34, s34, 32
s_mov_b32 s72, s34
s_mul_i32 s35, s34, 131072
s_add_u32 s36, s35, 0
buffer_load_dwordx2 v[144:145], v10, s[8:11], s36 offen
s_add_u32 s36, s35, 8192
buffer_load_dwordx2 v[146:147], v10, s[8:11], s36 offen
s_add_u32 s36, s35, 16384
buffer_load_dwordx2 v[148:149], v10, s[8:11], s36 offen
s_add_u32 s36, s35, 24576
buffer_load_dwordx2 v[150:151], v10, s[8:11], s36 offen
s_add_u32 s36, s35, 32768
buffer_load_dwordx2 v[152:153], v10, s[8:11], s36 offen
s_add_u32 s36, s35, 40960
buffer_load_dwordx2 v[154:155], v10, s[8:11], s36 offen
s_add_u32 s36, s35, 49152
buffer_load_dwordx2 v[156:157], v10, s[8:11], s36 offen
s_add_u32 s36, s35, 57344
buffer_load_dwordx2 v[158:159], v10, s[8:11], s36 offen
s_waitcnt vmcnt(63)
s_mul_i32 s3, s64, 4096
v_add_u32 v15, s3, v2
v_perm_b32 v160, v18, v16, s32
v_perm_b32 v161, v22, v20, s32
v_perm_b32 v162, v26, v24, s32
v_perm_b32 v163, v30, v28, s32
ds_write_b128 v15, v[160:163] offset:0
v_perm_b32 v164, v18, v16, s33
v_perm_b32 v165, v22, v20, s33
v_perm_b32 v166, v26, v24, s33
v_perm_b32 v167, v30, v28, s33
ds_write_b128 v15, v[164:167] offset:1024
v_perm_b32 v168, v19, v17, s32
v_perm_b32 v169, v23, v21, s32
v_perm_b32 v170, v27, v25, s32
v_perm_b32 v171, v31, v29, s32
ds_write_b128 v15, v[168:171] offset:2048
v_perm_b32 v172, v19, v17, s33
v_perm_b32 v173, v23, v21, s33
v_perm_b32 v174, v27, v25, s33
v_perm_b32 v175, v31, v29, s33
ds_write_b128 v15, v[172:175] offset:3072
s_waitcnt lgkmcnt(0)
s_waitcnt vmcnt(56)
s_mul_i32 s3, s65, 4096
v_add_u32 v15, s3, v2
v_perm_b32 v160, v34, v32, s32
v_perm_b32 v161, v38, v36, s32
v_perm_b32 v162, v42, v40, s32
v_perm_b32 v163, v46, v44, s32
ds_write_b128 v15, v[160:163] offset:0
v_perm_b32 v164, v34, v32, s33
v_perm_b32 v165, v38, v36, s33
v_perm_b32 v166, v42, v40, s33
v_perm_b32 v167, v46, v44, s33
ds_write_b128 v15, v[164:167] offset:1024
v_perm_b32 v168, v35, v33, s32
v_perm_b32 v169, v39, v37, s32
v_perm_b32 v170, v43, v41, s32
v_perm_b32 v171, v47, v45, s32
ds_write_b128 v15, v[168:171] offset:2048
v_perm_b32 v172, v35, v33, s33
v_perm_b32 v173, v39, v37, s33
v_perm_b32 v174, v43, v41, s33
v_perm_b32 v175, v47, v45, s33
ds_write_b128 v15, v[172:175] offset:3072
s_waitcnt lgkmcnt(0)
s_waitcnt vmcnt(48)
s_mul_i32 s3, s66, 4096
v_add_u32 v15, s3, v2
v_perm_b32 v160, v50, v48, s32
v_perm_b32 v161, v54, v52, s32
v_perm_b32 v162, v58, v56, s32
v_perm_b32 v163, v62, v60, s32
ds_write_b128 v15, v[160:163] offset:0
v_perm_b32 v164, v50, v48, s33
v_perm_b32 v165, v54, v52, s33
v_perm_b32 v166, v58, v56, s33
v_perm_b32 v167, v62, v60, s33
ds_write_b128 v15, v[164:167] offset:1024
v_perm_b32 v168, v51, v49, s32
v_perm_b32 v169, v55, v53, s32
v_perm_b32 v170, v59, v57, s32
v_perm_b32 v171, v63, v61, s32
ds_write_b128 v15, v[168:171] offset:2048
v_perm_b32 v172, v51, v49, s33
v_perm_b32 v173, v55, v53, s33
v_perm_b32 v174, v59, v57, s33
v_perm_b32 v175, v63, v61, s33
ds_write_b128 v15, v[172:175] offset:3072
s_waitcnt lgkmcnt(0)
s_waitcnt vmcnt(40)
s_mul_i32 s3, s67, 4096
v_add_u32 v15, s3, v2
v_perm_b32 v160, v66, v64, s32
v_perm_b32 v161, v70, v68, s32
v_perm_b32 v162, v74, v72, s32
v_perm_b32 v163, v78, v76, s32
ds_write_b128 v15, v[160:163] offset:0
v_perm_b32 v164, v66, v64, s33
v_perm_b32 v165, v70, v68, s33
v_perm_b32 v166, v74, v72, s33
v_perm_b32 v167, v78, v76, s33
ds_write_b128 v15, v[164:167] offset:1024
v_perm_b32 v168, v67, v65, s32
v_perm_b32 v169, v71, v69, s32
v_perm_b32 v170, v75, v73, s32
v_perm_b32 v171, v79, v77, s32
ds_write_b128 v15, v[168:171] offset:2048
v_perm_b32 v172, v67, v65, s33
v_perm_b32 v173, v71, v69, s33
v_perm_b32 v174, v75, v73, s33
v_perm_b32 v175, v79, v77, s33
ds_write_b128 v15, v[172:175] offset:3072
s_waitcnt lgkmcnt(0)
s_waitcnt vmcnt(32)
s_mul_i32 s3, s68, 4096
v_add_u32 v15, s3, v2
v_perm_b32 v160, v82, v80, s32
v_perm_b32 v161, v86, v84, s32
v_perm_b32 v162, v90, v88, s32
v_perm_b32 v163, v94, v92, s32
ds_write_b128 v15, v[160:163] offset:0
v_perm_b32 v164, v82, v80, s33
v_perm_b32 v165, v86, v84, s33
v_perm_b32 v166, v90, v88, s33
v_perm_b32 v167, v94, v92, s33
ds_write_b128 v15, v[164:167] offset:1024
v_perm_b32 v168, v83, v81, s32
v_perm_b32 v169, v87, v85, s32
v_perm_b32 v170, v91, v89, s32
v_perm_b32 v171, v95, v93, s32
ds_write_b128 v15, v[168:171] offset:2048
v_perm_b32 v172, v83, v81, s33
v_perm_b32 v173, v87, v85, s33
v_perm_b32 v174, v91, v89, s33
v_perm_b32 v175, v95, v93, s33
ds_write_b128 v15, v[172:175] offset:3072
s_waitcnt lgkmcnt(0)
s_waitcnt vmcnt(24)
s_mul_i32 s3, s69, 4096
v_add_u32 v15, s3, v2
v_perm_b32 v160, v98, v96, s32
v_perm_b32 v161, v102, v100, s32
v_perm_b32 v162, v106, v104, s32
v_perm_b32 v163, v110, v108, s32
ds_write_b128 v15, v[160:163] offset:0
v_perm_b32 v164, v98, v96, s33
v_perm_b32 v165, v102, v100, s33
v_perm_b32 v166, v106, v104, s33
v_perm_b32 v167, v110, v108, s33
ds_write_b128 v15, v[164:167] offset:1024
v_perm_b32 v168, v99, v97, s32
v_perm_b32 v169, v103, v101, s32
v_perm_b32 v170, v107, v105, s32
v_perm_b32 v171, v111, v109, s32
ds_write_b128 v15, v[168:171] offset:2048
v_perm_b32 v172, v99, v97, s33
v_perm_b32 v173, v103, v101, s33
v_perm_b32 v174, v107, v105, s33
v_perm_b32 v175, v111, v109, s33
ds_write_b128 v15, v[172:175] offset:3072
s_waitcnt lgkmcnt(0)
s_waitcnt vmcnt(16)
s_mul_i32 s3, s70, 4096
v_add_u32 v15, s3, v2
v_perm_b32 v160, v114, v112, s32
v_perm_b32 v161, v118, v116, s32
v_perm_b32 v162, v122, v120, s32
v_perm_b32 v163, v126, v124, s32
ds_write_b128 v15, v[160:163] offset:0
v_perm_b32 v164, v114, v112, s33
v_perm_b32 v165, v118, v116, s33
v_perm_b32 v166, v122, v120, s33
v_perm_b32 v167, v126, v124, s33
ds_write_b128 v15, v[164:167] offset:1024
v_perm_b32 v168, v115, v113, s32
v_perm_b32 v169, v119, v117, s32
v_perm_b32 v170, v123, v121, s32
v_perm_b32 v171, v127, v125, s32
ds_write_b128 v15, v[168:171] offset:2048
v_perm_b32 v172, v115, v113, s33
v_perm_b32 v173, v119, v117, s33
v_perm_b32 v174, v123, v121, s33
v_perm_b32 v175, v127, v125, s33
ds_write_b128 v15, v[172:175] offset:3072
s_waitcnt lgkmcnt(0)
s_waitcnt vmcnt(8)
s_mul_i32 s3, s71, 4096
v_add_u32 v15, s3, v2
v_perm_b32 v160, v130, v128, s32
v_perm_b32 v161, v134, v132, s32
v_perm_b32 v162, v138, v136, s32
v_perm_b32 v163, v142, v140, s32
ds_write_b128 v15, v[160:163] offset:0
v_perm_b32 v164, v130, v128, s33
v_perm_b32 v165, v134, v132, s33
v_perm_b32 v166, v138, v136, s33
v_perm_b32 v167, v142, v140, s33
ds_write_b128 v15, v[164:167] offset:1024
v_perm_b32 v168, v131, v129, s32
v_perm_b32 v169, v135, v133, s32
v_perm_b32 v170, v139, v137, s32
v_perm_b32 v171, v143, v141, s32
ds_write_b128 v15, v[168:171] offset:2048
v_perm_b32 v172, v131, v129, s33
v_perm_b32 v173, v135, v133, s33
v_perm_b32 v174, v139, v137, s33
v_perm_b32 v175, v143, v141, s33
ds_write_b128 v15, v[172:175] offset:3072
s_waitcnt lgkmcnt(0)
s_waitcnt vmcnt(0)
s_mul_i32 s3, s72, 4096
v_add_u32 v15, s3, v2
v_perm_b32 v160, v146, v144, s32
v_perm_b32 v161, v150, v148, s32
v_perm_b32 v162, v154, v152, s32
v_perm_b32 v163, v158, v156, s32
ds_write_b128 v15, v[160:163] offset:0
v_perm_b32 v164, v146, v144, s33
v_perm_b32 v165, v150, v148, s33
v_perm_b32 v166, v154, v152, s33
v_perm_b32 v167, v158, v156, s33
ds_write_b128 v15, v[164:167] offset:1024
v_perm_b32 v168, v147, v145, s32
v_perm_b32 v169, v151, v149, s32
v_perm_b32 v170, v155, v153, s32
v_perm_b32 v171, v159, v157, s32
ds_write_b128 v15, v[168:171] offset:2048
v_perm_b32 v172, v147, v145, s33
v_perm_b32 v173, v151, v149, s33
v_perm_b32 v174, v155, v153, s33
v_perm_b32 v175, v159, v157, s33
ds_write_b128 v15, v[172:175] offset:3072
s_waitcnt lgkmcnt(0)
s_add_u32 s90, s90, 1
s_cmp_lt_u32 s90, 1
s_cbranch_scc1 L_w_53
v_and_b32 v8, 31, v1
v_lshrrev_b32 v9, 5, v1
v_lshlrev_b32 v9, 2, v9
v_sub_u32 v8, v8, v9
v_cmp_le_i32_e64 s[40:41], 0, v8
v_cmp_le_i32_e64 s[42:43], 1, v8
v_cmp_le_i32_e64 s[44:45], 2, v8
v_cmp_le_i32_e64 s[46:47], 3, v8
v_cmp_le_i32_e64 s[48:49], 8, v8
v_cmp_le_i32_e64 s[50:51], 9, v8
v_cmp_le_i32_e64 s[52:53], 10, v8
v_cmp_le_i32_e64 s[54:55], 11, v8
v_cmp_le_i32_e64 s[64:65], 16, v8
v_cmp_le_i32_e64 s[66:67], 17, v8
v_cmp_le_i32_e64 s[68:69], 18, v8
v_cmp_le_i32_e64 s[70:71], 19, v8
v_cmp_le_i32_e64 s[72:73], 24, v8
v_cmp_le_i32_e64 s[74:75], 25, v8
v_cmp_le_i32_e64 s[76:77], 26, v8
v_cmp_le_i32_e64 s[78:79], 27, v8
v_mov_b32 v5, 0xff800000
v_lshrrev_b32 v9, 5, v1
v_and_b32 v8, 7, v1
v_lshlrev_b32 v8, 4, v8
v_lshl_add_u32 v6, v9, 7, v8
v_and_b32 v8, 31, v1
v_lshlrev_b32 v8, 4, v8
v_lshl_add_u32 v8, v9, 3, v8
v_add_u32 v7, 2048, v8
s_mov_b32 s38, 0x3e0293ee
s_lshr_b32 s62, s21, 3
s_lshr_b32 s22, s20, 1
s_and_b32 s23, s20, 1
s_mov_b32 s28, 0x1000
s_mul_i32 s3, s22, 0x2000
s_add_u32 s28, s28, s3
s_mul_i32 s3, s23, 0x40
s_add_u32 s28, s28, s3
s_mov_b32 s29, 0xc000
s_mul_i32 s3, s22, 0x4000
s_add_u32 s29, s29, s3
s_mul_i32 s3, s23, 0x100
s_add_u32 s29, s29, s3
s_mul_i32 s3, s62, 0x40
s_add_u32 s29, s29, s3
s_mov_b32 s30, 0x740000
s_mul_i32 s3, s22, 0x480000
s_add_u32 s30, s30, s3
s_mul_i32 s3, s23, 0x9000
s_add_u32 s30, s30, s3
s_mov_b32 s31, 0x9400000
s_mul_i32 s3, s22, 0x1000000
s_add_u32 s31, s31, s3
s_mul_i32 s3, s23, 0x40000
s_add_u32 s31, s31, s3
s_mul_i32 s3, s21, 0x2000
s_add_u32 s31, s31, s3
s_mov_b32 s80, 0x20000
s_mul_i32 s3, s22, 0x20000
s_add_u32 s80, s80, s3
s_mul_i32 s3, s23, 0x800
s_add_u32 s80, s80, s3
s_mul_i32 s3, s21, 0x40
s_add_u32 s80, s80, s3
s_mov_b32 s81, 0x60000
s_mul_i32 s3, s22, 0x20000
s_add_u32 s81, s81, s3
s_mul_i32 s3, s23, 0x800
s_add_u32 s81, s81, s3
s_mul_i32 s3, s21, 0x40
s_add_u32 s81, s81, s3
s_mov_b32 s82, 0x5400000
s_mul_i32 s3, s22, 0x2000000
s_add_u32 s82, s82, s3
s_mul_i32 s3, s23, 0x80000
s_add_u32 s82, s82, s3
s_mul_i32 s3, s21, 0x4000
s_add_u32 s82, s82, s3
s_mov_b32 s83, 0x3000000
s_mul_i32 s3, s22, 0x800000
s_add_u32 s83, s83, s3
s_mul_i32 s3, s23, 0x20000
s_add_u32 s83, s83, s3
s_mul_i32 s3, s21, 0x1000
s_add_u32 s83, s83, s3
v_cmp_eq_u32 vcc, 1, v1
v_mov_b32 v11, 2
v_mov_b32 v12, 4096
v_mov_b32 v8, 4
v_mov_b32 v9, 0x40000
v_cndmask_b32 v11, v11, v8, vcc
v_cndmask_b32 v12, v12, v9, vcc
s_mov_b32 s92, 0x7fff0000
s_mov_b32 s93, 0x7fff0000
s_mov_b32 s39, 0x7fff0000
s_mov_b32 s85, 0
s_waitcnt vmcnt(0) lgkmcnt(0)
s_cmp_lg_u32 s20, 0
s_cbranch_scc1 L_walld_55
s_mov_b32 s91, 0
L_wall_54:
buffer_load_dword v15, off, s[16:19], 0 sc1
s_add_u32 s91, s91, 1
s_cmp_gt_u32 s91, 200000
s_cbranch_scc1 L_FAIL
s_waitcnt vmcnt(0)
v_cmp_gt_u32 vcc, 32, v15
s_nop 0
s_nop 2
s_cbranch_vccz L_walld_55
s_sleep 4
s_branch L_wall_54
L_walld_55:
s_barrier
L_qa_top:
s_cmp_lg_u32 s85, 0
s_cbranch_scc1 L_warm_56
s_nop 7
s_nop 7
v_pk_mul_f32 v[176:177], v[176:177], v[28:29]
v_pk_mul_f32 v[178:179], v[178:179], v[28:29]
v_pk_mul_f32 v[180:181], v[180:181], v[28:29]
v_pk_mul_f32 v[182:183], v[182:183], v[28:29]
v_cvt_pk_bf16_f32 v32, v176, v177
v_cvt_pk_bf16_f32 v33, v178, v179
v_cvt_pk_bf16_f32 v34, v180, v181
v_cvt_pk_bf16_f32 v35, v182, v183
buffer_store_dwordx4 v[32:35], v2, s[4:7], s92 offen offset:0 sc1
v_pk_mul_f32 v[184:185], v[184:185], v[28:29]
v_pk_mul_f32 v[186:187], v[186:187], v[28:29]
v_pk_mul_f32 v[188:189], v[188:189], v[28:29]
v_pk_mul_f32 v[190:191], v[190:191], v[28:29]
v_cvt_pk_bf16_f32 v36, v184, v185
v_cvt_pk_bf16_f32 v37, v186, v187
v_cvt_pk_bf16_f32 v38, v188, v189
v_cvt_pk_bf16_f32 v39, v190, v191
buffer_store_dwordx4 v[36:39], v2, s[4:7], s92 offen offset:1024 sc1
v_pk_mul_f32 v[192:193], v[192:193], v[28:29]
v_pk_mul_f32 v[194:195], v[194:195], v[28:29]
v_pk_mul_f32 v[196:197], v[196:197], v[28:29]
v_pk_mul_f32 v[198:199], v[198:199], v[28:29]
v_cvt_pk_bf16_f32 v40, v192, v193
v_cvt_pk_bf16_f32 v41, v194, v195
v_cvt_pk_bf16_f32 v42, v196, v197
v_cvt_pk_bf16_f32 v43, v198, v199
buffer_store_dwordx4 v[40:43], v2, s[4:7], s92 offen offset:2048 sc1
v_pk_mul_f32 v[200:201], v[200:201], v[28:29]
v_pk_mul_f32 v[202:203], v[202:203], v[28:29]
v_pk_mul_f32 v[204:205], v[204:205], v[28:29]
v_pk_mul_f32 v[206:207], v[206:207], v[28:29]
v_cvt_pk_bf16_f32 v44, v200, v201
v_cvt_pk_bf16_f32 v45, v202, v203
v_cvt_pk_bf16_f32 v46, v204, v205
v_cvt_pk_bf16_f32 v47, v206, v207
buffer_store_dwordx4 v[44:47], v2, s[4:7], s92 offen offset:3072 sc1
s_mov_b32 s92, 0x7fff0000
s_mov_b32 s93, 0x7fff0000
buffer_load_dword v15, off, s[4:7], s80 sc1
s_mov_b32 s91, 0
s_waitcnt vmcnt(0)
s_mov_b64 exec, 1
v_mov_b32 v13, 1
buffer_atomic_add v13, off, s[4:7], s39 sc1
s_mov_b64 exec, -1
v_cmp_gt_u32 vcc, 2, v15
s_nop 0
s_nop 2
s_cbranch_vccz L_spd_58
L_sp_57:
buffer_load_dword v15, off, s[4:7], s80 sc1
s_add_u32 s91, s91, 1
s_cmp_gt_u32 s91, 200000
s_cbranch_scc1 L_FAIL
s_waitcnt vmcnt(0)
v_cmp_gt_u32 vcc, 2, v15
s_nop 0
s_nop 2
s_cbranch_vccnz L_sp_57
L_spd_58:
s_mov_b32 s39, 0x7fff0000
s_add_u32 s27, s30, 0x0
buffer_load_dwordx4 a[0:3], v2, s[4:7], s27 offen offset:0
buffer_load_dwordx4 a[4:7], v2, s[4:7], s27 offen offset:1024
buffer_load_dwordx4 a[8:11], v2, s[4:7], s27 offen offset:2048
buffer_load_dwordx4 a[12:15], v2, s[4:7], s27 offen offset:3072
s_add_u32 s27, s30, 0x1000
buffer_load_dwordx4 a[16:19], v2, s[4:7], s27 offen offset:0
buffer_load_dwordx4 a[20:23], v2, s[4:7], s27 offen offset:1024
buffer_load_dwordx4 a[24:27], v2, s[4:7], s27 offen offset:2048
buffer_load_dwordx4 a[28:31], v2, s[4:7], s27 offen offset:3072
s_waitcnt vmcnt(0)
L_warm_56:
ds_read_b128 v[128:131], v2 offset:0
ds_read_b128 v[132:135], v2 offset:1024
ds_read_b128 v[136:139], v2 offset:2048
ds_read_b128 v[140:143], v2 offset:3072
ds_read_b128 v[144:147], v2 offset:4096
ds_read_b128 v[148:151], v2 offset:5120
ds_read_b128 v[152:155], v2 offset:6144
ds_read_b128 v[156:159], v2 offset:7168
s_waitcnt lgkmcnt(4)
v_mfma_f32_32x32x16_bf16 v[64:79], v[128:131], a[0:3], 0
ds_read_b128 v[160:163], v2 offset:8192
s_add_u32 s27, s30, 8192
buffer_load_dwordx4 a[32:35], v2, s[4:7], s27 offen offset:0
v_mfma_f32_32x32x16_bf16 v[80:95], v[132:135], a[0:3], 0
ds_read_b128 v[164:167], v2 offset:9216
buffer_load_dwordx4 a[36:39], v2, s[4:7], s27 offen offset:1024
v_mfma_f32_32x32x16_bf16 v[96:111], v[136:139], a[0:3], 0
ds_read_b128 v[168:171], v2 offset:10240
v_mfma_f32_32x32x16_bf16 v[112:127], v[140:143], a[0:3], 0
ds_read_b128 v[172:175], v2 offset:11264
s_waitcnt lgkmcnt(4)
v_mfma_f32_32x32x16_bf16 v[64:79], v[144:147], a[4:7], v[64:79]
ds_read_b128 v[128:131], v2 offset:12288
buffer_load_dwordx4 a[40:43], v2, s[4:7], s27 offen offset:2048
v_pk_mul_f32 v[176:177], v[176:177], v[28:29]
v_pk_mul_f32 v[178:179], v[178:179], v[28:29]
v_pk_mul_f32 v[180:181], v[180:181], v[28:29]
v_mfma_f32_32x32x16_bf16 v[80:95], v[148:151], a[4:7], v[80:95]
ds_read_b128 v[132:135], v2 offset:13312
buffer_load_dwordx4 a[44:47], v2, s[4:7], s27 offen offset:3072
v_pk_mul_f32 v[182:183], v[182:183], v[28:29]
v_cvt_pk_bf16_f32 v32, v176, v177
v_cvt_pk_bf16_f32 v33, v178, v179
v_mfma_f32_32x32x16_bf16 v[96:111], v[152:155], a[4:7], v[96:111]
ds_read_b128 v[136:139], v2 offset:14336
v_cvt_pk_bf16_f32 v34, v180, v181
v_cvt_pk_bf16_f32 v35, v182, v183
buffer_store_dwordx4 v[32:35], v2, s[4:7], s92 offen offset:0 sc1
v_pk_mul_f32 v[184:185], v[184:185], v[28:29]
v_mfma_f32_32x32x16_bf16 v[112:127], v[156:159], a[4:7], v[112:127]
ds_read_b128 v[140:143], v2 offset:15360
v_pk_mul_f32 v[186:187], v[186:187], v[28:29]
v_pk_mul_f32 v[188:189], v[188:189], v[28:29]
v_pk_mul_f32 v[190:191], v[190:191], v[28:29]
v_cvt_pk_bf16_f32 v36, v184, v185
s_waitcnt lgkmcnt(4)
v_mfma_f32_32x32x16_bf16 v[64:79], v[160:163], a[8:11], v[64:79]
ds_read_b128 v[144:147], v2 offset:16384
s_add_u32 s27, s30, 12288
buffer_load_dwordx4 a[48:51], v2, s[4:7], s27 offen offset:0
v_cvt_pk_bf16_f32 v37, v186, v187
v_cvt_pk_bf16_f32 v38, v188, v189
v_cvt_pk_bf16_f32 v39, v190, v191
v_mfma_f32_32x32x16_bf16 v[80:95], v[164:167], a[8:11], v[80:95]
ds_read_b128 v[148:151], v2 offset:17408
buffer_load_dwordx4 a[52:55], v2, s[4:7], s27 offen offset:1024
buffer_store_dwordx4 v[36:39], v2, s[4:7], s92 offen offset:1024 sc1
v_pk_mul_f32 v[192:193], v[192:193], v[28:29]
v_pk_mul_f32 v[194:195], v[194:195], v[28:29]
v_mfma_f32_32x32x16_bf16 v[96:111], v[168:171], a[8:11], v[96:111]
ds_read_b128 v[152:155], v2 offset:18432
v_pk_mul_f32 v[196:197], v[196:197], v[28:29]
v_pk_mul_f32 v[198:199], v[198:199], v[28:29]
v_cvt_pk_bf16_f32 v40, v192, v193
v_cvt_pk_bf16_f32 v41, v194, v195
v_mfma_f32_32x32x16_bf16 v[112:127], v[172:175], a[8:11], v[112:127]
ds_read_b128 v[156:159], v2 offset:19456
v_cvt_pk_bf16_f32 v42, v196, v197
v_cvt_pk_bf16_f32 v43, v198, v199
buffer_store_dwordx4 v[40:43], v2, s[4:7], s92 offen offset:2048 sc1
v_pk_mul_f32 v[200:201], v[200:201], v[28:29]
s_waitcnt lgkmcnt(4)
v_mfma_f32_32x32x16_bf16 v[64:79], v[128:131], a[12:15], v[64:79]
ds_read_b128 v[160:163], v2 offset:20480
buffer_load_dwordx4 a[56:59], v2, s[4:7], s27 offen offset:2048
v_pk_mul_f32 v[202:203], v[202:203], v[28:29]
v_pk_mul_f32 v[204:205], v[204:205], v[28:29]
v_pk_mul_f32 v[206:207], v[206:207], v[28:29]
v_mfma_f32_32x32x16_bf16 v[80:95], v[132:135], a[12:15], v[80:95]
ds_read_b128 v[164:167], v2 offset:21504
buffer_load_dwordx4 a[60:63], v2, s[4:7], s27 offen offset:3072
v_cvt_pk_bf16_f32 v44, v200, v201
v_cvt_pk_bf16_f32 v45, v202, v203
v_cvt_pk_bf16_f32 v46, v204, v205
v_mfma_f32_32x32x16_bf16 v[96:111], v[136:139], a[12:15], v[96:111]
ds_read_b128 v[168:171], v2 offset:22528
v_cvt_pk_bf16_f32 v47, v206, v207
buffer_store_dwordx4 v[44:47], v2, s[4:7], s92 offen offset:3072 sc1
v_mfma_f32_32x32x16_bf16 v[112:127], v[140:143], a[12:15], v[112:127]
ds_read_b128 v[172:175], v2 offset:23552
s_waitcnt lgkmcnt(4)
v_mfma_f32_32x32x16_bf16 v[64:79], v[144:147], a[16:19], v[64:79]
ds_read_b128 v[128:131], v2 offset:24576
s_add_u32 s27, s30, 16384
buffer_load_dwordx4 a[64:67], v2, s[4:7], s27 offen offset:0
v_mfma_f32_32x32x16_bf16 v[80:95], v[148:151], a[16:19], v[80:95]
ds_read_b128 v[132:135], v2 offset:25600
buffer_load_dwordx4 a[68:71], v2, s[4:7], s27 offen offset:1024
v_mfma_f32_32x32x16_bf16 v[96:111], v[152:155], a[16:19], v[96:111]
ds_read_b128 v[136:139], v2 offset:26624
v_mfma_f32_32x32x16_bf16 v[112:127], v[156:159], a[16:19], v[112:127]
ds_read_b128 v[140:143], v2 offset:27648
s_waitcnt lgkmcnt(4)
v_mfma_f32_32x32x16_bf16 v[64:79], v[160:163], a[20:23], v[64:79]
ds_read_b128 v[144:147], v2 offset:28672
buffer_load_dwordx4 a[72:75], v2, s[4:7], s27 offen offset:2048
v_mfma_f32_32x32x16_bf16 v[80:95], v[164:167], a[20:23], v[80:95]
ds_read_b128 v[148:151], v2 offset:29696
buffer_load_dwordx4 a[76:79], v2, s[4:7], s27 offen offset:3072
v_mfma_f32_32x32x16_bf16 v[96:111], v[168:171], a[20:23], v[96:111]
ds_read_b128 v[152:155], v2 offset:30720
v_mfma_f32_32x32x16_bf16 v[112:127], v[172:175], a[20:23], v[112:127]
ds_read_b128 v[156:159], v2 offset:31744
s_waitcnt lgkmcnt(4)
v_mfma_f32_32x32x16_bf16 v[64:79], v[128:131], a[24:27], v[64:79]
ds_read_b128 v[160:163], v2 offset:32768
s_add_u32 s27, s30, 20480
buffer_load_dwordx4 a[80:83], v2, s[4:7], s27 offen offset:0
v_mfma_f32_32x32x16_bf16 v[80:95], v[132:135], a[24:27], v[80:95]
ds_read_b128 v[164:167], v2 offset:33792
buffer_load_dwordx4 a[84:87], v2, s[4:7], s27 offen offset:1024
v_mfma_f32_32x32x16_bf16 v[96:111], v[136:139], a[24:27], v[96:111]
ds_read_b128 v[168:171], v2 offset:34816
v_mfma_f32_32x32x16_bf16 v[112:127], v[140:143], a[24:27], v[112:127]
ds_read_b128 v[172:175], v2 offset:35840
s_waitcnt lgkmcnt(4)
v_mfma_f32_32x32x16_bf16 v[64:79], v[144:147], a[28:31], v[64:79]
ds_read_b128 v[128:131], v2 offset:36864
buffer_load_dwordx4 a[88:91], v2, s[4:7], s27 offen offset:2048
v_mfma_f32_32x32x16_bf16 v[80:95], v[148:151], a[28:31], v[80:95]
ds_read_b128 v[132:135], v2 offset:37888
buffer_load_dwordx4 a[92:95], v2, s[4:7], s27 offen offset:3072
v_mfma_f32_32x32x16_bf16 v[96:111], v[152:155], a[28:31], v[96:111]
ds_read_b128 v[136:139], v2 offset:38912
v_mfma_f32_32x32x16_bf16 v[112:127], v[156:159], a[28:31], v[112:127]
ds_read_b128 v[140:143], v2 offset:39936
s_waitcnt vmcnt(19) lgkmcnt(4)
v_mfma_f32_32x32x16_bf16 v[64:79], v[160:163], a[32:35], v[64:79]
ds_read_b128 v[144:147], v2 offset:40960
s_add_u32 s27, s30, 24576
buffer_load_dwordx4 a[96:99], v2, s[4:7], s27 offen offset:0
v_mfma_f32_32x32x16_bf16 v[80:95], v[164:167], a[32:35], v[80:95]
ds_read_b128 v[148:151], v2 offset:41984
buffer_load_dwordx4 a[100:103], v2, s[4:7], s27 offen offset:1024
v_mfma_f32_32x32x16_bf16 v[96:111], v[168:171], a[32:35], v[96:111]
ds_read_b128 v[152:155], v2 offset:43008
v_mfma_f32_32x32x16_bf16 v[112:127], v[172:175], a[32:35], v[112:127]
ds_read_b128 v[156:159], v2 offset:44032
s_waitcnt vmcnt(10)
s_mov_b64 exec, 1
v_mov_b32 v13, 1
buffer_atomic_add v13, off, s[4:7], s39 sc1
s_mov_b64 exec, -1
s_waitcnt vmcnt(21) lgkmcnt(4)
v_mfma_f32_32x32x16_bf16 v[64:79], v[128:131], a[36:39], v[64:79]
ds_read_b128 v[160:163], v2 offset:45056
buffer_load_dwordx4 a[104:107], v2, s[4:7], s27 offen offset:2048
v_mfma_f32_32x32x16_bf16 v[80:95], v[132:135], a[36:39], v[80:95]
ds_read_b128 v[164:167], v2 offset:46080
buffer_load_dwordx4 a[108:111], v2, s[4:7], s27 offen offset:3072
v_mfma_f32_32x32x16_bf16 v[96:111], v[136:139], a[36:39], v[96:111]
ds_read_b128 v[168:171], v2 offset:47104
v_mfma_f32_32x32x16_bf16 v[112:127], v[140:143], a[36:39], v[112:127]
ds_read_b128 v[172:175], v2 offset:48128
s_waitcnt vmcnt(22) lgkmcnt(4)
v_mfma_f32_32x32x16_bf16 v[64:79], v[144:147], a[40:43], v[64:79]
ds_read_b128 v[128:131], v2 offset:49152
s_add_u32 s27, s30, 28672
buffer_load_dwordx4 a[112:115], v2, s[4:7], s27 offen offset:0
v_mfma_f32_32x32x16_bf16 v[80:95], v[148:151], a[40:43], v[80:95]
ds_read_b128 v[132:135], v2 offset:50176
buffer_load_dwordx4 a[116:119], v2, s[4:7], s27 offen offset:1024
v_mfma_f32_32x32x16_bf16 v[96:111], v[152:155], a[40:43], v[96:111]
ds_read_b128 v[136:139], v2 offset:51200
v_mfma_f32_32x32x16_bf16 v[112:127], v[156:159], a[40:43], v[112:127]
ds_read_b128 v[140:143], v2 offset:52224
s_waitcnt vmcnt(23) lgkmcnt(4)
v_mfma_f32_32x32x16_bf16 v[64:79], v[160:163], a[44:47], v[64:79]
ds_read_b128 v[144:147], v2 offset:53248
buffer_load_dwordx4 a[120:123], v2, s[4:7], s27 offen offset:2048
v_mfma_f32_32x32x16_bf16 v[80:95], v[164:167], a[44:47], v[80:95]
ds_read_b128 v[148:151], v2 offset:54272
buffer_load_dwordx4 a[124:127], v2, s[4:7], s27 offen offset:3072
v_mfma_f32_32x32x16_bf16 v[96:111], v[168:171], a[44:47], v[96:111]
ds_read_b128 v[152:155], v2 offset:55296
v_mfma_f32_32x32x16_bf16 v[112:127], v[172:175], a[44:47], v[112:127]
ds_read_b128 v[156:159], v2 offset:56320
s_waitcnt vmcnt(23) lgkmcnt(4)
v_mfma_f32_32x32x16_bf16 v[64:79], v[128:131], a[48:51], v[64:79]
ds_read_b128 v[160:163], v2 offset:57344
s_add_u32 s27, s30, 32768
buffer_load_dwordx4 a[128:131], v2, s[4:7], s27 offen offset:0
v_mfma_f32_32x32x16_bf16 v[80:95], v[132:135], a[48:51], v[80:95]
ds_read_b128 v[164:167], v2 offset:58368
buffer_load_dwordx4 a[132:135], v2, s[4:7], s27 offen offset:1024
v_mfma_f32_32x32x16_bf16 v[96:111], v[136:139], a[48:51], v[96:111]
ds_read_b128 v[168:171], v2 offset:59392
v_mfma_f32_32x32x16_bf16 v[112:127], v[140:143], a[48:51], v[112:127]
ds_read_b128 v[172:175], v2 offset:60416
s_waitcnt vmcnt(24) lgkmcnt(4)
v_mfma_f32_32x32x16_bf16 v[64:79], v[144:147], a[52:55], v[64:79]
ds_read_b128 v[128:131], v3 offset:0
buffer_load_dwordx4 a[136:139], v2, s[4:7], s27 offen offset:2048
v_mfma_f32_32x32x16_bf16 v[80:95], v[148:151], a[52:55], v[80:95]
ds_read_b128 v[132:135], v3 offset:1024
buffer_load_dwordx4 a[140:143], v2, s[4:7], s27 offen offset:3072
v_mfma_f32_32x32x16_bf16 v[96:111], v[152:155], a[52:55], v[96:111]
ds_read_b128 v[136:139], v3 offset:2048
v_mfma_f32_32x32x16_bf16 v[112:127], v[156:159], a[52:55], v[112:127]
ds_read_b128 v[140:143], v3 offset:3072
s_waitcnt vmcnt(23) lgkmcnt(4)
v_mfma_f32_32x32x16_bf16 v[64:79], v[160:163], a[56:59], v[64:79]
ds_read_b128 v[144:147], v3 offset:4096
buffer_load_dwordx4 a[144:147], v2, s[4:7], s82 offen offset:0
v_mfma_f32_32x32x16_bf16 v[80:95], v[164:167], a[56:59], v[80:95]
ds_read_b128 v[148:151], v3 offset:5120
buffer_load_dwordx4 a[148:151], v2, s[4:7], s82 offen offset:1024
v_mfma_f32_32x32x16_bf16 v[96:111], v[168:171], a[56:59], v[96:111]
ds_read_b128 v[152:155], v3 offset:6144
v_mfma_f32_32x32x16_bf16 v[112:127], v[172:175], a[56:59], v[112:127]
ds_read_b128 v[156:159], v3 offset:7168
s_waitcnt vmcnt(24) lgkmcnt(4)
v_mfma_f32_32x32x16_bf16 v[64:79], v[128:131], a[60:63], v[64:79]
ds_read_b128 v[160:163], v3 offset:8192
buffer_load_dwordx4 a[152:155], v2, s[4:7], s82 offen offset:2048
v_mfma_f32_32x32x16_bf16 v[80:95], v[132:135], a[60:63], v[80:95]
ds_read_b128 v[164:167], v3 offset:9216
buffer_load_dwordx4 a[156:159], v2, s[4:7], s82 offen offset:3072
v_mfma_f32_32x32x16_bf16 v[96:111], v[136:139], a[60:63], v[96:111]
ds_read_b128 v[168:171], v3 offset:10240
v_mfma_f32_32x32x16_bf16 v[112:127], v[140:143], a[60:63], v[112:127]
ds_read_b128 v[172:175], v3 offset:11264
s_waitcnt vmcnt(24) lgkmcnt(4)
v_mfma_f32_32x32x16_bf16 v[64:79], v[144:147], a[64:67], v[64:79]
ds_read_b128 v[128:131], v3 offset:12288
s_add_u32 s34, s82, 4096
buffer_load_dwordx4 a[160:163], v2, s[4:7], s34 offen offset:0
v_mfma_f32_32x32x16_bf16 v[80:95], v[148:151], a[64:67], v[80:95]
ds_read_b128 v[132:135], v3 offset:13312
buffer_load_dwordx4 a[164:167], v2, s[4:7], s34 offen offset:1024
v_mfma_f32_32x32x16_bf16 v[96:111], v[152:155], a[64:67], v[96:111]
ds_read_b128 v[136:139], v3 offset:14336
v_mfma_f32_32x32x16_bf16 v[112:127], v[156:159], a[64:67], v[112:127]
ds_read_b128 v[140:143], v3 offset:15360
s_waitcnt vmcnt(25) lgkmcnt(4)
v_mfma_f32_32x32x16_bf16 v[64:79], v[160:163], a[68:71], v[64:79]
ds_read_b128 v[144:147], v3 offset:16384
buffer_load_dwordx4 a[168:171], v2, s[4:7], s34 offen offset:2048
v_mfma_f32_32x32x16_bf16 v[80:95], v[164:167], a[68:71], v[80:95]
ds_read_b128 v[148:151], v3 offset:17408
buffer_load_dwordx4 a[172:175], v2, s[4:7], s34 offen offset:3072
v_mfma_f32_32x32x16_bf16 v[96:111], v[168:171], a[68:71], v[96:111]
ds_read_b128 v[152:155], v3 offset:18432
v_mfma_f32_32x32x16_bf16 v[112:127], v[172:175], a[68:71], v[112:127]
ds_read_b128 v[156:159], v3 offset:19456
s_waitcnt vmcnt(26) lgkmcnt(4)
v_mfma_f32_32x32x16_bf16 v[64:79], v[128:131], a[72:75], v[64:79]
ds_read_b128 v[160:163], v3 offset:20480
s_add_u32 s34, s82, 8192
buffer_load_dwordx4 a[176:179], v2, s[4:7], s34 offen offset:0
v_mfma_f32_32x32x16_bf16 v[80:95], v[132:135], a[72:75], v[80:95]
ds_read_b128 v[164:167], v3 offset:21504
buffer_load_dwordx4 a[180:183], v2, s[4:7], s34 offen offset:1024
v_mfma_f32_32x32x16_bf16 v[96:111], v[136:139], a[72:75], v[96:111]
ds_read_b128 v[168:171], v3 offset:22528
v_mfma_f32_32x32x16_bf16 v[112:127], v[140:143], a[72:75], v[112:127]
ds_read_b128 v[172:175], v3 offset:23552
s_waitcnt vmcnt(27) lgkmcnt(4)
v_mfma_f32_32x32x16_bf16 v[64:79], v[144:147], a[76:79], v[64:79]
ds_read_b128 v[128:131], v3 offset:24576
buffer_load_dwordx4 a[184:187], v2, s[4:7], s34 offen offset:2048
v_mfma_f32_32x32x16_bf16 v[80:95], v[148:151], a[76:79], v[80:95]
ds_read_b128 v[132:135], v3 offset:25600
buffer_load_dwordx4 a[188:191], v2, s[4:7], s34 offen offset:3072
v_mfma_f32_32x32x16_bf16 v[96:111], v[152:155], a[76:79], v[96:111]
ds_read_b128 v[136:139], v3 offset:26624
v_mfma_f32_32x32x16_bf16 v[112:127], v[156:159], a[76:79], v[112:127]
ds_read_b128 v[140:143], v3 offset:27648
s_waitcnt vmcnt(28) lgkmcnt(4)
v_mfma_f32_32x32x16_bf16 v[64:79], v[160:163], a[80:83], v[64:79]
ds_read_b128 v[144:147], v3 offset:28672
s_add_u32 s34, s82, 12288
buffer_load_dwordx4 a[192:195], v2, s[4:7], s34 offen offset:0
v_mfma_f32_32x32x16_bf16 v[80:95], v[164:167], a[80:83], v[80:95]
ds_read_b128 v[148:151], v3 offset:29696
buffer_load_dwordx4 a[196:199], v2, s[4:7], s34 offen offset:1024
v_mfma_f32_32x32x16_bf16 v[96:111], v[168:171], a[80:83], v[96:111]
ds_read_b128 v[152:155], v3 offset:30720
v_mfma_f32_32x32x16_bf16 v[112:127], v[172:175], a[80:83], v[112:127]
ds_read_b128 v[156:159], v3 offset:31744
s_waitcnt vmcnt(29) lgkmcnt(4)
v_mfma_f32_32x32x16_bf16 v[64:79], v[128:131], a[84:87], v[64:79]
ds_read_b128 v[160:163], v3 offset:32768
buffer_load_dwordx4 a[200:203], v2, s[4:7], s34 offen offset:2048
v_mfma_f32_32x32x16_bf16 v[80:95], v[132:135], a[84:87], v[80:95]
ds_read_b128 v[164:167], v3 offset:33792
buffer_load_dwordx4 a[204:207], v2, s[4:7], s34 offen offset:3072
v_mfma_f32_32x32x16_bf16 v[96:111], v[136:139], a[84:87], v[96:111]
ds_read_b128 v[168:171], v3 offset:34816
v_mfma_f32_32x32x16_bf16 v[112:127], v[140:143], a[84:87], v[112:127]
ds_read_b128 v[172:175], v3 offset:35840
s_waitcnt vmcnt(30) lgkmcnt(4)
v_mfma_f32_32x32x16_bf16 v[64:79], v[144:147], a[88:91], v[64:79]
ds_read_b128 v[128:131], v3 offset:36864
v_mfma_f32_32x32x16_bf16 v[80:95], v[148:151], a[88:91], v[80:95]
ds_read_b128 v[132:135], v3 offset:37888
v_mfma_f32_32x32x16_bf16 v[96:111], v[152:155], a[88:91], v[96:111]
ds_read_b128 v[136:139], v3 offset:38912
v_mfma_f32_32x32x16_bf16 v[112:127], v[156:159], a[88:91], v[112:127]
ds_read_b128 v[140:143], v3 offset:39936
buffer_load_dword v14, v12, s[4:7], s80 offen sc1
s_waitcnt vmcnt(30) lgkmcnt(4)
v_mfma_f32_32x32x16_bf16 v[64:79], v[160:163], a[92:95], v[64:79]
ds_read_b128 v[144:147], v3 offset:40960
v_mfma_f32_32x32x16_bf16 v[80:95], v[164:167], a[92:95], v[80:95]
ds_read_b128 v[148:151], v3 offset:41984
v_mfma_f32_32x32x16_bf16 v[96:111], v[168:171], a[92:95], v[96:111]
ds_read_b128 v[152:155], v3 offset:43008
v_mfma_f32_32x32x16_bf16 v[112:127], v[172:175], a[92:95], v[112:127]
ds_read_b128 v[156:159], v3 offset:44032
s_waitcnt vmcnt(29) lgkmcnt(4)
v_mfma_f32_32x32x16_bf16 v[64:79], v[128:131], a[96:99], v[64:79]
ds_read_b128 v[160:163], v3 offset:45056
v_mfma_f32_32x32x16_bf16 v[80:95], v[132:135], a[96:99], v[80:95]
ds_read_b128 v[164:167], v3 offset:46080
v_mfma_f32_32x32x16_bf16 v[96:111], v[136:139], a[96:99], v[96:111]
ds_read_b128 v[168:171], v3 offset:47104
v_mfma_f32_32x32x16_bf16 v[112:127], v[140:143], a[96:99], v[112:127]
ds_read_b128 v[172:175], v3 offset:48128
s_waitcnt vmcnt(28) lgkmcnt(4)
v_mfma_f32_32x32x16_bf16 v[64:79], v[144:147], a[100:103], v[64:79]
ds_read_b128 v[128:131], v3 offset:49152
v_mfma_f32_32x32x16_bf16 v[80:95], v[148:151], a[100:103], v[80:95]
ds_read_b128 v[132:135], v3 offset:50176
v_mfma_f32_32x32x16_bf16 v[96:111], v[152:155], a[100:103], v[96:111]
ds_read_b128 v[136:139], v3 offset:51200
v_mfma_f32_32x32x16_bf16 v[112:127], v[156:159], a[100:103], v[112:127]
ds_read_b128 v[140:143], v3 offset:52224
s_waitcnt vmcnt(26) lgkmcnt(4)
v_mfma_f32_32x32x16_bf16 v[64:79], v[160:163], a[104:107], v[64:79]
ds_read_b128 v[144:147], v3 offset:53248
v_mfma_f32_32x32x16_bf16 v[80:95], v[164:167], a[104:107], v[80:95]
ds_read_b128 v[148:151], v3 offset:54272
v_mfma_f32_32x32x16_bf16 v[96:111], v[168:171], a[104:107], v[96:111]
ds_read_b128 v[152:155], v3 offset:55296
v_mfma_f32_32x32x16_bf16 v[112:127], v[172:175], a[104:107], v[112:127]
ds_read_b128 v[156:159], v3 offset:56320
s_waitcnt vmcnt(25) lgkmcnt(4)
v_mfma_f32_32x32x16_bf16 v[64:79], v[128:131], a[108:111], v[64:79]
ds_read_b128 v[160:163], v3 offset:57344
v_mfma_f32_32x32x16_bf16 v[80:95], v[132:135], a[108:111], v[80:95]
ds_read_b128 v[164:167], v3 offset:58368
v_mfma_f32_32x32x16_bf16 v[96:111], v[136:139], a[108:111], v[96:111]
ds_read_b128 v[168:171], v3 offset:59392
v_mfma_f32_32x32x16_bf16 v[112:127], v[140:143], a[108:111], v[112:127]
ds_read_b128 v[172:175], v3 offset:60416
s_waitcnt vmcnt(24) lgkmcnt(4)
v_mfma_f32_32x32x16_bf16 v[64:79], v[144:147], a[112:115], v[64:79]
ds_read_b128 v[128:131], v4 offset:0
v_mfma_f32_32x32x16_bf16 v[80:95], v[148:151], a[112:115], v[80:95]
ds_read_b128 v[132:135], v4 offset:1024
v_mfma_f32_32x32x16_bf16 v[96:111], v[152:155], a[112:115], v[96:111]
ds_read_b128 v[136:139], v4 offset:2048
v_mfma_f32_32x32x16_bf16 v[112:127], v[156:159], a[112:115], v[112:127]
ds_read_b128 v[140:143], v4 offset:3072
s_waitcnt vmcnt(23) lgkmcnt(4)
v_mfma_f32_32x32x16_bf16 v[64:79], v[160:163], a[116:119], v[64:79]
ds_read_b128 v[144:147], v4 offset:4096
v_mfma_f32_32x32x16_bf16 v[80:95], v[164:167], a[116:119], v[80:95]
ds_read_b128 v[148:151], v4 offset:5120
v_mfma_f32_32x32x16_bf16 v[96:111], v[168:171], a[116:119], v[96:111]
ds_read_b128 v[152:155], v4 offset:6144
v_mfma_f32_32x32x16_bf16 v[112:127], v[172:175], a[116:119], v[112:127]
ds_read_b128 v[156:159], v4 offset:7168
s_waitcnt vmcnt(0)
v_cmp_le_u32 vcc, v11, v14
s_nop 3
s_and_b32 s85, vcc_lo, 1
s_bfe_u32 s84, vcc_lo, 0x10001
s_cmp_lg_u32 s84, 0
s_cselect_b32 s88, s83, 0x7fff0000
s_cmp_lt_u32 s23, 62
s_cselect_b32 s85, s85, 0
s_add_u32 s86, s30, 0x12000
s_cmp_lg_u32 s85, 0
s_cselect_b32 s86, s86, 0x7fff0000
s_add_u32 s87, s86, 4096
s_waitcnt vmcnt(22) lgkmcnt(4)
v_mfma_f32_32x32x16_bf16 v[64:79], v[128:131], a[120:123], v[64:79]
ds_read_b128 v[160:163], v4 offset:8192
buffer_load_dwordx4 a[208:211], v6, s[4:7], s88 offen offset:0
v_mfma_f32_32x32x16_bf16 v[80:95], v[132:135], a[120:123], v[80:95]
ds_read_b128 v[164:167], v4 offset:9216
buffer_load_dwordx4 a[212:215], v6, s[4:7], s88 offen offset:256
v_mfma_f32_32x32x16_bf16 v[96:111], v[136:139], a[120:123], v[96:111]
ds_read_b128 v[168:171], v4 offset:10240
buffer_load_dwordx4 a[216:219], v6, s[4:7], s88 offen offset:512
v_mfma_f32_32x32x16_bf16 v[112:127], v[140:143], a[120:123], v[112:127]
ds_read_b128 v[172:175], v4 offset:11264
buffer_load_dwordx4 a[220:223], v6, s[4:7], s88 offen offset:768
s_waitcnt vmcnt(25) lgkmcnt(4)
v_mfma_f32_32x32x16_bf16 v[64:79], v[144:147], a[124:127], v[64:79]
ds_read_b128 v[128:131], v4 offset:12288
buffer_load_dwordx4 a[224:227], v6, s[4:7], s88 offen offset:1024
v_mfma_f32_32x32x16_bf16 v[80:95], v[148:151], a[124:127], v[80:95]
ds_read_b128 v[132:135], v4 offset:13312
buffer_load_dwordx4 a[228:231], v6, s[4:7], s88 offen offset:1280
v_mfma_f32_32x32x16_bf16 v[96:111], v[152:155], a[124:127], v[96:111]
ds_read_b128 v[136:139], v4 offset:14336
buffer_load_dwordx4 a[232:235], v6, s[4:7], s88 offen offset:1536
v_mfma_f32_32x32x16_bf16 v[112:127], v[156:159], a[124:127], v[112:127]
ds_read_b128 v[140:143], v4 offset:15360
buffer_load_dwordx4 a[236:239], v6, s[4:7], s88 offen offset:1792
s_waitcnt vmcnt(28) lgkmcnt(4)
v_mfma_f32_32x32x16_bf16 v[64:79], v[160:163], a[128:131], v[64:79]
ds_read_b128 v[144:147], v4 offset:16384
buffer_load_dwordx2 a[240:241], v7, s[4:7], s88 offen offset:0
v_mfma_f32_32x32x16_bf16 v[80:95], v[164:167], a[128:131], v[80:95]
ds_read_b128 v[148:151], v4 offset:17408
buffer_load_dwordx2 a[242:243], v7, s[4:7], s88 offen offset:512
v_mfma_f32_32x32x16_bf16 v[96:111], v[168:171], a[128:131], v[96:111]
ds_read_b128 v[152:155], v4 offset:18432
buffer_load_dwordx2 a[244:245], v7, s[4:7], s88 offen offset:1024
v_mfma_f32_32x32x16_bf16 v[112:127], v[172:175], a[128:131], v[112:127]
ds_read_b128 v[156:159], v4 offset:19456
buffer_load_dwordx2 a[246:247], v7, s[4:7], s88 offen offset:1536
s_waitcnt vmcnt(31) lgkmcnt(4)
v_mfma_f32_32x32x16_bf16 v[64:79], v[128:131], a[132:135], v[64:79]
ds_read_b128 v[160:163], v4 offset:20480
buffer_load_dwordx4 a[0:3], v2, s[4:7], s86 offen offset:0
v_mfma_f32_32x32x16_bf16 v[80:95], v[132:135], a[132:135], v[80:95]
ds_read_b128 v[164:167], v4 offset:21504
buffer_load_dwordx4 a[4:7], v2, s[4:7], s86 offen offset:1024
v_mfma_f32_32x32x16_bf16 v[96:111], v[136:139], a[132:135], v[96:111]
ds_read_b128 v[168:171], v4 offset:22528
buffer_load_dwordx4 a[8:11], v2, s[4:7], s86 offen offset:2048
v_mfma_f32_32x32x16_bf16 v[112:127], v[140:143], a[132:135], v[112:127]
ds_read_b128 v[172:175], v4 offset:23552
buffer_load_dwordx4 a[12:15], v2, s[4:7], s86 offen offset:3072
s_waitcnt vmcnt(34) lgkmcnt(4)
v_mfma_f32_32x32x16_bf16 v[64:79], v[144:147], a[136:139], v[64:79]
buffer_load_dwordx4 a[16:19], v2, s[4:7], s87 offen offset:0
v_mfma_f32_32x32x16_bf16 v[80:95], v[148:151], a[136:139], v[80:95]
buffer_load_dwordx4 a[20:23], v2, s[4:7], s87 offen offset:1024
v_mfma_f32_32x32x16_bf16 v[96:111], v[152:155], a[136:139], v[96:111]
buffer_load_dwordx4 a[24:27], v2, s[4:7], s87 offen offset:2048
v_mfma_f32_32x32x16_bf16 v[112:127], v[156:159], a[136:139], v[112:127]
buffer_load_dwordx4 a[28:31], v2, s[4:7], s87 offen offset:3072
s_waitcnt vmcnt(37) lgkmcnt(0)
v_mfma_f32_32x32x16_bf16 v[64:79], v[160:163], a[140:143], v[64:79]
v_mfma_f32_32x32x16_bf16 v[80:95], v[164:167], a[140:143], v[80:95]
v_mfma_f32_32x32x16_bf16 v[96:111], v[168:171], a[140:143], v[96:111]
v_mfma_f32_32x32x16_bf16 v[112:127], v[172:175], a[140:143], v[112:127]
v_cvt_pk_bf16_f32 v16, v64, v65
v_cvt_pk_bf16_f32 v17, v66, v67
v_cvt_pk_bf16_f32 v18, v68, v69
v_cvt_pk_bf16_f32 v19, v70, v71
v_cvt_pk_bf16_f32 v20, v72, v73
v_cvt_pk_bf16_f32 v21, v74, v75
v_cvt_pk_bf16_f32 v22, v76, v77
v_cvt_pk_bf16_f32 v23, v78, v79
v_mfma_f32_32x32x16_bf16 v[64:79], a[144:147], v[16:19], 0
v_cvt_pk_bf16_f32 v24, v80, v81
v_cvt_pk_bf16_f32 v25, v82, v83
v_cvt_pk_bf16_f32 v26, v84, v85
v_cvt_pk_bf16_f32 v27, v86, v87
v_mfma_f32_32x32x16_bf16 v[64:79], a[148:151], v[20:23], v[64:79]
v_cvt_pk_bf16_f32 v28, v88, v89
v_cvt_pk_bf16_f32 v29, v90, v91
v_cvt_pk_bf16_f32 v30, v92, v93
v_cvt_pk_bf16_f32 v31, v94, v95
v_mfma_f32_32x32x16_bf16 v[64:79], a[152:155], v[24:27], v[64:79]
v_cvt_pk_bf16_f32 v32, v96, v97
v_cvt_pk_bf16_f32 v33, v98, v99
v_cvt_pk_bf16_f32 v34, v100, v101
v_cvt_pk_bf16_f32 v35, v102, v103
v_mfma_f32_32x32x16_bf16 v[64:79], a[156:159], v[28:31], v[64:79]
v_cvt_pk_bf16_f32 v36, v104, v105
v_cvt_pk_bf16_f32 v37, v106, v107
v_cvt_pk_bf16_f32 v38, v108, v109
v_cvt_pk_bf16_f32 v39, v110, v111
v_mfma_f32_32x32x16_bf16 v[64:79], a[160:163], v[32:35], v[64:79]
v_cvt_pk_bf16_f32 v40, v112, v113
v_cvt_pk_bf16_f32 v41, v114, v115
v_cvt_pk_bf16_f32 v42, v116, v117
v_cvt_pk_bf16_f32 v43, v118, v119
v_mfma_f32_32x32x16_bf16 v[64:79], a[164:167], v[36:39], v[64:79]
v_cvt_pk_bf16_f32 v44, v120, v121
v_cvt_pk_bf16_f32 v45, v122, v123
v_cvt_pk_bf16_f32 v46, v124, v125
v_cvt_pk_bf16_f32 v47, v126, v127
v_mfma_f32_32x32x16_bf16 v[64:79], a[168:171], v[40:43], v[64:79]
v_mfma_f32_32x32x16_bf16 v[64:79], a[172:175], v[44:47], v[64:79]
s_cmp_eq_u32 s84, 1
s_cbranch_scc1 L_qa_hv_59
s_nop 8
s_mov_b32 s91, 0
L_sp_60:
buffer_load_dword v15, off, s[4:7], s81 sc1
s_add_u32 s91, s91, 1
s_cmp_gt_u32 s91, 200000
s_cbranch_scc1 L_FAIL
s_waitcnt vmcnt(0)
v_cmp_gt_u32 vcc, 4, v15
s_nop 0
s_nop 2
s_cbranch_vccz L_spd_61
s_sleep 1
s_branch L_sp_60
L_spd_61:
buffer_load_dwordx4 a[208:211], v6, s[4:7], s83 offen offset:0
buffer_load_dwordx4 a[212:215], v6, s[4:7], s83 offen offset:256
buffer_load_dwordx4 a[216:219], v6, s[4:7], s83 offen offset:512
buffer_load_dwordx4 a[220:223], v6, s[4:7], s83 offen offset:768
buffer_load_dwordx4 a[224:227], v6, s[4:7], s83 offen offset:1024
buffer_load_dwordx4 a[228:231], v6, s[4:7], s83 offen offset:1280
buffer_load_dwordx4 a[232:235], v6, s[4:7], s83 offen offset:1536
buffer_load_dwordx4 a[236:239], v6, s[4:7], s83 offen offset:1792
buffer_load_dwordx2 a[240:241], v7, s[4:7], s83 offen offset:0
buffer_load_dwordx2 a[242:243], v7, s[4:7], s83 offen offset:512
buffer_load_dwordx2 a[244:245], v7, s[4:7], s83 offen offset:1024
buffer_load_dwordx2 a[246:247], v7, s[4:7], s83 offen offset:1536
L_qa_hv_59:
s_waitcnt vmcnt(0)
v_mfma_f32_32x32x16_bf16 v[80:95], a[208:211], v[16:19], 0
v_mfma_f32_32x32x16_bf16 v[80:95], a[212:215], v[20:23], v[80:95]
v_mfma_f32_32x32x16_bf16 v[80:95], a[216:219], v[24:27], v[80:95]
v_cndmask_b32_e64 v64, v5, v64, s[40:41]
v_cndmask_b32_e64 v65, v5, v65, s[42:43]
v_cndmask_b32_e64 v66, v5, v66, s[44:45]
v_mfma_f32_32x32x16_bf16 v[80:95], a[220:223], v[28:31], v[80:95]
v_cndmask_b32_e64 v67, v5, v67, s[46:47]
v_cndmask_b32_e64 v68, v5, v68, s[48:49]
v_cndmask_b32_e64 v69, v5, v69, s[50:51]
v_mfma_f32_32x32x16_bf16 v[80:95], a[224:227], v[32:35], v[80:95]
v_cndmask_b32_e64 v70, v5, v70, s[52:53]
v_cndmask_b32_e64 v71, v5, v71, s[54:55]
v_cndmask_b32_e64 v72, v5, v72, s[64:65]
v_mfma_f32_32x32x16_bf16 v[80:95], a[228:231], v[36:39], v[80:95]
v_cndmask_b32_e64 v73, v5, v73, s[66:67]
v_cndmask_b32_e64 v74, v5, v74, s[68:69]
v_cndmask_b32_e64 v75, v5, v75, s[70:71]
v_mfma_f32_32x32x16_bf16 v[80:95], a[232:235], v[40:43], v[80:95]
v_cndmask_b32_e64 v76, v5, v76, s[72:73]
v_cndmask_b32_e64 v77, v5, v77, s[74:75]
v_cndmask_b32_e64 v78, v5, v78, s[76:77]
v_mfma_f32_32x32x16_bf16 v[80:95], a[236:239], v[44:47], v[80:95]
v_cndmask_b32_e64 v79, v5, v79, s[78:79]
v_max3_f32 v48, v64, v68, v72
v_max3_f32 v49, v65, v69, v73
v_max3_f32 v50, v66, v70, v74
v_max3_f32 v51, v67, v71, v75
s_nop 6
v_max3_f32 v48, v48, v76, v80
v_max3_f32 v49, v49, v77, v81
v_max3_f32 v50, v50, v78, v82
v_max3_f32 v51, v51, v79, v83
v_max3_f32 v48, v48, v49, v50
v_max_f32 v48, v48, v51
v_mov_b32 v52, v48
s_nop 1
v_permlane32_swap_b32 v48, v52
v_max_f32 v48, v48, v52
v_mul_f32 v48, s38, v48
v_fma_f32 v64, v64, s38, -v48
v_exp_f32 v64, v64
v_fma_f32 v65, v65, s38, -v48
v_exp_f32 v65, v65
v_fma_f32 v66, v66, s38, -v48
v_exp_f32 v66, v66
v_fma_f32 v67, v67, s38, -v48
v_exp_f32 v67, v67
v_fma_f32 v68, v68, s38, -v48
v_exp_f32 v68, v68
v_fma_f32 v69, v69, s38, -v48
v_exp_f32 v69, v69
v_fma_f32 v70, v70, s38, -v48
v_exp_f32 v70, v70
v_fma_f32 v71, v71, s38, -v48
v_exp_f32 v71, v71
v_fma_f32 v72, v72, s38, -v48
v_exp_f32 v72, v72
v_fma_f32 v73, v73, s38, -v48
v_exp_f32 v73, v73
v_fma_f32 v74, v74, s38, -v48
v_exp_f32 v74, v74
v_fma_f32 v75, v75, s38, -v48
v_exp_f32 v75, v75
v_fma_f32 v76, v76, s38, -v48
v_exp_f32 v76, v76
v_fma_f32 v77, v77, s38, -v48
v_exp_f32 v77, v77
v_fma_f32 v78, v78, s38, -v48
v_exp_f32 v78, v78
v_fma_f32 v79, v79, s38, -v48
v_exp_f32 v79, v79
v_fma_f32 v80, v80, s38, -v48
v_exp_f32 v80, v80
v_fma_f32 v81, v81, s38, -v48
v_exp_f32 v81, v81
v_fma_f32 v82, v82, s38, -v48
v_exp_f32 v82, v82
v_fma_f32 v83, v83, s38, -v48
v_exp_f32 v83, v83
v_cvt_pk_bf16_f32 v16, v64, v65
v_cvt_pk_bf16_f32 v17, v66, v67
v_cvt_pk_bf16_f32 v18, v68, v69
v_cvt_pk_bf16_f32 v19, v70, v71
v_cvt_pk_bf16_f32 v20, v72, v73
v_cvt_pk_bf16_f32 v21, v74, v75
v_cvt_pk_bf16_f32 v22, v76, v77
v_cvt_pk_bf16_f32 v23, v78, v79
v_cvt_pk_bf16_f32 v24, v80, v81
v_cvt_pk_bf16_f32 v25, v82, v83
v_mfma_f32_32x32x16_bf16 v[96:111], a[176:179], v[16:19], 0
v_add_f32 v28, v64, v68
v_add_f32 v29, v65, v69
v_add_f32 v30, v66, v70
v_add_f32 v31, v67, v71
v_add_f32 v28, v28, v72
v_add_f32 v29, v29, v73
v_mfma_f32_32x32x16_bf16 v[96:111], a[180:183], v[20:23], v[96:111]
v_add_f32 v30, v30, v74
v_add_f32 v31, v31, v75
v_add_f32 v28, v28, v76
v_add_f32 v29, v29, v77
v_add_f32 v30, v30, v78
v_add_f32 v31, v31, v79
v_mfma_f32_32x32x8bf16_1k v[96:111], a[240:241], v[24:25], v[96:111]
v_add_f32 v28, v28, v80
v_add_f32 v29, v29, v81
v_add_f32 v30, v30, v82
v_mfma_f32_32x32x16_bf16 v[112:127], a[184:187], v[16:19], 0
v_add_f32 v31, v31, v83
v_add_f32 v28, v28, v29
v_add_f32 v30, v30, v31
v_add_f32 v28, v28, v30
v_mov_b32 v29, v28
s_nop 1
v_permlane32_swap_b32 v28, v29
v_add_f32 v28, v28, v29
v_rcp_f32 v28, v28
s_nop 0
v_mov_b32 v29, v28
v_mfma_f32_32x32x16_bf16 v[112:127], a[188:191], v[20:23], v[112:127]
v_pk_mul_f32 v[96:97], v[96:97], v[28:29]
v_pk_mul_f32 v[98:99], v[98:99], v[28:29]
v_pk_mul_f32 v[100:101], v[100:101], v[28:29]
v_pk_mul_f32 v[102:103], v[102:103], v[28:29]
v_cvt_pk_bf16_f32 v32, v96, v97
v_cvt_pk_bf16_f32 v33, v98, v99
v_cvt_pk_bf16_f32 v34, v100, v101
v_cvt_pk_bf16_f32 v35, v102, v103
buffer_store_dwordx4 v[32:35], v2, s[4:7], s31 offen offset:0 sc1
v_pk_mul_f32 v[104:105], v[104:105], v[28:29]
v_mfma_f32_32x32x8bf16_1k v[112:127], a[242:243], v[24:25], v[112:127]
v_pk_mul_f32 v[106:107], v[106:107], v[28:29]
v_pk_mul_f32 v[108:109], v[108:109], v[28:29]
v_pk_mul_f32 v[110:111], v[110:111], v[28:29]
v_mfma_f32_32x32x16_bf16 v[176:191], a[192:195], v[16:19], 0
v_cvt_pk_bf16_f32 v36, v104, v105
v_cvt_pk_bf16_f32 v37, v106, v107
v_cvt_pk_bf16_f32 v38, v108, v109
v_cvt_pk_bf16_f32 v39, v110, v111
buffer_store_dwordx4 v[36:39], v2, s[4:7], s31 offen offset:1024 sc1
v_mfma_f32_32x32x16_bf16 v[176:191], a[196:199], v[20:23], v[176:191]
v_pk_mul_f32 v[112:113], v[112:113], v[28:29]
v_pk_mul_f32 v[114:115], v[114:115], v[28:29]
v_pk_mul_f32 v[116:117], v[116:117], v[28:29]
v_pk_mul_f32 v[118:119], v[118:119], v[28:29]
v_cvt_pk_bf16_f32 v40, v112, v113
v_cvt_pk_bf16_f32 v41, v114, v115
v_cvt_pk_bf16_f32 v42, v116, v117
v_cvt_pk_bf16_f32 v43, v118, v119
buffer_store_dwordx4 v[40:43], v2, s[4:7], s31 offen offset:2048 sc1
v_pk_mul_f32 v[120:121], v[120:121], v[28:29]
v_mfma_f32_32x32x8bf16_1k v[176:191], a[244:245], v[24:25], v[176:191]
v_pk_mul_f32 v[122:123], v[122:123], v[28:29]
v_pk_mul_f32 v[124:125], v[124:125], v[28:29]
v_pk_mul_f32 v[126:127], v[126:127], v[28:29]
v_mfma_f32_32x32x16_bf16 v[192:207], a[200:203], v[16:19], 0
v_cvt_pk_bf16_f32 v44, v120, v121
v_cvt_pk_bf16_f32 v45, v122, v123
v_cvt_pk_bf16_f32 v46, v124, v125
v_cvt_pk_bf16_f32 v47, v126, v127
buffer_store_dwordx4 v[44:47], v2, s[4:7], s31 offen offset:3072 sc1
v_mfma_f32_32x32x16_bf16 v[192:207], a[204:207], v[20:23], v[192:207]
v_mfma_f32_32x32x8bf16_1k v[192:207], a[246:247], v[24:25], v[192:207]
s_mov_b32 s39, s29
s_add_u32 s92, s31, 4096
s_add_u32 s93, s92, 4096
s_add_u32 s80, s80, 0x1000
s_add_u32 s81, s81, 0x1000
s_add_u32 s82, s82, 0x100000
s_add_u32 s83, s83, 0x40000
s_add_u32 s28, s28, 0x80
s_add_u32 s29, s29, 0x200
s_add_u32 s30, s30, 0x12000
s_add_u32 s31, s31, 0x80000
s_add_u32 s23, s23, 2
s_cmp_lt_u32 s23, 64
s_cbranch_scc1 L_qa_top
s_nop 7
s_nop 7
v_pk_mul_f32 v[176:177], v[176:177], v[28:29]
v_pk_mul_f32 v[178:179], v[178:179], v[28:29]
v_pk_mul_f32 v[180:181], v[180:181], v[28:29]
v_pk_mul_f32 v[182:183], v[182:183], v[28:29]
v_cvt_pk_bf16_f32 v32, v176, v177
v_cvt_pk_bf16_f32 v33, v178, v179
v_cvt_pk_bf16_f32 v34, v180, v181
v_cvt_pk_bf16_f32 v35, v182, v183
buffer_store_dwordx4 v[32:35], v2, s[4:7], s92 offen offset:0 sc1
v_pk_mul_f32 v[184:185], v[184:185], v[28:29]
v_pk_mul_f32 v[186:187], v[186:187], v[28:29]
v_pk_mul_f32 v[188:189], v[188:189], v[28:29]
v_pk_mul_f32 v[190:191], v[190:191], v[28:29]
v_cvt_pk_bf16_f32 v36, v184, v185
v_cvt_pk_bf16_f32 v37, v186, v187
v_cvt_pk_bf16_f32 v38, v188, v189
v_cvt_pk_bf16_f32 v39, v190, v191
buffer_store_dwordx4 v[36:39], v2, s[4:7], s92 offen offset:1024 sc1
v_pk_mul_f32 v[192:193], v[192:193], v[28:29]
v_pk_mul_f32 v[194:195], v[194:195], v[28:29]
v_pk_mul_f32 v[196:197], v[196:197], v[28:29]
v_pk_mul_f32 v[198:199], v[198:199], v[28:29]
v_cvt_pk_bf16_f32 v40, v192, v193
v_cvt_pk_bf16_f32 v41, v194, v195
v_cvt_pk_bf16_f32 v42, v196, v197
v_cvt_pk_bf16_f32 v43, v198, v199
buffer_store_dwordx4 v[40:43], v2, s[4:7], s92 offen offset:2048 sc1
v_pk_mul_f32 v[200:201], v[200:201], v[28:29]
v_pk_mul_f32 v[202:203], v[202:203], v[28:29]
v_pk_mul_f32 v[204:205], v[204:205], v[28:29]
v_pk_mul_f32 v[206:207], v[206:207], v[28:29]
v_cvt_pk_bf16_f32 v44, v200, v201
v_cvt_pk_bf16_f32 v45, v202, v203
v_cvt_pk_bf16_f32 v46, v204, v205
v_cvt_pk_bf16_f32 v47, v206, v207
buffer_store_dwordx4 v[44:47], v2, s[4:7], s92 offen offset:3072 sc1
s_mov_b32 s92, 0x7fff0000
s_mov_b32 s93, 0x7fff0000
s_waitcnt vmcnt(0)
s_mov_b64 exec, 1
v_mov_b32 v13, 1
buffer_atomic_add v13, off, s[4:7], s39 sc1
s_mov_b64 exec, -1
s_waitcnt vmcnt(0)
s_branch L_END
s_endpgm
L_R_op:
v_and_b32 v1, 63, v0
v_lshlrev_b32 v2, 4, v1
v_add_u32 v3, 61440, v2
v_add_u32 v4, 122880, v2
s_mov_b32 s32, 0x05040100
s_mov_b32 s33, 0x07060302
s_load_dwordx2 s[90:91], s[0:1], 64
s_waitcnt lgkmcnt(0)
s_mov_b32 s8, s90
s_and_b32 s9, s91, 0xffff
s_mov_b32 s10, 0x480000
s_mov_b32 s11, 0x20000
v_and_b32 v8, 31, v1
v_lshrrev_b32 v9, 5, v1
v_lshlrev_b32 v10, 2, v8
s_mov_b32 s3, 18432
v_mul_lo_u32 v13, v9, s3
v_add_u32 v10, v10, v13
s_lshl_b32 s3, s61, 7
v_add_u32 v10, s3, v10
s_mov_b32 s90, 0
L_w_62:
s_mul_i32 s34, s90, 64
s_add_u32 s34, s34, s20
s_mov_b32 s64, s34
s_lshr_b32 s91, s34, 3
s_lshl_b32 s92, s60, 3
s_add_u32 s91, s91, s92
s_lshl_b32 s91, s91, 7
s_and_b32 s92, s34, 1
s_lshl_b32 s92, s92, 6
s_add_u32 s91, s91, s92
s_bfe_u32 s92, s34, 0x20001
s_add_u32 s91, s91, s92
s_mul_i32 s35, s91, 1152
s_add_u32 s36, s35, 0
buffer_load_dword v16, v10, s[8:11], s36 offen
s_add_u32 s36, s35, 4608
buffer_load_dword v17, v10, s[8:11], s36 offen
s_add_u32 s36, s35, 9216
buffer_load_dword v18, v10, s[8:11], s36 offen
s_add_u32 s36, s35, 13824
buffer_load_dword v19, v10, s[8:11], s36 offen
s_add_u32 s36, s35, 36864
buffer_load_dword v20, v10, s[8:11], s36 offen
s_add_u32 s36, s35, 41472
buffer_load_dword v21, v10, s[8:11], s36 offen
s_add_u32 s36, s35, 46080
buffer_load_dword v22, v10, s[8:11], s36 offen
s_add_u32 s36, s35, 50688
buffer_load_dword v23, v10, s[8:11], s36 offen
s_mul_i32 s34, s90, 64
s_add_u32 s34, s34, s20
s_add_u32 s34, s34, 4
s_mov_b32 s65, s34
s_lshr_b32 s91, s34, 3
s_lshl_b32 s92, s60, 3
s_add_u32 s91, s91, s92
s_lshl_b32 s91, s91, 7
s_and_b32 s92, s34, 1
s_lshl_b32 s92, s92, 6
s_add_u32 s91, s91, s92
s_bfe_u32 s92, s34, 0x20001
s_add_u32 s91, s91, s92
s_mul_i32 s35, s91, 1152
s_add_u32 s36, s35, 0
buffer_load_dword v24, v10, s[8:11], s36 offen
s_add_u32 s36, s35, 4608
buffer_load_dword v25, v10, s[8:11], s36 offen
s_add_u32 s36, s35, 9216
buffer_load_dword v26, v10, s[8:11], s36 offen
s_add_u32 s36, s35, 13824
buffer_load_dword v27, v10, s[8:11], s36 offen
s_add_u32 s36, s35, 36864
buffer_load_dword v28, v10, s[8:11], s36 offen
s_add_u32 s36, s35, 41472
buffer_load_dword v29, v10, s[8:11], s36 offen
s_add_u32 s36, s35, 46080
buffer_load_dword v30, v10, s[8:11], s36 offen
s_add_u32 s36, s35, 50688
buffer_load_dword v31, v10, s[8:11], s36 offen
s_mul_i32 s34, s90, 64
s_add_u32 s34, s34, s20
s_add_u32 s34, s34, 8
s_mov_b32 s66, s34
s_lshr_b32 s91, s34, 3
s_lshl_b32 s92, s60, 3
s_add_u32 s91, s91, s92
s_lshl_b32 s91, s91, 7
s_and_b32 s92, s34, 1
s_lshl_b32 s92, s92, 6
s_add_u32 s91, s91, s92
s_bfe_u32 s92, s34, 0x20001
s_add_u32 s91, s91, s92
s_mul_i32 s35, s91, 1152
s_add_u32 s36, s35, 0
buffer_load_dword v32, v10, s[8:11], s36 offen
s_add_u32 s36, s35, 4608
buffer_load_dword v33, v10, s[8:11], s36 offen
s_add_u32 s36, s35, 9216
buffer_load_dword v34, v10, s[8:11], s36 offen
s_add_u32 s36, s35, 13824
buffer_load_dword v35, v10, s[8:11], s36 offen
s_add_u32 s36, s35, 36864
buffer_load_dword v36, v10, s[8:11], s36 offen
s_add_u32 s36, s35, 41472
buffer_load_dword v37, v10, s[8:11], s36 offen
s_add_u32 s36, s35, 46080
buffer_load_dword v38, v10, s[8:11], s36 offen
s_add_u32 s36, s35, 50688
buffer_load_dword v39, v10, s[8:11], s36 offen
s_mul_i32 s34, s90, 64
s_add_u32 s34, s34, s20
s_add_u32 s34, s34, 12
s_mov_b32 s67, s34
s_lshr_b32 s91, s34, 3
s_lshl_b32 s92, s60, 3
s_add_u32 s91, s91, s92
s_lshl_b32 s91, s91, 7
s_and_b32 s92, s34, 1
s_lshl_b32 s92, s92, 6
s_add_u32 s91, s91, s92
s_bfe_u32 s92, s34, 0x20001
s_add_u32 s91, s91, s92
s_mul_i32 s35, s91, 1152
s_add_u32 s36, s35, 0
buffer_load_dword v40, v10, s[8:11], s36 offen
s_add_u32 s36, s35, 4608
buffer_load_dword v41, v10, s[8:11], s36 offen
s_add_u32 s36, s35, 9216
buffer_load_dword v42, v10, s[8:11], s36 offen
s_add_u32 s36, s35, 13824
buffer_load_dword v43, v10, s[8:11], s36 offen
s_add_u32 s36, s35, 36864
buffer_load_dword v44, v10, s[8:11], s36 offen
s_add_u32 s36, s35, 41472
buffer_load_dword v45, v10, s[8:11], s36 offen
s_add_u32 s36, s35, 46080
buffer_load_dword v46, v10, s[8:11], s36 offen
s_add_u32 s36, s35, 50688
buffer_load_dword v47, v10, s[8:11], s36 offen
s_mul_i32 s34, s90, 64
s_add_u32 s34, s34, s20
s_add_u32 s34, s34, 16
s_mov_b32 s68, s34
s_lshr_b32 s91, s34, 3
s_lshl_b32 s92, s60, 3
s_add_u32 s91, s91, s92
s_lshl_b32 s91, s91, 7
s_and_b32 s92, s34, 1
s_lshl_b32 s92, s92, 6
s_add_u32 s91, s91, s92
s_bfe_u32 s92, s34, 0x20001
s_add_u32 s91, s91, s92
s_mul_i32 s35, s91, 1152
s_add_u32 s36, s35, 0
buffer_load_dword v48, v10, s[8:11], s36 offen
s_add_u32 s36, s35, 4608
buffer_load_dword v49, v10, s[8:11], s36 offen
s_add_u32 s36, s35, 9216
buffer_load_dword v50, v10, s[8:11], s36 offen
s_add_u32 s36, s35, 13824
buffer_load_dword v51, v10, s[8:11], s36 offen
s_add_u32 s36, s35, 36864
buffer_load_dword v52, v10, s[8:11], s36 offen
s_add_u32 s36, s35, 41472
buffer_load_dword v53, v10, s[8:11], s36 offen
s_add_u32 s36, s35, 46080
buffer_load_dword v54, v10, s[8:11], s36 offen
s_add_u32 s36, s35, 50688
buffer_load_dword v55, v10, s[8:11], s36 offen
s_mul_i32 s34, s90, 64
s_add_u32 s34, s34, s20
s_add_u32 s34, s34, 20
s_mov_b32 s69, s34
s_lshr_b32 s91, s34, 3
s_lshl_b32 s92, s60, 3
s_add_u32 s91, s91, s92
s_lshl_b32 s91, s91, 7
s_and_b32 s92, s34, 1
s_lshl_b32 s92, s92, 6
s_add_u32 s91, s91, s92
s_bfe_u32 s92, s34, 0x20001
s_add_u32 s91, s91, s92
s_mul_i32 s35, s91, 1152
s_add_u32 s36, s35, 0
buffer_load_dword v56, v10, s[8:11], s36 offen
s_add_u32 s36, s35, 4608
buffer_load_dword v57, v10, s[8:11], s36 offen
s_add_u32 s36, s35, 9216
buffer_load_dword v58, v10, s[8:11], s36 offen
s_add_u32 s36, s35, 13824
buffer_load_dword v59, v10, s[8:11], s36 offen
s_add_u32 s36, s35, 36864
buffer_load_dword v60, v10, s[8:11], s36 offen
s_add_u32 s36, s35, 41472
buffer_load_dword v61, v10, s[8:11], s36 offen
s_add_u32 s36, s35, 46080
buffer_load_dword v62, v10, s[8:11], s36 offen
s_add_u32 s36, s35, 50688
buffer_load_dword v63, v10, s[8:11], s36 offen
s_mul_i32 s34, s90, 64
s_add_u32 s34, s34, s20
s_add_u32 s34, s34, 24
s_mov_b32 s70, s34
s_lshr_b32 s91, s34, 3
s_lshl_b32 s92, s60, 3
s_add_u32 s91, s91, s92
s_lshl_b32 s91, s91, 7
s_and_b32 s92, s34, 1
s_lshl_b32 s92, s92, 6
s_add_u32 s91, s91, s92
s_bfe_u32 s92, s34, 0x20001
s_add_u32 s91, s91, s92
s_mul_i32 s35, s91, 1152
s_add_u32 s36, s35, 0
buffer_load_dword v64, v10, s[8:11], s36 offen
s_add_u32 s36, s35, 4608
buffer_load_dword v65, v10, s[8:11], s36 offen
s_add_u32 s36, s35, 9216
buffer_load_dword v66, v10, s[8:11], s36 offen
s_add_u32 s36, s35, 13824
buffer_load_dword v67, v10, s[8:11], s36 offen
s_add_u32 s36, s35, 36864
buffer_load_dword v68, v10, s[8:11], s36 offen
s_add_u32 s36, s35, 41472
buffer_load_dword v69, v10, s[8:11], s36 offen
s_add_u32 s36, s35, 46080
buffer_load_dword v70, v10, s[8:11], s36 offen
s_add_u32 s36, s35, 50688
buffer_load_dword v71, v10, s[8:11], s36 offen
s_mul_i32 s34, s90, 64
s_add_u32 s34, s34, s20
s_add_u32 s34, s34, 28
s_mov_b32 s71, s34
s_lshr_b32 s91, s34, 3
s_lshl_b32 s92, s60, 3
s_add_u32 s91, s91, s92
s_lshl_b32 s91, s91, 7
s_and_b32 s92, s34, 1
s_lshl_b32 s92, s92, 6
s_add_u32 s91, s91, s92
s_bfe_u32 s92, s34, 0x20001
s_add_u32 s91, s91, s92
s_mul_i32 s35, s91, 1152
s_add_u32 s36, s35, 0
buffer_load_dword v72, v10, s[8:11], s36 offen
s_add_u32 s36, s35, 4608
buffer_load_dword v73, v10, s[8:11], s36 offen
s_add_u32 s36, s35, 9216
buffer_load_dword v74, v10, s[8:11], s36 offen
s_add_u32 s36, s35, 13824
buffer_load_dword v75, v10, s[8:11], s36 offen
s_add_u32 s36, s35, 36864
buffer_load_dword v76, v10, s[8:11], s36 offen
s_add_u32 s36, s35, 41472
buffer_load_dword v77, v10, s[8:11], s36 offen
s_add_u32 s36, s35, 46080
buffer_load_dword v78, v10, s[8:11], s36 offen
s_add_u32 s36, s35, 50688
buffer_load_dword v79, v10, s[8:11], s36 offen
s_mul_i32 s34, s90, 64
s_add_u32 s34, s34, s20
s_add_u32 s34, s34, 32
s_mov_b32 s72, s34
s_lshr_b32 s91, s34, 3
s_lshl_b32 s92, s60, 3
s_add_u32 s91, s91, s92
s_lshl_b32 s91, s91, 7
s_and_b32 s92, s34, 1
s_lshl_b32 s92, s92, 6
s_add_u32 s91, s91, s92
s_bfe_u32 s92, s34, 0x20001
s_add_u32 s91, s91, s92
s_mul_i32 s35, s91, 1152
s_add_u32 s36, s35, 0
buffer_load_dword v80, v10, s[8:11], s36 offen
s_add_u32 s36, s35, 4608
buffer_load_dword v81, v10, s[8:11], s36 offen
s_add_u32 s36, s35, 9216
buffer_load_dword v82, v10, s[8:11], s36 offen
s_add_u32 s36, s35, 13824
buffer_load_dword v83, v10, s[8:11], s36 offen
s_add_u32 s36, s35, 36864
buffer_load_dword v84, v10, s[8:11], s36 offen
s_add_u32 s36, s35, 41472
buffer_load_dword v85, v10, s[8:11], s36 offen
s_add_u32 s36, s35, 46080
buffer_load_dword v86, v10, s[8:11], s36 offen
s_add_u32 s36, s35, 50688
buffer_load_dword v87, v10, s[8:11], s36 offen
s_mul_i32 s34, s90, 64
s_add_u32 s34, s34, s20
s_add_u32 s34, s34, 36
s_mov_b32 s73, s34
s_lshr_b32 s91, s34, 3
s_lshl_b32 s92, s60, 3
s_add_u32 s91, s91, s92
s_lshl_b32 s91, s91, 7
s_and_b32 s92, s34, 1
s_lshl_b32 s92, s92, 6
s_add_u32 s91, s91, s92
s_bfe_u32 s92, s34, 0x20001
s_add_u32 s91, s91, s92
s_mul_i32 s35, s91, 1152
s_add_u32 s36, s35, 0
buffer_load_dword v88, v10, s[8:11], s36 offen
s_add_u32 s36, s35, 4608
buffer_load_dword v89, v10, s[8:11], s36 offen
s_add_u32 s36, s35, 9216
buffer_load_dword v90, v10, s[8:11], s36 offen
s_add_u32 s36, s35, 13824
buffer_load_dword v91, v10, s[8:11], s36 offen
s_add_u32 s36, s35, 36864
buffer_load_dword v92, v10, s[8:11], s36 offen
s_add_u32 s36, s35, 41472
buffer_load_dword v93, v10, s[8:11], s36 offen
s_add_u32 s36, s35, 46080
buffer_load_dword v94, v10, s[8:11], s36 offen
s_add_u32 s36, s35, 50688
buffer_load_dword v95, v10, s[8:11], s36 offen
s_mul_i32 s34, s90, 64
s_add_u32 s34, s34, s20
s_add_u32 s34, s34, 40
s_mov_b32 s74, s34
s_lshr_b32 s91, s34, 3
s_lshl_b32 s92, s60, 3
s_add_u32 s91, s91, s92
s_lshl_b32 s91, s91, 7
s_and_b32 s92, s34, 1
s_lshl_b32 s92, s92, 6
s_add_u32 s91, s91, s92
s_bfe_u32 s92, s34, 0x20001
s_add_u32 s91, s91, s92
s_mul_i32 s35, s91, 1152
s_add_u32 s36, s35, 0
buffer_load_dword v96, v10, s[8:11], s36 offen
s_add_u32 s36, s35, 4608
buffer_load_dword v97, v10, s[8:11], s36 offen
s_add_u32 s36, s35, 9216
buffer_load_dword v98, v10, s[8:11], s36 offen
s_add_u32 s36, s35, 13824
buffer_load_dword v99, v10, s[8:11], s36 offen
s_add_u32 s36, s35, 36864
buffer_load_dword v100, v10, s[8:11], s36 offen
s_add_u32 s36, s35, 41472
buffer_load_dword v101, v10, s[8:11], s36 offen
s_add_u32 s36, s35, 46080
buffer_load_dword v102, v10, s[8:11], s36 offen
s_add_u32 s36, s35, 50688
buffer_load_dword v103, v10, s[8:11], s36 offen
s_mul_i32 s34, s90, 64
s_add_u32 s34, s34, s20
s_add_u32 s34, s34, 44
s_mov_b32 s75, s34
s_lshr_b32 s91, s34, 3
s_lshl_b32 s92, s60, 3
s_add_u32 s91, s91, s92
s_lshl_b32 s91, s91, 7
s_and_b32 s92, s34, 1
s_lshl_b32 s92, s92, 6
s_add_u32 s91, s91, s92
s_bfe_u32 s92, s34, 0x20001
s_add_u32 s91, s91, s92
s_mul_i32 s35, s91, 1152
s_add_u32 s36, s35, 0
buffer_load_dword v104, v10, s[8:11], s36 offen
s_add_u32 s36, s35, 4608
buffer_load_dword v105, v10, s[8:11], s36 offen
s_add_u32 s36, s35, 9216
buffer_load_dword v106, v10, s[8:11], s36 offen
s_add_u32 s36, s35, 13824
buffer_load_dword v107, v10, s[8:11], s36 offen
s_add_u32 s36, s35, 36864
buffer_load_dword v108, v10, s[8:11], s36 offen
s_add_u32 s36, s35, 41472
buffer_load_dword v109, v10, s[8:11], s36 offen
s_add_u32 s36, s35, 46080
buffer_load_dword v110, v10, s[8:11], s36 offen
s_add_u32 s36, s35, 50688
buffer_load_dword v111, v10, s[8:11], s36 offen
s_mul_i32 s34, s90, 64
s_add_u32 s34, s34, s20
s_add_u32 s34, s34, 48
s_mov_b32 s76, s34
s_lshr_b32 s91, s34, 3
s_lshl_b32 s92, s60, 3
s_add_u32 s91, s91, s92
s_lshl_b32 s91, s91, 7
s_and_b32 s92, s34, 1
s_lshl_b32 s92, s92, 6
s_add_u32 s91, s91, s92
s_bfe_u32 s92, s34, 0x20001
s_add_u32 s91, s91, s92
s_mul_i32 s35, s91, 1152
s_add_u32 s36, s35, 0
buffer_load_dword v112, v10, s[8:11], s36 offen
s_add_u32 s36, s35, 4608
buffer_load_dword v113, v10, s[8:11], s36 offen
s_add_u32 s36, s35, 9216
buffer_load_dword v114, v10, s[8:11], s36 offen
s_add_u32 s36, s35, 13824
buffer_load_dword v115, v10, s[8:11], s36 offen
s_add_u32 s36, s35, 36864
buffer_load_dword v116, v10, s[8:11], s36 offen
s_add_u32 s36, s35, 41472
buffer_load_dword v117, v10, s[8:11], s36 offen
s_add_u32 s36, s35, 46080
buffer_load_dword v118, v10, s[8:11], s36 offen
s_add_u32 s36, s35, 50688
buffer_load_dword v119, v10, s[8:11], s36 offen
s_mul_i32 s34, s90, 64
s_add_u32 s34, s34, s20
s_add_u32 s34, s34, 52
s_mov_b32 s77, s34
s_lshr_b32 s91, s34, 3
s_lshl_b32 s92, s60, 3
s_add_u32 s91, s91, s92
s_lshl_b32 s91, s91, 7
s_and_b32 s92, s34, 1
s_lshl_b32 s92, s92, 6
s_add_u32 s91, s91, s92
s_bfe_u32 s92, s34, 0x20001
s_add_u32 s91, s91, s92
s_mul_i32 s35, s91, 1152
s_add_u32 s36, s35, 0
buffer_load_dword v120, v10, s[8:11], s36 offen
s_add_u32 s36, s35, 4608
buffer_load_dword v121, v10, s[8:11], s36 offen
s_add_u32 s36, s35, 9216
buffer_load_dword v122, v10, s[8:11], s36 offen
s_add_u32 s36, s35, 13824
buffer_load_dword v123, v10, s[8:11], s36 offen
s_add_u32 s36, s35, 36864
buffer_load_dword v124, v10, s[8:11], s36 offen
s_add_u32 s36, s35, 41472
buffer_load_dword v125, v10, s[8:11], s36 offen
s_add_u32 s36, s35, 46080
buffer_load_dword v126, v10, s[8:11], s36 offen
s_add_u32 s36, s35, 50688
buffer_load_dword v127, v10, s[8:11], s36 offen
s_mul_i32 s34, s90, 64
s_add_u32 s34, s34, s20
s_add_u32 s34, s34, 56
s_mov_b32 s78, s34
s_lshr_b32 s91, s34, 3
s_lshl_b32 s92, s60, 3
s_add_u32 s91, s91, s92
s_lshl_b32 s91, s91, 7
s_and_b32 s92, s34, 1
s_lshl_b32 s92, s92, 6
s_add_u32 s91, s91, s92
s_bfe_u32 s92, s34, 0x20001
s_add_u32 s91, s91, s92
s_mul_i32 s35, s91, 1152
s_add_u32 s36, s35, 0
buffer_load_dword v128, v10, s[8:11], s36 offen
s_add_u32 s36, s35, 4608
buffer_load_dword v129, v10, s[8:11], s36 offen
s_add_u32 s36, s35, 9216
buffer_load_dword v130, v10, s[8:11], s36 offen
s_add_u32 s36, s35, 13824
buffer_load_dword v131, v10, s[8:11], s36 offen
s_add_u32 s36, s35, 36864
buffer_load_dword v132, v10, s[8:11], s36 offen
s_add_u32 s36, s35, 41472
buffer_load_dword v133, v10, s[8:11], s36 offen
s_add_u32 s36, s35, 46080
buffer_load_dword v134, v10, s[8:11], s36 offen
s_add_u32 s36, s35, 50688
buffer_load_dword v135, v10, s[8:11], s36 offen
s_mul_i32 s34, s90, 64
s_add_u32 s34, s34, s20
s_add_u32 s34, s34, 60
s_mov_b32 s79, s34
s_lshr_b32 s91, s34, 3
s_lshl_b32 s92, s60, 3
s_add_u32 s91, s91, s92
s_lshl_b32 s91, s91, 7
s_and_b32 s92, s34, 1
s_lshl_b32 s92, s92, 6
s_add_u32 s91, s91, s92
s_bfe_u32 s92, s34, 0x20001
s_add_u32 s91, s91, s92
s_mul_i32 s35, s91, 1152
s_add_u32 s36, s35, 0
buffer_load_dword v136, v10, s[8:11], s36 offen
s_add_u32 s36, s35, 4608
buffer_load_dword v137, v10, s[8:11], s36 offen
s_add_u32 s36, s35, 9216
buffer_load_dword v138, v10, s[8:11], s36 offen
s_add_u32 s36, s35, 13824
buffer_load_dword v139, v10, s[8:11], s36 offen
s_add_u32 s36, s35, 36864
buffer_load_dword v140, v10, s[8:11], s36 offen
s_add_u32 s36, s35, 41472
buffer_load_dword v141, v10, s[8:11], s36 offen
s_add_u32 s36, s35, 46080
buffer_load_dword v142, v10, s[8:11], s36 offen
s_add_u32 s36, s35, 50688
buffer_load_dword v143, v10, s[8:11], s36 offen
s_waitcnt vmcnt(63)
s_mul_i32 s3, s64, 2048
v_add_u32 v15, s3, v2
v_perm_b32 v144, v17, v16, s32
v_perm_b32 v145, v19, v18, s32
v_perm_b32 v146, v21, v20, s32
v_perm_b32 v147, v23, v22, s32
ds_write_b128 v15, v[144:147] offset:0
v_perm_b32 v148, v17, v16, s33
v_perm_b32 v149, v19, v18, s33
v_perm_b32 v150, v21, v20, s33
v_perm_b32 v151, v23, v22, s33
ds_write_b128 v15, v[148:151] offset:1024
s_waitcnt lgkmcnt(0)
s_waitcnt vmcnt(63)
s_mul_i32 s3, s65, 2048
v_add_u32 v15, s3, v2
v_perm_b32 v144, v25, v24, s32
v_perm_b32 v145, v27, v26, s32
v_perm_b32 v146, v29, v28, s32
v_perm_b32 v147, v31, v30, s32
ds_write_b128 v15, v[144:147] offset:0
v_perm_b32 v148, v25, v24, s33
v_perm_b32 v149, v27, v26, s33
v_perm_b32 v150, v29, v28, s33
v_perm_b32 v151, v31, v30, s33
ds_write_b128 v15, v[148:151] offset:1024
s_waitcnt lgkmcnt(0)
s_waitcnt vmcnt(63)
s_mul_i32 s3, s66, 2048
v_add_u32 v15, s3, v2
v_perm_b32 v144, v33, v32, s32
v_perm_b32 v145, v35, v34, s32
v_perm_b32 v146, v37, v36, s32
v_perm_b32 v147, v39, v38, s32
ds_write_b128 v15, v[144:147] offset:0
v_perm_b32 v148, v33, v32, s33
v_perm_b32 v149, v35, v34, s33
v_perm_b32 v150, v37, v36, s33
v_perm_b32 v151, v39, v38, s33
ds_write_b128 v15, v[148:151] offset:1024
s_waitcnt lgkmcnt(0)
s_waitcnt vmcnt(63)
s_mul_i32 s3, s67, 2048
v_add_u32 v15, s3, v2
v_perm_b32 v144, v41, v40, s32
v_perm_b32 v145, v43, v42, s32
v_perm_b32 v146, v45, v44, s32
v_perm_b32 v147, v47, v46, s32
ds_write_b128 v15, v[144:147] offset:0
v_perm_b32 v148, v41, v40, s33
v_perm_b32 v149, v43, v42, s33
v_perm_b32 v150, v45, v44, s33
v_perm_b32 v151, v47, v46, s33
ds_write_b128 v15, v[148:151] offset:1024
s_waitcnt lgkmcnt(0)
s_waitcnt vmcnt(63)
s_mul_i32 s3, s68, 2048
v_add_u32 v15, s3, v2
v_perm_b32 v144, v49, v48, s32
v_perm_b32 v145, v51, v50, s32
v_perm_b32 v146, v53, v52, s32
v_perm_b32 v147, v55, v54, s32
ds_write_b128 v15, v[144:147] offset:0
v_perm_b32 v148, v49, v48, s33
v_perm_b32 v149, v51, v50, s33
v_perm_b32 v150, v53, v52, s33
v_perm_b32 v151, v55, v54, s33
ds_write_b128 v15, v[148:151] offset:1024
s_waitcnt lgkmcnt(0)
s_waitcnt vmcnt(63)
s_mul_i32 s3, s69, 2048
v_add_u32 v15, s3, v2
v_perm_b32 v144, v57, v56, s32
v_perm_b32 v145, v59, v58, s32
v_perm_b32 v146, v61, v60, s32
v_perm_b32 v147, v63, v62, s32
ds_write_b128 v15, v[144:147] offset:0
v_perm_b32 v148, v57, v56, s33
v_perm_b32 v149, v59, v58, s33
v_perm_b32 v150, v61, v60, s33
v_perm_b32 v151, v63, v62, s33
ds_write_b128 v15, v[148:151] offset:1024
s_waitcnt lgkmcnt(0)
s_waitcnt vmcnt(63)
s_mul_i32 s3, s70, 2048
v_add_u32 v15, s3, v2
v_perm_b32 v144, v65, v64, s32
v_perm_b32 v145, v67, v66, s32
v_perm_b32 v146, v69, v68, s32
v_perm_b32 v147, v71, v70, s32
ds_write_b128 v15, v[144:147] offset:0
v_perm_b32 v148, v65, v64, s33
v_perm_b32 v149, v67, v66, s33
v_perm_b32 v150, v69, v68, s33
v_perm_b32 v151, v71, v70, s33
ds_write_b128 v15, v[148:151] offset:1024
s_waitcnt lgkmcnt(0)
s_waitcnt vmcnt(63)
s_mul_i32 s3, s71, 2048
v_add_u32 v15, s3, v2
v_perm_b32 v144, v73, v72, s32
v_perm_b32 v145, v75, v74, s32
v_perm_b32 v146, v77, v76, s32
v_perm_b32 v147, v79, v78, s32
ds_write_b128 v15, v[144:147] offset:0
v_perm_b32 v148, v73, v72, s33
v_perm_b32 v149, v75, v74, s33
v_perm_b32 v150, v77, v76, s33
v_perm_b32 v151, v79, v78, s33
ds_write_b128 v15, v[148:151] offset:1024
s_waitcnt lgkmcnt(0)
s_waitcnt vmcnt(56)
s_mul_i32 s3, s72, 2048
v_add_u32 v15, s3, v2
v_perm_b32 v144, v81, v80, s32
v_perm_b32 v145, v83, v82, s32
v_perm_b32 v146, v85, v84, s32
v_perm_b32 v147, v87, v86, s32
ds_write_b128 v15, v[144:147] offset:0
v_perm_b32 v148, v81, v80, s33
v_perm_b32 v149, v83, v82, s33
v_perm_b32 v150, v85, v84, s33
v_perm_b32 v151, v87, v86, s33
ds_write_b128 v15, v[148:151] offset:1024
s_waitcnt lgkmcnt(0)
s_waitcnt vmcnt(48)
s_mul_i32 s3, s73, 2048
v_add_u32 v15, s3, v2
v_perm_b32 v144, v89, v88, s32
v_perm_b32 v145, v91, v90, s32
v_perm_b32 v146, v93, v92, s32
v_perm_b32 v147, v95, v94, s32
ds_write_b128 v15, v[144:147] offset:0
v_perm_b32 v148, v89, v88, s33
v_perm_b32 v149, v91, v90, s33
v_perm_b32 v150, v93, v92, s33
v_perm_b32 v151, v95, v94, s33
ds_write_b128 v15, v[148:151] offset:1024
s_waitcnt lgkmcnt(0)
s_waitcnt vmcnt(40)
s_mul_i32 s3, s74, 2048
v_add_u32 v15, s3, v2
v_perm_b32 v144, v97, v96, s32
v_perm_b32 v145, v99, v98, s32
v_perm_b32 v146, v101, v100, s32
v_perm_b32 v147, v103, v102, s32
ds_write_b128 v15, v[144:147] offset:0
v_perm_b32 v148, v97, v96, s33
v_perm_b32 v149, v99, v98, s33
v_perm_b32 v150, v101, v100, s33
v_perm_b32 v151, v103, v102, s33
ds_write_b128 v15, v[148:151] offset:1024
s_waitcnt lgkmcnt(0)
s_waitcnt vmcnt(32)
s_mul_i32 s3, s75, 2048
v_add_u32 v15, s3, v2
v_perm_b32 v144, v105, v104, s32
v_perm_b32 v145, v107, v106, s32
v_perm_b32 v146, v109, v108, s32
v_perm_b32 v147, v111, v110, s32
ds_write_b128 v15, v[144:147] offset:0
v_perm_b32 v148, v105, v104, s33
v_perm_b32 v149, v107, v106, s33
v_perm_b32 v150, v109, v108, s33
v_perm_b32 v151, v111, v110, s33
ds_write_b128 v15, v[148:151] offset:1024
s_waitcnt lgkmcnt(0)
s_waitcnt vmcnt(24)
s_mul_i32 s3, s76, 2048
v_add_u32 v15, s3, v2
v_perm_b32 v144, v113, v112, s32
v_perm_b32 v145, v115, v114, s32
v_perm_b32 v146, v117, v116, s32
v_perm_b32 v147, v119, v118, s32
ds_write_b128 v15, v[144:147] offset:0
v_perm_b32 v148, v113, v112, s33
v_perm_b32 v149, v115, v114, s33
v_perm_b32 v150, v117, v116, s33
v_perm_b32 v151, v119, v118, s33
ds_write_b128 v15, v[148:151] offset:1024
s_waitcnt lgkmcnt(0)
s_waitcnt vmcnt(16)
s_mul_i32 s3, s77, 2048
v_add_u32 v15, s3, v2
v_perm_b32 v144, v121, v120, s32
v_perm_b32 v145, v123, v122, s32
v_perm_b32 v146, v125, v124, s32
v_perm_b32 v147, v127, v126, s32
ds_write_b128 v15, v[144:147] offset:0
v_perm_b32 v148, v121, v120, s33
v_perm_b32 v149, v123, v122, s33
v_perm_b32 v150, v125, v124, s33
v_perm_b32 v151, v127, v126, s33
ds_write_b128 v15, v[148:151] offset:1024
s_waitcnt lgkmcnt(0)
s_waitcnt vmcnt(8)
s_mul_i32 s3, s78, 2048
v_add_u32 v15, s3, v2
v_perm_b32 v144, v129, v128, s32
v_perm_b32 v145, v131, v130, s32
v_perm_b32 v146, v133, v132, s32
v_perm_b32 v147, v135, v134, s32
ds_write_b128 v15, v[144:147] offset:0
v_perm_b32 v148, v129, v128, s33
v_perm_b32 v149, v131, v130, s33
v_perm_b32 v150, v133, v132, s33
v_perm_b32 v151, v135, v134, s33
ds_write_b128 v15, v[148:151] offset:1024
s_waitcnt lgkmcnt(0)
s_waitcnt vmcnt(0)
s_mul_i32 s3, s79, 2048
v_add_u32 v15, s3, v2
v_perm_b32 v144, v137, v136, s32
v_perm_b32 v145, v139, v138, s32
v_perm_b32 v146, v141, v140, s32
v_perm_b32 v147, v143, v142, s32
ds_write_b128 v15, v[144:147] offset:0
v_perm_b32 v148, v137, v136, s33
v_perm_b32 v149, v139, v138, s33
v_perm_b32 v150, v141, v140, s33
v_perm_b32 v151, v143, v142, s33
ds_write_b128 v15, v[148:151] offset:1024
s_waitcnt lgkmcnt(0)
s_add_u32 s90, s90, 1
s_cmp_lt_u32 s90, 1
s_cbranch_scc1 L_w_62
s_lshr_b32 s22, s20, 1
s_and_b32 s23, s20, 1
s_mov_b32 s28, 0xc000
s_mul_i32 s3, s22, 0x4000
s_add_u32 s28, s28, s3
s_mul_i32 s3, s23, 0x100
s_add_u32 s28, s28, s3
s_mul_i32 s3, s60, 0x40
s_add_u32 s28, s28, s3
s_mov_b32 s29, 0xa000
s_mul_i32 s3, s22, 0x1000
s_add_u32 s29, s29, s3
s_mul_i32 s3, s23, 0x40
s_add_u32 s29, s29, s3
s_mov_b32 s30, 0x9400000
s_mul_i32 s3, s22, 0x1000000
s_add_u32 s30, s30, s3
s_mul_i32 s3, s23, 0x40000
s_add_u32 s30, s30, s3
s_mul_i32 s3, s60, 0x10000
s_add_u32 s30, s30, s3
s_mov_b32 s31, 0x4000000
s_mul_i32 s3, s22, 0x900000
s_add_u32 s31, s31, s3
s_mul_i32 s3, s23, 0x24000
s_add_u32 s31, s31, s3
s_mul_i32 s3, s60, 0x9000
s_add_u32 s31, s31, s3
s_mul_i32 s3, s61, 0x1000
s_add_u32 s31, s31, s3
s_mov_b32 s39, 0x7fff0000
s_mov_b32 s85, 0
s_waitcnt vmcnt(0) lgkmcnt(0)
s_cmp_lg_u32 s20, 0
s_cbranch_scc1 L_walld_64
s_mov_b32 s91, 0
L_wall_63:
buffer_load_dword v15, off, s[16:19], 0 sc1
s_add_u32 s91, s91, 1
s_cmp_gt_u32 s91, 200000
s_cbranch_scc1 L_FAIL
s_waitcnt vmcnt(0)
v_cmp_gt_u32 vcc, 32, v15
s_nop 0
s_nop 2
s_cbranch_vccz L_walld_64
s_sleep 4
s_branch L_wall_63
L_walld_64:
s_barrier
L_op_top:
s_cmp_lg_u32 s85, 0
s_cbranch_scc1 L_warm_65
buffer_load_dword v15, off, s[4:7], s28 sc1
s_mov_b32 s91, 0
s_waitcnt vmcnt(0)
s_mov_b64 exec, 1
v_mov_b32 v13, 1
buffer_atomic_add v13, off, s[4:7], s39 sc1
s_mov_b64 exec, -1
v_cmp_gt_u32 vcc, 8, v15
s_nop 0
s_nop 2
s_cbranch_vccz L_spd_67
L_sp_66:
buffer_load_dword v15, off, s[4:7], s28 sc1
s_add_u32 s91, s91, 1
s_cmp_gt_u32 s91, 200000
s_cbranch_scc1 L_FAIL
s_waitcnt vmcnt(0)
v_cmp_gt_u32 vcc, 8, v15
s_nop 0
s_nop 2
s_cbranch_vccnz L_sp_66
L_spd_67:
s_mov_b32 s39, 0x7fff0000
s_add_u32 s27, s30, 0x0
buffer_load_dwordx4 a[0:3], v2, s[4:7], s27 offen offset:0
buffer_load_dwordx4 a[4:7], v2, s[4:7], s27 offen offset:1024
buffer_load_dwordx4 a[8:11], v2, s[4:7], s27 offen offset:2048
buffer_load_dwordx4 a[12:15], v2, s[4:7], s27 offen offset:3072
s_add_u32 s27, s30, 0x1000
buffer_load_dwordx4 a[16:19], v2, s[4:7], s27 offen offset:0
buffer_load_dwordx4 a[20:23], v2, s[4:7], s27 offen offset:1024
buffer_load_dwordx4 a[24:27], v2, s[4:7], s27 offen offset:2048
buffer_load_dwordx4 a[28:31], v2, s[4:7], s27 offen offset:3072
s_waitcnt vmcnt(0)
L_warm_65:
ds_read_b128 v[128:131], v2 offset:0
ds_read_b128 v[132:135], v2 offset:1024
ds_read_b128 v[136:139], v2 offset:2048
ds_read_b128 v[140:143], v2 offset:3072
s_waitcnt lgkmcnt(2)
v_mfma_f32_32x32x16_bf16 v[64:79], v[128:131], a[0:3], 0
ds_read_b128 v[144:147], v2 offset:4096
s_add_u32 s27, s30, 8192
buffer_load_dwordx4 a[32:35], v2, s[4:7], s27 offen offset:0
v_mfma_f32_32x32x16_bf16 v[80:95], v[132:135], a[0:3], 0
ds_read_b128 v[148:151], v2 offset:5120
buffer_load_dwordx4 a[36:39], v2, s[4:7], s27 offen offset:1024
s_waitcnt lgkmcnt(2)
v_mfma_f32_32x32x16_bf16 v[64:79], v[136:139], a[4:7], v[64:79]
ds_read_b128 v[128:131], v2 offset:6144
buffer_load_dwordx4 a[40:43], v2, s[4:7], s27 offen offset:2048
v_mfma_f32_32x32x16_bf16 v[80:95], v[140:143], a[4:7], v[80:95]
ds_read_b128 v[132:135], v2 offset:7168
buffer_load_dwordx4 a[44:47], v2, s[4:7], s27 offen offset:3072
s_waitcnt lgkmcnt(2)
v_mfma_f32_32x32x16_bf16 v[64:79], v[144:147], a[8:11], v[64:79]
ds_read_b128 v[136:139], v2 offset:8192
s_add_u32 s27, s30, 12288
buffer_load_dwordx4 a[48:51], v2, s[4:7], s27 offen offset:0
v_mfma_f32_32x32x16_bf16 v[80:95], v[148:151], a[8:11], v[80:95]
ds_read_b128 v[140:143], v2 offset:9216
buffer_load_dwordx4 a[52:55], v2, s[4:7], s27 offen offset:1024
s_waitcnt lgkmcnt(2)
v_mfma_f32_32x32x16_bf16 v[64:79], v[128:131], a[12:15], v[64:79]
ds_read_b128 v[144:147], v2 offset:10240
buffer_load_dwordx4 a[56:59], v2, s[4:7], s27 offen offset:2048
v_mfma_f32_32x32x16_bf16 v[80:95], v[132:135], a[12:15], v[80:95]
ds_read_b128 v[148:151], v2 offset:11264
buffer_load_dwordx4 a[60:63], v2, s[4:7], s27 offen offset:3072
s_waitcnt lgkmcnt(2)
v_mfma_f32_32x32x16_bf16 v[64:79], v[136:139], a[16:19], v[64:79]
ds_read_b128 v[128:131], v2 offset:12288
s_add_u32 s27, s30, 16384
buffer_load_dwordx4 a[64:67], v2, s[4:7], s27 offen offset:0
v_mfma_f32_32x32x16_bf16 v[80:95], v[140:143], a[16:19], v[80:95]
ds_read_b128 v[132:135], v2 offset:13312
buffer_load_dwordx4 a[68:71], v2, s[4:7], s27 offen offset:1024
s_waitcnt lgkmcnt(2)
v_mfma_f32_32x32x16_bf16 v[64:79], v[144:147], a[20:23], v[64:79]
ds_read_b128 v[136:139], v2 offset:14336
buffer_load_dwordx4 a[72:75], v2, s[4:7], s27 offen offset:2048
v_mfma_f32_32x32x16_bf16 v[80:95], v[148:151], a[20:23], v[80:95]
ds_read_b128 v[140:143], v2 offset:15360
buffer_load_dwordx4 a[76:79], v2, s[4:7], s27 offen offset:3072
s_waitcnt lgkmcnt(2)
v_mfma_f32_32x32x16_bf16 v[64:79], v[128:131], a[24:27], v[64:79]
ds_read_b128 v[144:147], v2 offset:16384
s_add_u32 s27, s30, 20480
buffer_load_dwordx4 a[80:83], v2, s[4:7], s27 offen offset:0
v_mfma_f32_32x32x16_bf16 v[80:95], v[132:135], a[24:27], v[80:95]
ds_read_b128 v[148:151], v2 offset:17408
buffer_load_dwordx4 a[84:87], v2, s[4:7], s27 offen offset:1024
s_waitcnt lgkmcnt(2)
v_mfma_f32_32x32x16_bf16 v[64:79], v[136:139], a[28:31], v[64:79]
ds_read_b128 v[128:131], v2 offset:18432
buffer_load_dwordx4 a[88:91], v2, s[4:7], s27 offen offset:2048
v_mfma_f32_32x32x16_bf16 v[80:95], v[140:143], a[28:31], v[80:95]
ds_read_b128 v[132:135], v2 offset:19456
buffer_load_dwordx4 a[92:95], v2, s[4:7], s27 offen offset:3072
s_waitcnt vmcnt(15) lgkmcnt(2)
v_mfma_f32_32x32x16_bf16 v[64:79], v[144:147], a[32:35], v[64:79]
ds_read_b128 v[136:139], v2 offset:20480
s_add_u32 s27, s30, 24576
buffer_load_dwordx4 a[96:99], v2, s[4:7], s27 offen offset:0
s_mov_b64 exec, 1
v_mov_b32 v13, 1
buffer_atomic_add v13, off, s[4:7], s39 sc1
s_mov_b64 exec, -1
v_mfma_f32_32x32x16_bf16 v[80:95], v[148:151], a[32:35], v[80:95]
ds_read_b128 v[140:143], v2 offset:21504
buffer_load_dwordx4 a[100:103], v2, s[4:7], s27 offen offset:1024
s_waitcnt vmcnt(17) lgkmcnt(2)
v_mfma_f32_32x32x16_bf16 v[64:79], v[128:131], a[36:39], v[64:79]
ds_read_b128 v[144:147], v2 offset:22528
buffer_load_dwordx4 a[104:107], v2, s[4:7], s27 offen offset:2048
v_mfma_f32_32x32x16_bf16 v[80:95], v[132:135], a[36:39], v[80:95]
ds_read_b128 v[148:151], v2 offset:23552
buffer_load_dwordx4 a[108:111], v2, s[4:7], s27 offen offset:3072
s_waitcnt vmcnt(18) lgkmcnt(2)
v_mfma_f32_32x32x16_bf16 v[64:79], v[136:139], a[40:43], v[64:79]
ds_read_b128 v[128:131], v2 offset:24576
s_add_u32 s27, s30, 28672
buffer_load_dwordx4 a[112:115], v2, s[4:7], s27 offen offset:0
v_mfma_f32_32x32x16_bf16 v[80:95], v[140:143], a[40:43], v[80:95]
ds_read_b128 v[132:135], v2 offset:25600
buffer_load_dwordx4 a[116:119], v2, s[4:7], s27 offen offset:1024
s_waitcnt vmcnt(19) lgkmcnt(2)
v_mfma_f32_32x32x16_bf16 v[64:79], v[144:147], a[44:47], v[64:79]
ds_read_b128 v[136:139], v2 offset:26624
buffer_load_dwordx4 a[120:123], v2, s[4:7], s27 offen offset:2048
v_mfma_f32_32x32x16_bf16 v[80:95], v[148:151], a[44:47], v[80:95]
ds_read_b128 v[140:143], v2 offset:27648
buffer_load_dwordx4 a[124:127], v2, s[4:7], s27 offen offset:3072
s_waitcnt vmcnt(20) lgkmcnt(2)
v_mfma_f32_32x32x16_bf16 v[64:79], v[128:131], a[48:51], v[64:79]
ds_read_b128 v[144:147], v2 offset:28672
s_add_u32 s27, s30, 32768
buffer_load_dwordx4 a[128:131], v2, s[4:7], s27 offen offset:0
v_mfma_f32_32x32x16_bf16 v[80:95], v[132:135], a[48:51], v[80:95]
ds_read_b128 v[148:151], v2 offset:29696
buffer_load_dwordx4 a[132:135], v2, s[4:7], s27 offen offset:1024
s_waitcnt vmcnt(21) lgkmcnt(2)
v_mfma_f32_32x32x16_bf16 v[64:79], v[136:139], a[52:55], v[64:79]
ds_read_b128 v[128:131], v2 offset:30720
buffer_load_dwordx4 a[136:139], v2, s[4:7], s27 offen offset:2048
v_mfma_f32_32x32x16_bf16 v[80:95], v[140:143], a[52:55], v[80:95]
ds_read_b128 v[132:135], v2 offset:31744
buffer_load_dwordx4 a[140:143], v2, s[4:7], s27 offen offset:3072
s_waitcnt vmcnt(22) lgkmcnt(2)
v_mfma_f32_32x32x16_bf16 v[64:79], v[144:147], a[56:59], v[64:79]
ds_read_b128 v[136:139], v2 offset:32768
s_add_u32 s27, s30, 36864
buffer_load_dwordx4 a[144:147], v2, s[4:7], s27 offen offset:0
v_mfma_f32_32x32x16_bf16 v[80:95], v[148:151], a[56:59], v[80:95]
ds_read_b128 v[140:143], v2 offset:33792
buffer_load_dwordx4 a[148:151], v2, s[4:7], s27 offen offset:1024
s_waitcnt vmcnt(23) lgkmcnt(2)
v_mfma_f32_32x32x16_bf16 v[64:79], v[128:131], a[60:63], v[64:79]
ds_read_b128 v[144:147], v2 offset:34816
buffer_load_dwordx4 a[152:155], v2, s[4:7], s27 offen offset:2048
v_mfma_f32_32x32x16_bf16 v[80:95], v[132:135], a[60:63], v[80:95]
ds_read_b128 v[148:151], v2 offset:35840
buffer_load_dwordx4 a[156:159], v2, s[4:7], s27 offen offset:3072
s_waitcnt vmcnt(24) lgkmcnt(2)
v_mfma_f32_32x32x16_bf16 v[64:79], v[136:139], a[64:67], v[64:79]
ds_read_b128 v[128:131], v2 offset:36864
s_add_u32 s27, s30, 40960
buffer_load_dwordx4 a[160:163], v2, s[4:7], s27 offen offset:0
v_mfma_f32_32x32x16_bf16 v[80:95], v[140:143], a[64:67], v[80:95]
ds_read_b128 v[132:135], v2 offset:37888
buffer_load_dwordx4 a[164:167], v2, s[4:7], s27 offen offset:1024
s_waitcnt vmcnt(25) lgkmcnt(2)
v_mfma_f32_32x32x16_bf16 v[64:79], v[144:147], a[68:71], v[64:79]
ds_read_b128 v[136:139], v2 offset:38912
buffer_load_dwordx4 a[168:171], v2, s[4:7], s27 offen offset:2048
v_mfma_f32_32x32x16_bf16 v[80:95], v[148:151], a[68:71], v[80:95]
ds_read_b128 v[140:143], v2 offset:39936
buffer_load_dwordx4 a[172:175], v2, s[4:7], s27 offen offset:3072
s_waitcnt vmcnt(26) lgkmcnt(2)
v_mfma_f32_32x32x16_bf16 v[64:79], v[128:131], a[72:75], v[64:79]
ds_read_b128 v[144:147], v2 offset:40960
s_add_u32 s27, s30, 45056
buffer_load_dwordx4 a[176:179], v2, s[4:7], s27 offen offset:0
v_mfma_f32_32x32x16_bf16 v[80:95], v[132:135], a[72:75], v[80:95]
ds_read_b128 v[148:151], v2 offset:41984
buffer_load_dwordx4 a[180:183], v2, s[4:7], s27 offen offset:1024
s_waitcnt vmcnt(27) lgkmcnt(2)
v_mfma_f32_32x32x16_bf16 v[64:79], v[136:139], a[76:79], v[64:79]
ds_read_b128 v[128:131], v2 offset:43008
buffer_load_dwordx4 a[184:187], v2, s[4:7], s27 offen offset:2048
v_mfma_f32_32x32x16_bf16 v[80:95], v[140:143], a[76:79], v[80:95]
ds_read_b128 v[132:135], v2 offset:44032
buffer_load_dwordx4 a[188:191], v2, s[4:7], s27 offen offset:3072
s_waitcnt vmcnt(28) lgkmcnt(2)
v_mfma_f32_32x32x16_bf16 v[64:79], v[144:147], a[80:83], v[64:79]
ds_read_b128 v[136:139], v2 offset:45056
s_add_u32 s27, s30, 49152
buffer_load_dwordx4 a[192:195], v2, s[4:7], s27 offen offset:0
v_mfma_f32_32x32x16_bf16 v[80:95], v[148:151], a[80:83], v[80:95]
ds_read_b128 v[140:143], v2 offset:46080
buffer_load_dwordx4 a[196:199], v2, s[4:7], s27 offen offset:1024
s_waitcnt vmcnt(29) lgkmcnt(2)
v_mfma_f32_32x32x16_bf16 v[64:79], v[128:131], a[84:87], v[64:79]
ds_read_b128 v[144:147], v2 offset:47104
buffer_load_dwordx4 a[200:203], v2, s[4:7], s27 offen offset:2048
v_mfma_f32_32x32x16_bf16 v[80:95], v[132:135], a[84:87], v[80:95]
ds_read_b128 v[148:151], v2 offset:48128
buffer_load_dwordx4 a[204:207], v2, s[4:7], s27 offen offset:3072
s_waitcnt vmcnt(30) lgkmcnt(2)
v_mfma_f32_32x32x16_bf16 v[64:79], v[136:139], a[88:91], v[64:79]
ds_read_b128 v[128:131], v2 offset:49152
s_add_u32 s27, s30, 53248
buffer_load_dwordx4 a[208:211], v2, s[4:7], s27 offen offset:0
v_mfma_f32_32x32x16_bf16 v[80:95], v[140:143], a[88:91], v[80:95]
ds_read_b128 v[132:135], v2 offset:50176
buffer_load_dwordx4 a[212:215], v2, s[4:7], s27 offen offset:1024
s_waitcnt vmcnt(31) lgkmcnt(2)
v_mfma_f32_32x32x16_bf16 v[64:79], v[144:147], a[92:95], v[64:79]
ds_read_b128 v[136:139], v2 offset:51200
buffer_load_dwordx4 a[216:219], v2, s[4:7], s27 offen offset:2048
v_mfma_f32_32x32x16_bf16 v[80:95], v[148:151], a[92:95], v[80:95]
ds_read_b128 v[140:143], v2 offset:52224
buffer_load_dwordx4 a[220:223], v2, s[4:7], s27 offen offset:3072
s_waitcnt vmcnt(32) lgkmcnt(2)
v_mfma_f32_32x32x16_bf16 v[64:79], v[128:131], a[96:99], v[64:79]
ds_read_b128 v[144:147], v2 offset:53248
s_add_u32 s27, s30, 57344
buffer_load_dwordx4 a[224:227], v2, s[4:7], s27 offen offset:0
v_mfma_f32_32x32x16_bf16 v[80:95], v[132:135], a[96:99], v[80:95]
ds_read_b128 v[148:151], v2 offset:54272
buffer_load_dwordx4 a[228:231], v2, s[4:7], s27 offen offset:1024
s_waitcnt vmcnt(32) lgkmcnt(2)
v_mfma_f32_32x32x16_bf16 v[64:79], v[136:139], a[100:103], v[64:79]
ds_read_b128 v[128:131], v2 offset:55296
buffer_load_dwordx4 a[232:235], v2, s[4:7], s27 offen offset:2048
v_mfma_f32_32x32x16_bf16 v[80:95], v[140:143], a[100:103], v[80:95]
ds_read_b128 v[132:135], v2 offset:56320
buffer_load_dwordx4 a[236:239], v2, s[4:7], s27 offen offset:3072
s_waitcnt vmcnt(33) lgkmcnt(2)
v_mfma_f32_32x32x16_bf16 v[64:79], v[144:147], a[104:107], v[64:79]
ds_read_b128 v[136:139], v2 offset:57344
s_add_u32 s27, s30, 61440
buffer_load_dwordx4 a[240:243], v2, s[4:7], s27 offen offset:0
v_mfma_f32_32x32x16_bf16 v[80:95], v[148:151], a[104:107], v[80:95]
ds_read_b128 v[140:143], v2 offset:58368
buffer_load_dwordx4 a[244:247], v2, s[4:7], s27 offen offset:1024
s_waitcnt vmcnt(34) lgkmcnt(2)
v_mfma_f32_32x32x16_bf16 v[64:79], v[128:131], a[108:111], v[64:79]
ds_read_b128 v[144:147], v2 offset:59392
buffer_load_dwordx4 a[248:251], v2, s[4:7], s27 offen offset:2048
v_mfma_f32_32x32x16_bf16 v[80:95], v[132:135], a[108:111], v[80:95]
ds_read_b128 v[148:151], v2 offset:60416
buffer_load_dwordx4 a[252:255], v2, s[4:7], s27 offen offset:3072
s_waitcnt vmcnt(35) lgkmcnt(2)
v_mfma_f32_32x32x16_bf16 v[64:79], v[136:139], a[112:115], v[64:79]
ds_read_b128 v[128:131], v3 offset:0
v_mfma_f32_32x32x16_bf16 v[80:95], v[140:143], a[112:115], v[80:95]
ds_read_b128 v[132:135], v3 offset:1024
s_waitcnt vmcnt(34) lgkmcnt(2)
v_mfma_f32_32x32x16_bf16 v[64:79], v[144:147], a[116:119], v[64:79]
ds_read_b128 v[136:139], v3 offset:2048
v_mfma_f32_32x32x16_bf16 v[80:95], v[148:151], a[116:119], v[80:95]
ds_read_b128 v[140:143], v3 offset:3072
s_waitcnt vmcnt(33) lgkmcnt(2)
v_mfma_f32_32x32x16_bf16 v[64:79], v[128:131], a[120:123], v[64:79]
ds_read_b128 v[144:147], v3 offset:4096
v_mfma_f32_32x32x16_bf16 v[80:95], v[132:135], a[120:123], v[80:95]
ds_read_b128 v[148:151], v3 offset:5120
s_waitcnt vmcnt(32) lgkmcnt(2)
v_mfma_f32_32x32x16_bf16 v[64:79], v[136:139], a[124:127], v[64:79]
ds_read_b128 v[128:131], v3 offset:6144
v_mfma_f32_32x32x16_bf16 v[80:95], v[140:143], a[124:127], v[80:95]
ds_read_b128 v[132:135], v3 offset:7168
s_waitcnt vmcnt(31) lgkmcnt(2)
v_mfma_f32_32x32x16_bf16 v[64:79], v[144:147], a[128:131], v[64:79]
ds_read_b128 v[136:139], v3 offset:8192
v_mfma_f32_32x32x16_bf16 v[80:95], v[148:151], a[128:131], v[80:95]
ds_read_b128 v[140:143], v3 offset:9216
s_waitcnt vmcnt(30) lgkmcnt(2)
v_mfma_f32_32x32x16_bf16 v[64:79], v[128:131], a[132:135], v[64:79]
ds_read_b128 v[144:147], v3 offset:10240
v_mfma_f32_32x32x16_bf16 v[80:95], v[132:135], a[132:135], v[80:95]
ds_read_b128 v[148:151], v3 offset:11264
s_waitcnt vmcnt(29) lgkmcnt(2)
v_mfma_f32_32x32x16_bf16 v[64:79], v[136:139], a[136:139], v[64:79]
ds_read_b128 v[128:131], v3 offset:12288
v_mfma_f32_32x32x16_bf16 v[80:95], v[140:143], a[136:139], v[80:95]
ds_read_b128 v[132:135], v3 offset:13312
s_waitcnt vmcnt(28) lgkmcnt(2)
v_mfma_f32_32x32x16_bf16 v[64:79], v[144:147], a[140:143], v[64:79]
ds_read_b128 v[136:139], v3 offset:14336
v_mfma_f32_32x32x16_bf16 v[80:95], v[148:151], a[140:143], v[80:95]
ds_read_b128 v[140:143], v3 offset:15360
s_waitcnt vmcnt(27) lgkmcnt(2)
v_mfma_f32_32x32x16_bf16 v[64:79], v[128:131], a[144:147], v[64:79]
ds_read_b128 v[144:147], v3 offset:16384
v_mfma_f32_32x32x16_bf16 v[80:95], v[132:135], a[144:147], v[80:95]
ds_read_b128 v[148:151], v3 offset:17408
s_add_u32 s3, s28, 0x200
buffer_load_dword v14, off, s[4:7], s3 sc1
s_waitcnt vmcnt(27) lgkmcnt(2)
v_mfma_f32_32x32x16_bf16 v[64:79], v[136:139], a[148:151], v[64:79]
ds_read_b128 v[128:131], v3 offset:18432
v_mfma_f32_32x32x16_bf16 v[80:95], v[140:143], a[148:151], v[80:95]
ds_read_b128 v[132:135], v3 offset:19456
s_waitcnt vmcnt(26) lgkmcnt(2)
v_mfma_f32_32x32x16_bf16 v[64:79], v[144:147], a[152:155], v[64:79]
ds_read_b128 v[136:139], v3 offset:20480
v_mfma_f32_32x32x16_bf16 v[80:95], v[148:151], a[152:155], v[80:95]
ds_read_b128 v[140:143], v3 offset:21504
s_waitcnt vmcnt(25) lgkmcnt(2)
v_mfma_f32_32x32x16_bf16 v[64:79], v[128:131], a[156:159], v[64:79]
ds_read_b128 v[144:147], v3 offset:22528
v_mfma_f32_32x32x16_bf16 v[80:95], v[132:135], a[156:159], v[80:95]
ds_read_b128 v[148:151], v3 offset:23552
s_waitcnt vmcnt(24) lgkmcnt(2)
v_mfma_f32_32x32x16_bf16 v[64:79], v[136:139], a[160:163], v[64:79]
ds_read_b128 v[128:131], v3 offset:24576
v_mfma_f32_32x32x16_bf16 v[80:95], v[140:143], a[160:163], v[80:95]
ds_read_b128 v[132:135], v3 offset:25600
s_waitcnt vmcnt(23) lgkmcnt(2)
v_mfma_f32_32x32x16_bf16 v[64:79], v[144:147], a[164:167], v[64:79]
ds_read_b128 v[136:139], v3 offset:26624
v_mfma_f32_32x32x16_bf16 v[80:95], v[148:151], a[164:167], v[80:95]
ds_read_b128 v[140:143], v3 offset:27648
s_waitcnt vmcnt(22) lgkmcnt(2)
v_mfma_f32_32x32x16_bf16 v[64:79], v[128:131], a[168:171], v[64:79]
ds_read_b128 v[144:147], v3 offset:28672
v_mfma_f32_32x32x16_bf16 v[80:95], v[132:135], a[168:171], v[80:95]
ds_read_b128 v[148:151], v3 offset:29696
s_waitcnt vmcnt(21) lgkmcnt(2)
v_mfma_f32_32x32x16_bf16 v[64:79], v[136:139], a[172:175], v[64:79]
ds_read_b128 v[128:131], v3 offset:30720
v_mfma_f32_32x32x16_bf16 v[80:95], v[140:143], a[172:175], v[80:95]
ds_read_b128 v[132:135], v3 offset:31744
s_waitcnt vmcnt(20) lgkmcnt(2)
v_mfma_f32_32x32x16_bf16 v[64:79], v[144:147], a[176:179], v[64:79]
ds_read_b128 v[136:139], v3 offset:32768
v_mfma_f32_32x32x16_bf16 v[80:95], v[148:151], a[176:179], v[80:95]
ds_read_b128 v[140:143], v3 offset:33792
s_waitcnt vmcnt(19) lgkmcnt(2)
v_mfma_f32_32x32x16_bf16 v[64:79], v[128:131], a[180:183], v[64:79]
ds_read_b128 v[144:147], v3 offset:34816
v_mfma_f32_32x32x16_bf16 v[80:95], v[132:135], a[180:183], v[80:95]
ds_read_b128 v[148:151], v3 offset:35840
s_waitcnt vmcnt(18) lgkmcnt(2)
v_mfma_f32_32x32x16_bf16 v[64:79], v[136:139], a[184:187], v[64:79]
ds_read_b128 v[128:131], v3 offset:36864
v_mfma_f32_32x32x16_bf16 v[80:95], v[140:143], a[184:187], v[80:95]
ds_read_b128 v[132:135], v3 offset:37888
s_waitcnt vmcnt(17) lgkmcnt(2)
v_mfma_f32_32x32x16_bf16 v[64:79], v[144:147], a[188:191], v[64:79]
ds_read_b128 v[136:139], v3 offset:38912
v_mfma_f32_32x32x16_bf16 v[80:95], v[148:151], a[188:191], v[80:95]
ds_read_b128 v[140:143], v3 offset:39936
s_waitcnt vmcnt(16) lgkmcnt(2)
v_mfma_f32_32x32x16_bf16 v[64:79], v[128:131], a[192:195], v[64:79]
ds_read_b128 v[144:147], v3 offset:40960
v_mfma_f32_32x32x16_bf16 v[80:95], v[132:135], a[192:195], v[80:95]
ds_read_b128 v[148:151], v3 offset:41984
s_waitcnt vmcnt(15) lgkmcnt(2)
v_mfma_f32_32x32x16_bf16 v[64:79], v[136:139], a[196:199], v[64:79]
ds_read_b128 v[128:131], v3 offset:43008
v_mfma_f32_32x32x16_bf16 v[80:95], v[140:143], a[196:199], v[80:95]
ds_read_b128 v[132:135], v3 offset:44032
s_waitcnt vmcnt(14) lgkmcnt(2)
v_mfma_f32_32x32x16_bf16 v[64:79], v[144:147], a[200:203], v[64:79]
ds_read_b128 v[136:139], v3 offset:45056
v_mfma_f32_32x32x16_bf16 v[80:95], v[148:151], a[200:203], v[80:95]
ds_read_b128 v[140:143], v3 offset:46080
s_waitcnt vmcnt(13) lgkmcnt(2)
v_mfma_f32_32x32x16_bf16 v[64:79], v[128:131], a[204:207], v[64:79]
ds_read_b128 v[144:147], v3 offset:47104
v_mfma_f32_32x32x16_bf16 v[80:95], v[132:135], a[204:207], v[80:95]
ds_read_b128 v[148:151], v3 offset:48128
s_waitcnt vmcnt(12) lgkmcnt(2)
v_mfma_f32_32x32x16_bf16 v[64:79], v[136:139], a[208:211], v[64:79]
ds_read_b128 v[128:131], v3 offset:49152
v_mfma_f32_32x32x16_bf16 v[80:95], v[140:143], a[208:211], v[80:95]
ds_read_b128 v[132:135], v3 offset:50176
s_waitcnt vmcnt(11) lgkmcnt(2)
v_mfma_f32_32x32x16_bf16 v[64:79], v[144:147], a[212:215], v[64:79]
ds_read_b128 v[136:139], v3 offset:51200
v_mfma_f32_32x32x16_bf16 v[80:95], v[148:151], a[212:215], v[80:95]
ds_read_b128 v[140:143], v3 offset:52224
s_waitcnt vmcnt(10) lgkmcnt(2)
v_mfma_f32_32x32x16_bf16 v[64:79], v[128:131], a[216:219], v[64:79]
ds_read_b128 v[144:147], v3 offset:53248
v_mfma_f32_32x32x16_bf16 v[80:95], v[132:135], a[216:219], v[80:95]
ds_read_b128 v[148:151], v3 offset:54272
s_waitcnt vmcnt(0)
v_cmp_le_u32 vcc, 8, v14
s_nop 3
s_and_b32 s85, vcc_lo, 1
s_cmp_lt_u32 s23, 62
s_cselect_b32 s85, s85, 0
s_add_u32 s86, s30, 0x80000
s_cmp_lg_u32 s85, 0
s_cselect_b32 s86, s86, 0x7fff0000
s_add_u32 s87, s86, 4096
s_waitcnt vmcnt(9) lgkmcnt(2)
v_mfma_f32_32x32x16_bf16 v[64:79], v[136:139], a[220:223], v[64:79]
ds_read_b128 v[128:131], v3 offset:55296
buffer_load_dwordx4 a[0:3], v2, s[4:7], s86 offen offset:0
v_mfma_f32_32x32x16_bf16 v[80:95], v[140:143], a[220:223], v[80:95]
ds_read_b128 v[132:135], v3 offset:56320
buffer_load_dwordx4 a[4:7], v2, s[4:7], s86 offen offset:1024
s_waitcnt vmcnt(10) lgkmcnt(2)
v_mfma_f32_32x32x16_bf16 v[64:79], v[144:147], a[224:227], v[64:79]
ds_read_b128 v[136:139], v3 offset:57344
buffer_load_dwordx4 a[8:11], v2, s[4:7], s86 offen offset:2048
v_mfma_f32_32x32x16_bf16 v[80:95], v[148:151], a[224:227], v[80:95]
ds_read_b128 v[140:143], v3 offset:58368
buffer_load_dwordx4 a[12:15], v2, s[4:7], s86 offen offset:3072
s_waitcnt vmcnt(11) lgkmcnt(2)
v_mfma_f32_32x32x16_bf16 v[64:79], v[128:131], a[228:231], v[64:79]
ds_read_b128 v[144:147], v3 offset:59392
buffer_load_dwordx4 a[16:19], v2, s[4:7], s87 offen offset:0
v_mfma_f32_32x32x16_bf16 v[80:95], v[132:135], a[228:231], v[80:95]
ds_read_b128 v[148:151], v3 offset:60416
buffer_load_dwordx4 a[20:23], v2, s[4:7], s87 offen offset:1024
s_waitcnt vmcnt(12) lgkmcnt(2)
v_mfma_f32_32x32x16_bf16 v[64:79], v[136:139], a[232:235], v[64:79]
ds_read_b128 v[128:131], v4 offset:0
buffer_load_dwordx4 a[24:27], v2, s[4:7], s87 offen offset:2048
v_mfma_f32_32x32x16_bf16 v[80:95], v[140:143], a[232:235], v[80:95]
ds_read_b128 v[132:135], v4 offset:1024
buffer_load_dwordx4 a[28:31], v2, s[4:7], s87 offen offset:3072
s_waitcnt vmcnt(13) lgkmcnt(2)
v_mfma_f32_32x32x16_bf16 v[64:79], v[144:147], a[236:239], v[64:79]
ds_read_b128 v[136:139], v4 offset:2048
v_mfma_f32_32x32x16_bf16 v[80:95], v[148:151], a[236:239], v[80:95]
ds_read_b128 v[140:143], v4 offset:3072
s_waitcnt vmcnt(12) lgkmcnt(2)
v_mfma_f32_32x32x16_bf16 v[64:79], v[128:131], a[240:243], v[64:79]
ds_read_b128 v[144:147], v4 offset:4096
v_mfma_f32_32x32x16_bf16 v[80:95], v[132:135], a[240:243], v[80:95]
ds_read_b128 v[148:151], v4 offset:5120
s_waitcnt vmcnt(11) lgkmcnt(2)
v_mfma_f32_32x32x16_bf16 v[64:79], v[136:139], a[244:247], v[64:79]
ds_read_b128 v[128:131], v4 offset:6144
v_mfma_f32_32x32x16_bf16 v[80:95], v[140:143], a[244:247], v[80:95]
ds_read_b128 v[132:135], v4 offset:7168
s_waitcnt vmcnt(10) lgkmcnt(2)
v_mfma_f32_32x32x16_bf16 v[64:79], v[144:147], a[248:251], v[64:79]
v_mfma_f32_32x32x16_bf16 v[80:95], v[148:151], a[248:251], v[80:95]
s_waitcnt vmcnt(9) lgkmcnt(0)
v_mfma_f32_32x32x16_bf16 v[64:79], v[128:131], a[252:255], v[64:79]
v_mfma_f32_32x32x16_bf16 v[80:95], v[132:135], a[252:255], v[80:95]
s_nop 11
v_cvt_pk_bf16_f32 v16, v64, v80
v_cvt_pk_bf16_f32 v17, v65, v81
v_cvt_pk_bf16_f32 v18, v66, v82
v_cvt_pk_bf16_f32 v19, v67, v83
buffer_store_dwordx4 v[16:19], v2, s[4:7], s31 offen offset:0 sc1
v_cvt_pk_bf16_f32 v20, v68, v84
v_cvt_pk_bf16_f32 v21, v69, v85
v_cvt_pk_bf16_f32 v22, v70, v86
v_cvt_pk_bf16_f32 v23, v71, v87
buffer_store_dwordx4 v[20:23], v2, s[4:7], s31 offen offset:1024 sc1
v_cvt_pk_bf16_f32 v24, v72, v88
v_cvt_pk_bf16_f32 v25, v73, v89
v_cvt_pk_bf16_f32 v26, v74, v90
v_cvt_pk_bf16_f32 v27, v75, v91
buffer_store_dwordx4 v[24:27], v2, s[4:7], s31 offen offset:2048 sc1
v_cvt_pk_bf16_f32 v28, v76, v92
v_cvt_pk_bf16_f32 v29, v77, v93
v_cvt_pk_bf16_f32 v30, v78, v94
v_cvt_pk_bf16_f32 v31, v79, v95
buffer_store_dwordx4 v[28:31], v2, s[4:7], s31 offen offset:3072 sc1
s_waitcnt vmcnt(4)
s_mov_b32 s39, s29
s_add_u32 s28, s28, 0x200
s_add_u32 s29, s29, 0x80
s_add_u32 s30, s30, 0x80000
s_add_u32 s31, s31, 0x48000
s_add_u32 s23, s23, 2
s_cmp_lt_u32 s23, 64
s_cbranch_scc1 L_op_top
s_waitcnt vmcnt(0)
s_mov_b64 exec, 1
v_mov_b32 v13, 1
buffer_atomic_add v13, off, s[4:7], s39 sc1
s_mov_b64 exec, -1
s_waitcnt vmcnt(0)
s_branch L_END
s_endpgm
L_R_aw:
v_and_b32 v1, 63, v0
v_lshlrev_b32 v2, 4, v1
v_add_u32 v3, 61440, v2
v_add_u32 v4, 122880, v2
s_mov_b32 s32, 0x05040100
s_mov_b32 s33, 0x07060302
s_load_dwordx2 s[90:91], s[0:1], 16
s_waitcnt lgkmcnt(0)
s_mov_b32 s8, s90
s_and_b32 s9, s91, 0xffff
s_mov_b32 s10, 0xa2000
s_mov_b32 s11, 0x20000
v_and_b32 v8, 31, v1
v_lshrrev_b32 v9, 5, v1
s_lshl_b32 s3, s21, 8
v_lshlrev_b32 v12, 2, v8
v_add_u32 v12, s3, v12
s_cmp_eq_u32 s21, 4
s_mov_b32 s61, 128
s_cselect_b32 s61, 0x7fff0000, s61
s_mov_b32 s3, 4608
v_mul_lo_u32 v13, v9, s3
v_add_u32 v10, v12, v13
v_add_u32 v11, s61, v10
s_mov_b32 s90, 0
L_w_68:
s_mul_i32 s34, s90, 32
s_add_u32 s34, s34, s20
s_mov_b32 s64, s34
s_mul_i32 s35, s34, 20736
s_add_u32 s36, s35, 0
buffer_load_dword v16, v10, s[8:11], s36 offen
buffer_load_dword v24, v11, s[8:11], s36 offen
s_add_u32 s36, s35, 1152
buffer_load_dword v17, v10, s[8:11], s36 offen
buffer_load_dword v25, v11, s[8:11], s36 offen
s_add_u32 s36, s35, 2304
buffer_load_dword v18, v10, s[8:11], s36 offen
buffer_load_dword v26, v11, s[8:11], s36 offen
s_add_u32 s36, s35, 3456
buffer_load_dword v19, v10, s[8:11], s36 offen
buffer_load_dword v27, v11, s[8:11], s36 offen
s_add_u32 s36, s35, 9216
buffer_load_dword v20, v10, s[8:11], s36 offen
buffer_load_dword v28, v11, s[8:11], s36 offen
s_add_u32 s36, s35, 10368
buffer_load_dword v21, v10, s[8:11], s36 offen
buffer_load_dword v29, v11, s[8:11], s36 offen
s_add_u32 s36, s35, 11520
buffer_load_dword v22, v10, s[8:11], s36 offen
buffer_load_dword v30, v11, s[8:11], s36 offen
s_add_u32 s36, s35, 12672
buffer_load_dword v23, v10, s[8:11], s36 offen
buffer_load_dword v31, v11, s[8:11], s36 offen
s_mul_i32 s34, s90, 32
s_add_u32 s34, s34, s20
s_add_u32 s34, s34, 4
s_mov_b32 s65, s34
s_mul_i32 s35, s34, 20736
s_add_u32 s36, s35, 0
buffer_load_dword v32, v10, s[8:11], s36 offen
buffer_load_dword v40, v11, s[8:11], s36 offen
s_add_u32 s36, s35, 1152
buffer_load_dword v33, v10, s[8:11], s36 offen
buffer_load_dword v41, v11, s[8:11], s36 offen
s_add_u32 s36, s35, 2304
buffer_load_dword v34, v10, s[8:11], s36 offen
buffer_load_dword v42, v11, s[8:11], s36 offen
s_add_u32 s36, s35, 3456
buffer_load_dword v35, v10, s[8:11], s36 offen
buffer_load_dword v43, v11, s[8:11], s36 offen
s_add_u32 s36, s35, 9216
buffer_load_dword v36, v10, s[8:11], s36 offen
buffer_load_dword v44, v11, s[8:11], s36 offen
s_add_u32 s36, s35, 10368
buffer_load_dword v37, v10, s[8:11], s36 offen
buffer_load_dword v45, v11, s[8:11], s36 offen
s_add_u32 s36, s35, 11520
buffer_load_dword v38, v10, s[8:11], s36 offen
buffer_load_dword v46, v11, s[8:11], s36 offen
s_add_u32 s36, s35, 12672
buffer_load_dword v39, v10, s[8:11], s36 offen
buffer_load_dword v47, v11, s[8:11], s36 offen
s_mul_i32 s34, s90, 32
s_add_u32 s34, s34, s20
s_add_u32 s34, s34, 8
s_mov_b32 s66, s34
s_mul_i32 s35, s34, 20736
s_add_u32 s36, s35, 0
buffer_load_dword v48, v10, s[8:11], s36 offen
buffer_load_dword v56, v11, s[8:11], s36 offen
s_add_u32 s36, s35, 1152
buffer_load_dword v49, v10, s[8:11], s36 offen
buffer_load_dword v57, v11, s[8:11], s36 offen
s_add_u32 s36, s35, 2304
buffer_load_dword v50, v10, s[8:11], s36 offen
buffer_load_dword v58, v11, s[8:11], s36 offen
s_add_u32 s36, s35, 3456
buffer_load_dword v51, v10, s[8:11], s36 offen
buffer_load_dword v59, v11, s[8:11], s36 offen
s_add_u32 s36, s35, 9216
buffer_load_dword v52, v10, s[8:11], s36 offen
buffer_load_dword v60, v11, s[8:11], s36 offen
s_add_u32 s36, s35, 10368
buffer_load_dword v53, v10, s[8:11], s36 offen
buffer_load_dword v61, v11, s[8:11], s36 offen
s_add_u32 s36, s35, 11520
buffer_load_dword v54, v10, s[8:11], s36 offen
buffer_load_dword v62, v11, s[8:11], s36 offen
s_add_u32 s36, s35, 12672
buffer_load_dword v55, v10, s[8:11], s36 offen
buffer_load_dword v63, v11, s[8:11], s36 offen
s_mul_i32 s34, s90, 32
s_add_u32 s34, s34, s20
s_add_u32 s34, s34, 12
s_mov_b32 s67, s34
s_mul_i32 s35, s34, 20736
s_add_u32 s36, s35, 0
buffer_load_dword v64, v10, s[8:11], s36 offen
buffer_load_dword v72, v11, s[8:11], s36 offen
s_add_u32 s36, s35, 1152
buffer_load_dword v65, v10, s[8:11], s36 offen
buffer_load_dword v73, v11, s[8:11], s36 offen
s_add_u32 s36, s35, 2304
buffer_load_dword v66, v10, s[8:11], s36 offen
buffer_load_dword v74, v11, s[8:11], s36 offen
s_add_u32 s36, s35, 3456
buffer_load_dword v67, v10, s[8:11], s36 offen
buffer_load_dword v75, v11, s[8:11], s36 offen
s_add_u32 s36, s35, 9216
buffer_load_dword v68, v10, s[8:11], s36 offen
buffer_load_dword v76, v11, s[8:11], s36 offen
s_add_u32 s36, s35, 10368
buffer_load_dword v69, v10, s[8:11], s36 offen
buffer_load_dword v77, v11, s[8:11], s36 offen
s_add_u32 s36, s35, 11520
buffer_load_dword v70, v10, s[8:11], s36 offen
buffer_load_dword v78, v11, s[8:11], s36 offen
s_add_u32 s36, s35, 12672
buffer_load_dword v71, v10, s[8:11], s36 offen
buffer_load_dword v79, v11, s[8:11], s36 offen
s_mul_i32 s34, s90, 32
s_add_u32 s34, s34, s20
s_add_u32 s34, s34, 16
s_mov_b32 s68, s34
s_mul_i32 s35, s34, 20736
s_add_u32 s36, s35, 0
buffer_load_dword v80, v10, s[8:11], s36 offen
buffer_load_dword v88, v11, s[8:11], s36 offen
s_add_u32 s36, s35, 1152
buffer_load_dword v81, v10, s[8:11], s36 offen
buffer_load_dword v89, v11, s[8:11], s36 offen
s_add_u32 s36, s35, 2304
buffer_load_dword v82, v10, s[8:11], s36 offen
buffer_load_dword v90, v11, s[8:11], s36 offen
s_add_u32 s36, s35, 3456
buffer_load_dword v83, v10, s[8:11], s36 offen
buffer_load_dword v91, v11, s[8:11], s36 offen
s_add_u32 s36, s35, 9216
buffer_load_dword v84, v10, s[8:11], s36 offen
buffer_load_dword v92, v11, s[8:11], s36 offen
s_add_u32 s36, s35, 10368
buffer_load_dword v85, v10, s[8:11], s36 offen
buffer_load_dword v93, v11, s[8:11], s36 offen
s_add_u32 s36, s35, 11520
buffer_load_dword v86, v10, s[8:11], s36 offen
buffer_load_dword v94, v11, s[8:11], s36 offen
s_add_u32 s36, s35, 12672
buffer_load_dword v87, v10, s[8:11], s36 offen
buffer_load_dword v95, v11, s[8:11], s36 offen
s_mul_i32 s34, s90, 32
s_add_u32 s34, s34, s20
s_add_u32 s34, s34, 20
s_mov_b32 s69, s34
s_mul_i32 s35, s34, 20736
s_add_u32 s36, s35, 0
buffer_load_dword v96, v10, s[8:11], s36 offen
buffer_load_dword v104, v11, s[8:11], s36 offen
s_add_u32 s36, s35, 1152
buffer_load_dword v97, v10, s[8:11], s36 offen
buffer_load_dword v105, v11, s[8:11], s36 offen
s_add_u32 s36, s35, 2304
buffer_load_dword v98, v10, s[8:11], s36 offen
buffer_load_dword v106, v11, s[8:11], s36 offen
s_add_u32 s36, s35, 3456
buffer_load_dword v99, v10, s[8:11], s36 offen
buffer_load_dword v107, v11, s[8:11], s36 offen
s_add_u32 s36, s35, 9216
buffer_load_dword v100, v10, s[8:11], s36 offen
buffer_load_dword v108, v11, s[8:11], s36 offen
s_add_u32 s36, s35, 10368
buffer_load_dword v101, v10, s[8:11], s36 offen
buffer_load_dword v109, v11, s[8:11], s36 offen
s_add_u32 s36, s35, 11520
buffer_load_dword v102, v10, s[8:11], s36 offen
buffer_load_dword v110, v11, s[8:11], s36 offen
s_add_u32 s36, s35, 12672
buffer_load_dword v103, v10, s[8:11], s36 offen
buffer_load_dword v111, v11, s[8:11], s36 offen
s_mul_i32 s34, s90, 32
s_add_u32 s34, s34, s20
s_add_u32 s34, s34, 24
s_mov_b32 s70, s34
s_mul_i32 s35, s34, 20736
s_add_u32 s36, s35, 0
buffer_load_dword v112, v10, s[8:11], s36 offen
buffer_load_dword v120, v11, s[8:11], s36 offen
s_add_u32 s36, s35, 1152
buffer_load_dword v113, v10, s[8:11], s36 offen
buffer_load_dword v121, v11, s[8:11], s36 offen
s_add_u32 s36, s35, 2304
buffer_load_dword v114, v10, s[8:11], s36 offen
buffer_load_dword v122, v11, s[8:11], s36 offen
s_add_u32 s36, s35, 3456
buffer_load_dword v115, v10, s[8:11], s36 offen
buffer_load_dword v123, v11, s[8:11], s36 offen
s_add_u32 s36, s35, 9216
buffer_load_dword v116, v10, s[8:11], s36 offen
buffer_load_dword v124, v11, s[8:11], s36 offen
s_add_u32 s36, s35, 10368
buffer_load_dword v117, v10, s[8:11], s36 offen
buffer_load_dword v125, v11, s[8:11], s36 offen
s_add_u32 s36, s35, 11520
buffer_load_dword v118, v10, s[8:11], s36 offen
buffer_load_dword v126, v11, s[8:11], s36 offen
s_add_u32 s36, s35, 12672
buffer_load_dword v119, v10, s[8:11], s36 offen
buffer_load_dword v127, v11, s[8:11], s36 offen
s_mul_i32 s34, s90, 32
s_add_u32 s34, s34, s20
s_add_u32 s34, s34, 28
s_mov_b32 s71, s34
s_mul_i32 s35, s34, 20736
s_add_u32 s36, s35, 0
buffer_load_dword v128, v10, s[8:11], s36 offen
buffer_load_dword v136, v11, s[8:11], s36 offen
s_add_u32 s36, s35, 1152
buffer_load_dword v129, v10, s[8:11], s36 offen
buffer_load_dword v137, v11, s[8:11], s36 offen
s_add_u32 s36, s35, 2304
buffer_load_dword v130, v10, s[8:11], s36 offen
buffer_load_dword v138, v11, s[8:11], s36 offen
s_add_u32 s36, s35, 3456
buffer_load_dword v131, v10, s[8:11], s36 offen
buffer_load_dword v139, v11, s[8:11], s36 offen
s_add_u32 s36, s35, 9216
buffer_load_dword v132, v10, s[8:11], s36 offen
buffer_load_dword v140, v11, s[8:11], s36 offen
s_add_u32 s36, s35, 10368
buffer_load_dword v133, v10, s[8:11], s36 offen
buffer_load_dword v141, v11, s[8:11], s36 offen
s_add_u32 s36, s35, 11520
buffer_load_dword v134, v10, s[8:11], s36 offen
buffer_load_dword v142, v11, s[8:11], s36 offen
s_add_u32 s36, s35, 12672
buffer_load_dword v135, v10, s[8:11], s36 offen
buffer_load_dword v143, v11, s[8:11], s36 offen
s_waitcnt vmcnt(63)
s_mul_i32 s3, s64, 4096
v_add_u32 v15, s3, v2
v_perm_b32 v144, v17, v16, s32
v_perm_b32 v145, v19, v18, s32
v_perm_b32 v146, v21, v20, s32
v_perm_b32 v147, v23, v22, s32
ds_write_b128 v15, v[144:147] offset:0
v_perm_b32 v148, v17, v16, s33
v_perm_b32 v149, v19, v18, s33
v_perm_b32 v150, v21, v20, s33
v_perm_b32 v151, v23, v22, s33
ds_write_b128 v15, v[148:151] offset:1024
v_perm_b32 v152, v25, v24, s32
v_perm_b32 v153, v27, v26, s32
v_perm_b32 v154, v29, v28, s32
v_perm_b32 v155, v31, v30, s32
ds_write_b128 v15, v[152:155] offset:2048
v_perm_b32 v156, v25, v24, s33
v_perm_b32 v157, v27, v26, s33
v_perm_b32 v158, v29, v28, s33
v_perm_b32 v159, v31, v30, s33
ds_write_b128 v15, v[156:159] offset:3072
s_waitcnt lgkmcnt(0)
s_waitcnt vmcnt(63)
s_mul_i32 s3, s65, 4096
v_add_u32 v15, s3, v2
v_perm_b32 v144, v33, v32, s32
v_perm_b32 v145, v35, v34, s32
v_perm_b32 v146, v37, v36, s32
v_perm_b32 v147, v39, v38, s32
ds_write_b128 v15, v[144:147] offset:0
v_perm_b32 v148, v33, v32, s33
v_perm_b32 v149, v35, v34, s33
v_perm_b32 v150, v37, v36, s33
v_perm_b32 v151, v39, v38, s33
ds_write_b128 v15, v[148:151] offset:1024
v_perm_b32 v152, v41, v40, s32
v_perm_b32 v153, v43, v42, s32
v_perm_b32 v154, v45, v44, s32
v_perm_b32 v155, v47, v46, s32
ds_write_b128 v15, v[152:155] offset:2048
v_perm_b32 v156, v41, v40, s33
v_perm_b32 v157, v43, v42, s33
v_perm_b32 v158, v45, v44, s33
v_perm_b32 v159, v47, v46, s33
ds_write_b128 v15, v[156:159] offset:3072
s_waitcnt lgkmcnt(0)
s_waitcnt vmcnt(63)
s_mul_i32 s3, s66, 4096
v_add_u32 v15, s3, v2
v_perm_b32 v144, v49, v48, s32
v_perm_b32 v145, v51, v50, s32
v_perm_b32 v146, v53, v52, s32
v_perm_b32 v147, v55, v54, s32
ds_write_b128 v15, v[144:147] offset:0
v_perm_b32 v148, v49, v48, s33
v_perm_b32 v149, v51, v50, s33
v_perm_b32 v150, v53, v52, s33
v_perm_b32 v151, v55, v54, s33
ds_write_b128 v15, v[148:151] offset:1024
v_perm_b32 v152, v57, v56, s32
v_perm_b32 v153, v59, v58, s32
v_perm_b32 v154, v61, v60, s32
v_perm_b32 v155, v63, v62, s32
ds_write_b128 v15, v[152:155] offset:2048
v_perm_b32 v156, v57, v56, s33
v_perm_b32 v157, v59, v58, s33
v_perm_b32 v158, v61, v60, s33
v_perm_b32 v159, v63, v62, s33
ds_write_b128 v15, v[156:159] offset:3072
s_waitcnt lgkmcnt(0)
s_waitcnt vmcnt(63)
s_mul_i32 s3, s67, 4096
v_add_u32 v15, s3, v2
v_perm_b32 v144, v65, v64, s32
v_perm_b32 v145, v67, v66, s32
v_perm_b32 v146, v69, v68, s32
v_perm_b32 v147, v71, v70, s32
ds_write_b128 v15, v[144:147] offset:0
v_perm_b32 v148, v65, v64, s33
v_perm_b32 v149, v67, v66, s33
v_perm_b32 v150, v69, v68, s33
v_perm_b32 v151, v71, v70, s33
ds_write_b128 v15, v[148:151] offset:1024
v_perm_b32 v152, v73, v72, s32
v_perm_b32 v153, v75, v74, s32
v_perm_b32 v154, v77, v76, s32
v_perm_b32 v155, v79, v78, s32
ds_write_b128 v15, v[152:155] offset:2048
v_perm_b32 v156, v73, v72, s33
v_perm_b32 v157, v75, v74, s33
v_perm_b32 v158, v77, v76, s33
v_perm_b32 v159, v79, v78, s33
ds_write_b128 v15, v[156:159] offset:3072
s_waitcnt lgkmcnt(0)
s_waitcnt vmcnt(48)
s_mul_i32 s3, s68, 4096
v_add_u32 v15, s3, v2
v_perm_b32 v144, v81, v80, s32
v_perm_b32 v145, v83, v82, s32
v_perm_b32 v146, v85, v84, s32
v_perm_b32 v147, v87, v86, s32
ds_write_b128 v15, v[144:147] offset:0
v_perm_b32 v148, v81, v80, s33
v_perm_b32 v149, v83, v82, s33
v_perm_b32 v150, v85, v84, s33
v_perm_b32 v151, v87, v86, s33
ds_write_b128 v15, v[148:151] offset:1024
v_perm_b32 v152, v89, v88, s32
v_perm_b32 v153, v91, v90, s32
v_perm_b32 v154, v93, v92, s32
v_perm_b32 v155, v95, v94, s32
ds_write_b128 v15, v[152:155] offset:2048
v_perm_b32 v156, v89, v88, s33
v_perm_b32 v157, v91, v90, s33
v_perm_b32 v158, v93, v92, s33
v_perm_b32 v159, v95, v94, s33
ds_write_b128 v15, v[156:159] offset:3072
s_waitcnt lgkmcnt(0)
s_waitcnt vmcnt(32)
s_mul_i32 s3, s69, 4096
v_add_u32 v15, s3, v2
v_perm_b32 v144, v97, v96, s32
v_perm_b32 v145, v99, v98, s32
v_perm_b32 v146, v101, v100, s32
v_perm_b32 v147, v103, v102, s32
ds_write_b128 v15, v[144:147] offset:0
v_perm_b32 v148, v97, v96, s33
v_perm_b32 v149, v99, v98, s33
v_perm_b32 v150, v101, v100, s33
v_perm_b32 v151, v103, v102, s33
ds_write_b128 v15, v[148:151] offset:1024
v_perm_b32 v152, v105, v104, s32
v_perm_b32 v153, v107, v106, s32
v_perm_b32 v154, v109, v108, s32
v_perm_b32 v155, v111, v110, s32
ds_write_b128 v15, v[152:155] offset:2048
v_perm_b32 v156, v105, v104, s33
v_perm_b32 v157, v107, v106, s33
v_perm_b32 v158, v109, v108, s33
v_perm_b32 v159, v111, v110, s33
ds_write_b128 v15, v[156:159] offset:3072
s_waitcnt lgkmcnt(0)
s_waitcnt vmcnt(16)
s_mul_i32 s3, s70, 4096
v_add_u32 v15, s3, v2
v_perm_b32 v144, v113, v112, s32
v_perm_b32 v145, v115, v114, s32
v_perm_b32 v146, v117, v116, s32
v_perm_b32 v147, v119, v118, s32
ds_write_b128 v15, v[144:147] offset:0
v_perm_b32 v148, v113, v112, s33
v_perm_b32 v149, v115, v114, s33
v_perm_b32 v150, v117, v116, s33
v_perm_b32 v151, v119, v118, s33
ds_write_b128 v15, v[148:151] offset:1024
v_perm_b32 v152, v121, v120, s32
v_perm_b32 v153, v123, v122, s32
v_perm_b32 v154, v125, v124, s32
v_perm_b32 v155, v127, v126, s32
ds_write_b128 v15, v[152:155] offset:2048
v_perm_b32 v156, v121, v120, s33
v_perm_b32 v157, v123, v122, s33
v_perm_b32 v158, v125, v124, s33
v_perm_b32 v159, v127, v126, s33
ds_write_b128 v15, v[156:159] offset:3072
s_waitcnt lgkmcnt(0)
s_waitcnt vmcnt(0)
s_mul_i32 s3, s71, 4096
v_add_u32 v15, s3, v2
v_perm_b32 v144, v129, v128, s32
v_perm_b32 v145, v131, v130, s32
v_perm_b32 v146, v133, v132, s32
v_perm_b32 v147, v135, v134, s32
ds_write_b128 v15, v[144:147] offset:0
v_perm_b32 v148, v129, v128, s33
v_perm_b32 v149, v131, v130, s33
v_perm_b32 v150, v133, v132, s33
v_perm_b32 v151, v135, v134, s33
ds_write_b128 v15, v[148:151] offset:1024
v_perm_b32 v152, v137, v136, s32
v_perm_b32 v153, v139, v138, s32
v_perm_b32 v154, v141, v140, s32
v_perm_b32 v155, v143, v142, s32
ds_write_b128 v15, v[152:155] offset:2048
v_perm_b32 v156, v137, v136, s33
v_perm_b32 v157, v139, v138, s33
v_perm_b32 v158, v141, v140, s33
v_perm_b32 v159, v143, v142, s33
ds_write_b128 v15, v[156:159] offset:3072
s_waitcnt lgkmcnt(0)
s_add_u32 s90, s90, 1
s_cmp_lt_u32 s90, 1
s_cbranch_scc1 L_w_68
s_mov_b32 s3, 82944
v_mul_lo_u32 v13, v9, s3
v_add_u32 v10, v12, v13
v_add_u32 v11, s61, v10
s_mov_b32 s90, 0
L_w_69:
s_add_u32 s34, s20, 32
s_mov_b32 s64, s34
s_mul_i32 s35, s20, 165888
s_add_u32 s36, s35, 18432
buffer_load_dword v16, v10, s[8:11], s36 offen
buffer_load_dword v24, v11, s[8:11], s36 offen
s_add_u32 s36, s35, 19584
buffer_load_dword v17, v10, s[8:11], s36 offen
buffer_load_dword v25, v11, s[8:11], s36 offen
s_add_u32 s36, s35, 39168
buffer_load_dword v18, v10, s[8:11], s36 offen
buffer_load_dword v26, v11, s[8:11], s36 offen
s_add_u32 s36, s35, 40320
buffer_load_dword v19, v10, s[8:11], s36 offen
buffer_load_dword v27, v11, s[8:11], s36 offen
s_add_u32 s36, s35, 59904
buffer_load_dword v20, v10, s[8:11], s36 offen
buffer_load_dword v28, v11, s[8:11], s36 offen
s_add_u32 s36, s35, 61056
buffer_load_dword v21, v10, s[8:11], s36 offen
buffer_load_dword v29, v11, s[8:11], s36 offen
s_add_u32 s36, s35, 80640
buffer_load_dword v22, v10, s[8:11], s36 offen
buffer_load_dword v30, v11, s[8:11], s36 offen
s_add_u32 s36, s35, 81792
buffer_load_dword v23, v10, s[8:11], s36 offen
buffer_load_dword v31, v11, s[8:11], s36 offen
s_waitcnt vmcnt(0)
s_mul_i32 s3, s64, 4096
v_add_u32 v15, s3, v2
v_perm_b32 v32, v17, v16, s32
v_perm_b32 v33, v19, v18, s32
v_perm_b32 v34, v21, v20, s32
v_perm_b32 v35, v23, v22, s32
ds_write_b128 v15, v[32:35] offset:0
v_perm_b32 v36, v17, v16, s33
v_perm_b32 v37, v19, v18, s33
v_perm_b32 v38, v21, v20, s33
v_perm_b32 v39, v23, v22, s33
ds_write_b128 v15, v[36:39] offset:1024
v_perm_b32 v40, v25, v24, s32
v_perm_b32 v41, v27, v26, s32
v_perm_b32 v42, v29, v28, s32
v_perm_b32 v43, v31, v30, s32
ds_write_b128 v15, v[40:43] offset:2048
v_perm_b32 v44, v25, v24, s33
v_perm_b32 v45, v27, v26, s33
v_perm_b32 v46, v29, v28, s33
v_perm_b32 v47, v31, v30, s33
ds_write_b128 v15, v[44:47] offset:3072
s_waitcnt lgkmcnt(0)
s_add_u32 s90, s90, 1
s_cmp_lt_u32 s90, 1
s_cbranch_scc1 L_w_69
s_cmp_eq_u32 s21, 4
s_cselect_b32 s61, 0x7fff0000, 0
v_add_u32 v12, s61, v2
s_lshr_b32 s22, s20, 1
s_and_b32 s23, s20, 1
s_mov_b32 s28, 0x6000
s_mul_i32 s3, s22, 0x1000
s_add_u32 s28, s28, s3
s_mul_i32 s3, s23, 0x40
s_add_u32 s28, s28, s3
s_mov_b32 s29, 0x8000
s_mul_i32 s3, s22, 0x1000
s_add_u32 s29, s29, s3
s_mul_i32 s3, s23, 0x40
s_add_u32 s29, s29, s3
s_mov_b32 s30, 0x1a00000
s_mul_i32 s3, s22, 0x240000
s_add_u32 s30, s30, s3
s_mul_i32 s3, s23, 0x9000
s_add_u32 s30, s30, s3
s_mov_b32 s31, 0x1500000
s_mul_i32 s3, s22, 0x240000
s_add_u32 s31, s31, s3
s_mul_i32 s3, s23, 0x9000
s_add_u32 s31, s31, s3
s_mul_i32 s3, s21, 0x2000
s_add_u32 s31, s31, s3
s_mov_b32 s39, 0x7fff0000
s_mov_b32 s85, 0
s_waitcnt vmcnt(0) lgkmcnt(0)
s_cmp_lg_u32 s20, 0
s_cbranch_scc1 L_walld_71
s_mov_b32 s91, 0
L_wall_70:
buffer_load_dword v15, off, s[16:19], 0 sc1
s_add_u32 s91, s91, 1
s_cmp_gt_u32 s91, 200000
s_cbranch_scc1 L_FAIL
s_waitcnt vmcnt(0)
v_cmp_gt_u32 vcc, 32, v15
s_nop 0
s_nop 2
s_cbranch_vccz L_walld_71
s_sleep 4
s_branch L_wall_70
L_walld_71:
s_barrier
L_aw_top:
s_cmp_lg_u32 s85, 0
s_cbranch_scc1 L_warm_72
buffer_load_dword v15, off, s[4:7], s28 sc1
s_mov_b32 s91, 0
s_waitcnt vmcnt(0)
s_mov_b64 exec, 1
v_mov_b32 v13, 1
buffer_atomic_add v13, off, s[4:7], s39 sc1
s_mov_b64 exec, -1
v_cmp_gt_u32 vcc, 32, v15
s_nop 0
s_nop 2
s_cbranch_vccz L_spd_74
L_sp_73:
buffer_load_dword v15, off, s[4:7], s28 sc1
s_add_u32 s91, s91, 1
s_cmp_gt_u32 s91, 200000
s_cbranch_scc1 L_FAIL
s_waitcnt vmcnt(0)
v_cmp_gt_u32 vcc, 32, v15
s_nop 0
s_nop 2
s_cbranch_vccnz L_sp_73
L_spd_74:
s_mov_b32 s39, 0x7fff0000
s_add_u32 s27, s30, 0x0
buffer_load_dwordx4 a[0:3], v2, s[4:7], s27 offen offset:0
buffer_load_dwordx4 a[4:7], v2, s[4:7], s27 offen offset:1024
buffer_load_dwordx4 a[8:11], v2, s[4:7], s27 offen offset:2048
buffer_load_dwordx4 a[12:15], v2, s[4:7], s27 offen offset:3072
s_add_u32 s27, s30, 0x1000
buffer_load_dwordx4 a[16:19], v2, s[4:7], s27 offen offset:0
buffer_load_dwordx4 a[20:23], v2, s[4:7], s27 offen offset:1024
buffer_load_dwordx4 a[24:27], v2, s[4:7], s27 offen offset:2048
buffer_load_dwordx4 a[28:31], v2, s[4:7], s27 offen offset:3072
s_waitcnt vmcnt(0)
L_warm_72:
ds_read_b128 v[128:131], v2 offset:0
ds_read_b128 v[132:135], v2 offset:1024
ds_read_b128 v[136:139], v2 offset:2048
ds_read_b128 v[140:143], v2 offset:3072
ds_read_b128 v[144:147], v2 offset:4096
ds_read_b128 v[148:151], v2 offset:5120
ds_read_b128 v[152:155], v2 offset:6144
ds_read_b128 v[156:159], v2 offset:7168
s_waitcnt lgkmcnt(4)
v_mfma_f32_32x32x16_bf16 v[64:79], v[128:131], a[0:3], 0
ds_read_b128 v[160:163], v2 offset:8192
s_add_u32 s27, s30, 8192
buffer_load_dwordx4 a[32:35], v2, s[4:7], s27 offen offset:0
v_mfma_f32_32x32x16_bf16 v[80:95], v[132:135], a[0:3], 0
ds_read_b128 v[164:167], v2 offset:9216
buffer_load_dwordx4 a[36:39], v2, s[4:7], s27 offen offset:1024
v_mfma_f32_32x32x16_bf16 v[96:111], v[136:139], a[0:3], 0
ds_read_b128 v[168:171], v2 offset:10240
v_mfma_f32_32x32x16_bf16 v[112:127], v[140:143], a[0:3], 0
ds_read_b128 v[172:175], v2 offset:11264
s_waitcnt lgkmcnt(4)
v_mfma_f32_32x32x16_bf16 v[64:79], v[144:147], a[4:7], v[64:79]
ds_read_b128 v[128:131], v2 offset:12288
buffer_load_dwordx4 a[40:43], v2, s[4:7], s27 offen offset:2048
v_mfma_f32_32x32x16_bf16 v[80:95], v[148:151], a[4:7], v[80:95]
ds_read_b128 v[132:135], v2 offset:13312
buffer_load_dwordx4 a[44:47], v2, s[4:7], s27 offen offset:3072
v_mfma_f32_32x32x16_bf16 v[96:111], v[152:155], a[4:7], v[96:111]
ds_read_b128 v[136:139], v2 offset:14336
v_mfma_f32_32x32x16_bf16 v[112:127], v[156:159], a[4:7], v[112:127]
ds_read_b128 v[140:143], v2 offset:15360
s_waitcnt lgkmcnt(4)
v_mfma_f32_32x32x16_bf16 v[64:79], v[160:163], a[8:11], v[64:79]
ds_read_b128 v[144:147], v2 offset:16384
s_add_u32 s27, s30, 12288
buffer_load_dwordx4 a[48:51], v2, s[4:7], s27 offen offset:0
v_mfma_f32_32x32x16_bf16 v[80:95], v[164:167], a[8:11], v[80:95]
ds_read_b128 v[148:151], v2 offset:17408
buffer_load_dwordx4 a[52:55], v2, s[4:7], s27 offen offset:1024
v_mfma_f32_32x32x16_bf16 v[96:111], v[168:171], a[8:11], v[96:111]
ds_read_b128 v[152:155], v2 offset:18432
v_mfma_f32_32x32x16_bf16 v[112:127], v[172:175], a[8:11], v[112:127]
ds_read_b128 v[156:159], v2 offset:19456
s_waitcnt lgkmcnt(4)
v_mfma_f32_32x32x16_bf16 v[64:79], v[128:131], a[12:15], v[64:79]
ds_read_b128 v[160:163], v2 offset:20480
buffer_load_dwordx4 a[56:59], v2, s[4:7], s27 offen offset:2048
v_mfma_f32_32x32x16_bf16 v[80:95], v[132:135], a[12:15], v[80:95]
ds_read_b128 v[164:167], v2 offset:21504
buffer_load_dwordx4 a[60:63], v2, s[4:7], s27 offen offset:3072
v_mfma_f32_32x32x16_bf16 v[96:111], v[136:139], a[12:15], v[96:111]
ds_read_b128 v[168:171], v2 offset:22528
v_mfma_f32_32x32x16_bf16 v[112:127], v[140:143], a[12:15], v[112:127]
ds_read_b128 v[172:175], v2 offset:23552
s_waitcnt lgkmcnt(4)
v_mfma_f32_32x32x16_bf16 v[64:79], v[144:147], a[16:19], v[64:79]
ds_read_b128 v[128:131], v2 offset:24576
s_add_u32 s27, s30, 16384
buffer_load_dwordx4 a[64:67], v2, s[4:7], s27 offen offset:0
v_mfma_f32_32x32x16_bf16 v[80:95], v[148:151], a[16:19], v[80:95]
ds_read_b128 v[132:135], v2 offset:25600
buffer_load_dwordx4 a[68:71], v2, s[4:7], s27 offen offset:1024
v_mfma_f32_32x32x16_bf16 v[96:111], v[152:155], a[16:19], v[96:111]
ds_read_b128 v[136:139], v2 offset:26624
v_mfma_f32_32x32x16_bf16 v[112:127], v[156:159], a[16:19], v[112:127]
ds_read_b128 v[140:143], v2 offset:27648
s_waitcnt lgkmcnt(4)
v_mfma_f32_32x32x16_bf16 v[64:79], v[160:163], a[20:23], v[64:79]
ds_read_b128 v[144:147], v2 offset:28672
buffer_load_dwordx4 a[72:75], v2, s[4:7], s27 offen offset:2048
v_mfma_f32_32x32x16_bf16 v[80:95], v[164:167], a[20:23], v[80:95]
ds_read_b128 v[148:151], v2 offset:29696
buffer_load_dwordx4 a[76:79], v2, s[4:7], s27 offen offset:3072
v_mfma_f32_32x32x16_bf16 v[96:111], v[168:171], a[20:23], v[96:111]
ds_read_b128 v[152:155], v2 offset:30720
v_mfma_f32_32x32x16_bf16 v[112:127], v[172:175], a[20:23], v[112:127]
ds_read_b128 v[156:159], v2 offset:31744
s_waitcnt lgkmcnt(4)
v_mfma_f32_32x32x16_bf16 v[64:79], v[128:131], a[24:27], v[64:79]
ds_read_b128 v[160:163], v2 offset:32768
s_add_u32 s27, s30, 20480
buffer_load_dwordx4 a[80:83], v2, s[4:7], s27 offen offset:0
v_mfma_f32_32x32x16_bf16 v[80:95], v[132:135], a[24:27], v[80:95]
ds_read_b128 v[164:167], v2 offset:33792
buffer_load_dwordx4 a[84:87], v2, s[4:7], s27 offen offset:1024
v_mfma_f32_32x32x16_bf16 v[96:111], v[136:139], a[24:27], v[96:111]
ds_read_b128 v[168:171], v2 offset:34816
v_mfma_f32_32x32x16_bf16 v[112:127], v[140:143], a[24:27], v[112:127]
ds_read_b128 v[172:175], v2 offset:35840
s_waitcnt lgkmcnt(4)
v_mfma_f32_32x32x16_bf16 v[64:79], v[144:147], a[28:31], v[64:79]
ds_read_b128 v[128:131], v2 offset:36864
buffer_load_dwordx4 a[88:91], v2, s[4:7], s27 offen offset:2048
v_mfma_f32_32x32x16_bf16 v[80:95], v[148:151], a[28:31], v[80:95]
ds_read_b128 v[132:135], v2 offset:37888
buffer_load_dwordx4 a[92:95], v2, s[4:7], s27 offen offset:3072
v_mfma_f32_32x32x16_bf16 v[96:111], v[152:155], a[28:31], v[96:111]
ds_read_b128 v[136:139], v2 offset:38912
v_mfma_f32_32x32x16_bf16 v[112:127], v[156:159], a[28:31], v[112:127]
ds_read_b128 v[140:143], v2 offset:39936
s_waitcnt vmcnt(15) lgkmcnt(4)
v_mfma_f32_32x32x16_bf16 v[64:79], v[160:163], a[32:35], v[64:79]
ds_read_b128 v[144:147], v2 offset:40960
s_add_u32 s27, s30, 24576
buffer_load_dwordx4 a[96:99], v2, s[4:7], s27 offen offset:0
s_mov_b64 exec, 1
v_mov_b32 v13, 1
buffer_atomic_add v13, off, s[4:7], s39 sc1
s_mov_b64 exec, -1
v_mfma_f32_32x32x16_bf16 v[80:95], v[164:167], a[32:35], v[80:95]
ds_read_b128 v[148:151], v2 offset:41984
buffer_load_dwordx4 a[100:103], v2, s[4:7], s27 offen offset:1024
v_mfma_f32_32x32x16_bf16 v[96:111], v[168:171], a[32:35], v[96:111]
ds_read_b128 v[152:155], v2 offset:43008
v_mfma_f32_32x32x16_bf16 v[112:127], v[172:175], a[32:35], v[112:127]
ds_read_b128 v[156:159], v2 offset:44032
s_waitcnt vmcnt(17) lgkmcnt(4)
v_mfma_f32_32x32x16_bf16 v[64:79], v[128:131], a[36:39], v[64:79]
ds_read_b128 v[160:163], v2 offset:45056
buffer_load_dwordx4 a[104:107], v2, s[4:7], s27 offen offset:2048
v_mfma_f32_32x32x16_bf16 v[80:95], v[132:135], a[36:39], v[80:95]
ds_read_b128 v[164:167], v2 offset:46080
buffer_load_dwordx4 a[108:111], v2, s[4:7], s27 offen offset:3072
v_mfma_f32_32x32x16_bf16 v[96:111], v[136:139], a[36:39], v[96:111]
ds_read_b128 v[168:171], v2 offset:47104
v_mfma_f32_32x32x16_bf16 v[112:127], v[140:143], a[36:39], v[112:127]
ds_read_b128 v[172:175], v2 offset:48128
s_waitcnt vmcnt(18) lgkmcnt(4)
v_mfma_f32_32x32x16_bf16 v[64:79], v[144:147], a[40:43], v[64:79]
ds_read_b128 v[128:131], v2 offset:49152
s_add_u32 s27, s30, 28672
buffer_load_dwordx4 a[112:115], v2, s[4:7], s27 offen offset:0
v_mfma_f32_32x32x16_bf16 v[80:95], v[148:151], a[40:43], v[80:95]
ds_read_b128 v[132:135], v2 offset:50176
buffer_load_dwordx4 a[116:119], v2, s[4:7], s27 offen offset:1024
v_mfma_f32_32x32x16_bf16 v[96:111], v[152:155], a[40:43], v[96:111]
ds_read_b128 v[136:139], v2 offset:51200
v_mfma_f32_32x32x16_bf16 v[112:127], v[156:159], a[40:43], v[112:127]
ds_read_b128 v[140:143], v2 offset:52224
s_waitcnt vmcnt(19) lgkmcnt(4)
v_mfma_f32_32x32x16_bf16 v[64:79], v[160:163], a[44:47], v[64:79]
ds_read_b128 v[144:147], v2 offset:53248
buffer_load_dwordx4 a[120:123], v2, s[4:7], s27 offen offset:2048
v_mfma_f32_32x32x16_bf16 v[80:95], v[164:167], a[44:47], v[80:95]
ds_read_b128 v[148:151], v2 offset:54272
buffer_load_dwordx4 a[124:127], v2, s[4:7], s27 offen offset:3072
v_mfma_f32_32x32x16_bf16 v[96:111], v[168:171], a[44:47], v[96:111]
ds_read_b128 v[152:155], v2 offset:55296
v_mfma_f32_32x32x16_bf16 v[112:127], v[172:175], a[44:47], v[112:127]
ds_read_b128 v[156:159], v2 offset:56320
s_waitcnt vmcnt(20) lgkmcnt(4)
v_mfma_f32_32x32x16_bf16 v[64:79], v[128:131], a[48:51], v[64:79]
ds_read_b128 v[160:163], v2 offset:57344
s_add_u32 s27, s30, 32768
buffer_load_dwordx4 a[128:131], v2, s[4:7], s27 offen offset:0
v_mfma_f32_32x32x16_bf16 v[80:95], v[132:135], a[48:51], v[80:95]
ds_read_b128 v[164:167], v2 offset:58368
buffer_load_dwordx4 a[132:135], v2, s[4:7], s27 offen offset:1024
v_mfma_f32_32x32x16_bf16 v[96:111], v[136:139], a[48:51], v[96:111]
ds_read_b128 v[168:171], v2 offset:59392
v_mfma_f32_32x32x16_bf16 v[112:127], v[140:143], a[48:51], v[112:127]
ds_read_b128 v[172:175], v2 offset:60416
s_waitcnt vmcnt(21) lgkmcnt(4)
v_mfma_f32_32x32x16_bf16 v[64:79], v[144:147], a[52:55], v[64:79]
ds_read_b128 v[128:131], v3 offset:0
buffer_load_dwordx4 a[136:139], v2, s[4:7], s27 offen offset:2048
v_mfma_f32_32x32x16_bf16 v[80:95], v[148:151], a[52:55], v[80:95]
ds_read_b128 v[132:135], v3 offset:1024
buffer_load_dwordx4 a[140:143], v2, s[4:7], s27 offen offset:3072
v_mfma_f32_32x32x16_bf16 v[96:111], v[152:155], a[52:55], v[96:111]
ds_read_b128 v[136:139], v3 offset:2048
v_mfma_f32_32x32x16_bf16 v[112:127], v[156:159], a[52:55], v[112:127]
ds_read_b128 v[140:143], v3 offset:3072
s_waitcnt vmcnt(22) lgkmcnt(4)
v_mfma_f32_32x32x16_bf16 v[64:79], v[160:163], a[56:59], v[64:79]
ds_read_b128 v[144:147], v3 offset:4096
v_mfma_f32_32x32x16_bf16 v[80:95], v[164:167], a[56:59], v[80:95]
ds_read_b128 v[148:151], v3 offset:5120
v_mfma_f32_32x32x16_bf16 v[96:111], v[168:171], a[56:59], v[96:111]
ds_read_b128 v[152:155], v3 offset:6144
v_mfma_f32_32x32x16_bf16 v[112:127], v[172:175], a[56:59], v[112:127]
ds_read_b128 v[156:159], v3 offset:7168
s_waitcnt vmcnt(21) lgkmcnt(4)
v_mfma_f32_32x32x16_bf16 v[64:79], v[128:131], a[60:63], v[64:79]
ds_read_b128 v[160:163], v3 offset:8192
v_mfma_f32_32x32x16_bf16 v[80:95], v[132:135], a[60:63], v[80:95]
ds_read_b128 v[164:167], v3 offset:9216
v_mfma_f32_32x32x16_bf16 v[96:111], v[136:139], a[60:63], v[96:111]
ds_read_b128 v[168:171], v3 offset:10240
v_mfma_f32_32x32x16_bf16 v[112:127], v[140:143], a[60:63], v[112:127]
ds_read_b128 v[172:175], v3 offset:11264
s_waitcnt vmcnt(20) lgkmcnt(4)
v_mfma_f32_32x32x16_bf16 v[64:79], v[144:147], a[64:67], v[64:79]
ds_read_b128 v[128:131], v3 offset:12288
v_mfma_f32_32x32x16_bf16 v[80:95], v[148:151], a[64:67], v[80:95]
ds_read_b128 v[132:135], v3 offset:13312
v_mfma_f32_32x32x16_bf16 v[96:111], v[152:155], a[64:67], v[96:111]
ds_read_b128 v[136:139], v3 offset:14336
v_mfma_f32_32x32x16_bf16 v[112:127], v[156:159], a[64:67], v[112:127]
ds_read_b128 v[140:143], v3 offset:15360
s_add_u32 s3, s28, 0x80
buffer_load_dword v14, off, s[4:7], s3 sc1
s_waitcnt vmcnt(20) lgkmcnt(4)
v_mfma_f32_32x32x16_bf16 v[64:79], v[160:163], a[68:71], v[64:79]
ds_read_b128 v[144:147], v3 offset:16384
v_mfma_f32_32x32x16_bf16 v[80:95], v[164:167], a[68:71], v[80:95]
ds_read_b128 v[148:151], v3 offset:17408
v_mfma_f32_32x32x16_bf16 v[96:111], v[168:171], a[68:71], v[96:111]
ds_read_b128 v[152:155], v3 offset:18432
v_mfma_f32_32x32x16_bf16 v[112:127], v[172:175], a[68:71], v[112:127]
ds_read_b128 v[156:159], v3 offset:19456
s_waitcnt vmcnt(19) lgkmcnt(4)
v_mfma_f32_32x32x16_bf16 v[64:79], v[128:131], a[72:75], v[64:79]
ds_read_b128 v[160:163], v3 offset:20480
v_mfma_f32_32x32x16_bf16 v[80:95], v[132:135], a[72:75], v[80:95]
ds_read_b128 v[164:167], v3 offset:21504
v_mfma_f32_32x32x16_bf16 v[96:111], v[136:139], a[72:75], v[96:111]
ds_read_b128 v[168:171], v3 offset:22528
v_mfma_f32_32x32x16_bf16 v[112:127], v[140:143], a[72:75], v[112:127]
ds_read_b128 v[172:175], v3 offset:23552
s_waitcnt vmcnt(18) lgkmcnt(4)
v_mfma_f32_32x32x16_bf16 v[64:79], v[144:147], a[76:79], v[64:79]
ds_read_b128 v[128:131], v3 offset:24576
v_mfma_f32_32x32x16_bf16 v[80:95], v[148:151], a[76:79], v[80:95]
ds_read_b128 v[132:135], v3 offset:25600
v_mfma_f32_32x32x16_bf16 v[96:111], v[152:155], a[76:79], v[96:111]
ds_read_b128 v[136:139], v3 offset:26624
v_mfma_f32_32x32x16_bf16 v[112:127], v[156:159], a[76:79], v[112:127]
ds_read_b128 v[140:143], v3 offset:27648
s_waitcnt vmcnt(17) lgkmcnt(4)
v_mfma_f32_32x32x16_bf16 v[64:79], v[160:163], a[80:83], v[64:79]
ds_read_b128 v[144:147], v3 offset:28672
v_mfma_f32_32x32x16_bf16 v[80:95], v[164:167], a[80:83], v[80:95]
ds_read_b128 v[148:151], v3 offset:29696
v_mfma_f32_32x32x16_bf16 v[96:111], v[168:171], a[80:83], v[96:111]
ds_read_b128 v[152:155], v3 offset:30720
v_mfma_f32_32x32x16_bf16 v[112:127], v[172:175], a[80:83], v[112:127]
ds_read_b128 v[156:159], v3 offset:31744
s_waitcnt vmcnt(16) lgkmcnt(4)
v_mfma_f32_32x32x16_bf16 v[64:79], v[128:131], a[84:87], v[64:79]
ds_read_b128 v[160:163], v3 offset:32768
v_mfma_f32_32x32x16_bf16 v[80:95], v[132:135], a[84:87], v[80:95]
ds_read_b128 v[164:167], v3 offset:33792
v_mfma_f32_32x32x16_bf16 v[96:111], v[136:139], a[84:87], v[96:111]
ds_read_b128 v[168:171], v3 offset:34816
v_mfma_f32_32x32x16_bf16 v[112:127], v[140:143], a[84:87], v[112:127]
ds_read_b128 v[172:175], v3 offset:35840
s_waitcnt vmcnt(15) lgkmcnt(4)
v_mfma_f32_32x32x16_bf16 v[64:79], v[144:147], a[88:91], v[64:79]
ds_read_b128 v[128:131], v3 offset:36864
v_mfma_f32_32x32x16_bf16 v[80:95], v[148:151], a[88:91], v[80:95]
ds_read_b128 v[132:135], v3 offset:37888
v_mfma_f32_32x32x16_bf16 v[96:111], v[152:155], a[88:91], v[96:111]
ds_read_b128 v[136:139], v3 offset:38912
v_mfma_f32_32x32x16_bf16 v[112:127], v[156:159], a[88:91], v[112:127]
ds_read_b128 v[140:143], v3 offset:39936
s_waitcnt vmcnt(14) lgkmcnt(4)
v_mfma_f32_32x32x16_bf16 v[64:79], v[160:163], a[92:95], v[64:79]
ds_read_b128 v[144:147], v3 offset:40960
v_mfma_f32_32x32x16_bf16 v[80:95], v[164:167], a[92:95], v[80:95]
ds_read_b128 v[148:151], v3 offset:41984
v_mfma_f32_32x32x16_bf16 v[96:111], v[168:171], a[92:95], v[96:111]
ds_read_b128 v[152:155], v3 offset:43008
v_mfma_f32_32x32x16_bf16 v[112:127], v[172:175], a[92:95], v[112:127]
ds_read_b128 v[156:159], v3 offset:44032
s_waitcnt vmcnt(13) lgkmcnt(4)
v_mfma_f32_32x32x16_bf16 v[64:79], v[128:131], a[96:99], v[64:79]
ds_read_b128 v[160:163], v3 offset:45056
v_mfma_f32_32x32x16_bf16 v[80:95], v[132:135], a[96:99], v[80:95]
ds_read_b128 v[164:167], v3 offset:46080
v_mfma_f32_32x32x16_bf16 v[96:111], v[136:139], a[96:99], v[96:111]
ds_read_b128 v[168:171], v3 offset:47104
v_mfma_f32_32x32x16_bf16 v[112:127], v[140:143], a[96:99], v[112:127]
ds_read_b128 v[172:175], v3 offset:48128
s_waitcnt vmcnt(11) lgkmcnt(4)
v_mfma_f32_32x32x16_bf16 v[64:79], v[144:147], a[100:103], v[64:79]
ds_read_b128 v[128:131], v3 offset:49152
v_mfma_f32_32x32x16_bf16 v[80:95], v[148:151], a[100:103], v[80:95]
ds_read_b128 v[132:135], v3 offset:50176
v_mfma_f32_32x32x16_bf16 v[96:111], v[152:155], a[100:103], v[96:111]
ds_read_b128 v[136:139], v3 offset:51200
v_mfma_f32_32x32x16_bf16 v[112:127], v[156:159], a[100:103], v[112:127]
ds_read_b128 v[140:143], v3 offset:52224
s_waitcnt vmcnt(0)
v_cmp_le_u32 vcc, 32, v14
s_nop 3
s_and_b32 s85, vcc_lo, 1
s_cmp_lt_u32 s23, 62
s_cselect_b32 s85, s85, 0
s_add_u32 s86, s30, 0x12000
s_cmp_lg_u32 s85, 0
s_cselect_b32 s86, s86, 0x7fff0000
s_add_u32 s87, s86, 4096
s_waitcnt vmcnt(10) lgkmcnt(4)
v_mfma_f32_32x32x16_bf16 v[64:79], v[160:163], a[104:107], v[64:79]
ds_read_b128 v[144:147], v3 offset:53248
buffer_load_dwordx4 a[0:3], v2, s[4:7], s86 offen offset:0
v_mfma_f32_32x32x16_bf16 v[80:95], v[164:167], a[104:107], v[80:95]
ds_read_b128 v[148:151], v3 offset:54272
buffer_load_dwordx4 a[4:7], v2, s[4:7], s86 offen offset:1024
v_mfma_f32_32x32x16_bf16 v[96:111], v[168:171], a[104:107], v[96:111]
ds_read_b128 v[152:155], v3 offset:55296
buffer_load_dwordx4 a[8:11], v2, s[4:7], s86 offen offset:2048
v_mfma_f32_32x32x16_bf16 v[112:127], v[172:175], a[104:107], v[112:127]
ds_read_b128 v[156:159], v3 offset:56320
buffer_load_dwordx4 a[12:15], v2, s[4:7], s86 offen offset:3072
s_waitcnt vmcnt(13) lgkmcnt(4)
v_mfma_f32_32x32x16_bf16 v[64:79], v[128:131], a[108:111], v[64:79]
ds_read_b128 v[160:163], v3 offset:57344
buffer_load_dwordx4 a[16:19], v2, s[4:7], s87 offen offset:0
v_mfma_f32_32x32x16_bf16 v[80:95], v[132:135], a[108:111], v[80:95]
ds_read_b128 v[164:167], v3 offset:58368
buffer_load_dwordx4 a[20:23], v2, s[4:7], s87 offen offset:1024
v_mfma_f32_32x32x16_bf16 v[96:111], v[136:139], a[108:111], v[96:111]
ds_read_b128 v[168:171], v3 offset:59392
buffer_load_dwordx4 a[24:27], v2, s[4:7], s87 offen offset:2048
v_mfma_f32_32x32x16_bf16 v[112:127], v[140:143], a[108:111], v[112:127]
ds_read_b128 v[172:175], v3 offset:60416
buffer_load_dwordx4 a[28:31], v2, s[4:7], s87 offen offset:3072
s_waitcnt vmcnt(16) lgkmcnt(4)
v_mfma_f32_32x32x16_bf16 v[64:79], v[144:147], a[112:115], v[64:79]
ds_read_b128 v[128:131], v4 offset:0
v_mfma_f32_32x32x16_bf16 v[80:95], v[148:151], a[112:115], v[80:95]
ds_read_b128 v[132:135], v4 offset:1024
v_mfma_f32_32x32x16_bf16 v[96:111], v[152:155], a[112:115], v[96:111]
ds_read_b128 v[136:139], v4 offset:2048
v_mfma_f32_32x32x16_bf16 v[112:127], v[156:159], a[112:115], v[112:127]
ds_read_b128 v[140:143], v4 offset:3072
s_waitcnt vmcnt(15) lgkmcnt(4)
v_mfma_f32_32x32x16_bf16 v[64:79], v[160:163], a[116:119], v[64:79]
ds_read_b128 v[144:147], v4 offset:4096
v_mfma_f32_32x32x16_bf16 v[80:95], v[164:167], a[116:119], v[80:95]
ds_read_b128 v[148:151], v4 offset:5120
v_mfma_f32_32x32x16_bf16 v[96:111], v[168:171], a[116:119], v[96:111]
ds_read_b128 v[152:155], v4 offset:6144
v_mfma_f32_32x32x16_bf16 v[112:127], v[172:175], a[116:119], v[112:127]
ds_read_b128 v[156:159], v4 offset:7168
s_waitcnt vmcnt(14) lgkmcnt(4)
v_mfma_f32_32x32x16_bf16 v[64:79], v[128:131], a[120:123], v[64:79]
ds_read_b128 v[160:163], v4 offset:8192
v_mfma_f32_32x32x16_bf16 v[80:95], v[132:135], a[120:123], v[80:95]
ds_read_b128 v[164:167], v4 offset:9216
v_mfma_f32_32x32x16_bf16 v[96:111], v[136:139], a[120:123], v[96:111]
ds_read_b128 v[168:171], v4 offset:10240
v_mfma_f32_32x32x16_bf16 v[112:127], v[140:143], a[120:123], v[112:127]
ds_read_b128 v[172:175], v4 offset:11264
s_waitcnt vmcnt(13) lgkmcnt(4)
v_mfma_f32_32x32x16_bf16 v[64:79], v[144:147], a[124:127], v[64:79]
ds_read_b128 v[128:131], v4 offset:12288
v_mfma_f32_32x32x16_bf16 v[80:95], v[148:151], a[124:127], v[80:95]
ds_read_b128 v[132:135], v4 offset:13312
v_mfma_f32_32x32x16_bf16 v[96:111], v[152:155], a[124:127], v[96:111]
ds_read_b128 v[136:139], v4 offset:14336
v_mfma_f32_32x32x16_bf16 v[112:127], v[156:159], a[124:127], v[112:127]
ds_read_b128 v[140:143], v4 offset:15360
s_waitcnt vmcnt(12) lgkmcnt(4)
v_mfma_f32_32x32x16_bf16 v[64:79], v[160:163], a[128:131], v[64:79]
ds_read_b128 v[144:147], v4 offset:16384
v_mfma_f32_32x32x16_bf16 v[80:95], v[164:167], a[128:131], v[80:95]
ds_read_b128 v[148:151], v4 offset:17408
v_mfma_f32_32x32x16_bf16 v[96:111], v[168:171], a[128:131], v[96:111]
ds_read_b128 v[152:155], v4 offset:18432
v_mfma_f32_32x32x16_bf16 v[112:127], v[172:175], a[128:131], v[112:127]
ds_read_b128 v[156:159], v4 offset:19456
s_waitcnt vmcnt(11) lgkmcnt(4)
v_mfma_f32_32x32x16_bf16 v[64:79], v[128:131], a[132:135], v[64:79]
ds_read_b128 v[160:163], v4 offset:20480
v_mfma_f32_32x32x16_bf16 v[80:95], v[132:135], a[132:135], v[80:95]
ds_read_b128 v[164:167], v4 offset:21504
v_mfma_f32_32x32x16_bf16 v[96:111], v[136:139], a[132:135], v[96:111]
ds_read_b128 v[168:171], v4 offset:22528
v_mfma_f32_32x32x16_bf16 v[112:127], v[140:143], a[132:135], v[112:127]
ds_read_b128 v[172:175], v4 offset:23552
s_waitcnt vmcnt(10) lgkmcnt(4)
v_mfma_f32_32x32x16_bf16 v[64:79], v[144:147], a[136:139], v[64:79]
v_mfma_f32_32x32x16_bf16 v[80:95], v[148:151], a[136:139], v[80:95]
v_mfma_f32_32x32x16_bf16 v[96:111], v[152:155], a[136:139], v[96:111]
v_mfma_f32_32x32x16_bf16 v[112:127], v[156:159], a[136:139], v[112:127]
s_waitcnt vmcnt(9) lgkmcnt(0)
v_mfma_f32_32x32x16_bf16 v[64:79], v[160:163], a[140:143], v[64:79]
v_mfma_f32_32x32x16_bf16 v[80:95], v[164:167], a[140:143], v[80:95]
v_mfma_f32_32x32x16_bf16 v[96:111], v[168:171], a[140:143], v[96:111]
v_mfma_f32_32x32x16_bf16 v[112:127], v[172:175], a[140:143], v[112:127]
v_cvt_pk_bf16_f32 v16, v64, v80
v_cvt_pk_bf16_f32 v17, v65, v81
v_cvt_pk_bf16_f32 v18, v66, v82
v_cvt_pk_bf16_f32 v19, v67, v83
buffer_store_dwordx4 v[16:19], v2, s[4:7], s31 offen offset:0 sc1
v_cvt_pk_bf16_f32 v20, v68, v84
v_cvt_pk_bf16_f32 v21, v69, v85
v_cvt_pk_bf16_f32 v22, v70, v86
v_cvt_pk_bf16_f32 v23, v71, v87
buffer_store_dwordx4 v[20:23], v2, s[4:7], s31 offen offset:1024 sc1
v_cvt_pk_bf16_f32 v24, v72, v88
v_cvt_pk_bf16_f32 v25, v73, v89
v_cvt_pk_bf16_f32 v26, v74, v90
v_cvt_pk_bf16_f32 v27, v75, v91
buffer_store_dwordx4 v[24:27], v2, s[4:7], s31 offen offset:2048 sc1
v_cvt_pk_bf16_f32 v28, v76, v92
v_cvt_pk_bf16_f32 v29, v77, v93
v_cvt_pk_bf16_f32 v30, v78, v94
v_cvt_pk_bf16_f32 v31, v79, v95
buffer_store_dwordx4 v[28:31], v2, s[4:7], s31 offen offset:3072 sc1
v_cvt_pk_bf16_f32 v16, v96, v112
v_cvt_pk_bf16_f32 v17, v97, v113
v_cvt_pk_bf16_f32 v18, v98, v114
v_cvt_pk_bf16_f32 v19, v99, v115
s_add_u32 s37, s31, 4096
buffer_store_dwordx4 v[16:19], v12, s[4:7], s37 offen offset:0 sc1
v_cvt_pk_bf16_f32 v20, v100, v116
v_cvt_pk_bf16_f32 v21, v101, v117
v_cvt_pk_bf16_f32 v22, v102, v118
v_cvt_pk_bf16_f32 v23, v103, v119
buffer_store_dwordx4 v[20:23], v12, s[4:7], s37 offen offset:1024 sc1
v_cvt_pk_bf16_f32 v24, v104, v120
v_cvt_pk_bf16_f32 v25, v105, v121
v_cvt_pk_bf16_f32 v26, v106, v122
v_cvt_pk_bf16_f32 v27, v107, v123
buffer_store_dwordx4 v[24:27], v12, s[4:7], s37 offen offset:2048 sc1
v_cvt_pk_bf16_f32 v28, v108, v124
v_cvt_pk_bf16_f32 v29, v109, v125
v_cvt_pk_bf16_f32 v30, v110, v126
v_cvt_pk_bf16_f32 v31, v111, v127
buffer_store_dwordx4 v[28:31], v12, s[4:7], s37 offen offset:3072 sc1
s_waitcnt vmcnt(8)
s_mov_b32 s39, s29
s_add_u32 s28, s28, 0x80
s_add_u32 s29, s29, 0x80
s_add_u32 s30, s30, 0x12000
s_add_u32 s31, s31, 0x12000
s_add_u32 s23, s23, 2
s_cmp_lt_u32 s23, 64
s_cbranch_scc1 L_aw_top
s_waitcnt vmcnt(0)
s_mov_b64 exec, 1
v_mov_b32 v13, 1
buffer_atomic_add v13, off, s[4:7], s39 sc1
s_mov_b64 exec, -1
s_waitcnt vmcnt(0)
s_branch L_END
s_endpgm
L_R_aq:
v_and_b32 v1, 63, v0
v_lshlrev_b32 v2, 4, v1
v_add_u32 v3, 61440, v2
v_add_u32 v4, 122880, v2
s_mov_b32 s32, 0x05040100
s_mov_b32 s33, 0x07060302
s_load_dwordx2 s[90:91], s[0:1], 8
s_waitcnt lgkmcnt(0)
s_mov_b32 s8, s90
s_and_b32 s9, s91, 0xffff
s_mov_b32 s10, 0x1e6000
s_mov_b32 s11, 0x20000
v_and_b32 v8, 31, v1
v_lshrrev_b32 v9, 5, v1
s_mov_b32 s38, 0x3eae1a93
s_mov_b32 s3, 27648
v_mul_lo_u32 v11, v9, s3
s_cmp_ge_u32 s21, 12
s_cbranch_scc1 L_aq_x
s_lshr_b32 s91, s21, 2
s_and_b32 s92, s21, 3
v_lshrrev_b32 v10, 2, v8
v_mul_u32_u24 v10, 36, v10
v_and_b32 v12, 3, v8
v_lshl_add_u32 v10, v12, 3, v10
v_add_u32 v10, v10, v11
s_mul_i32 s3, s91, 1152
s_mul_i32 s93, s92, 288
s_add_u32 s3, s3, s93
v_add_u32 v10, s3, v10
s_mov_b32 s60, s91
s_mov_b32 s61, s92
s_mov_b32 s90, 0
L_w_75:
s_mul_i32 s34, s90, 36
s_add_u32 s34, s34, s20
s_mov_b32 s64, s34
s_mul_i32 s35, s34, 55296
s_add_u32 s36, s35, 0
buffer_load_dwordx2 v[16:17], v10, s[8:11], s36 offen
s_add_u32 s36, s35, 3456
buffer_load_dwordx2 v[18:19], v10, s[8:11], s36 offen
s_add_u32 s36, s35, 6912
buffer_load_dwordx2 v[20:21], v10, s[8:11], s36 offen
s_add_u32 s36, s35, 10368
buffer_load_dwordx2 v[22:23], v10, s[8:11], s36 offen
s_add_u32 s36, s35, 13824
buffer_load_dwordx2 v[24:25], v10, s[8:11], s36 offen
s_add_u32 s36, s35, 17280
buffer_load_dwordx2 v[26:27], v10, s[8:11], s36 offen
s_add_u32 s36, s35, 20736
buffer_load_dwordx2 v[28:29], v10, s[8:11], s36 offen
s_add_u32 s36, s35, 24192
buffer_load_dwordx2 v[30:31], v10, s[8:11], s36 offen
s_mul_i32 s34, s90, 36
s_add_u32 s34, s34, s20
s_add_u32 s34, s34, 4
s_mov_b32 s65, s34
s_mul_i32 s35, s34, 55296
s_add_u32 s36, s35, 0
buffer_load_dwordx2 v[32:33], v10, s[8:11], s36 offen
s_add_u32 s36, s35, 3456
buffer_load_dwordx2 v[34:35], v10, s[8:11], s36 offen
s_add_u32 s36, s35, 6912
buffer_load_dwordx2 v[36:37], v10, s[8:11], s36 offen
s_add_u32 s36, s35, 10368
buffer_load_dwordx2 v[38:39], v10, s[8:11], s36 offen
s_add_u32 s36, s35, 13824
buffer_load_dwordx2 v[40:41], v10, s[8:11], s36 offen
s_add_u32 s36, s35, 17280
buffer_load_dwordx2 v[42:43], v10, s[8:11], s36 offen
s_add_u32 s36, s35, 20736
buffer_load_dwordx2 v[44:45], v10, s[8:11], s36 offen
s_add_u32 s36, s35, 24192
buffer_load_dwordx2 v[46:47], v10, s[8:11], s36 offen
s_mul_i32 s34, s90, 36
s_add_u32 s34, s34, s20
s_add_u32 s34, s34, 8
s_mov_b32 s66, s34
s_mul_i32 s35, s34, 55296
s_add_u32 s36, s35, 0
buffer_load_dwordx2 v[48:49], v10, s[8:11], s36 offen
s_add_u32 s36, s35, 3456
buffer_load_dwordx2 v[50:51], v10, s[8:11], s36 offen
s_add_u32 s36, s35, 6912
buffer_load_dwordx2 v[52:53], v10, s[8:11], s36 offen
s_add_u32 s36, s35, 10368
buffer_load_dwordx2 v[54:55], v10, s[8:11], s36 offen
s_add_u32 s36, s35, 13824
buffer_load_dwordx2 v[56:57], v10, s[8:11], s36 offen
s_add_u32 s36, s35, 17280
buffer_load_dwordx2 v[58:59], v10, s[8:11], s36 offen
s_add_u32 s36, s35, 20736
buffer_load_dwordx2 v[60:61], v10, s[8:11], s36 offen
s_add_u32 s36, s35, 24192
buffer_load_dwordx2 v[62:63], v10, s[8:11], s36 offen
s_mul_i32 s34, s90, 36
s_add_u32 s34, s34, s20
s_add_u32 s34, s34, 12
s_mov_b32 s67, s34
s_mul_i32 s35, s34, 55296
s_add_u32 s36, s35, 0
buffer_load_dwordx2 v[64:65], v10, s[8:11], s36 offen
s_add_u32 s36, s35, 3456
buffer_load_dwordx2 v[66:67], v10, s[8:11], s36 offen
s_add_u32 s36, s35, 6912
buffer_load_dwordx2 v[68:69], v10, s[8:11], s36 offen
s_add_u32 s36, s35, 10368
buffer_load_dwordx2 v[70:71], v10, s[8:11], s36 offen
s_add_u32 s36, s35, 13824
buffer_load_dwordx2 v[72:73], v10, s[8:11], s36 offen
s_add_u32 s36, s35, 17280
buffer_load_dwordx2 v[74:75], v10, s[8:11], s36 offen
s_add_u32 s36, s35, 20736
buffer_load_dwordx2 v[76:77], v10, s[8:11], s36 offen
s_add_u32 s36, s35, 24192
buffer_load_dwordx2 v[78:79], v10, s[8:11], s36 offen
s_mul_i32 s34, s90, 36
s_add_u32 s34, s34, s20
s_add_u32 s34, s34, 16
s_mov_b32 s68, s34
s_mul_i32 s35, s34, 55296
s_add_u32 s36, s35, 0
buffer_load_dwordx2 v[80:81], v10, s[8:11], s36 offen
s_add_u32 s36, s35, 3456
buffer_load_dwordx2 v[82:83], v10, s[8:11], s36 offen
s_add_u32 s36, s35, 6912
buffer_load_dwordx2 v[84:85], v10, s[8:11], s36 offen
s_add_u32 s36, s35, 10368
buffer_load_dwordx2 v[86:87], v10, s[8:11], s36 offen
s_add_u32 s36, s35, 13824
buffer_load_dwordx2 v[88:89], v10, s[8:11], s36 offen
s_add_u32 s36, s35, 17280
buffer_load_dwordx2 v[90:91], v10, s[8:11], s36 offen
s_add_u32 s36, s35, 20736
buffer_load_dwordx2 v[92:93], v10, s[8:11], s36 offen
s_add_u32 s36, s35, 24192
buffer_load_dwordx2 v[94:95], v10, s[8:11], s36 offen
s_mul_i32 s34, s90, 36
s_add_u32 s34, s34, s20
s_add_u32 s34, s34, 20
s_mov_b32 s69, s34
s_mul_i32 s35, s34, 55296
s_add_u32 s36, s35, 0
buffer_load_dwordx2 v[96:97], v10, s[8:11], s36 offen
s_add_u32 s36, s35, 3456
buffer_load_dwordx2 v[98:99], v10, s[8:11], s36 offen
s_add_u32 s36, s35, 6912
buffer_load_dwordx2 v[100:101], v10, s[8:11], s36 offen
s_add_u32 s36, s35, 10368
buffer_load_dwordx2 v[102:103], v10, s[8:11], s36 offen
s_add_u32 s36, s35, 13824
buffer_load_dwordx2 v[104:105], v10, s[8:11], s36 offen
s_add_u32 s36, s35, 17280
buffer_load_dwordx2 v[106:107], v10, s[8:11], s36 offen
s_add_u32 s36, s35, 20736
buffer_load_dwordx2 v[108:109], v10, s[8:11], s36 offen
s_add_u32 s36, s35, 24192
buffer_load_dwordx2 v[110:111], v10, s[8:11], s36 offen
s_mul_i32 s34, s90, 36
s_add_u32 s34, s34, s20
s_add_u32 s34, s34, 24
s_mov_b32 s70, s34
s_mul_i32 s35, s34, 55296
s_add_u32 s36, s35, 0
buffer_load_dwordx2 v[112:113], v10, s[8:11], s36 offen
s_add_u32 s36, s35, 3456
buffer_load_dwordx2 v[114:115], v10, s[8:11], s36 offen
s_add_u32 s36, s35, 6912
buffer_load_dwordx2 v[116:117], v10, s[8:11], s36 offen
s_add_u32 s36, s35, 10368
buffer_load_dwordx2 v[118:119], v10, s[8:11], s36 offen
s_add_u32 s36, s35, 13824
buffer_load_dwordx2 v[120:121], v10, s[8:11], s36 offen
s_add_u32 s36, s35, 17280
buffer_load_dwordx2 v[122:123], v10, s[8:11], s36 offen
s_add_u32 s36, s35, 20736
buffer_load_dwordx2 v[124:125], v10, s[8:11], s36 offen
s_add_u32 s36, s35, 24192
buffer_load_dwordx2 v[126:127], v10, s[8:11], s36 offen
s_mul_i32 s34, s90, 36
s_add_u32 s34, s34, s20
s_add_u32 s34, s34, 28
s_mov_b32 s71, s34
s_mul_i32 s35, s34, 55296
s_add_u32 s36, s35, 0
buffer_load_dwordx2 v[128:129], v10, s[8:11], s36 offen
s_add_u32 s36, s35, 3456
buffer_load_dwordx2 v[130:131], v10, s[8:11], s36 offen
s_add_u32 s36, s35, 6912
buffer_load_dwordx2 v[132:133], v10, s[8:11], s36 offen
s_add_u32 s36, s35, 10368
buffer_load_dwordx2 v[134:135], v10, s[8:11], s36 offen
s_add_u32 s36, s35, 13824
buffer_load_dwordx2 v[136:137], v10, s[8:11], s36 offen
s_add_u32 s36, s35, 17280
buffer_load_dwordx2 v[138:139], v10, s[8:11], s36 offen
s_add_u32 s36, s35, 20736
buffer_load_dwordx2 v[140:141], v10, s[8:11], s36 offen
s_add_u32 s36, s35, 24192
buffer_load_dwordx2 v[142:143], v10, s[8:11], s36 offen
s_mul_i32 s34, s90, 36
s_add_u32 s34, s34, s20
s_add_u32 s34, s34, 32
s_mov_b32 s72, s34
s_mul_i32 s35, s34, 55296
s_add_u32 s36, s35, 0
buffer_load_dwordx2 v[144:145], v10, s[8:11], s36 offen
s_add_u32 s36, s35, 3456
buffer_load_dwordx2 v[146:147], v10, s[8:11], s36 offen
s_add_u32 s36, s35, 6912
buffer_load_dwordx2 v[148:149], v10, s[8:11], s36 offen
s_add_u32 s36, s35, 10368
buffer_load_dwordx2 v[150:151], v10, s[8:11], s36 offen
s_add_u32 s36, s35, 13824
buffer_load_dwordx2 v[152:153], v10, s[8:11], s36 offen
s_add_u32 s36, s35, 17280
buffer_load_dwordx2 v[154:155], v10, s[8:11], s36 offen
s_add_u32 s36, s35, 20736
buffer_load_dwordx2 v[156:157], v10, s[8:11], s36 offen
s_add_u32 s36, s35, 24192
buffer_load_dwordx2 v[158:159], v10, s[8:11], s36 offen
s_waitcnt vmcnt(63)
s_mul_i32 s3, s64, 4096
v_add_u32 v15, s3, v2
v_perm_b32 v160, v18, v16, s32
v_perm_b32 v161, v22, v20, s32
v_perm_b32 v162, v26, v24, s32
v_perm_b32 v163, v30, v28, s32
ds_write_b128 v15, v[160:163] offset:0
v_perm_b32 v164, v18, v16, s33
v_perm_b32 v165, v22, v20, s33
v_perm_b32 v166, v26, v24, s33
v_perm_b32 v167, v30, v28, s33
ds_write_b128 v15, v[164:167] offset:1024
v_perm_b32 v168, v19, v17, s32
v_perm_b32 v169, v23, v21, s32
v_perm_b32 v170, v27, v25, s32
v_perm_b32 v171, v31, v29, s32
ds_write_b128 v15, v[168:171] offset:2048
v_perm_b32 v172, v19, v17, s33
v_perm_b32 v173, v23, v21, s33
v_perm_b32 v174, v27, v25, s33
v_perm_b32 v175, v31, v29, s33
ds_write_b128 v15, v[172:175] offset:3072
s_waitcnt lgkmcnt(0)
s_waitcnt vmcnt(56)
s_mul_i32 s3, s65, 4096
v_add_u32 v15, s3, v2
v_perm_b32 v160, v34, v32, s32
v_perm_b32 v161, v38, v36, s32
v_perm_b32 v162, v42, v40, s32
v_perm_b32 v163, v46, v44, s32
ds_write_b128 v15, v[160:163] offset:0
v_perm_b32 v164, v34, v32, s33
v_perm_b32 v165, v38, v36, s33
v_perm_b32 v166, v42, v40, s33
v_perm_b32 v167, v46, v44, s33
ds_write_b128 v15, v[164:167] offset:1024
v_perm_b32 v168, v35, v33, s32
v_perm_b32 v169, v39, v37, s32
v_perm_b32 v170, v43, v41, s32
v_perm_b32 v171, v47, v45, s32
ds_write_b128 v15, v[168:171] offset:2048
v_perm_b32 v172, v35, v33, s33
v_perm_b32 v173, v39, v37, s33
v_perm_b32 v174, v43, v41, s33
v_perm_b32 v175, v47, v45, s33
ds_write_b128 v15, v[172:175] offset:3072
s_waitcnt lgkmcnt(0)
s_waitcnt vmcnt(48)
s_mul_i32 s3, s66, 4096
v_add_u32 v15, s3, v2
v_perm_b32 v160, v50, v48, s32
v_perm_b32 v161, v54, v52, s32
v_perm_b32 v162, v58, v56, s32
v_perm_b32 v163, v62, v60, s32
ds_write_b128 v15, v[160:163] offset:0
v_perm_b32 v164, v50, v48, s33
v_perm_b32 v165, v54, v52, s33
v_perm_b32 v166, v58, v56, s33
v_perm_b32 v167, v62, v60, s33
ds_write_b128 v15, v[164:167] offset:1024
v_perm_b32 v168, v51, v49, s32
v_perm_b32 v169, v55, v53, s32
v_perm_b32 v170, v59, v57, s32
v_perm_b32 v171, v63, v61, s32
ds_write_b128 v15, v[168:171] offset:2048
v_perm_b32 v172, v51, v49, s33
v_perm_b32 v173, v55, v53, s33
v_perm_b32 v174, v59, v57, s33
v_perm_b32 v175, v63, v61, s33
ds_write_b128 v15, v[172:175] offset:3072
s_waitcnt lgkmcnt(0)
s_waitcnt vmcnt(40)
s_mul_i32 s3, s67, 4096
v_add_u32 v15, s3, v2
v_perm_b32 v160, v66, v64, s32
v_perm_b32 v161, v70, v68, s32
v_perm_b32 v162, v74, v72, s32
v_perm_b32 v163, v78, v76, s32
ds_write_b128 v15, v[160:163] offset:0
v_perm_b32 v164, v66, v64, s33
v_perm_b32 v165, v70, v68, s33
v_perm_b32 v166, v74, v72, s33
v_perm_b32 v167, v78, v76, s33
ds_write_b128 v15, v[164:167] offset:1024
v_perm_b32 v168, v67, v65, s32
v_perm_b32 v169, v71, v69, s32
v_perm_b32 v170, v75, v73, s32
v_perm_b32 v171, v79, v77, s32
ds_write_b128 v15, v[168:171] offset:2048
v_perm_b32 v172, v67, v65, s33
v_perm_b32 v173, v71, v69, s33
v_perm_b32 v174, v75, v73, s33
v_perm_b32 v175, v79, v77, s33
ds_write_b128 v15, v[172:175] offset:3072
s_waitcnt lgkmcnt(0)
s_waitcnt vmcnt(32)
s_mul_i32 s3, s68, 4096
v_add_u32 v15, s3, v2
v_perm_b32 v160, v82, v80, s32
v_perm_b32 v161, v86, v84, s32
v_perm_b32 v162, v90, v88, s32
v_perm_b32 v163, v94, v92, s32
ds_write_b128 v15, v[160:163] offset:0
v_perm_b32 v164, v82, v80, s33
v_perm_b32 v165, v86, v84, s33
v_perm_b32 v166, v90, v88, s33
v_perm_b32 v167, v94, v92, s33
ds_write_b128 v15, v[164:167] offset:1024
v_perm_b32 v168, v83, v81, s32
v_perm_b32 v169, v87, v85, s32
v_perm_b32 v170, v91, v89, s32
v_perm_b32 v171, v95, v93, s32
ds_write_b128 v15, v[168:171] offset:2048
v_perm_b32 v172, v83, v81, s33
v_perm_b32 v173, v87, v85, s33
v_perm_b32 v174, v91, v89, s33
v_perm_b32 v175, v95, v93, s33
ds_write_b128 v15, v[172:175] offset:3072
s_waitcnt lgkmcnt(0)
s_waitcnt vmcnt(24)
s_mul_i32 s3, s69, 4096
v_add_u32 v15, s3, v2
v_perm_b32 v160, v98, v96, s32
v_perm_b32 v161, v102, v100, s32
v_perm_b32 v162, v106, v104, s32
v_perm_b32 v163, v110, v108, s32
ds_write_b128 v15, v[160:163] offset:0
v_perm_b32 v164, v98, v96, s33
v_perm_b32 v165, v102, v100, s33
v_perm_b32 v166, v106, v104, s33
v_perm_b32 v167, v110, v108, s33
ds_write_b128 v15, v[164:167] offset:1024
v_perm_b32 v168, v99, v97, s32
v_perm_b32 v169, v103, v101, s32
v_perm_b32 v170, v107, v105, s32
v_perm_b32 v171, v111, v109, s32
ds_write_b128 v15, v[168:171] offset:2048
v_perm_b32 v172, v99, v97, s33
v_perm_b32 v173, v103, v101, s33
v_perm_b32 v174, v107, v105, s33
v_perm_b32 v175, v111, v109, s33
ds_write_b128 v15, v[172:175] offset:3072
s_waitcnt lgkmcnt(0)
s_waitcnt vmcnt(16)
s_mul_i32 s3, s70, 4096
v_add_u32 v15, s3, v2
v_perm_b32 v160, v114, v112, s32
v_perm_b32 v161, v118, v116, s32
v_perm_b32 v162, v122, v120, s32
v_perm_b32 v163, v126, v124, s32
ds_write_b128 v15, v[160:163] offset:0
v_perm_b32 v164, v114, v112, s33
v_perm_b32 v165, v118, v116, s33
v_perm_b32 v166, v122, v120, s33
v_perm_b32 v167, v126, v124, s33
ds_write_b128 v15, v[164:167] offset:1024
v_perm_b32 v168, v115, v113, s32
v_perm_b32 v169, v119, v117, s32
v_perm_b32 v170, v123, v121, s32
v_perm_b32 v171, v127, v125, s32
ds_write_b128 v15, v[168:171] offset:2048
v_perm_b32 v172, v115, v113, s33
v_perm_b32 v173, v119, v117, s33
v_perm_b32 v174, v123, v121, s33
v_perm_b32 v175, v127, v125, s33
ds_write_b128 v15, v[172:175] offset:3072
s_waitcnt lgkmcnt(0)
s_waitcnt vmcnt(8)
s_mul_i32 s3, s71, 4096
v_add_u32 v15, s3, v2
v_perm_b32 v160, v130, v128, s32
v_perm_b32 v161, v134, v132, s32
v_perm_b32 v162, v138, v136, s32
v_perm_b32 v163, v142, v140, s32
ds_write_b128 v15, v[160:163] offset:0
v_perm_b32 v164, v130, v128, s33
v_perm_b32 v165, v134, v132, s33
v_perm_b32 v166, v138, v136, s33
v_perm_b32 v167, v142, v140, s33
ds_write_b128 v15, v[164:167] offset:1024
v_perm_b32 v168, v131, v129, s32
v_perm_b32 v169, v135, v133, s32
v_perm_b32 v170, v139, v137, s32
v_perm_b32 v171, v143, v141, s32
ds_write_b128 v15, v[168:171] offset:2048
v_perm_b32 v172, v131, v129, s33
v_perm_b32 v173, v135, v133, s33
v_perm_b32 v174, v139, v137, s33
v_perm_b32 v175, v143, v141, s33
ds_write_b128 v15, v[172:175] offset:3072
s_waitcnt lgkmcnt(0)
s_waitcnt vmcnt(0)
s_mul_i32 s3, s72, 4096
v_add_u32 v15, s3, v2
v_perm_b32 v160, v146, v144, s32
v_perm_b32 v161, v150, v148, s32
v_perm_b32 v162, v154, v152, s32
v_perm_b32 v163, v158, v156, s32
ds_write_b128 v15, v[160:163] offset:0
v_perm_b32 v164, v146, v144, s33
v_perm_b32 v165, v150, v148, s33
v_perm_b32 v166, v154, v152, s33
v_perm_b32 v167, v158, v156, s33
ds_write_b128 v15, v[164:167] offset:1024
v_perm_b32 v168, v147, v145, s32
v_perm_b32 v169, v151, v149, s32
v_perm_b32 v170, v155, v153, s32
v_perm_b32 v171, v159, v157, s32
ds_write_b128 v15, v[168:171] offset:2048
v_perm_b32 v172, v147, v145, s33
v_perm_b32 v173, v151, v149, s33
v_perm_b32 v174, v155, v153, s33
v_perm_b32 v175, v159, v157, s33
ds_write_b128 v15, v[172:175] offset:3072
s_waitcnt lgkmcnt(0)
s_add_u32 s90, s90, 1
s_cmp_lt_u32 s90, 1
s_cbranch_scc1 L_w_75
s_cmp_eq_u32 s60, 2
s_cbranch_scc1 L_aq_v
s_cmp_eq_u32 s60, 0
s_cselect_b32 s38, s38, 1.0
v_lshlrev_b32 v12, 10, v9
v_lshl_add_u32 v12, v8, 4, v12
s_lshr_b32 s22, s20, 1
s_and_b32 s23, s20, 1
s_mov_b32 s28, 0x0
s_mul_i32 s3, s22, 0x2000
s_add_u32 s28, s28, s3
s_mul_i32 s3, s23, 0x40
s_add_u32 s28, s28, s3
s_mov_b32 s29, 0x4000
s_mul_i32 s3, s22, 0x1000
s_add_u32 s29, s29, s3
s_mul_i32 s3, s23, 0x40
s_add_u32 s29, s29, s3
s_mov_b32 s30, 0x500000
s_mul_i32 s3, s22, 0x480000
s_add_u32 s30, s30, s3
s_mul_i32 s3, s23, 0x9000
s_add_u32 s30, s30, s3
s_mov_b32 s31, 0x2000000
s_mul_i32 s3, s22, 0x800000
s_add_u32 s31, s31, s3
s_mul_i32 s3, s23, 0x20000
s_add_u32 s31, s31, s3
s_mul_i32 s3, s60, 0x8000
s_add_u32 s31, s31, s3
s_mul_i32 s3, s61, 0x2000
s_add_u32 s31, s31, s3
s_mov_b32 s39, 0x7fff0000
s_mov_b32 s85, 0
s_waitcnt vmcnt(0) lgkmcnt(0)
s_cmp_lg_u32 s20, 0
s_cbranch_scc1 L_walld_77
s_mov_b32 s91, 0
L_wall_76:
buffer_load_dword v15, off, s[16:19], 0 sc1
s_add_u32 s91, s91, 1
s_cmp_gt_u32 s91, 200000
s_cbranch_scc1 L_FAIL
s_waitcnt vmcnt(0)
v_cmp_gt_u32 vcc, 32, v15
s_nop 0
s_nop 2
s_cbranch_vccz L_walld_77
s_sleep 4
s_branch L_wall_76
L_walld_77:
s_barrier
L_aqm_top:
s_cmp_lg_u32 s85, 0
s_cbranch_scc1 L_warm_78
buffer_load_dword v15, off, s[4:7], s28 sc1
s_mov_b32 s91, 0
s_waitcnt vmcnt(0)
s_mov_b64 exec, 1
v_mov_b32 v13, 1
buffer_atomic_add v13, off, s[4:7], s39 sc1
s_mov_b64 exec, -1
v_cmp_gt_u32 vcc, 4, v15
s_nop 0
s_nop 2
s_cbranch_vccz L_spd_80
L_sp_79:
buffer_load_dword v15, off, s[4:7], s28 sc1
s_add_u32 s91, s91, 1
s_cmp_gt_u32 s91, 200000
s_cbranch_scc1 L_FAIL
s_waitcnt vmcnt(0)
v_cmp_gt_u32 vcc, 4, v15
s_nop 0
s_nop 2
s_cbranch_vccnz L_sp_79
L_spd_80:
s_mov_b32 s39, 0x7fff0000
s_add_u32 s27, s30, 0x0
buffer_load_dwordx4 a[0:3], v2, s[4:7], s27 offen offset:0
buffer_load_dwordx4 a[4:7], v2, s[4:7], s27 offen offset:1024
buffer_load_dwordx4 a[8:11], v2, s[4:7], s27 offen offset:2048
buffer_load_dwordx4 a[12:15], v2, s[4:7], s27 offen offset:3072
s_add_u32 s27, s30, 0x1000
buffer_load_dwordx4 a[16:19], v2, s[4:7], s27 offen offset:0
buffer_load_dwordx4 a[20:23], v2, s[4:7], s27 offen offset:1024
buffer_load_dwordx4 a[24:27], v2, s[4:7], s27 offen offset:2048
buffer_load_dwordx4 a[28:31], v2, s[4:7], s27 offen offset:3072
s_waitcnt vmcnt(0)
L_warm_78:
ds_read_b128 v[128:131], v2 offset:0
ds_read_b128 v[132:135], v2 offset:1024
ds_read_b128 v[136:139], v2 offset:2048
ds_read_b128 v[140:143], v2 offset:3072
ds_read_b128 v[144:147], v2 offset:4096
ds_read_b128 v[148:151], v2 offset:5120
ds_read_b128 v[152:155], v2 offset:6144
ds_read_b128 v[156:159], v2 offset:7168
s_waitcnt lgkmcnt(4)
v_mfma_f32_32x32x16_bf16 v[64:79], v[128:131], a[0:3], 0
ds_read_b128 v[160:163], v2 offset:8192
s_add_u32 s27, s30, 8192
buffer_load_dwordx4 a[32:35], v2, s[4:7], s27 offen offset:0
v_mfma_f32_32x32x16_bf16 v[80:95], v[132:135], a[0:3], 0
ds_read_b128 v[164:167], v2 offset:9216
buffer_load_dwordx4 a[36:39], v2, s[4:7], s27 offen offset:1024
v_mfma_f32_32x32x16_bf16 v[96:111], v[136:139], a[0:3], 0
ds_read_b128 v[168:171], v2 offset:10240
v_mfma_f32_32x32x16_bf16 v[112:127], v[140:143], a[0:3], 0
ds_read_b128 v[172:175], v2 offset:11264
s_waitcnt lgkmcnt(4)
v_mfma_f32_32x32x16_bf16 v[64:79], v[144:147], a[4:7], v[64:79]
ds_read_b128 v[128:131], v2 offset:12288
buffer_load_dwordx4 a[40:43], v2, s[4:7], s27 offen offset:2048
v_mfma_f32_32x32x16_bf16 v[80:95], v[148:151], a[4:7], v[80:95]
ds_read_b128 v[132:135], v2 offset:13312
buffer_load_dwordx4 a[44:47], v2, s[4:7], s27 offen offset:3072
v_mfma_f32_32x32x16_bf16 v[96:111], v[152:155], a[4:7], v[96:111]
ds_read_b128 v[136:139], v2 offset:14336
v_mfma_f32_32x32x16_bf16 v[112:127], v[156:159], a[4:7], v[112:127]
ds_read_b128 v[140:143], v2 offset:15360
s_waitcnt lgkmcnt(4)
v_mfma_f32_32x32x16_bf16 v[64:79], v[160:163], a[8:11], v[64:79]
ds_read_b128 v[144:147], v2 offset:16384
s_add_u32 s27, s30, 12288
buffer_load_dwordx4 a[48:51], v2, s[4:7], s27 offen offset:0
v_mfma_f32_32x32x16_bf16 v[80:95], v[164:167], a[8:11], v[80:95]
ds_read_b128 v[148:151], v2 offset:17408
buffer_load_dwordx4 a[52:55], v2, s[4:7], s27 offen offset:1024
v_mfma_f32_32x32x16_bf16 v[96:111], v[168:171], a[8:11], v[96:111]
ds_read_b128 v[152:155], v2 offset:18432
v_mfma_f32_32x32x16_bf16 v[112:127], v[172:175], a[8:11], v[112:127]
ds_read_b128 v[156:159], v2 offset:19456
s_waitcnt lgkmcnt(4)
v_mfma_f32_32x32x16_bf16 v[64:79], v[128:131], a[12:15], v[64:79]
ds_read_b128 v[160:163], v2 offset:20480
buffer_load_dwordx4 a[56:59], v2, s[4:7], s27 offen offset:2048
v_mfma_f32_32x32x16_bf16 v[80:95], v[132:135], a[12:15], v[80:95]
ds_read_b128 v[164:167], v2 offset:21504
buffer_load_dwordx4 a[60:63], v2, s[4:7], s27 offen offset:3072
v_mfma_f32_32x32x16_bf16 v[96:111], v[136:139], a[12:15], v[96:111]
ds_read_b128 v[168:171], v2 offset:22528
v_mfma_f32_32x32x16_bf16 v[112:127], v[140:143], a[12:15], v[112:127]
ds_read_b128 v[172:175], v2 offset:23552
s_waitcnt lgkmcnt(4)
v_mfma_f32_32x32x16_bf16 v[64:79], v[144:147], a[16:19], v[64:79]
ds_read_b128 v[128:131], v2 offset:24576
s_add_u32 s27, s30, 16384
buffer_load_dwordx4 a[64:67], v2, s[4:7], s27 offen offset:0
v_mfma_f32_32x32x16_bf16 v[80:95], v[148:151], a[16:19], v[80:95]
ds_read_b128 v[132:135], v2 offset:25600
buffer_load_dwordx4 a[68:71], v2, s[4:7], s27 offen offset:1024
v_mfma_f32_32x32x16_bf16 v[96:111], v[152:155], a[16:19], v[96:111]
ds_read_b128 v[136:139], v2 offset:26624
v_mfma_f32_32x32x16_bf16 v[112:127], v[156:159], a[16:19], v[112:127]
ds_read_b128 v[140:143], v2 offset:27648
s_waitcnt lgkmcnt(4)
v_mfma_f32_32x32x16_bf16 v[64:79], v[160:163], a[20:23], v[64:79]
ds_read_b128 v[144:147], v2 offset:28672
buffer_load_dwordx4 a[72:75], v2, s[4:7], s27 offen offset:2048
v_mfma_f32_32x32x16_bf16 v[80:95], v[164:167], a[20:23], v[80:95]
ds_read_b128 v[148:151], v2 offset:29696
buffer_load_dwordx4 a[76:79], v2, s[4:7], s27 offen offset:3072
v_mfma_f32_32x32x16_bf16 v[96:111], v[168:171], a[20:23], v[96:111]
ds_read_b128 v[152:155], v2 offset:30720
v_mfma_f32_32x32x16_bf16 v[112:127], v[172:175], a[20:23], v[112:127]
ds_read_b128 v[156:159], v2 offset:31744
s_waitcnt lgkmcnt(4)
v_mfma_f32_32x32x16_bf16 v[64:79], v[128:131], a[24:27], v[64:79]
ds_read_b128 v[160:163], v2 offset:32768
s_add_u32 s27, s30, 20480
buffer_load_dwordx4 a[80:83], v2, s[4:7], s27 offen offset:0
v_mfma_f32_32x32x16_bf16 v[80:95], v[132:135], a[24:27], v[80:95]
ds_read_b128 v[164:167], v2 offset:33792
buffer_load_dwordx4 a[84:87], v2, s[4:7], s27 offen offset:1024
v_mfma_f32_32x32x16_bf16 v[96:111], v[136:139], a[24:27], v[96:111]
ds_read_b128 v[168:171], v2 offset:34816
v_mfma_f32_32x32x16_bf16 v[112:127], v[140:143], a[24:27], v[112:127]
ds_read_b128 v[172:175], v2 offset:35840
s_waitcnt lgkmcnt(4)
v_mfma_f32_32x32x16_bf16 v[64:79], v[144:147], a[28:31], v[64:79]
ds_read_b128 v[128:131], v2 offset:36864
buffer_load_dwordx4 a[88:91], v2, s[4:7], s27 offen offset:2048
v_mfma_f32_32x32x16_bf16 v[80:95], v[148:151], a[28:31], v[80:95]
ds_read_b128 v[132:135], v2 offset:37888
buffer_load_dwordx4 a[92:95], v2, s[4:7], s27 offen offset:3072
v_mfma_f32_32x32x16_bf16 v[96:111], v[152:155], a[28:31], v[96:111]
ds_read_b128 v[136:139], v2 offset:38912
v_mfma_f32_32x32x16_bf16 v[112:127], v[156:159], a[28:31], v[112:127]
ds_read_b128 v[140:143], v2 offset:39936
s_waitcnt vmcnt(15) lgkmcnt(4)
v_mfma_f32_32x32x16_bf16 v[64:79], v[160:163], a[32:35], v[64:79]
ds_read_b128 v[144:147], v2 offset:40960
s_add_u32 s27, s30, 24576
buffer_load_dwordx4 a[96:99], v2, s[4:7], s27 offen offset:0
s_mov_b64 exec, 1
v_mov_b32 v13, 1
buffer_atomic_add v13, off, s[4:7], s39 sc1
s_mov_b64 exec, -1
v_mfma_f32_32x32x16_bf16 v[80:95], v[164:167], a[32:35], v[80:95]
ds_read_b128 v[148:151], v2 offset:41984
buffer_load_dwordx4 a[100:103], v2, s[4:7], s27 offen offset:1024
v_mfma_f32_32x32x16_bf16 v[96:111], v[168:171], a[32:35], v[96:111]
ds_read_b128 v[152:155], v2 offset:43008
v_mfma_f32_32x32x16_bf16 v[112:127], v[172:175], a[32:35], v[112:127]
ds_read_b128 v[156:159], v2 offset:44032
s_waitcnt vmcnt(17) lgkmcnt(4)
v_mfma_f32_32x32x16_bf16 v[64:79], v[128:131], a[36:39], v[64:79]
ds_read_b128 v[160:163], v2 offset:45056
buffer_load_dwordx4 a[104:107], v2, s[4:7], s27 offen offset:2048
v_mfma_f32_32x32x16_bf16 v[80:95], v[132:135], a[36:39], v[80:95]
ds_read_b128 v[164:167], v2 offset:46080
buffer_load_dwordx4 a[108:111], v2, s[4:7], s27 offen offset:3072
v_mfma_f32_32x32x16_bf16 v[96:111], v[136:139], a[36:39], v[96:111]
ds_read_b128 v[168:171], v2 offset:47104
v_mfma_f32_32x32x16_bf16 v[112:127], v[140:143], a[36:39], v[112:127]
ds_read_b128 v[172:175], v2 offset:48128
s_waitcnt vmcnt(18) lgkmcnt(4)
v_mfma_f32_32x32x16_bf16 v[64:79], v[144:147], a[40:43], v[64:79]
ds_read_b128 v[128:131], v2 offset:49152
s_add_u32 s27, s30, 28672
buffer_load_dwordx4 a[112:115], v2, s[4:7], s27 offen offset:0
v_mfma_f32_32x32x16_bf16 v[80:95], v[148:151], a[40:43], v[80:95]
ds_read_b128 v[132:135], v2 offset:50176
buffer_load_dwordx4 a[116:119], v2, s[4:7], s27 offen offset:1024
v_mfma_f32_32x32x16_bf16 v[96:111], v[152:155], a[40:43], v[96:111]
ds_read_b128 v[136:139], v2 offset:51200
v_mfma_f32_32x32x16_bf16 v[112:127], v[156:159], a[40:43], v[112:127]
ds_read_b128 v[140:143], v2 offset:52224
s_waitcnt vmcnt(19) lgkmcnt(4)
v_mfma_f32_32x32x16_bf16 v[64:79], v[160:163], a[44:47], v[64:79]
ds_read_b128 v[144:147], v2 offset:53248
buffer_load_dwordx4 a[120:123], v2, s[4:7], s27 offen offset:2048
v_mfma_f32_32x32x16_bf16 v[80:95], v[164:167], a[44:47], v[80:95]
ds_read_b128 v[148:151], v2 offset:54272
buffer_load_dwordx4 a[124:127], v2, s[4:7], s27 offen offset:3072
v_mfma_f32_32x32x16_bf16 v[96:111], v[168:171], a[44:47], v[96:111]
ds_read_b128 v[152:155], v2 offset:55296
v_mfma_f32_32x32x16_bf16 v[112:127], v[172:175], a[44:47], v[112:127]
ds_read_b128 v[156:159], v2 offset:56320
s_waitcnt vmcnt(20) lgkmcnt(4)
v_mfma_f32_32x32x16_bf16 v[64:79], v[128:131], a[48:51], v[64:79]
ds_read_b128 v[160:163], v2 offset:57344
s_add_u32 s27, s30, 32768
buffer_load_dwordx4 a[128:131], v2, s[4:7], s27 offen offset:0
v_mfma_f32_32x32x16_bf16 v[80:95], v[132:135], a[48:51], v[80:95]
ds_read_b128 v[164:167], v2 offset:58368
buffer_load_dwordx4 a[132:135], v2, s[4:7], s27 offen offset:1024
v_mfma_f32_32x32x16_bf16 v[96:111], v[136:139], a[48:51], v[96:111]
ds_read_b128 v[168:171], v2 offset:59392
v_mfma_f32_32x32x16_bf16 v[112:127], v[140:143], a[48:51], v[112:127]
ds_read_b128 v[172:175], v2 offset:60416
s_waitcnt vmcnt(21) lgkmcnt(4)
v_mfma_f32_32x32x16_bf16 v[64:79], v[144:147], a[52:55], v[64:79]
ds_read_b128 v[128:131], v3 offset:0
buffer_load_dwordx4 a[136:139], v2, s[4:7], s27 offen offset:2048
v_mfma_f32_32x32x16_bf16 v[80:95], v[148:151], a[52:55], v[80:95]
ds_read_b128 v[132:135], v3 offset:1024
buffer_load_dwordx4 a[140:143], v2, s[4:7], s27 offen offset:3072
v_mfma_f32_32x32x16_bf16 v[96:111], v[152:155], a[52:55], v[96:111]
ds_read_b128 v[136:139], v3 offset:2048
v_mfma_f32_32x32x16_bf16 v[112:127], v[156:159], a[52:55], v[112:127]
ds_read_b128 v[140:143], v3 offset:3072
s_waitcnt vmcnt(22) lgkmcnt(4)
v_mfma_f32_32x32x16_bf16 v[64:79], v[160:163], a[56:59], v[64:79]
ds_read_b128 v[144:147], v3 offset:4096
v_mfma_f32_32x32x16_bf16 v[80:95], v[164:167], a[56:59], v[80:95]
ds_read_b128 v[148:151], v3 offset:5120
v_mfma_f32_32x32x16_bf16 v[96:111], v[168:171], a[56:59], v[96:111]
ds_read_b128 v[152:155], v3 offset:6144
v_mfma_f32_32x32x16_bf16 v[112:127], v[172:175], a[56:59], v[112:127]
ds_read_b128 v[156:159], v3 offset:7168
s_waitcnt vmcnt(21) lgkmcnt(4)
v_mfma_f32_32x32x16_bf16 v[64:79], v[128:131], a[60:63], v[64:79]
ds_read_b128 v[160:163], v3 offset:8192
v_mfma_f32_32x32x16_bf16 v[80:95], v[132:135], a[60:63], v[80:95]
ds_read_b128 v[164:167], v3 offset:9216
v_mfma_f32_32x32x16_bf16 v[96:111], v[136:139], a[60:63], v[96:111]
ds_read_b128 v[168:171], v3 offset:10240
v_mfma_f32_32x32x16_bf16 v[112:127], v[140:143], a[60:63], v[112:127]
ds_read_b128 v[172:175], v3 offset:11264
s_waitcnt vmcnt(20) lgkmcnt(4)
v_mfma_f32_32x32x16_bf16 v[64:79], v[144:147], a[64:67], v[64:79]
ds_read_b128 v[128:131], v3 offset:12288
v_mfma_f32_32x32x16_bf16 v[80:95], v[148:151], a[64:67], v[80:95]
ds_read_b128 v[132:135], v3 offset:13312
v_mfma_f32_32x32x16_bf16 v[96:111], v[152:155], a[64:67], v[96:111]
ds_read_b128 v[136:139], v3 offset:14336
v_mfma_f32_32x32x16_bf16 v[112:127], v[156:159], a[64:67], v[112:127]
ds_read_b128 v[140:143], v3 offset:15360
s_add_u32 s3, s28, 0x80
buffer_load_dword v14, off, s[4:7], s3 sc1
s_waitcnt vmcnt(20) lgkmcnt(4)
v_mfma_f32_32x32x16_bf16 v[64:79], v[160:163], a[68:71], v[64:79]
ds_read_b128 v[144:147], v3 offset:16384
v_mfma_f32_32x32x16_bf16 v[80:95], v[164:167], a[68:71], v[80:95]
ds_read_b128 v[148:151], v3 offset:17408
v_mfma_f32_32x32x16_bf16 v[96:111], v[168:171], a[68:71], v[96:111]
ds_read_b128 v[152:155], v3 offset:18432
v_mfma_f32_32x32x16_bf16 v[112:127], v[172:175], a[68:71], v[112:127]
ds_read_b128 v[156:159], v3 offset:19456
s_waitcnt vmcnt(19) lgkmcnt(4)
v_mfma_f32_32x32x16_bf16 v[64:79], v[128:131], a[72:75], v[64:79]
ds_read_b128 v[160:163], v3 offset:20480
v_mfma_f32_32x32x16_bf16 v[80:95], v[132:135], a[72:75], v[80:95]
ds_read_b128 v[164:167], v3 offset:21504
v_mfma_f32_32x32x16_bf16 v[96:111], v[136:139], a[72:75], v[96:111]
ds_read_b128 v[168:171], v3 offset:22528
v_mfma_f32_32x32x16_bf16 v[112:127], v[140:143], a[72:75], v[112:127]
ds_read_b128 v[172:175], v3 offset:23552
s_waitcnt vmcnt(18) lgkmcnt(4)
v_mfma_f32_32x32x16_bf16 v[64:79], v[144:147], a[76:79], v[64:79]
ds_read_b128 v[128:131], v3 offset:24576
v_mfma_f32_32x32x16_bf16 v[80:95], v[148:151], a[76:79], v[80:95]
ds_read_b128 v[132:135], v3 offset:25600
v_mfma_f32_32x32x16_bf16 v[96:111], v[152:155], a[76:79], v[96:111]
ds_read_b128 v[136:139], v3 offset:26624
v_mfma_f32_32x32x16_bf16 v[112:127], v[156:159], a[76:79], v[112:127]
ds_read_b128 v[140:143], v3 offset:27648
s_waitcnt vmcnt(17) lgkmcnt(4)
v_mfma_f32_32x32x16_bf16 v[64:79], v[160:163], a[80:83], v[64:79]
ds_read_b128 v[144:147], v3 offset:28672
v_mfma_f32_32x32x16_bf16 v[80:95], v[164:167], a[80:83], v[80:95]
ds_read_b128 v[148:151], v3 offset:29696
v_mfma_f32_32x32x16_bf16 v[96:111], v[168:171], a[80:83], v[96:111]
ds_read_b128 v[152:155], v3 offset:30720
v_mfma_f32_32x32x16_bf16 v[112:127], v[172:175], a[80:83], v[112:127]
ds_read_b128 v[156:159], v3 offset:31744
s_waitcnt vmcnt(16) lgkmcnt(4)
v_mfma_f32_32x32x16_bf16 v[64:79], v[128:131], a[84:87], v[64:79]
ds_read_b128 v[160:163], v3 offset:32768
v_mfma_f32_32x32x16_bf16 v[80:95], v[132:135], a[84:87], v[80:95]
ds_read_b128 v[164:167], v3 offset:33792
v_mfma_f32_32x32x16_bf16 v[96:111], v[136:139], a[84:87], v[96:111]
ds_read_b128 v[168:171], v3 offset:34816
v_mfma_f32_32x32x16_bf16 v[112:127], v[140:143], a[84:87], v[112:127]
ds_read_b128 v[172:175], v3 offset:35840
s_waitcnt vmcnt(15) lgkmcnt(4)
v_mfma_f32_32x32x16_bf16 v[64:79], v[144:147], a[88:91], v[64:79]
ds_read_b128 v[128:131], v3 offset:36864
v_mfma_f32_32x32x16_bf16 v[80:95], v[148:151], a[88:91], v[80:95]
ds_read_b128 v[132:135], v3 offset:37888
v_mfma_f32_32x32x16_bf16 v[96:111], v[152:155], a[88:91], v[96:111]
ds_read_b128 v[136:139], v3 offset:38912
v_mfma_f32_32x32x16_bf16 v[112:127], v[156:159], a[88:91], v[112:127]
ds_read_b128 v[140:143], v3 offset:39936
s_waitcnt vmcnt(14) lgkmcnt(4)
v_mfma_f32_32x32x16_bf16 v[64:79], v[160:163], a[92:95], v[64:79]
ds_read_b128 v[144:147], v3 offset:40960
v_mfma_f32_32x32x16_bf16 v[80:95], v[164:167], a[92:95], v[80:95]
ds_read_b128 v[148:151], v3 offset:41984
v_mfma_f32_32x32x16_bf16 v[96:111], v[168:171], a[92:95], v[96:111]
ds_read_b128 v[152:155], v3 offset:43008
v_mfma_f32_32x32x16_bf16 v[112:127], v[172:175], a[92:95], v[112:127]
ds_read_b128 v[156:159], v3 offset:44032
s_waitcnt vmcnt(13) lgkmcnt(4)
v_mfma_f32_32x32x16_bf16 v[64:79], v[128:131], a[96:99], v[64:79]
ds_read_b128 v[160:163], v3 offset:45056
v_mfma_f32_32x32x16_bf16 v[80:95], v[132:135], a[96:99], v[80:95]
ds_read_b128 v[164:167], v3 offset:46080
v_mfma_f32_32x32x16_bf16 v[96:111], v[136:139], a[96:99], v[96:111]
ds_read_b128 v[168:171], v3 offset:47104
v_mfma_f32_32x32x16_bf16 v[112:127], v[140:143], a[96:99], v[112:127]
ds_read_b128 v[172:175], v3 offset:48128
s_waitcnt vmcnt(11) lgkmcnt(4)
v_mfma_f32_32x32x16_bf16 v[64:79], v[144:147], a[100:103], v[64:79]
ds_read_b128 v[128:131], v3 offset:49152
v_mfma_f32_32x32x16_bf16 v[80:95], v[148:151], a[100:103], v[80:95]
ds_read_b128 v[132:135], v3 offset:50176
v_mfma_f32_32x32x16_bf16 v[96:111], v[152:155], a[100:103], v[96:111]
ds_read_b128 v[136:139], v3 offset:51200
v_mfma_f32_32x32x16_bf16 v[112:127], v[156:159], a[100:103], v[112:127]
ds_read_b128 v[140:143], v3 offset:52224
s_waitcnt vmcnt(0)
v_cmp_le_u32 vcc, 4, v14
s_nop 3
s_and_b32 s85, vcc_lo, 1
s_cmp_lt_u32 s23, 62
s_cselect_b32 s85, s85, 0
s_add_u32 s86, s30, 0x12000
s_cmp_lg_u32 s85, 0
s_cselect_b32 s86, s86, 0x7fff0000
s_add_u32 s87, s86, 4096
s_waitcnt vmcnt(10) lgkmcnt(4)
v_mfma_f32_32x32x16_bf16 v[64:79], v[160:163], a[104:107], v[64:79]
ds_read_b128 v[144:147], v3 offset:53248
buffer_load_dwordx4 a[0:3], v2, s[4:7], s86 offen offset:0
v_mfma_f32_32x32x16_bf16 v[80:95], v[164:167], a[104:107], v[80:95]
ds_read_b128 v[148:151], v3 offset:54272
buffer_load_dwordx4 a[4:7], v2, s[4:7], s86 offen offset:1024
v_mfma_f32_32x32x16_bf16 v[96:111], v[168:171], a[104:107], v[96:111]
ds_read_b128 v[152:155], v3 offset:55296
buffer_load_dwordx4 a[8:11], v2, s[4:7], s86 offen offset:2048
v_mfma_f32_32x32x16_bf16 v[112:127], v[172:175], a[104:107], v[112:127]
ds_read_b128 v[156:159], v3 offset:56320
buffer_load_dwordx4 a[12:15], v2, s[4:7], s86 offen offset:3072
s_waitcnt vmcnt(13) lgkmcnt(4)
v_mfma_f32_32x32x16_bf16 v[64:79], v[128:131], a[108:111], v[64:79]
ds_read_b128 v[160:163], v3 offset:57344
buffer_load_dwordx4 a[16:19], v2, s[4:7], s87 offen offset:0
v_mfma_f32_32x32x16_bf16 v[80:95], v[132:135], a[108:111], v[80:95]
ds_read_b128 v[164:167], v3 offset:58368
buffer_load_dwordx4 a[20:23], v2, s[4:7], s87 offen offset:1024
v_mfma_f32_32x32x16_bf16 v[96:111], v[136:139], a[108:111], v[96:111]
ds_read_b128 v[168:171], v3 offset:59392
buffer_load_dwordx4 a[24:27], v2, s[4:7], s87 offen offset:2048
v_mfma_f32_32x32x16_bf16 v[112:127], v[140:143], a[108:111], v[112:127]
ds_read_b128 v[172:175], v3 offset:60416
buffer_load_dwordx4 a[28:31], v2, s[4:7], s87 offen offset:3072
s_waitcnt vmcnt(16) lgkmcnt(4)
v_mfma_f32_32x32x16_bf16 v[64:79], v[144:147], a[112:115], v[64:79]
ds_read_b128 v[128:131], v4 offset:0
v_mfma_f32_32x32x16_bf16 v[80:95], v[148:151], a[112:115], v[80:95]
ds_read_b128 v[132:135], v4 offset:1024
v_mfma_f32_32x32x16_bf16 v[96:111], v[152:155], a[112:115], v[96:111]
ds_read_b128 v[136:139], v4 offset:2048
v_mfma_f32_32x32x16_bf16 v[112:127], v[156:159], a[112:115], v[112:127]
ds_read_b128 v[140:143], v4 offset:3072
s_waitcnt vmcnt(15) lgkmcnt(4)
v_mfma_f32_32x32x16_bf16 v[64:79], v[160:163], a[116:119], v[64:79]
ds_read_b128 v[144:147], v4 offset:4096
v_mfma_f32_32x32x16_bf16 v[80:95], v[164:167], a[116:119], v[80:95]
ds_read_b128 v[148:151], v4 offset:5120
v_mfma_f32_32x32x16_bf16 v[96:111], v[168:171], a[116:119], v[96:111]
ds_read_b128 v[152:155], v4 offset:6144
v_mfma_f32_32x32x16_bf16 v[112:127], v[172:175], a[116:119], v[112:127]
ds_read_b128 v[156:159], v4 offset:7168
s_waitcnt vmcnt(14) lgkmcnt(4)
v_mfma_f32_32x32x16_bf16 v[64:79], v[128:131], a[120:123], v[64:79]
ds_read_b128 v[160:163], v4 offset:8192
v_mfma_f32_32x32x16_bf16 v[80:95], v[132:135], a[120:123], v[80:95]
ds_read_b128 v[164:167], v4 offset:9216
v_mfma_f32_32x32x16_bf16 v[96:111], v[136:139], a[120:123], v[96:111]
ds_read_b128 v[168:171], v4 offset:10240
v_mfma_f32_32x32x16_bf16 v[112:127], v[140:143], a[120:123], v[112:127]
ds_read_b128 v[172:175], v4 offset:11264
s_waitcnt vmcnt(13) lgkmcnt(4)
v_mfma_f32_32x32x16_bf16 v[64:79], v[144:147], a[124:127], v[64:79]
ds_read_b128 v[128:131], v4 offset:12288
v_mfma_f32_32x32x16_bf16 v[80:95], v[148:151], a[124:127], v[80:95]
ds_read_b128 v[132:135], v4 offset:13312
v_mfma_f32_32x32x16_bf16 v[96:111], v[152:155], a[124:127], v[96:111]
ds_read_b128 v[136:139], v4 offset:14336
v_mfma_f32_32x32x16_bf16 v[112:127], v[156:159], a[124:127], v[112:127]
ds_read_b128 v[140:143], v4 offset:15360
s_waitcnt vmcnt(12) lgkmcnt(4)
v_mfma_f32_32x32x16_bf16 v[64:79], v[160:163], a[128:131], v[64:79]
ds_read_b128 v[144:147], v4 offset:16384
v_mfma_f32_32x32x16_bf16 v[80:95], v[164:167], a[128:131], v[80:95]
ds_read_b128 v[148:151], v4 offset:17408
v_mfma_f32_32x32x16_bf16 v[96:111], v[168:171], a[128:131], v[96:111]
ds_read_b128 v[152:155], v4 offset:18432
v_mfma_f32_32x32x16_bf16 v[112:127], v[172:175], a[128:131], v[112:127]
ds_read_b128 v[156:159], v4 offset:19456
s_waitcnt vmcnt(11) lgkmcnt(4)
v_mfma_f32_32x32x16_bf16 v[64:79], v[128:131], a[132:135], v[64:79]
ds_read_b128 v[160:163], v4 offset:20480
v_mfma_f32_32x32x16_bf16 v[80:95], v[132:135], a[132:135], v[80:95]
ds_read_b128 v[164:167], v4 offset:21504
v_mfma_f32_32x32x16_bf16 v[96:111], v[136:139], a[132:135], v[96:111]
ds_read_b128 v[168:171], v4 offset:22528
v_mfma_f32_32x32x16_bf16 v[112:127], v[140:143], a[132:135], v[112:127]
ds_read_b128 v[172:175], v4 offset:23552
s_waitcnt vmcnt(10) lgkmcnt(4)
v_mfma_f32_32x32x16_bf16 v[64:79], v[144:147], a[136:139], v[64:79]
v_mfma_f32_32x32x16_bf16 v[80:95], v[148:151], a[136:139], v[80:95]
v_mfma_f32_32x32x16_bf16 v[96:111], v[152:155], a[136:139], v[96:111]
v_mfma_f32_32x32x16_bf16 v[112:127], v[156:159], a[136:139], v[112:127]
s_waitcnt vmcnt(9) lgkmcnt(0)
v_mfma_f32_32x32x16_bf16 v[64:79], v[160:163], a[140:143], v[64:79]
v_mfma_f32_32x32x16_bf16 v[80:95], v[164:167], a[140:143], v[80:95]
v_mfma_f32_32x32x16_bf16 v[96:111], v[168:171], a[140:143], v[96:111]
v_mfma_f32_32x32x16_bf16 v[112:127], v[172:175], a[140:143], v[112:127]
v_mul_f32 v64, s38, v64
v_mul_f32 v80, s38, v80
v_cvt_pk_bf16_f32 v16, v64, v80
v_mul_f32 v65, s38, v65
v_mul_f32 v81, s38, v81
v_cvt_pk_bf16_f32 v17, v65, v81
v_mul_f32 v66, s38, v66
v_mul_f32 v82, s38, v82
v_cvt_pk_bf16_f32 v18, v66, v82
v_mul_f32 v67, s38, v67
v_mul_f32 v83, s38, v83
v_cvt_pk_bf16_f32 v19, v67, v83
buffer_store_dwordx4 v[16:19], v12, s[4:7], s31 offen offset:0 sc1
v_mul_f32 v96, s38, v96
v_mul_f32 v112, s38, v112
v_cvt_pk_bf16_f32 v20, v96, v112
v_mul_f32 v97, s38, v97
v_mul_f32 v113, s38, v113
v_cvt_pk_bf16_f32 v21, v97, v113
v_mul_f32 v98, s38, v98
v_mul_f32 v114, s38, v114
v_cvt_pk_bf16_f32 v22, v98, v114
v_mul_f32 v99, s38, v99
v_mul_f32 v115, s38, v115
v_cvt_pk_bf16_f32 v23, v99, v115
buffer_store_dwordx4 v[20:23], v12, s[4:7], s31 offen offset:512 sc1
v_mul_f32 v68, s38, v68
v_mul_f32 v84, s38, v84
v_cvt_pk_bf16_f32 v24, v68, v84
v_mul_f32 v69, s38, v69
v_mul_f32 v85, s38, v85
v_cvt_pk_bf16_f32 v25, v69, v85
v_mul_f32 v70, s38, v70
v_mul_f32 v86, s38, v86
v_cvt_pk_bf16_f32 v26, v70, v86
v_mul_f32 v71, s38, v71
v_mul_f32 v87, s38, v87
v_cvt_pk_bf16_f32 v27, v71, v87
buffer_store_dwordx4 v[24:27], v12, s[4:7], s31 offen offset:2048 sc1
v_mul_f32 v100, s38, v100
v_mul_f32 v116, s38, v116
v_cvt_pk_bf16_f32 v28, v100, v116
v_mul_f32 v101, s38, v101
v_mul_f32 v117, s38, v117
v_cvt_pk_bf16_f32 v29, v101, v117
v_mul_f32 v102, s38, v102
v_mul_f32 v118, s38, v118
v_cvt_pk_bf16_f32 v30, v102, v118
v_mul_f32 v103, s38, v103
v_mul_f32 v119, s38, v119
v_cvt_pk_bf16_f32 v31, v103, v119
buffer_store_dwordx4 v[28:31], v12, s[4:7], s31 offen offset:2560 sc1
v_mul_f32 v72, s38, v72
v_mul_f32 v88, s38, v88
v_cvt_pk_bf16_f32 v16, v72, v88
v_mul_f32 v73, s38, v73
v_mul_f32 v89, s38, v89
v_cvt_pk_bf16_f32 v17, v73, v89
v_mul_f32 v74, s38, v74
v_mul_f32 v90, s38, v90
v_cvt_pk_bf16_f32 v18, v74, v90
v_mul_f32 v75, s38, v75
v_mul_f32 v91, s38, v91
v_cvt_pk_bf16_f32 v19, v75, v91
s_add_u32 s37, s31, 4096
buffer_store_dwordx4 v[16:19], v12, s[4:7], s37 offen offset:0 sc1
v_mul_f32 v104, s38, v104
v_mul_f32 v120, s38, v120
v_cvt_pk_bf16_f32 v20, v104, v120
v_mul_f32 v105, s38, v105
v_mul_f32 v121, s38, v121
v_cvt_pk_bf16_f32 v21, v105, v121
v_mul_f32 v106, s38, v106
v_mul_f32 v122, s38, v122
v_cvt_pk_bf16_f32 v22, v106, v122
v_mul_f32 v107, s38, v107
v_mul_f32 v123, s38, v123
v_cvt_pk_bf16_f32 v23, v107, v123
buffer_store_dwordx4 v[20:23], v12, s[4:7], s37 offen offset:512 sc1
v_mul_f32 v76, s38, v76
v_mul_f32 v92, s38, v92
v_cvt_pk_bf16_f32 v24, v76, v92
v_mul_f32 v77, s38, v77
v_mul_f32 v93, s38, v93
v_cvt_pk_bf16_f32 v25, v77, v93
v_mul_f32 v78, s38, v78
v_mul_f32 v94, s38, v94
v_cvt_pk_bf16_f32 v26, v78, v94
v_mul_f32 v79, s38, v79
v_mul_f32 v95, s38, v95
v_cvt_pk_bf16_f32 v27, v79, v95
buffer_store_dwordx4 v[24:27], v12, s[4:7], s37 offen offset:2048 sc1
v_mul_f32 v108, s38, v108
v_mul_f32 v124, s38, v124
v_cvt_pk_bf16_f32 v28, v108, v124
v_mul_f32 v109, s38, v109
v_mul_f32 v125, s38, v125
v_cvt_pk_bf16_f32 v29, v109, v125
v_mul_f32 v110, s38, v110
v_mul_f32 v126, s38, v126
v_cvt_pk_bf16_f32 v30, v110, v126
v_mul_f32 v111, s38, v111
v_mul_f32 v127, s38, v127
v_cvt_pk_bf16_f32 v31, v111, v127
buffer_store_dwordx4 v[28:31], v12, s[4:7], s37 offen offset:2560 sc1
s_waitcnt vmcnt(8)
s_mov_b32 s39, s29
s_add_u32 s28, s28, 0x80
s_add_u32 s29, s29, 0x80
s_add_u32 s30, s30, 0x12000
s_add_u32 s31, s31, 0x40000
s_add_u32 s23, s23, 2
s_cmp_lt_u32 s23, 64
s_cbranch_scc1 L_aqm_top
s_waitcnt vmcnt(0)
s_mov_b64 exec, 1
v_mov_b32 v13, 1
buffer_atomic_add v13, off, s[4:7], s39 sc1
s_mov_b64 exec, -1
s_waitcnt vmcnt(0)
s_branch L_END
L_aq_v:
s_lshr_b32 s22, s20, 1
s_and_b32 s23, s20, 1
s_mov_b32 s28, 0x0
s_mul_i32 s3, s22, 0x2000
s_add_u32 s28, s28, s3
s_mul_i32 s3, s23, 0x40
s_add_u32 s28, s28, s3
s_mov_b32 s29, 0x4000
s_mul_i32 s3, s22, 0x1000
s_add_u32 s29, s29, s3
s_mul_i32 s3, s23, 0x40
s_add_u32 s29, s29, s3
s_mov_b32 s30, 0x500000
s_mul_i32 s3, s22, 0x480000
s_add_u32 s30, s30, s3
s_mul_i32 s3, s23, 0x9000
s_add_u32 s30, s30, s3
s_mov_b32 s31, 0x2010000
s_mul_i32 s3, s22, 0x800000
s_add_u32 s31, s31, s3
s_mul_i32 s3, s23, 0x20000
s_add_u32 s31, s31, s3
s_mul_i32 s3, s61, 0x2000
s_add_u32 s31, s31, s3
s_mov_b32 s39, 0x7fff0000
s_mov_b32 s85, 0
s_waitcnt vmcnt(0) lgkmcnt(0)
s_cmp_lg_u32 s20, 0
s_cbranch_scc1 L_walld_82
s_mov_b32 s91, 0
L_wall_81:
buffer_load_dword v15, off, s[16:19], 0 sc1
s_add_u32 s91, s91, 1
s_cmp_gt_u32 s91, 200000
s_cbranch_scc1 L_FAIL
s_waitcnt vmcnt(0)
v_cmp_gt_u32 vcc, 32, v15
s_nop 0
s_nop 2
s_cbranch_vccz L_walld_82
s_sleep 4
s_branch L_wall_81
L_walld_82:
s_barrier
L_aqv_top:
s_cmp_lg_u32 s85, 0
s_cbranch_scc1 L_warm_83
buffer_load_dword v15, off, s[4:7], s28 sc1
s_mov_b32 s91, 0
s_waitcnt vmcnt(0)
s_mov_b64 exec, 1
v_mov_b32 v13, 1
buffer_atomic_add v13, off, s[4:7], s39 sc1
s_mov_b64 exec, -1
v_cmp_gt_u32 vcc, 4, v15
s_nop 0
s_nop 2
s_cbranch_vccz L_spd_85
L_sp_84:
buffer_load_dword v15, off, s[4:7], s28 sc1
s_add_u32 s91, s91, 1
s_cmp_gt_u32 s91, 200000
s_cbranch_scc1 L_FAIL
s_waitcnt vmcnt(0)
v_cmp_gt_u32 vcc, 4, v15
s_nop 0
s_nop 2
s_cbranch_vccnz L_sp_84
L_spd_85:
s_mov_b32 s39, 0x7fff0000
s_add_u32 s27, s30, 0x0
buffer_load_dwordx4 a[0:3], v2, s[4:7], s27 offen offset:0
buffer_load_dwordx4 a[4:7], v2, s[4:7], s27 offen offset:1024
buffer_load_dwordx4 a[8:11], v2, s[4:7], s27 offen offset:2048
buffer_load_dwordx4 a[12:15], v2, s[4:7], s27 offen offset:3072
s_add_u32 s27, s30, 0x1000
buffer_load_dwordx4 a[16:19], v2, s[4:7], s27 offen offset:0
buffer_load_dwordx4 a[20:23], v2, s[4:7], s27 offen offset:1024
buffer_load_dwordx4 a[24:27], v2, s[4:7], s27 offen offset:2048
buffer_load_dwordx4 a[28:31], v2, s[4:7], s27 offen offset:3072
s_waitcnt vmcnt(0)
L_warm_83:
ds_read_b128 v[128:131], v2 offset:0
ds_read_b128 v[132:135], v2 offset:1024
ds_read_b128 v[136:139], v2 offset:2048
ds_read_b128 v[140:143], v2 offset:3072
ds_read_b128 v[144:147], v2 offset:4096
ds_read_b128 v[148:151], v2 offset:5120
ds_read_b128 v[152:155], v2 offset:6144
ds_read_b128 v[156:159], v2 offset:7168
s_waitcnt lgkmcnt(4)
v_mfma_f32_32x32x16_bf16 v[64:79], a[0:3], v[128:131], 0
ds_read_b128 v[160:163], v2 offset:8192
s_add_u32 s27, s30, 8192
buffer_load_dwordx4 a[32:35], v2, s[4:7], s27 offen offset:0
v_mfma_f32_32x32x16_bf16 v[80:95], a[0:3], v[132:135], 0
ds_read_b128 v[164:167], v2 offset:9216
buffer_load_dwordx4 a[36:39], v2, s[4:7], s27 offen offset:1024
v_mfma_f32_32x32x16_bf16 v[96:111], a[0:3], v[136:139], 0
ds_read_b128 v[168:171], v2 offset:10240
v_mfma_f32_32x32x16_bf16 v[112:127], a[0:3], v[140:143], 0
ds_read_b128 v[172:175], v2 offset:11264
s_waitcnt lgkmcnt(4)
v_mfma_f32_32x32x16_bf16 v[64:79], a[4:7], v[144:147], v[64:79]
ds_read_b128 v[128:131], v2 offset:12288
buffer_load_dwordx4 a[40:43], v2, s[4:7], s27 offen offset:2048
v_mfma_f32_32x32x16_bf16 v[80:95], a[4:7], v[148:151], v[80:95]
ds_read_b128 v[132:135], v2 offset:13312
buffer_load_dwordx4 a[44:47], v2, s[4:7], s27 offen offset:3072
v_mfma_f32_32x32x16_bf16 v[96:111], a[4:7], v[152:155], v[96:111]
ds_read_b128 v[136:139], v2 offset:14336
v_mfma_f32_32x32x16_bf16 v[112:127], a[4:7], v[156:159], v[112:127]
ds_read_b128 v[140:143], v2 offset:15360
s_waitcnt lgkmcnt(4)
v_mfma_f32_32x32x16_bf16 v[64:79], a[8:11], v[160:163], v[64:79]
ds_read_b128 v[144:147], v2 offset:16384
s_add_u32 s27, s30, 12288
buffer_load_dwordx4 a[48:51], v2, s[4:7], s27 offen offset:0
v_mfma_f32_32x32x16_bf16 v[80:95], a[8:11], v[164:167], v[80:95]
ds_read_b128 v[148:151], v2 offset:17408
buffer_load_dwordx4 a[52:55], v2, s[4:7], s27 offen offset:1024
v_mfma_f32_32x32x16_bf16 v[96:111], a[8:11], v[168:171], v[96:111]
ds_read_b128 v[152:155], v2 offset:18432
v_mfma_f32_32x32x16_bf16 v[112:127], a[8:11], v[172:175], v[112:127]
ds_read_b128 v[156:159], v2 offset:19456
s_waitcnt lgkmcnt(4)
v_mfma_f32_32x32x16_bf16 v[64:79], a[12:15], v[128:131], v[64:79]
ds_read_b128 v[160:163], v2 offset:20480
buffer_load_dwordx4 a[56:59], v2, s[4:7], s27 offen offset:2048
v_mfma_f32_32x32x16_bf16 v[80:95], a[12:15], v[132:135], v[80:95]
ds_read_b128 v[164:167], v2 offset:21504
buffer_load_dwordx4 a[60:63], v2, s[4:7], s27 offen offset:3072
v_mfma_f32_32x32x16_bf16 v[96:111], a[12:15], v[136:139], v[96:111]
ds_read_b128 v[168:171], v2 offset:22528
v_mfma_f32_32x32x16_bf16 v[112:127], a[12:15], v[140:143], v[112:127]
ds_read_b128 v[172:175], v2 offset:23552
s_waitcnt lgkmcnt(4)
v_mfma_f32_32x32x16_bf16 v[64:79], a[16:19], v[144:147], v[64:79]
ds_read_b128 v[128:131], v2 offset:24576
s_add_u32 s27, s30, 16384
buffer_load_dwordx4 a[64:67], v2, s[4:7], s27 offen offset:0
v_mfma_f32_32x32x16_bf16 v[80:95], a[16:19], v[148:151], v[80:95]
ds_read_b128 v[132:135], v2 offset:25600
buffer_load_dwordx4 a[68:71], v2, s[4:7], s27 offen offset:1024
v_mfma_f32_32x32x16_bf16 v[96:111], a[16:19], v[152:155], v[96:111]
ds_read_b128 v[136:139], v2 offset:26624
v_mfma_f32_32x32x16_bf16 v[112:127], a[16:19], v[156:159], v[112:127]
ds_read_b128 v[140:143], v2 offset:27648
s_waitcnt lgkmcnt(4)
v_mfma_f32_32x32x16_bf16 v[64:79], a[20:23], v[160:163], v[64:79]
ds_read_b128 v[144:147], v2 offset:28672
buffer_load_dwordx4 a[72:75], v2, s[4:7], s27 offen offset:2048
v_mfma_f32_32x32x16_bf16 v[80:95], a[20:23], v[164:167], v[80:95]
ds_read_b128 v[148:151], v2 offset:29696
buffer_load_dwordx4 a[76:79], v2, s[4:7], s27 offen offset:3072
v_mfma_f32_32x32x16_bf16 v[96:111], a[20:23], v[168:171], v[96:111]
ds_read_b128 v[152:155], v2 offset:30720
v_mfma_f32_32x32x16_bf16 v[112:127], a[20:23], v[172:175], v[112:127]
ds_read_b128 v[156:159], v2 offset:31744
s_waitcnt lgkmcnt(4)
v_mfma_f32_32x32x16_bf16 v[64:79], a[24:27], v[128:131], v[64:79]
ds_read_b128 v[160:163], v2 offset:32768
s_add_u32 s27, s30, 20480
buffer_load_dwordx4 a[80:83], v2, s[4:7], s27 offen offset:0
v_mfma_f32_32x32x16_bf16 v[80:95], a[24:27], v[132:135], v[80:95]
ds_read_b128 v[164:167], v2 offset:33792
buffer_load_dwordx4 a[84:87], v2, s[4:7], s27 offen offset:1024
v_mfma_f32_32x32x16_bf16 v[96:111], a[24:27], v[136:139], v[96:111]
ds_read_b128 v[168:171], v2 offset:34816
v_mfma_f32_32x32x16_bf16 v[112:127], a[24:27], v[140:143], v[112:127]
ds_read_b128 v[172:175], v2 offset:35840
s_waitcnt lgkmcnt(4)
v_mfma_f32_32x32x16_bf16 v[64:79], a[28:31], v[144:147], v[64:79]
ds_read_b128 v[128:131], v2 offset:36864
buffer_load_dwordx4 a[88:91], v2, s[4:7], s27 offen offset:2048
v_mfma_f32_32x32x16_bf16 v[80:95], a[28:31], v[148:151], v[80:95]
ds_read_b128 v[132:135], v2 offset:37888
buffer_load_dwordx4 a[92:95], v2, s[4:7], s27 offen offset:3072
v_mfma_f32_32x32x16_bf16 v[96:111], a[28:31], v[152:155], v[96:111]
ds_read_b128 v[136:139], v2 offset:38912
v_mfma_f32_32x32x16_bf16 v[112:127], a[28:31], v[156:159], v[112:127]
ds_read_b128 v[140:143], v2 offset:39936
s_waitcnt vmcnt(15) lgkmcnt(4)
v_mfma_f32_32x32x16_bf16 v[64:79], a[32:35], v[160:163], v[64:79]
ds_read_b128 v[144:147], v2 offset:40960
s_add_u32 s27, s30, 24576
buffer_load_dwordx4 a[96:99], v2, s[4:7], s27 offen offset:0
s_mov_b64 exec, 1
v_mov_b32 v13, 1
buffer_atomic_add v13, off, s[4:7], s39 sc1
s_mov_b64 exec, -1
v_mfma_f32_32x32x16_bf16 v[80:95], a[32:35], v[164:167], v[80:95]
ds_read_b128 v[148:151], v2 offset:41984
buffer_load_dwordx4 a[100:103], v2, s[4:7], s27 offen offset:1024
v_mfma_f32_32x32x16_bf16 v[96:111], a[32:35], v[168:171], v[96:111]
ds_read_b128 v[152:155], v2 offset:43008
v_mfma_f32_32x32x16_bf16 v[112:127], a[32:35], v[172:175], v[112:127]
ds_read_b128 v[156:159], v2 offset:44032
s_waitcnt vmcnt(17) lgkmcnt(4)
v_mfma_f32_32x32x16_bf16 v[64:79], a[36:39], v[128:131], v[64:79]
ds_read_b128 v[160:163], v2 offset:45056
buffer_load_dwordx4 a[104:107], v2, s[4:7], s27 offen offset:2048
v_mfma_f32_32x32x16_bf16 v[80:95], a[36:39], v[132:135], v[80:95]
ds_read_b128 v[164:167], v2 offset:46080
buffer_load_dwordx4 a[108:111], v2, s[4:7], s27 offen offset:3072
v_mfma_f32_32x32x16_bf16 v[96:111], a[36:39], v[136:139], v[96:111]
ds_read_b128 v[168:171], v2 offset:47104
v_mfma_f32_32x32x16_bf16 v[112:127], a[36:39], v[140:143], v[112:127]
ds_read_b128 v[172:175], v2 offset:48128
s_waitcnt vmcnt(18) lgkmcnt(4)
v_mfma_f32_32x32x16_bf16 v[64:79], a[40:43], v[144:147], v[64:79]
ds_read_b128 v[128:131], v2 offset:49152
s_add_u32 s27, s30, 28672
buffer_load_dwordx4 a[112:115], v2, s[4:7], s27 offen offset:0
v_mfma_f32_32x32x16_bf16 v[80:95], a[40:43], v[148:151], v[80:95]
ds_read_b128 v[132:135], v2 offset:50176
buffer_load_dwordx4 a[116:119], v2, s[4:7], s27 offen offset:1024
v_mfma_f32_32x32x16_bf16 v[96:111], a[40:43], v[152:155], v[96:111]
ds_read_b128 v[136:139], v2 offset:51200
v_mfma_f32_32x32x16_bf16 v[112:127], a[40:43], v[156:159], v[112:127]
ds_read_b128 v[140:143], v2 offset:52224
s_waitcnt vmcnt(19) lgkmcnt(4)
v_mfma_f32_32x32x16_bf16 v[64:79], a[44:47], v[160:163], v[64:79]
ds_read_b128 v[144:147], v2 offset:53248
buffer_load_dwordx4 a[120:123], v2, s[4:7], s27 offen offset:2048
v_mfma_f32_32x32x16_bf16 v[80:95], a[44:47], v[164:167], v[80:95]
ds_read_b128 v[148:151], v2 offset:54272
buffer_load_dwordx4 a[124:127], v2, s[4:7], s27 offen offset:3072
v_mfma_f32_32x32x16_bf16 v[96:111], a[44:47], v[168:171], v[96:111]
ds_read_b128 v[152:155], v2 offset:55296
v_mfma_f32_32x32x16_bf16 v[112:127], a[44:47], v[172:175], v[112:127]
ds_read_b128 v[156:159], v2 offset:56320
s_waitcnt vmcnt(20) lgkmcnt(4)
v_mfma_f32_32x32x16_bf16 v[64:79], a[48:51], v[128:131], v[64:79]
ds_read_b128 v[160:163], v2 offset:57344
s_add_u32 s27, s30, 32768
buffer_load_dwordx4 a[128:131], v2, s[4:7], s27 offen offset:0
v_mfma_f32_32x32x16_bf16 v[80:95], a[48:51], v[132:135], v[80:95]
ds_read_b128 v[164:167], v2 offset:58368
buffer_load_dwordx4 a[132:135], v2, s[4:7], s27 offen offset:1024
v_mfma_f32_32x32x16_bf16 v[96:111], a[48:51], v[136:139], v[96:111]
ds_read_b128 v[168:171], v2 offset:59392
v_mfma_f32_32x32x16_bf16 v[112:127], a[48:51], v[140:143], v[112:127]
ds_read_b128 v[172:175], v2 offset:60416
s_waitcnt vmcnt(21) lgkmcnt(4)
v_mfma_f32_32x32x16_bf16 v[64:79], a[52:55], v[144:147], v[64:79]
ds_read_b128 v[128:131], v3 offset:0
buffer_load_dwordx4 a[136:139], v2, s[4:7], s27 offen offset:2048
v_mfma_f32_32x32x16_bf16 v[80:95], a[52:55], v[148:151], v[80:95]
ds_read_b128 v[132:135], v3 offset:1024
buffer_load_dwordx4 a[140:143], v2, s[4:7], s27 offen offset:3072
v_mfma_f32_32x32x16_bf16 v[96:111], a[52:55], v[152:155], v[96:111]
ds_read_b128 v[136:139], v3 offset:2048
v_mfma_f32_32x32x16_bf16 v[112:127], a[52:55], v[156:159], v[112:127]
ds_read_b128 v[140:143], v3 offset:3072
s_waitcnt vmcnt(22) lgkmcnt(4)
v_mfma_f32_32x32x16_bf16 v[64:79], a[56:59], v[160:163], v[64:79]
ds_read_b128 v[144:147], v3 offset:4096
v_mfma_f32_32x32x16_bf16 v[80:95], a[56:59], v[164:167], v[80:95]
ds_read_b128 v[148:151], v3 offset:5120
v_mfma_f32_32x32x16_bf16 v[96:111], a[56:59], v[168:171], v[96:111]
ds_read_b128 v[152:155], v3 offset:6144
v_mfma_f32_32x32x16_bf16 v[112:127], a[56:59], v[172:175], v[112:127]
ds_read_b128 v[156:159], v3 offset:7168
s_waitcnt vmcnt(21) lgkmcnt(4)
v_mfma_f32_32x32x16_bf16 v[64:79], a[60:63], v[128:131], v[64:79]
ds_read_b128 v[160:163], v3 offset:8192
v_mfma_f32_32x32x16_bf16 v[80:95], a[60:63], v[132:135], v[80:95]
ds_read_b128 v[164:167], v3 offset:9216
v_mfma_f32_32x32x16_bf16 v[96:111], a[60:63], v[136:139], v[96:111]
ds_read_b128 v[168:171], v3 offset:10240
v_mfma_f32_32x32x16_bf16 v[112:127], a[60:63], v[140:143], v[112:127]
ds_read_b128 v[172:175], v3 offset:11264
s_waitcnt vmcnt(20) lgkmcnt(4)
v_mfma_f32_32x32x16_bf16 v[64:79], a[64:67], v[144:147], v[64:79]
ds_read_b128 v[128:131], v3 offset:12288
v_mfma_f32_32x32x16_bf16 v[80:95], a[64:67], v[148:151], v[80:95]
ds_read_b128 v[132:135], v3 offset:13312
v_mfma_f32_32x32x16_bf16 v[96:111], a[64:67], v[152:155], v[96:111]
ds_read_b128 v[136:139], v3 offset:14336
v_mfma_f32_32x32x16_bf16 v[112:127], a[64:67], v[156:159], v[112:127]
ds_read_b128 v[140:143], v3 offset:15360
s_add_u32 s3, s28, 0x80
buffer_load_dword v14, off, s[4:7], s3 sc1
s_waitcnt vmcnt(20) lgkmcnt(4)
v_mfma_f32_32x32x16_bf16 v[64:79], a[68:71], v[160:163], v[64:79]
ds_read_b128 v[144:147], v3 offset:16384
v_mfma_f32_32x32x16_bf16 v[80:95], a[68:71], v[164:167], v[80:95]
ds_read_b128 v[148:151], v3 offset:17408
v_mfma_f32_32x32x16_bf16 v[96:111], a[68:71], v[168:171], v[96:111]
ds_read_b128 v[152:155], v3 offset:18432
v_mfma_f32_32x32x16_bf16 v[112:127], a[68:71], v[172:175], v[112:127]
ds_read_b128 v[156:159], v3 offset:19456
s_waitcnt vmcnt(19) lgkmcnt(4)
v_mfma_f32_32x32x16_bf16 v[64:79], a[72:75], v[128:131], v[64:79]
ds_read_b128 v[160:163], v3 offset:20480
v_mfma_f32_32x32x16_bf16 v[80:95], a[72:75], v[132:135], v[80:95]
ds_read_b128 v[164:167], v3 offset:21504
v_mfma_f32_32x32x16_bf16 v[96:111], a[72:75], v[136:139], v[96:111]
ds_read_b128 v[168:171], v3 offset:22528
v_mfma_f32_32x32x16_bf16 v[112:127], a[72:75], v[140:143], v[112:127]
ds_read_b128 v[172:175], v3 offset:23552
s_waitcnt vmcnt(18) lgkmcnt(4)
v_mfma_f32_32x32x16_bf16 v[64:79], a[76:79], v[144:147], v[64:79]
ds_read_b128 v[128:131], v3 offset:24576
v_mfma_f32_32x32x16_bf16 v[80:95], a[76:79], v[148:151], v[80:95]
ds_read_b128 v[132:135], v3 offset:25600
v_mfma_f32_32x32x16_bf16 v[96:111], a[76:79], v[152:155], v[96:111]
ds_read_b128 v[136:139], v3 offset:26624
v_mfma_f32_32x32x16_bf16 v[112:127], a[76:79], v[156:159], v[112:127]
ds_read_b128 v[140:143], v3 offset:27648
s_waitcnt vmcnt(17) lgkmcnt(4)
v_mfma_f32_32x32x16_bf16 v[64:79], a[80:83], v[160:163], v[64:79]
ds_read_b128 v[144:147], v3 offset:28672
v_mfma_f32_32x32x16_bf16 v[80:95], a[80:83], v[164:167], v[80:95]
ds_read_b128 v[148:151], v3 offset:29696
v_mfma_f32_32x32x16_bf16 v[96:111], a[80:83], v[168:171], v[96:111]
ds_read_b128 v[152:155], v3 offset:30720
v_mfma_f32_32x32x16_bf16 v[112:127], a[80:83], v[172:175], v[112:127]
ds_read_b128 v[156:159], v3 offset:31744
s_waitcnt vmcnt(16) lgkmcnt(4)
v_mfma_f32_32x32x16_bf16 v[64:79], a[84:87], v[128:131], v[64:79]
ds_read_b128 v[160:163], v3 offset:32768
v_mfma_f32_32x32x16_bf16 v[80:95], a[84:87], v[132:135], v[80:95]
ds_read_b128 v[164:167], v3 offset:33792
v_mfma_f32_32x32x16_bf16 v[96:111], a[84:87], v[136:139], v[96:111]
ds_read_b128 v[168:171], v3 offset:34816
v_mfma_f32_32x32x16_bf16 v[112:127], a[84:87], v[140:143], v[112:127]
ds_read_b128 v[172:175], v3 offset:35840
s_waitcnt vmcnt(15) lgkmcnt(4)
v_mfma_f32_32x32x16_bf16 v[64:79], a[88:91], v[144:147], v[64:79]
ds_read_b128 v[128:131], v3 offset:36864
v_mfma_f32_32x32x16_bf16 v[80:95], a[88:91], v[148:151], v[80:95]
ds_read_b128 v[132:135], v3 offset:37888
v_mfma_f32_32x32x16_bf16 v[96:111], a[88:91], v[152:155], v[96:111]
ds_read_b128 v[136:139], v3 offset:38912
v_mfma_f32_32x32x16_bf16 v[112:127], a[88:91], v[156:159], v[112:127]
ds_read_b128 v[140:143], v3 offset:39936
s_waitcnt vmcnt(14) lgkmcnt(4)
v_mfma_f32_32x32x16_bf16 v[64:79], a[92:95], v[160:163], v[64:79]
ds_read_b128 v[144:147], v3 offset:40960
v_mfma_f32_32x32x16_bf16 v[80:95], a[92:95], v[164:167], v[80:95]
ds_read_b128 v[148:151], v3 offset:41984
v_mfma_f32_32x32x16_bf16 v[96:111], a[92:95], v[168:171], v[96:111]
ds_read_b128 v[152:155], v3 offset:43008
v_mfma_f32_32x32x16_bf16 v[112:127], a[92:95], v[172:175], v[112:127]
ds_read_b128 v[156:159], v3 offset:44032
s_waitcnt vmcnt(13) lgkmcnt(4)
v_mfma_f32_32x32x16_bf16 v[64:79], a[96:99], v[128:131], v[64:79]
ds_read_b128 v[160:163], v3 offset:45056
v_mfma_f32_32x32x16_bf16 v[80:95], a[96:99], v[132:135], v[80:95]
ds_read_b128 v[164:167], v3 offset:46080
v_mfma_f32_32x32x16_bf16 v[96:111], a[96:99], v[136:139], v[96:111]
ds_read_b128 v[168:171], v3 offset:47104
v_mfma_f32_32x32x16_bf16 v[112:127], a[96:99], v[140:143], v[112:127]
ds_read_b128 v[172:175], v3 offset:48128
s_waitcnt vmcnt(11) lgkmcnt(4)
v_mfma_f32_32x32x16_bf16 v[64:79], a[100:103], v[144:147], v[64:79]
ds_read_b128 v[128:131], v3 offset:49152
v_mfma_f32_32x32x16_bf16 v[80:95], a[100:103], v[148:151], v[80:95]
ds_read_b128 v[132:135], v3 offset:50176
v_mfma_f32_32x32x16_bf16 v[96:111], a[100:103], v[152:155], v[96:111]
ds_read_b128 v[136:139], v3 offset:51200
v_mfma_f32_32x32x16_bf16 v[112:127], a[100:103], v[156:159], v[112:127]
ds_read_b128 v[140:143], v3 offset:52224
s_waitcnt vmcnt(0)
v_cmp_le_u32 vcc, 4, v14
s_nop 3
s_and_b32 s85, vcc_lo, 1
s_cmp_lt_u32 s23, 62
s_cselect_b32 s85, s85, 0
s_add_u32 s86, s30, 0x12000
s_cmp_lg_u32 s85, 0
s_cselect_b32 s86, s86, 0x7fff0000
s_add_u32 s87, s86, 4096
s_waitcnt vmcnt(10) lgkmcnt(4)
v_mfma_f32_32x32x16_bf16 v[64:79], a[104:107], v[160:163], v[64:79]
ds_read_b128 v[144:147], v3 offset:53248
buffer_load_dwordx4 a[0:3], v2, s[4:7], s86 offen offset:0
v_mfma_f32_32x32x16_bf16 v[80:95], a[104:107], v[164:167], v[80:95]
ds_read_b128 v[148:151], v3 offset:54272
buffer_load_dwordx4 a[4:7], v2, s[4:7], s86 offen offset:1024
v_mfma_f32_32x32x16_bf16 v[96:111], a[104:107], v[168:171], v[96:111]
ds_read_b128 v[152:155], v3 offset:55296
buffer_load_dwordx4 a[8:11], v2, s[4:7], s86 offen offset:2048
v_mfma_f32_32x32x16_bf16 v[112:127], a[104:107], v[172:175], v[112:127]
ds_read_b128 v[156:159], v3 offset:56320
buffer_load_dwordx4 a[12:15], v2, s[4:7], s86 offen offset:3072
s_waitcnt vmcnt(13) lgkmcnt(4)
v_mfma_f32_32x32x16_bf16 v[64:79], a[108:111], v[128:131], v[64:79]
ds_read_b128 v[160:163], v3 offset:57344
buffer_load_dwordx4 a[16:19], v2, s[4:7], s87 offen offset:0
v_mfma_f32_32x32x16_bf16 v[80:95], a[108:111], v[132:135], v[80:95]
ds_read_b128 v[164:167], v3 offset:58368
buffer_load_dwordx4 a[20:23], v2, s[4:7], s87 offen offset:1024
v_mfma_f32_32x32x16_bf16 v[96:111], a[108:111], v[136:139], v[96:111]
ds_read_b128 v[168:171], v3 offset:59392
buffer_load_dwordx4 a[24:27], v2, s[4:7], s87 offen offset:2048
v_mfma_f32_32x32x16_bf16 v[112:127], a[108:111], v[140:143], v[112:127]
ds_read_b128 v[172:175], v3 offset:60416
buffer_load_dwordx4 a[28:31], v2, s[4:7], s87 offen offset:3072
s_waitcnt vmcnt(16) lgkmcnt(4)
v_mfma_f32_32x32x16_bf16 v[64:79], a[112:115], v[144:147], v[64:79]
ds_read_b128 v[128:131], v4 offset:0
v_mfma_f32_32x32x16_bf16 v[80:95], a[112:115], v[148:151], v[80:95]
ds_read_b128 v[132:135], v4 offset:1024
v_mfma_f32_32x32x16_bf16 v[96:111], a[112:115], v[152:155], v[96:111]
ds_read_b128 v[136:139], v4 offset:2048
v_mfma_f32_32x32x16_bf16 v[112:127], a[112:115], v[156:159], v[112:127]
ds_read_b128 v[140:143], v4 offset:3072
s_waitcnt vmcnt(15) lgkmcnt(4)
v_mfma_f32_32x32x16_bf16 v[64:79], a[116:119], v[160:163], v[64:79]
ds_read_b128 v[144:147], v4 offset:4096
v_mfma_f32_32x32x16_bf16 v[80:95], a[116:119], v[164:167], v[80:95]
ds_read_b128 v[148:151], v4 offset:5120
v_mfma_f32_32x32x16_bf16 v[96:111], a[116:119], v[168:171], v[96:111]
ds_read_b128 v[152:155], v4 offset:6144
v_mfma_f32_32x32x16_bf16 v[112:127], a[116:119], v[172:175], v[112:127]
ds_read_b128 v[156:159], v4 offset:7168
s_waitcnt vmcnt(14) lgkmcnt(4)
v_mfma_f32_32x32x16_bf16 v[64:79], a[120:123], v[128:131], v[64:79]
ds_read_b128 v[160:163], v4 offset:8192
v_mfma_f32_32x32x16_bf16 v[80:95], a[120:123], v[132:135], v[80:95]
ds_read_b128 v[164:167], v4 offset:9216
v_mfma_f32_32x32x16_bf16 v[96:111], a[120:123], v[136:139], v[96:111]
ds_read_b128 v[168:171], v4 offset:10240
v_mfma_f32_32x32x16_bf16 v[112:127], a[120:123], v[140:143], v[112:127]
ds_read_b128 v[172:175], v4 offset:11264
s_waitcnt vmcnt(13) lgkmcnt(4)
v_mfma_f32_32x32x16_bf16 v[64:79], a[124:127], v[144:147], v[64:79]
ds_read_b128 v[128:131], v4 offset:12288
v_mfma_f32_32x32x16_bf16 v[80:95], a[124:127], v[148:151], v[80:95]
ds_read_b128 v[132:135], v4 offset:13312
v_mfma_f32_32x32x16_bf16 v[96:111], a[124:127], v[152:155], v[96:111]
ds_read_b128 v[136:139], v4 offset:14336
v_mfma_f32_32x32x16_bf16 v[112:127], a[124:127], v[156:159], v[112:127]
ds_read_b128 v[140:143], v4 offset:15360
s_waitcnt vmcnt(12) lgkmcnt(4)
v_mfma_f32_32x32x16_bf16 v[64:79], a[128:131], v[160:163], v[64:79]
ds_read_b128 v[144:147], v4 offset:16384
v_mfma_f32_32x32x16_bf16 v[80:95], a[128:131], v[164:167], v[80:95]
ds_read_b128 v[148:151], v4 offset:17408
v_mfma_f32_32x32x16_bf16 v[96:111], a[128:131], v[168:171], v[96:111]
ds_read_b128 v[152:155], v4 offset:18432
v_mfma_f32_32x32x16_bf16 v[112:127], a[128:131], v[172:175], v[112:127]
ds_read_b128 v[156:159], v4 offset:19456
s_waitcnt vmcnt(11) lgkmcnt(4)
v_mfma_f32_32x32x16_bf16 v[64:79], a[132:135], v[128:131], v[64:79]
ds_read_b128 v[160:163], v4 offset:20480
v_mfma_f32_32x32x16_bf16 v[80:95], a[132:135], v[132:135], v[80:95]
ds_read_b128 v[164:167], v4 offset:21504
v_mfma_f32_32x32x16_bf16 v[96:111], a[132:135], v[136:139], v[96:111]
ds_read_b128 v[168:171], v4 offset:22528
v_mfma_f32_32x32x16_bf16 v[112:127], a[132:135], v[140:143], v[112:127]
ds_read_b128 v[172:175], v4 offset:23552
s_waitcnt vmcnt(10) lgkmcnt(4)
v_mfma_f32_32x32x16_bf16 v[64:79], a[136:139], v[144:147], v[64:79]
v_mfma_f32_32x32x16_bf16 v[80:95], a[136:139], v[148:151], v[80:95]
v_mfma_f32_32x32x16_bf16 v[96:111], a[136:139], v[152:155], v[96:111]
v_mfma_f32_32x32x16_bf16 v[112:127], a[136:139], v[156:159], v[112:127]
s_waitcnt vmcnt(9) lgkmcnt(0)
v_mfma_f32_32x32x16_bf16 v[64:79], a[140:143], v[160:163], v[64:79]
v_mfma_f32_32x32x16_bf16 v[80:95], a[140:143], v[164:167], v[80:95]
v_mfma_f32_32x32x16_bf16 v[96:111], a[140:143], v[168:171], v[96:111]
v_mfma_f32_32x32x16_bf16 v[112:127], a[140:143], v[172:175], v[112:127]
v_cvt_pk_bf16_f32 v16, v64, v65
v_cvt_pk_bf16_f32 v17, v66, v67
v_cvt_pk_bf16_f32 v18, v68, v69
v_cvt_pk_bf16_f32 v19, v70, v71
buffer_store_dwordx4 v[16:19], v2, s[4:7], s31 offen offset:0 sc1
v_cvt_pk_bf16_f32 v20, v72, v73
v_cvt_pk_bf16_f32 v21, v74, v75
v_cvt_pk_bf16_f32 v22, v76, v77
v_cvt_pk_bf16_f32 v23, v78, v79
buffer_store_dwordx4 v[20:23], v2, s[4:7], s31 offen offset:1024 sc1
v_cvt_pk_bf16_f32 v24, v80, v81
v_cvt_pk_bf16_f32 v25, v82, v83
v_cvt_pk_bf16_f32 v26, v84, v85
v_cvt_pk_bf16_f32 v27, v86, v87
buffer_store_dwordx4 v[24:27], v2, s[4:7], s31 offen offset:2048 sc1
v_cvt_pk_bf16_f32 v28, v88, v89
v_cvt_pk_bf16_f32 v29, v90, v91
v_cvt_pk_bf16_f32 v30, v92, v93
v_cvt_pk_bf16_f32 v31, v94, v95
buffer_store_dwordx4 v[28:31], v2, s[4:7], s31 offen offset:3072 sc1
v_cvt_pk_bf16_f32 v16, v96, v97
v_cvt_pk_bf16_f32 v17, v98, v99
v_cvt_pk_bf16_f32 v18, v100, v101
v_cvt_pk_bf16_f32 v19, v102, v103
s_add_u32 s37, s31, 4096
buffer_store_dwordx4 v[16:19], v2, s[4:7], s37 offen offset:0 sc1
v_cvt_pk_bf16_f32 v20, v104, v105
v_cvt_pk_bf16_f32 v21, v106, v107
v_cvt_pk_bf16_f32 v22, v108, v109
v_cvt_pk_bf16_f32 v23, v110, v111
buffer_store_dwordx4 v[20:23], v2, s[4:7], s37 offen offset:1024 sc1
v_cvt_pk_bf16_f32 v24, v112, v113
v_cvt_pk_bf16_f32 v25, v114, v115
v_cvt_pk_bf16_f32 v26, v116, v117
v_cvt_pk_bf16_f32 v27, v118, v119
buffer_store_dwordx4 v[24:27], v2, s[4:7], s37 offen offset:2048 sc1
v_cvt_pk_bf16_f32 v28, v120, v121
v_cvt_pk_bf16_f32 v29, v122, v123
v_cvt_pk_bf16_f32 v30, v124, v125
v_cvt_pk_bf16_f32 v31, v126, v127
buffer_store_dwordx4 v[28:31], v2, s[4:7], s37 offen offset:3072 sc1
s_waitcnt vmcnt(8)
s_mov_b32 s39, s29
s_add_u32 s28, s28, 0x80
s_add_u32 s29, s29, 0x80
s_add_u32 s30, s30, 0x12000
s_add_u32 s31, s31, 0x40000
s_add_u32 s23, s23, 2
s_cmp_lt_u32 s23, 64
s_cbranch_scc1 L_aqv_top
s_waitcnt vmcnt(0)
s_mov_b64 exec, 1
v_mov_b32 v13, 1
buffer_atomic_add v13, off, s[4:7], s39 sc1
s_mov_b64 exec, -1
s_waitcnt vmcnt(0)
s_branch L_END
L_aq_x:
v_mul_u32_u24 v10, 36, v8
v_add_u32 v10, v10, v11
v_add_u32 v10, 32, v10
s_cmp_eq_u32 s21, 14
s_cbranch_scc1 L_aq_xv
s_sub_u32 s60, s21, 12
s_mul_i32 s3, s60, 1152
v_add_u32 v10, s3, v10
s_mov_b32 s90, 0
L_w_86:
s_mul_i32 s34, s90, 36
s_add_u32 s34, s34, s20
s_mov_b32 s64, s34
s_mul_i32 s35, s34, 55296
s_add_u32 s36, s35, 0
buffer_load_dword v16, v10, s[8:11], s36 offen
s_add_u32 s36, s35, 3456
buffer_load_dword v17, v10, s[8:11], s36 offen
s_add_u32 s36, s35, 6912
buffer_load_dword v18, v10, s[8:11], s36 offen
s_add_u32 s36, s35, 10368
buffer_load_dword v19, v10, s[8:11], s36 offen
s_add_u32 s36, s35, 13824
buffer_load_dword v20, v10, s[8:11], s36 offen
s_add_u32 s36, s35, 17280
buffer_load_dword v21, v10, s[8:11], s36 offen
s_add_u32 s36, s35, 20736
buffer_load_dword v22, v10, s[8:11], s36 offen
s_add_u32 s36, s35, 24192
buffer_load_dword v23, v10, s[8:11], s36 offen
s_mul_i32 s34, s90, 36
s_add_u32 s34, s34, s20
s_add_u32 s34, s34, 4
s_mov_b32 s65, s34
s_mul_i32 s35, s34, 55296
s_add_u32 s36, s35, 0
buffer_load_dword v24, v10, s[8:11], s36 offen
s_add_u32 s36, s35, 3456
buffer_load_dword v25, v10, s[8:11], s36 offen
s_add_u32 s36, s35, 6912
buffer_load_dword v26, v10, s[8:11], s36 offen
s_add_u32 s36, s35, 10368
buffer_load_dword v27, v10, s[8:11], s36 offen
s_add_u32 s36, s35, 13824
buffer_load_dword v28, v10, s[8:11], s36 offen
s_add_u32 s36, s35, 17280
buffer_load_dword v29, v10, s[8:11], s36 offen
s_add_u32 s36, s35, 20736
buffer_load_dword v30, v10, s[8:11], s36 offen
s_add_u32 s36, s35, 24192
buffer_load_dword v31, v10, s[8:11], s36 offen
s_mul_i32 s34, s90, 36
s_add_u32 s34, s34, s20
s_add_u32 s34, s34, 8
s_mov_b32 s66, s34
s_mul_i32 s35, s34, 55296
s_add_u32 s36, s35, 0
buffer_load_dword v32, v10, s[8:11], s36 offen
s_add_u32 s36, s35, 3456
buffer_load_dword v33, v10, s[8:11], s36 offen
s_add_u32 s36, s35, 6912
buffer_load_dword v34, v10, s[8:11], s36 offen
s_add_u32 s36, s35, 10368
buffer_load_dword v35, v10, s[8:11], s36 offen
s_add_u32 s36, s35, 13824
buffer_load_dword v36, v10, s[8:11], s36 offen
s_add_u32 s36, s35, 17280
buffer_load_dword v37, v10, s[8:11], s36 offen
s_add_u32 s36, s35, 20736
buffer_load_dword v38, v10, s[8:11], s36 offen
s_add_u32 s36, s35, 24192
buffer_load_dword v39, v10, s[8:11], s36 offen
s_mul_i32 s34, s90, 36
s_add_u32 s34, s34, s20
s_add_u32 s34, s34, 12
s_mov_b32 s67, s34
s_mul_i32 s35, s34, 55296
s_add_u32 s36, s35, 0
buffer_load_dword v40, v10, s[8:11], s36 offen
s_add_u32 s36, s35, 3456
buffer_load_dword v41, v10, s[8:11], s36 offen
s_add_u32 s36, s35, 6912
buffer_load_dword v42, v10, s[8:11], s36 offen
s_add_u32 s36, s35, 10368
buffer_load_dword v43, v10, s[8:11], s36 offen
s_add_u32 s36, s35, 13824
buffer_load_dword v44, v10, s[8:11], s36 offen
s_add_u32 s36, s35, 17280
buffer_load_dword v45, v10, s[8:11], s36 offen
s_add_u32 s36, s35, 20736
buffer_load_dword v46, v10, s[8:11], s36 offen
s_add_u32 s36, s35, 24192
buffer_load_dword v47, v10, s[8:11], s36 offen
s_mul_i32 s34, s90, 36
s_add_u32 s34, s34, s20
s_add_u32 s34, s34, 16
s_mov_b32 s68, s34
s_mul_i32 s35, s34, 55296
s_add_u32 s36, s35, 0
buffer_load_dword v48, v10, s[8:11], s36 offen
s_add_u32 s36, s35, 3456
buffer_load_dword v49, v10, s[8:11], s36 offen
s_add_u32 s36, s35, 6912
buffer_load_dword v50, v10, s[8:11], s36 offen
s_add_u32 s36, s35, 10368
buffer_load_dword v51, v10, s[8:11], s36 offen
s_add_u32 s36, s35, 13824
buffer_load_dword v52, v10, s[8:11], s36 offen
s_add_u32 s36, s35, 17280
buffer_load_dword v53, v10, s[8:11], s36 offen
s_add_u32 s36, s35, 20736
buffer_load_dword v54, v10, s[8:11], s36 offen
s_add_u32 s36, s35, 24192
buffer_load_dword v55, v10, s[8:11], s36 offen
s_mul_i32 s34, s90, 36
s_add_u32 s34, s34, s20
s_add_u32 s34, s34, 20
s_mov_b32 s69, s34
s_mul_i32 s35, s34, 55296
s_add_u32 s36, s35, 0
buffer_load_dword v56, v10, s[8:11], s36 offen
s_add_u32 s36, s35, 3456
buffer_load_dword v57, v10, s[8:11], s36 offen
s_add_u32 s36, s35, 6912
buffer_load_dword v58, v10, s[8:11], s36 offen
s_add_u32 s36, s35, 10368
buffer_load_dword v59, v10, s[8:11], s36 offen
s_add_u32 s36, s35, 13824
buffer_load_dword v60, v10, s[8:11], s36 offen
s_add_u32 s36, s35, 17280
buffer_load_dword v61, v10, s[8:11], s36 offen
s_add_u32 s36, s35, 20736
buffer_load_dword v62, v10, s[8:11], s36 offen
s_add_u32 s36, s35, 24192
buffer_load_dword v63, v10, s[8:11], s36 offen
s_mul_i32 s34, s90, 36
s_add_u32 s34, s34, s20
s_add_u32 s34, s34, 24
s_mov_b32 s70, s34
s_mul_i32 s35, s34, 55296
s_add_u32 s36, s35, 0
buffer_load_dword v64, v10, s[8:11], s36 offen
s_add_u32 s36, s35, 3456
buffer_load_dword v65, v10, s[8:11], s36 offen
s_add_u32 s36, s35, 6912
buffer_load_dword v66, v10, s[8:11], s36 offen
s_add_u32 s36, s35, 10368
buffer_load_dword v67, v10, s[8:11], s36 offen
s_add_u32 s36, s35, 13824
buffer_load_dword v68, v10, s[8:11], s36 offen
s_add_u32 s36, s35, 17280
buffer_load_dword v69, v10, s[8:11], s36 offen
s_add_u32 s36, s35, 20736
buffer_load_dword v70, v10, s[8:11], s36 offen
s_add_u32 s36, s35, 24192
buffer_load_dword v71, v10, s[8:11], s36 offen
s_mul_i32 s34, s90, 36
s_add_u32 s34, s34, s20
s_add_u32 s34, s34, 28
s_mov_b32 s71, s34
s_mul_i32 s35, s34, 55296
s_add_u32 s36, s35, 0
buffer_load_dword v72, v10, s[8:11], s36 offen
s_add_u32 s36, s35, 3456
buffer_load_dword v73, v10, s[8:11], s36 offen
s_add_u32 s36, s35, 6912
buffer_load_dword v74, v10, s[8:11], s36 offen
s_add_u32 s36, s35, 10368
buffer_load_dword v75, v10, s[8:11], s36 offen
s_add_u32 s36, s35, 13824
buffer_load_dword v76, v10, s[8:11], s36 offen
s_add_u32 s36, s35, 17280
buffer_load_dword v77, v10, s[8:11], s36 offen
s_add_u32 s36, s35, 20736
buffer_load_dword v78, v10, s[8:11], s36 offen
s_add_u32 s36, s35, 24192
buffer_load_dword v79, v10, s[8:11], s36 offen
s_mul_i32 s34, s90, 36
s_add_u32 s34, s34, s20
s_add_u32 s34, s34, 32
s_mov_b32 s72, s34
s_mul_i32 s35, s34, 55296
s_add_u32 s36, s35, 0
buffer_load_dword v80, v10, s[8:11], s36 offen
s_add_u32 s36, s35, 3456
buffer_load_dword v81, v10, s[8:11], s36 offen
s_add_u32 s36, s35, 6912
buffer_load_dword v82, v10, s[8:11], s36 offen
s_add_u32 s36, s35, 10368
buffer_load_dword v83, v10, s[8:11], s36 offen
s_add_u32 s36, s35, 13824
buffer_load_dword v84, v10, s[8:11], s36 offen
s_add_u32 s36, s35, 17280
buffer_load_dword v85, v10, s[8:11], s36 offen
s_add_u32 s36, s35, 20736
buffer_load_dword v86, v10, s[8:11], s36 offen
s_add_u32 s36, s35, 24192
buffer_load_dword v87, v10, s[8:11], s36 offen
s_waitcnt vmcnt(63)
s_mul_i32 s3, s64, 2048
v_add_u32 v15, s3, v2
v_perm_b32 v88, v17, v16, s32
v_perm_b32 v89, v19, v18, s32
v_perm_b32 v90, v21, v20, s32
v_perm_b32 v91, v23, v22, s32
ds_write_b128 v15, v[88:91] offset:0
v_perm_b32 v92, v17, v16, s33
v_perm_b32 v93, v19, v18, s33
v_perm_b32 v94, v21, v20, s33
v_perm_b32 v95, v23, v22, s33
ds_write_b128 v15, v[92:95] offset:1024
s_waitcnt lgkmcnt(0)
s_waitcnt vmcnt(56)
s_mul_i32 s3, s65, 2048
v_add_u32 v15, s3, v2
v_perm_b32 v88, v25, v24, s32
v_perm_b32 v89, v27, v26, s32
v_perm_b32 v90, v29, v28, s32
v_perm_b32 v91, v31, v30, s32
ds_write_b128 v15, v[88:91] offset:0
v_perm_b32 v92, v25, v24, s33
v_perm_b32 v93, v27, v26, s33
v_perm_b32 v94, v29, v28, s33
v_perm_b32 v95, v31, v30, s33
ds_write_b128 v15, v[92:95] offset:1024
s_waitcnt lgkmcnt(0)
s_waitcnt vmcnt(48)
s_mul_i32 s3, s66, 2048
v_add_u32 v15, s3, v2
v_perm_b32 v88, v33, v32, s32
v_perm_b32 v89, v35, v34, s32
v_perm_b32 v90, v37, v36, s32
v_perm_b32 v91, v39, v38, s32
ds_write_b128 v15, v[88:91] offset:0
v_perm_b32 v92, v33, v32, s33
v_perm_b32 v93, v35, v34, s33
v_perm_b32 v94, v37, v36, s33
v_perm_b32 v95, v39, v38, s33
ds_write_b128 v15, v[92:95] offset:1024
s_waitcnt lgkmcnt(0)
s_waitcnt vmcnt(40)
s_mul_i32 s3, s67, 2048
v_add_u32 v15, s3, v2
v_perm_b32 v88, v41, v40, s32
v_perm_b32 v89, v43, v42, s32
v_perm_b32 v90, v45, v44, s32
v_perm_b32 v91, v47, v46, s32
ds_write_b128 v15, v[88:91] offset:0
v_perm_b32 v92, v41, v40, s33
v_perm_b32 v93, v43, v42, s33
v_perm_b32 v94, v45, v44, s33
v_perm_b32 v95, v47, v46, s33
ds_write_b128 v15, v[92:95] offset:1024
s_waitcnt lgkmcnt(0)
s_waitcnt vmcnt(32)
s_mul_i32 s3, s68, 2048
v_add_u32 v15, s3, v2
v_perm_b32 v88, v49, v48, s32
v_perm_b32 v89, v51, v50, s32
v_perm_b32 v90, v53, v52, s32
v_perm_b32 v91, v55, v54, s32
ds_write_b128 v15, v[88:91] offset:0
v_perm_b32 v92, v49, v48, s33
v_perm_b32 v93, v51, v50, s33
v_perm_b32 v94, v53, v52, s33
v_perm_b32 v95, v55, v54, s33
ds_write_b128 v15, v[92:95] offset:1024
s_waitcnt lgkmcnt(0)
s_waitcnt vmcnt(24)
s_mul_i32 s3, s69, 2048
v_add_u32 v15, s3, v2
v_perm_b32 v88, v57, v56, s32
v_perm_b32 v89, v59, v58, s32
v_perm_b32 v90, v61, v60, s32
v_perm_b32 v91, v63, v62, s32
ds_write_b128 v15, v[88:91] offset:0
v_perm_b32 v92, v57, v56, s33
v_perm_b32 v93, v59, v58, s33
v_perm_b32 v94, v61, v60, s33
v_perm_b32 v95, v63, v62, s33
ds_write_b128 v15, v[92:95] offset:1024
s_waitcnt lgkmcnt(0)
s_waitcnt vmcnt(16)
s_mul_i32 s3, s70, 2048
v_add_u32 v15, s3, v2
v_perm_b32 v88, v65, v64, s32
v_perm_b32 v89, v67, v66, s32
v_perm_b32 v90, v69, v68, s32
v_perm_b32 v91, v71, v70, s32
ds_write_b128 v15, v[88:91] offset:0
v_perm_b32 v92, v65, v64, s33
v_perm_b32 v93, v67, v66, s33
v_perm_b32 v94, v69, v68, s33
v_perm_b32 v95, v71, v70, s33
ds_write_b128 v15, v[92:95] offset:1024
s_waitcnt lgkmcnt(0)
s_waitcnt vmcnt(8)
s_mul_i32 s3, s71, 2048
v_add_u32 v15, s3, v2
v_perm_b32 v88, v73, v72, s32
v_perm_b32 v89, v75, v74, s32
v_perm_b32 v90, v77, v76, s32
v_perm_b32 v91, v79, v78, s32
ds_write_b128 v15, v[88:91] offset:0
v_perm_b32 v92, v73, v72, s33
v_perm_b32 v93, v75, v74, s33
v_perm_b32 v94, v77, v76, s33
v_perm_b32 v95, v79, v78, s33
ds_write_b128 v15, v[92:95] offset:1024
s_waitcnt lgkmcnt(0)
s_waitcnt vmcnt(0)
s_mul_i32 s3, s72, 2048
v_add_u32 v15, s3, v2
v_perm_b32 v88, v81, v80, s32
v_perm_b32 v89, v83, v82, s32
v_perm_b32 v90, v85, v84, s32
v_perm_b32 v91, v87, v86, s32
ds_write_b128 v15, v[88:91] offset:0
v_perm_b32 v92, v81, v80, s33
v_perm_b32 v93, v83, v82, s33
v_perm_b32 v94, v85, v84, s33
v_perm_b32 v95, v87, v86, s33
ds_write_b128 v15, v[92:95] offset:1024
s_waitcnt lgkmcnt(0)
s_add_u32 s90, s90, 1
s_cmp_lt_u32 s90, 1
s_cbranch_scc1 L_w_86
s_cmp_eq_u32 s60, 0
s_cselect_b32 s38, s38, 1.0
s_lshr_b32 s22, s20, 1
s_and_b32 s23, s20, 1
s_mov_b32 s28, 0x0
s_mul_i32 s3, s22, 0x2000
s_add_u32 s28, s28, s3
s_mul_i32 s3, s23, 0x40
s_add_u32 s28, s28, s3
s_mov_b32 s29, 0x4000
s_mul_i32 s3, s22, 0x1000
s_add_u32 s29, s29, s3
s_mul_i32 s3, s23, 0x40
s_add_u32 s29, s29, s3
s_mov_b32 s30, 0x500000
s_mul_i32 s3, s22, 0x480000
s_add_u32 s30, s30, s3
s_mul_i32 s3, s23, 0x9000
s_add_u32 s30, s30, s3
s_mov_b32 s31, 0x2018000
s_mul_i32 s3, s22, 0x800000
s_add_u32 s31, s31, s3
s_mul_i32 s3, s23, 0x20000
s_add_u32 s31, s31, s3
s_mul_i32 s3, s60, 0x1000
s_add_u32 s31, s31, s3
s_mov_b32 s39, 0x7fff0000
s_mov_b32 s85, 0
s_waitcnt vmcnt(0) lgkmcnt(0)
s_cmp_lg_u32 s20, 0
s_cbranch_scc1 L_walld_88
s_mov_b32 s91, 0
L_wall_87:
buffer_load_dword v15, off, s[16:19], 0 sc1
s_add_u32 s91, s91, 1
s_cmp_gt_u32 s91, 200000
s_cbranch_scc1 L_FAIL
s_waitcnt vmcnt(0)
v_cmp_gt_u32 vcc, 32, v15
s_nop 0
s_nop 2
s_cbranch_vccz L_walld_88
s_sleep 4
s_branch L_wall_87
L_walld_88:
s_barrier
L_aqx_top:
s_cmp_lg_u32 s85, 0
s_cbranch_scc1 L_warm_89
buffer_load_dword v15, off, s[4:7], s28 sc1
s_mov_b32 s91, 0
s_waitcnt vmcnt(0)
s_mov_b64 exec, 1
v_mov_b32 v13, 1
buffer_atomic_add v13, off, s[4:7], s39 sc1
s_mov_b64 exec, -1
v_cmp_gt_u32 vcc, 4, v15
s_nop 0
s_nop 2
s_cbranch_vccz L_spd_91
L_sp_90:
buffer_load_dword v15, off, s[4:7], s28 sc1
s_add_u32 s91, s91, 1
s_cmp_gt_u32 s91, 200000
s_cbranch_scc1 L_FAIL
s_waitcnt vmcnt(0)
v_cmp_gt_u32 vcc, 4, v15
s_nop 0
s_nop 2
s_cbranch_vccnz L_sp_90
L_spd_91:
s_mov_b32 s39, 0x7fff0000
s_add_u32 s27, s30, 0x0
buffer_load_dwordx4 a[0:3], v2, s[4:7], s27 offen offset:0
buffer_load_dwordx4 a[4:7], v2, s[4:7], s27 offen offset:1024
buffer_load_dwordx4 a[8:11], v2, s[4:7], s27 offen offset:2048
buffer_load_dwordx4 a[12:15], v2, s[4:7], s27 offen offset:3072
s_add_u32 s27, s30, 0x1000
buffer_load_dwordx4 a[16:19], v2, s[4:7], s27 offen offset:0
buffer_load_dwordx4 a[20:23], v2, s[4:7], s27 offen offset:1024
buffer_load_dwordx4 a[24:27], v2, s[4:7], s27 offen offset:2048
buffer_load_dwordx4 a[28:31], v2, s[4:7], s27 offen offset:3072
s_waitcnt vmcnt(0)
L_warm_89:
ds_read_b128 v[128:131], v2 offset:0
ds_read_b128 v[132:135], v2 offset:1024
ds_read_b128 v[136:139], v2 offset:2048
ds_read_b128 v[140:143], v2 offset:3072
s_waitcnt lgkmcnt(2)
v_mfma_f32_32x32x16_bf16 v[64:79], v[128:131], a[0:3], 0
ds_read_b128 v[144:147], v2 offset:4096
s_add_u32 s27, s30, 8192
buffer_load_dwordx4 a[32:35], v2, s[4:7], s27 offen offset:0
v_mfma_f32_32x32x16_bf16 v[80:95], v[132:135], a[0:3], 0
ds_read_b128 v[148:151], v2 offset:5120
buffer_load_dwordx4 a[36:39], v2, s[4:7], s27 offen offset:1024
s_waitcnt lgkmcnt(2)
v_mfma_f32_32x32x16_bf16 v[64:79], v[136:139], a[4:7], v[64:79]
ds_read_b128 v[128:131], v2 offset:6144
buffer_load_dwordx4 a[40:43], v2, s[4:7], s27 offen offset:2048
v_mfma_f32_32x32x16_bf16 v[80:95], v[140:143], a[4:7], v[80:95]
ds_read_b128 v[132:135], v2 offset:7168
buffer_load_dwordx4 a[44:47], v2, s[4:7], s27 offen offset:3072
s_waitcnt lgkmcnt(2)
v_mfma_f32_32x32x16_bf16 v[64:79], v[144:147], a[8:11], v[64:79]
ds_read_b128 v[136:139], v2 offset:8192
s_add_u32 s27, s30, 12288
buffer_load_dwordx4 a[48:51], v2, s[4:7], s27 offen offset:0
v_mfma_f32_32x32x16_bf16 v[80:95], v[148:151], a[8:11], v[80:95]
ds_read_b128 v[140:143], v2 offset:9216
buffer_load_dwordx4 a[52:55], v2, s[4:7], s27 offen offset:1024
s_waitcnt lgkmcnt(2)
v_mfma_f32_32x32x16_bf16 v[64:79], v[128:131], a[12:15], v[64:79]
ds_read_b128 v[144:147], v2 offset:10240
buffer_load_dwordx4 a[56:59], v2, s[4:7], s27 offen offset:2048
v_mfma_f32_32x32x16_bf16 v[80:95], v[132:135], a[12:15], v[80:95]
ds_read_b128 v[148:151], v2 offset:11264
buffer_load_dwordx4 a[60:63], v2, s[4:7], s27 offen offset:3072
s_waitcnt lgkmcnt(2)
v_mfma_f32_32x32x16_bf16 v[64:79], v[136:139], a[16:19], v[64:79]
ds_read_b128 v[128:131], v2 offset:12288
s_add_u32 s27, s30, 16384
buffer_load_dwordx4 a[64:67], v2, s[4:7], s27 offen offset:0
v_mfma_f32_32x32x16_bf16 v[80:95], v[140:143], a[16:19], v[80:95]
ds_read_b128 v[132:135], v2 offset:13312
buffer_load_dwordx4 a[68:71], v2, s[4:7], s27 offen offset:1024
s_waitcnt lgkmcnt(2)
v_mfma_f32_32x32x16_bf16 v[64:79], v[144:147], a[20:23], v[64:79]
ds_read_b128 v[136:139], v2 offset:14336
buffer_load_dwordx4 a[72:75], v2, s[4:7], s27 offen offset:2048
v_mfma_f32_32x32x16_bf16 v[80:95], v[148:151], a[20:23], v[80:95]
ds_read_b128 v[140:143], v2 offset:15360
buffer_load_dwordx4 a[76:79], v2, s[4:7], s27 offen offset:3072
s_waitcnt lgkmcnt(2)
v_mfma_f32_32x32x16_bf16 v[64:79], v[128:131], a[24:27], v[64:79]
ds_read_b128 v[144:147], v2 offset:16384
s_add_u32 s27, s30, 20480
buffer_load_dwordx4 a[80:83], v2, s[4:7], s27 offen offset:0
v_mfma_f32_32x32x16_bf16 v[80:95], v[132:135], a[24:27], v[80:95]
ds_read_b128 v[148:151], v2 offset:17408
buffer_load_dwordx4 a[84:87], v2, s[4:7], s27 offen offset:1024
s_waitcnt lgkmcnt(2)
v_mfma_f32_32x32x16_bf16 v[64:79], v[136:139], a[28:31], v[64:79]
ds_read_b128 v[128:131], v2 offset:18432
buffer_load_dwordx4 a[88:91], v2, s[4:7], s27 offen offset:2048
v_mfma_f32_32x32x16_bf16 v[80:95], v[140:143], a[28:31], v[80:95]
ds_read_b128 v[132:135], v2 offset:19456
buffer_load_dwordx4 a[92:95], v2, s[4:7], s27 offen offset:3072
s_waitcnt vmcnt(15) lgkmcnt(2)
v_mfma_f32_32x32x16_bf16 v[64:79], v[144:147], a[32:35], v[64:79]
ds_read_b128 v[136:139], v2 offset:20480
s_add_u32 s27, s30, 24576
buffer_load_dwordx4 a[96:99], v2, s[4:7], s27 offen offset:0
s_mov_b64 exec, 1
v_mov_b32 v13, 1
buffer_atomic_add v13, off, s[4:7], s39 sc1
s_mov_b64 exec, -1
v_mfma_f32_32x32x16_bf16 v[80:95], v[148:151], a[32:35], v[80:95]
ds_read_b128 v[140:143], v2 offset:21504
buffer_load_dwordx4 a[100:103], v2, s[4:7], s27 offen offset:1024
s_waitcnt vmcnt(17) lgkmcnt(2)
v_mfma_f32_32x32x16_bf16 v[64:79], v[128:131], a[36:39], v[64:79]
ds_read_b128 v[144:147], v2 offset:22528
buffer_load_dwordx4 a[104:107], v2, s[4:7], s27 offen offset:2048
v_mfma_f32_32x32x16_bf16 v[80:95], v[132:135], a[36:39], v[80:95]
ds_read_b128 v[148:151], v2 offset:23552
buffer_load_dwordx4 a[108:111], v2, s[4:7], s27 offen offset:3072
s_waitcnt vmcnt(18) lgkmcnt(2)
v_mfma_f32_32x32x16_bf16 v[64:79], v[136:139], a[40:43], v[64:79]
ds_read_b128 v[128:131], v2 offset:24576
s_add_u32 s27, s30, 28672
buffer_load_dwordx4 a[112:115], v2, s[4:7], s27 offen offset:0
v_mfma_f32_32x32x16_bf16 v[80:95], v[140:143], a[40:43], v[80:95]
ds_read_b128 v[132:135], v2 offset:25600
buffer_load_dwordx4 a[116:119], v2, s[4:7], s27 offen offset:1024
s_waitcnt vmcnt(19) lgkmcnt(2)
v_mfma_f32_32x32x16_bf16 v[64:79], v[144:147], a[44:47], v[64:79]
ds_read_b128 v[136:139], v2 offset:26624
buffer_load_dwordx4 a[120:123], v2, s[4:7], s27 offen offset:2048
v_mfma_f32_32x32x16_bf16 v[80:95], v[148:151], a[44:47], v[80:95]
ds_read_b128 v[140:143], v2 offset:27648
buffer_load_dwordx4 a[124:127], v2, s[4:7], s27 offen offset:3072
s_waitcnt vmcnt(20) lgkmcnt(2)
v_mfma_f32_32x32x16_bf16 v[64:79], v[128:131], a[48:51], v[64:79]
ds_read_b128 v[144:147], v2 offset:28672
s_add_u32 s27, s30, 32768
buffer_load_dwordx4 a[128:131], v2, s[4:7], s27 offen offset:0
v_mfma_f32_32x32x16_bf16 v[80:95], v[132:135], a[48:51], v[80:95]
ds_read_b128 v[148:151], v2 offset:29696
buffer_load_dwordx4 a[132:135], v2, s[4:7], s27 offen offset:1024
s_waitcnt vmcnt(21) lgkmcnt(2)
v_mfma_f32_32x32x16_bf16 v[64:79], v[136:139], a[52:55], v[64:79]
ds_read_b128 v[128:131], v2 offset:30720
buffer_load_dwordx4 a[136:139], v2, s[4:7], s27 offen offset:2048
v_mfma_f32_32x32x16_bf16 v[80:95], v[140:143], a[52:55], v[80:95]
ds_read_b128 v[132:135], v2 offset:31744
buffer_load_dwordx4 a[140:143], v2, s[4:7], s27 offen offset:3072
s_waitcnt vmcnt(22) lgkmcnt(2)
v_mfma_f32_32x32x16_bf16 v[64:79], v[144:147], a[56:59], v[64:79]
ds_read_b128 v[136:139], v2 offset:32768
v_mfma_f32_32x32x16_bf16 v[80:95], v[148:151], a[56:59], v[80:95]
ds_read_b128 v[140:143], v2 offset:33792
s_waitcnt vmcnt(21) lgkmcnt(2)
v_mfma_f32_32x32x16_bf16 v[64:79], v[128:131], a[60:63], v[64:79]
ds_read_b128 v[144:147], v2 offset:34816
v_mfma_f32_32x32x16_bf16 v[80:95], v[132:135], a[60:63], v[80:95]
ds_read_b128 v[148:151], v2 offset:35840
s_waitcnt vmcnt(20) lgkmcnt(2)
v_mfma_f32_32x32x16_bf16 v[64:79], v[136:139], a[64:67], v[64:79]
ds_read_b128 v[128:131], v2 offset:36864
v_mfma_f32_32x32x16_bf16 v[80:95], v[140:143], a[64:67], v[80:95]
ds_read_b128 v[132:135], v2 offset:37888
s_add_u32 s3, s28, 0x80
buffer_load_dword v14, off, s[4:7], s3 sc1
s_waitcnt vmcnt(20) lgkmcnt(2)
v_mfma_f32_32x32x16_bf16 v[64:79], v[144:147], a[68:71], v[64:79]
ds_read_b128 v[136:139], v2 offset:38912
v_mfma_f32_32x32x16_bf16 v[80:95], v[148:151], a[68:71], v[80:95]
ds_read_b128 v[140:143], v2 offset:39936
s_waitcnt vmcnt(19) lgkmcnt(2)
v_mfma_f32_32x32x16_bf16 v[64:79], v[128:131], a[72:75], v[64:79]
ds_read_b128 v[144:147], v2 offset:40960
v_mfma_f32_32x32x16_bf16 v[80:95], v[132:135], a[72:75], v[80:95]
ds_read_b128 v[148:151], v2 offset:41984
s_waitcnt vmcnt(18) lgkmcnt(2)
v_mfma_f32_32x32x16_bf16 v[64:79], v[136:139], a[76:79], v[64:79]
ds_read_b128 v[128:131], v2 offset:43008
v_mfma_f32_32x32x16_bf16 v[80:95], v[140:143], a[76:79], v[80:95]
ds_read_b128 v[132:135], v2 offset:44032
s_waitcnt vmcnt(17) lgkmcnt(2)
v_mfma_f32_32x32x16_bf16 v[64:79], v[144:147], a[80:83], v[64:79]
ds_read_b128 v[136:139], v2 offset:45056
v_mfma_f32_32x32x16_bf16 v[80:95], v[148:151], a[80:83], v[80:95]
ds_read_b128 v[140:143], v2 offset:46080
s_waitcnt vmcnt(16) lgkmcnt(2)
v_mfma_f32_32x32x16_bf16 v[64:79], v[128:131], a[84:87], v[64:79]
ds_read_b128 v[144:147], v2 offset:47104
v_mfma_f32_32x32x16_bf16 v[80:95], v[132:135], a[84:87], v[80:95]
ds_read_b128 v[148:151], v2 offset:48128
s_waitcnt vmcnt(15) lgkmcnt(2)
v_mfma_f32_32x32x16_bf16 v[64:79], v[136:139], a[88:91], v[64:79]
ds_read_b128 v[128:131], v2 offset:49152
v_mfma_f32_32x32x16_bf16 v[80:95], v[140:143], a[88:91], v[80:95]
ds_read_b128 v[132:135], v2 offset:50176
s_waitcnt vmcnt(14) lgkmcnt(2)
v_mfma_f32_32x32x16_bf16 v[64:79], v[144:147], a[92:95], v[64:79]
ds_read_b128 v[136:139], v2 offset:51200
v_mfma_f32_32x32x16_bf16 v[80:95], v[148:151], a[92:95], v[80:95]
ds_read_b128 v[140:143], v2 offset:52224
s_waitcnt vmcnt(13) lgkmcnt(2)
v_mfma_f32_32x32x16_bf16 v[64:79], v[128:131], a[96:99], v[64:79]
ds_read_b128 v[144:147], v2 offset:53248
v_mfma_f32_32x32x16_bf16 v[80:95], v[132:135], a[96:99], v[80:95]
ds_read_b128 v[148:151], v2 offset:54272
s_waitcnt vmcnt(11) lgkmcnt(2)
v_mfma_f32_32x32x16_bf16 v[64:79], v[136:139], a[100:103], v[64:79]
ds_read_b128 v[128:131], v2 offset:55296
v_mfma_f32_32x32x16_bf16 v[80:95], v[140:143], a[100:103], v[80:95]
ds_read_b128 v[132:135], v2 offset:56320
s_waitcnt vmcnt(10) lgkmcnt(2)
v_mfma_f32_32x32x16_bf16 v[64:79], v[144:147], a[104:107], v[64:79]
ds_read_b128 v[136:139], v2 offset:57344
v_mfma_f32_32x32x16_bf16 v[80:95], v[148:151], a[104:107], v[80:95]
ds_read_b128 v[140:143], v2 offset:58368
s_waitcnt vmcnt(9) lgkmcnt(2)
v_mfma_f32_32x32x16_bf16 v[64:79], v[128:131], a[108:111], v[64:79]
ds_read_b128 v[144:147], v2 offset:59392
v_mfma_f32_32x32x16_bf16 v[80:95], v[132:135], a[108:111], v[80:95]
ds_read_b128 v[148:151], v2 offset:60416
s_waitcnt vmcnt(8) lgkmcnt(2)
v_mfma_f32_32x32x16_bf16 v[64:79], v[136:139], a[112:115], v[64:79]
ds_read_b128 v[128:131], v3 offset:0
v_mfma_f32_32x32x16_bf16 v[80:95], v[140:143], a[112:115], v[80:95]
ds_read_b128 v[132:135], v3 offset:1024
s_waitcnt vmcnt(7) lgkmcnt(2)
v_mfma_f32_32x32x16_bf16 v[64:79], v[144:147], a[116:119], v[64:79]
ds_read_b128 v[136:139], v3 offset:2048
v_mfma_f32_32x32x16_bf16 v[80:95], v[148:151], a[116:119], v[80:95]
ds_read_b128 v[140:143], v3 offset:3072
s_waitcnt vmcnt(6) lgkmcnt(2)
v_mfma_f32_32x32x16_bf16 v[64:79], v[128:131], a[120:123], v[64:79]
ds_read_b128 v[144:147], v3 offset:4096
v_mfma_f32_32x32x16_bf16 v[80:95], v[132:135], a[120:123], v[80:95]
ds_read_b128 v[148:151], v3 offset:5120
s_waitcnt vmcnt(0)
v_cmp_le_u32 vcc, 4, v14
s_nop 3
s_and_b32 s85, vcc_lo, 1
s_cmp_lt_u32 s23, 62
s_cselect_b32 s85, s85, 0
s_add_u32 s86, s30, 0x12000
s_cmp_lg_u32 s85, 0
s_cselect_b32 s86, s86, 0x7fff0000
s_add_u32 s87, s86, 4096
s_waitcnt vmcnt(5) lgkmcnt(2)
v_mfma_f32_32x32x16_bf16 v[64:79], v[136:139], a[124:127], v[64:79]
ds_read_b128 v[128:131], v3 offset:6144
buffer_load_dwordx4 a[0:3], v2, s[4:7], s86 offen offset:0
v_mfma_f32_32x32x16_bf16 v[80:95], v[140:143], a[124:127], v[80:95]
ds_read_b128 v[132:135], v3 offset:7168
buffer_load_dwordx4 a[4:7], v2, s[4:7], s86 offen offset:1024
s_waitcnt vmcnt(6) lgkmcnt(2)
v_mfma_f32_32x32x16_bf16 v[64:79], v[144:147], a[128:131], v[64:79]
ds_read_b128 v[136:139], v3 offset:8192
buffer_load_dwordx4 a[8:11], v2, s[4:7], s86 offen offset:2048
v_mfma_f32_32x32x16_bf16 v[80:95], v[148:151], a[128:131], v[80:95]
ds_read_b128 v[140:143], v3 offset:9216
buffer_load_dwordx4 a[12:15], v2, s[4:7], s86 offen offset:3072
s_waitcnt vmcnt(7) lgkmcnt(2)
v_mfma_f32_32x32x16_bf16 v[64:79], v[128:131], a[132:135], v[64:79]
ds_read_b128 v[144:147], v3 offset:10240
buffer_load_dwordx4 a[16:19], v2, s[4:7], s87 offen offset:0
v_mfma_f32_32x32x16_bf16 v[80:95], v[132:135], a[132:135], v[80:95]
ds_read_b128 v[148:151], v3 offset:11264
buffer_load_dwordx4 a[20:23], v2, s[4:7], s87 offen offset:1024
s_waitcnt vmcnt(8) lgkmcnt(2)
v_mfma_f32_32x32x16_bf16 v[64:79], v[136:139], a[136:139], v[64:79]
buffer_load_dwordx4 a[24:27], v2, s[4:7], s87 offen offset:2048
v_mfma_f32_32x32x16_bf16 v[80:95], v[140:143], a[136:139], v[80:95]
buffer_load_dwordx4 a[28:31], v2, s[4:7], s87 offen offset:3072
s_waitcnt vmcnt(9) lgkmcnt(0)
v_mfma_f32_32x32x16_bf16 v[64:79], v[144:147], a[140:143], v[64:79]
v_mfma_f32_32x32x16_bf16 v[80:95], v[148:151], a[140:143], v[80:95]
s_nop 3
v_mul_f32 v64, s38, v64
s_nop 6
v_mul_f32 v80, s38, v80
v_cvt_pk_bf16_f32 v16, v64, v80
v_mul_f32 v65, s38, v65
v_mul_f32 v81, s38, v81
v_cvt_pk_bf16_f32 v17, v65, v81
v_mul_f32 v66, s38, v66
v_mul_f32 v82, s38, v82
v_cvt_pk_bf16_f32 v18, v66, v82
v_mul_f32 v67, s38, v67
v_mul_f32 v83, s38, v83
v_cvt_pk_bf16_f32 v19, v67, v83
buffer_store_dwordx4 v[16:19], v2, s[4:7], s31 offen offset:0 sc1
v_mul_f32 v68, s38, v68
v_mul_f32 v84, s38, v84
v_cvt_pk_bf16_f32 v20, v68, v84
v_mul_f32 v69, s38, v69
v_mul_f32 v85, s38, v85
v_cvt_pk_bf16_f32 v21, v69, v85
v_mul_f32 v70, s38, v70
v_mul_f32 v86, s38, v86
v_cvt_pk_bf16_f32 v22, v70, v86
v_mul_f32 v71, s38, v71
v_mul_f32 v87, s38, v87
v_cvt_pk_bf16_f32 v23, v71, v87
buffer_store_dwordx4 v[20:23], v2, s[4:7], s31 offen offset:1024 sc1
v_mul_f32 v72, s38, v72
v_mul_f32 v88, s38, v88
v_cvt_pk_bf16_f32 v24, v72, v88
v_mul_f32 v73, s38, v73
v_mul_f32 v89, s38, v89
v_cvt_pk_bf16_f32 v25, v73, v89
v_mul_f32 v74, s38, v74
v_mul_f32 v90, s38, v90
v_cvt_pk_bf16_f32 v26, v74, v90
v_mul_f32 v75, s38, v75
v_mul_f32 v91, s38, v91
v_cvt_pk_bf16_f32 v27, v75, v91
buffer_store_dwordx4 v[24:27], v2, s[4:7], s31 offen offset:2048 sc1
v_mul_f32 v76, s38, v76
v_mul_f32 v92, s38, v92
v_cvt_pk_bf16_f32 v28, v76, v92
v_mul_f32 v77, s38, v77
v_mul_f32 v93, s38, v93
v_cvt_pk_bf16_f32 v29, v77, v93
v_mul_f32 v78, s38, v78
v_mul_f32 v94, s38, v94
v_cvt_pk_bf16_f32 v30, v78, v94
v_mul_f32 v79, s38, v79
v_mul_f32 v95, s38, v95
v_cvt_pk_bf16_f32 v31, v79, v95
buffer_store_dwordx4 v[28:31], v2, s[4:7], s31 offen offset:3072 sc1
s_waitcnt vmcnt(4)
s_mov_b32 s39, s29
s_add_u32 s28, s28, 0x80
s_add_u32 s29, s29, 0x80
s_add_u32 s30, s30, 0x12000
s_add_u32 s31, s31, 0x40000
s_add_u32 s23, s23, 2
s_cmp_lt_u32 s23, 64
s_cbranch_scc1 L_aqx_top
s_waitcnt vmcnt(0)
s_mov_b64 exec, 1
v_mov_b32 v13, 1
buffer_atomic_add v13, off, s[4:7], s39 sc1
s_mov_b64 exec, -1
s_waitcnt vmcnt(0)
s_branch L_END
L_aq_xv:
v_add_u32 v10, 2304, v10
s_mov_b32 s90, 0
L_w_92:
s_mul_i32 s34, s90, 36
s_add_u32 s34, s34, s20
s_mov_b32 s64, s34
s_mul_i32 s35, s34, 55296
s_add_u32 s36, s35, 0
buffer_load_dword v16, v10, s[8:11], s36 offen
s_add_u32 s36, s35, 3456
buffer_load_dword v17, v10, s[8:11], s36 offen
s_add_u32 s36, s35, 6912
buffer_load_dword v18, v10, s[8:11], s36 offen
s_add_u32 s36, s35, 10368
buffer_load_dword v19, v10, s[8:11], s36 offen
s_add_u32 s36, s35, 13824
buffer_load_dword v20, v10, s[8:11], s36 offen
s_add_u32 s36, s35, 17280
buffer_load_dword v21, v10, s[8:11], s36 offen
s_add_u32 s36, s35, 20736
buffer_load_dword v22, v10, s[8:11], s36 offen
s_add_u32 s36, s35, 24192
buffer_load_dword v23, v10, s[8:11], s36 offen
s_mul_i32 s34, s90, 36
s_add_u32 s34, s34, s20
s_add_u32 s34, s34, 4
s_mov_b32 s65, s34
s_mul_i32 s35, s34, 55296
s_add_u32 s36, s35, 0
buffer_load_dword v24, v10, s[8:11], s36 offen
s_add_u32 s36, s35, 3456
buffer_load_dword v25, v10, s[8:11], s36 offen
s_add_u32 s36, s35, 6912
buffer_load_dword v26, v10, s[8:11], s36 offen
s_add_u32 s36, s35, 10368
buffer_load_dword v27, v10, s[8:11], s36 offen
s_add_u32 s36, s35, 13824
buffer_load_dword v28, v10, s[8:11], s36 offen
s_add_u32 s36, s35, 17280
buffer_load_dword v29, v10, s[8:11], s36 offen
s_add_u32 s36, s35, 20736
buffer_load_dword v30, v10, s[8:11], s36 offen
s_add_u32 s36, s35, 24192
buffer_load_dword v31, v10, s[8:11], s36 offen
s_mul_i32 s34, s90, 36
s_add_u32 s34, s34, s20
s_add_u32 s34, s34, 8
s_mov_b32 s66, s34
s_mul_i32 s35, s34, 55296
s_add_u32 s36, s35, 0
buffer_load_dword v32, v10, s[8:11], s36 offen
s_add_u32 s36, s35, 3456
buffer_load_dword v33, v10, s[8:11], s36 offen
s_add_u32 s36, s35, 6912
buffer_load_dword v34, v10, s[8:11], s36 offen
s_add_u32 s36, s35, 10368
buffer_load_dword v35, v10, s[8:11], s36 offen
s_add_u32 s36, s35, 13824
buffer_load_dword v36, v10, s[8:11], s36 offen
s_add_u32 s36, s35, 17280
buffer_load_dword v37, v10, s[8:11], s36 offen
s_add_u32 s36, s35, 20736
buffer_load_dword v38, v10, s[8:11], s36 offen
s_add_u32 s36, s35, 24192
buffer_load_dword v39, v10, s[8:11], s36 offen
s_mul_i32 s34, s90, 36
s_add_u32 s34, s34, s20
s_add_u32 s34, s34, 12
s_mov_b32 s67, s34
s_mul_i32 s35, s34, 55296
s_add_u32 s36, s35, 0
buffer_load_dword v40, v10, s[8:11], s36 offen
s_add_u32 s36, s35, 3456
buffer_load_dword v41, v10, s[8:11], s36 offen
s_add_u32 s36, s35, 6912
buffer_load_dword v42, v10, s[8:11], s36 offen
s_add_u32 s36, s35, 10368
buffer_load_dword v43, v10, s[8:11], s36 offen
s_add_u32 s36, s35, 13824
buffer_load_dword v44, v10, s[8:11], s36 offen
s_add_u32 s36, s35, 17280
buffer_load_dword v45, v10, s[8:11], s36 offen
s_add_u32 s36, s35, 20736
buffer_load_dword v46, v10, s[8:11], s36 offen
s_add_u32 s36, s35, 24192
buffer_load_dword v47, v10, s[8:11], s36 offen
s_mul_i32 s34, s90, 36
s_add_u32 s34, s34, s20
s_add_u32 s34, s34, 16
s_mov_b32 s68, s34
s_mul_i32 s35, s34, 55296
s_add_u32 s36, s35, 0
buffer_load_dword v48, v10, s[8:11], s36 offen
s_add_u32 s36, s35, 3456
buffer_load_dword v49, v10, s[8:11], s36 offen
s_add_u32 s36, s35, 6912
buffer_load_dword v50, v10, s[8:11], s36 offen
s_add_u32 s36, s35, 10368
buffer_load_dword v51, v10, s[8:11], s36 offen
s_add_u32 s36, s35, 13824
buffer_load_dword v52, v10, s[8:11], s36 offen
s_add_u32 s36, s35, 17280
buffer_load_dword v53, v10, s[8:11], s36 offen
s_add_u32 s36, s35, 20736
buffer_load_dword v54, v10, s[8:11], s36 offen
s_add_u32 s36, s35, 24192
buffer_load_dword v55, v10, s[8:11], s36 offen
s_mul_i32 s34, s90, 36
s_add_u32 s34, s34, s20
s_add_u32 s34, s34, 20
s_mov_b32 s69, s34
s_mul_i32 s35, s34, 55296
s_add_u32 s36, s35, 0
buffer_load_dword v56, v10, s[8:11], s36 offen
s_add_u32 s36, s35, 3456
buffer_load_dword v57, v10, s[8:11], s36 offen
s_add_u32 s36, s35, 6912
buffer_load_dword v58, v10, s[8:11], s36 offen
s_add_u32 s36, s35, 10368
buffer_load_dword v59, v10, s[8:11], s36 offen
s_add_u32 s36, s35, 13824
buffer_load_dword v60, v10, s[8:11], s36 offen
s_add_u32 s36, s35, 17280
buffer_load_dword v61, v10, s[8:11], s36 offen
s_add_u32 s36, s35, 20736
buffer_load_dword v62, v10, s[8:11], s36 offen
s_add_u32 s36, s35, 24192
buffer_load_dword v63, v10, s[8:11], s36 offen
s_mul_i32 s34, s90, 36
s_add_u32 s34, s34, s20
s_add_u32 s34, s34, 24
s_mov_b32 s70, s34
s_mul_i32 s35, s34, 55296
s_add_u32 s36, s35, 0
buffer_load_dword v64, v10, s[8:11], s36 offen
s_add_u32 s36, s35, 3456
buffer_load_dword v65, v10, s[8:11], s36 offen
s_add_u32 s36, s35, 6912
buffer_load_dword v66, v10, s[8:11], s36 offen
s_add_u32 s36, s35, 10368
buffer_load_dword v67, v10, s[8:11], s36 offen
s_add_u32 s36, s35, 13824
buffer_load_dword v68, v10, s[8:11], s36 offen
s_add_u32 s36, s35, 17280
buffer_load_dword v69, v10, s[8:11], s36 offen
s_add_u32 s36, s35, 20736
buffer_load_dword v70, v10, s[8:11], s36 offen
s_add_u32 s36, s35, 24192
buffer_load_dword v71, v10, s[8:11], s36 offen
s_mul_i32 s34, s90, 36
s_add_u32 s34, s34, s20
s_add_u32 s34, s34, 28
s_mov_b32 s71, s34
s_mul_i32 s35, s34, 55296
s_add_u32 s36, s35, 0
buffer_load_dword v72, v10, s[8:11], s36 offen
s_add_u32 s36, s35, 3456
buffer_load_dword v73, v10, s[8:11], s36 offen
s_add_u32 s36, s35, 6912
buffer_load_dword v74, v10, s[8:11], s36 offen
s_add_u32 s36, s35, 10368
buffer_load_dword v75, v10, s[8:11], s36 offen
s_add_u32 s36, s35, 13824
buffer_load_dword v76, v10, s[8:11], s36 offen
s_add_u32 s36, s35, 17280
buffer_load_dword v77, v10, s[8:11], s36 offen
s_add_u32 s36, s35, 20736
buffer_load_dword v78, v10, s[8:11], s36 offen
s_add_u32 s36, s35, 24192
buffer_load_dword v79, v10, s[8:11], s36 offen
s_mul_i32 s34, s90, 36
s_add_u32 s34, s34, s20
s_add_u32 s34, s34, 32
s_mov_b32 s72, s34
s_mul_i32 s35, s34, 55296
s_add_u32 s36, s35, 0
buffer_load_dword v80, v10, s[8:11], s36 offen
s_add_u32 s36, s35, 3456
buffer_load_dword v81, v10, s[8:11], s36 offen
s_add_u32 s36, s35, 6912
buffer_load_dword v82, v10, s[8:11], s36 offen
s_add_u32 s36, s35, 10368
buffer_load_dword v83, v10, s[8:11], s36 offen
s_add_u32 s36, s35, 13824
buffer_load_dword v84, v10, s[8:11], s36 offen
s_add_u32 s36, s35, 17280
buffer_load_dword v85, v10, s[8:11], s36 offen
s_add_u32 s36, s35, 20736
buffer_load_dword v86, v10, s[8:11], s36 offen
s_add_u32 s36, s35, 24192
buffer_load_dword v87, v10, s[8:11], s36 offen
s_waitcnt vmcnt(63)
s_mul_i32 s3, s64, 2048
v_add_u32 v15, s3, v2
v_perm_b32 v88, v17, v16, s32
v_perm_b32 v89, v19, v18, s32
v_perm_b32 v90, v21, v20, s32
v_perm_b32 v91, v23, v22, s32
ds_write_b128 v15, v[88:91] offset:0
v_perm_b32 v92, v17, v16, s33
v_perm_b32 v93, v19, v18, s33
v_perm_b32 v94, v21, v20, s33
v_perm_b32 v95, v23, v22, s33
ds_write_b128 v15, v[92:95] offset:1024
s_waitcnt lgkmcnt(0)
s_waitcnt vmcnt(56)
s_mul_i32 s3, s65, 2048
v_add_u32 v15, s3, v2
v_perm_b32 v88, v25, v24, s32
v_perm_b32 v89, v27, v26, s32
v_perm_b32 v90, v29, v28, s32
v_perm_b32 v91, v31, v30, s32
ds_write_b128 v15, v[88:91] offset:0
v_perm_b32 v92, v25, v24, s33
v_perm_b32 v93, v27, v26, s33
v_perm_b32 v94, v29, v28, s33
v_perm_b32 v95, v31, v30, s33
ds_write_b128 v15, v[92:95] offset:1024
s_waitcnt lgkmcnt(0)
s_waitcnt vmcnt(48)
s_mul_i32 s3, s66, 2048
v_add_u32 v15, s3, v2
v_perm_b32 v88, v33, v32, s32
v_perm_b32 v89, v35, v34, s32
v_perm_b32 v90, v37, v36, s32
v_perm_b32 v91, v39, v38, s32
ds_write_b128 v15, v[88:91] offset:0
v_perm_b32 v92, v33, v32, s33
v_perm_b32 v93, v35, v34, s33
v_perm_b32 v94, v37, v36, s33
v_perm_b32 v95, v39, v38, s33
ds_write_b128 v15, v[92:95] offset:1024
s_waitcnt lgkmcnt(0)
s_waitcnt vmcnt(40)
s_mul_i32 s3, s67, 2048
v_add_u32 v15, s3, v2
v_perm_b32 v88, v41, v40, s32
v_perm_b32 v89, v43, v42, s32
v_perm_b32 v90, v45, v44, s32
v_perm_b32 v91, v47, v46, s32
ds_write_b128 v15, v[88:91] offset:0
v_perm_b32 v92, v41, v40, s33
v_perm_b32 v93, v43, v42, s33
v_perm_b32 v94, v45, v44, s33
v_perm_b32 v95, v47, v46, s33
ds_write_b128 v15, v[92:95] offset:1024
s_waitcnt lgkmcnt(0)
s_waitcnt vmcnt(32)
s_mul_i32 s3, s68, 2048
v_add_u32 v15, s3, v2
v_perm_b32 v88, v49, v48, s32
v_perm_b32 v89, v51, v50, s32
v_perm_b32 v90, v53, v52, s32
v_perm_b32 v91, v55, v54, s32
ds_write_b128 v15, v[88:91] offset:0
v_perm_b32 v92, v49, v48, s33
v_perm_b32 v93, v51, v50, s33
v_perm_b32 v94, v53, v52, s33
v_perm_b32 v95, v55, v54, s33
ds_write_b128 v15, v[92:95] offset:1024
s_waitcnt lgkmcnt(0)
s_waitcnt vmcnt(24)
s_mul_i32 s3, s69, 2048
v_add_u32 v15, s3, v2
v_perm_b32 v88, v57, v56, s32
v_perm_b32 v89, v59, v58, s32
v_perm_b32 v90, v61, v60, s32
v_perm_b32 v91, v63, v62, s32
ds_write_b128 v15, v[88:91] offset:0
v_perm_b32 v92, v57, v56, s33
v_perm_b32 v93, v59, v58, s33
v_perm_b32 v94, v61, v60, s33
v_perm_b32 v95, v63, v62, s33
ds_write_b128 v15, v[92:95] offset:1024
s_waitcnt lgkmcnt(0)
s_waitcnt vmcnt(16)
s_mul_i32 s3, s70, 2048
v_add_u32 v15, s3, v2
v_perm_b32 v88, v65, v64, s32
v_perm_b32 v89, v67, v66, s32
v_perm_b32 v90, v69, v68, s32
v_perm_b32 v91, v71, v70, s32
ds_write_b128 v15, v[88:91] offset:0
v_perm_b32 v92, v65, v64, s33
v_perm_b32 v93, v67, v66, s33
v_perm_b32 v94, v69, v68, s33
v_perm_b32 v95, v71, v70, s33
ds_write_b128 v15, v[92:95] offset:1024
s_waitcnt lgkmcnt(0)
s_waitcnt vmcnt(8)
s_mul_i32 s3, s71, 2048
v_add_u32 v15, s3, v2
v_perm_b32 v88, v73, v72, s32
v_perm_b32 v89, v75, v74, s32
v_perm_b32 v90, v77, v76, s32
v_perm_b32 v91, v79, v78, s32
ds_write_b128 v15, v[88:91] offset:0
v_perm_b32 v92, v73, v72, s33
v_perm_b32 v93, v75, v74, s33
v_perm_b32 v94, v77, v76, s33
v_perm_b32 v95, v79, v78, s33
ds_write_b128 v15, v[92:95] offset:1024
s_waitcnt lgkmcnt(0)
s_waitcnt vmcnt(0)
s_mul_i32 s3, s72, 2048
v_add_u32 v15, s3, v2
v_perm_b32 v88, v81, v80, s32
v_perm_b32 v89, v83, v82, s32
v_perm_b32 v90, v85, v84, s32
v_perm_b32 v91, v87, v86, s32
ds_write_b128 v15, v[88:91] offset:0
v_perm_b32 v92, v81, v80, s33
v_perm_b32 v93, v83, v82, s33
v_perm_b32 v94, v85, v84, s33
v_perm_b32 v95, v87, v86, s33
ds_write_b128 v15, v[92:95] offset:1024
s_waitcnt lgkmcnt(0)
s_add_u32 s90, s90, 1
s_cmp_lt_u32 s90, 1
s_cbranch_scc1 L_w_92
s_lshr_b32 s22, s20, 1
s_and_b32 s23, s20, 1
s_mov_b32 s28, 0x0
s_mul_i32 s3, s22, 0x2000
s_add_u32 s28, s28, s3
s_mul_i32 s3, s23, 0x40
s_add_u32 s28, s28, s3
s_mov_b32 s29, 0x4000
s_mul_i32 s3, s22, 0x1000
s_add_u32 s29, s29, s3
s_mul_i32 s3, s23, 0x40
s_add_u32 s29, s29, s3
s_mov_b32 s30, 0x500000
s_mul_i32 s3, s22, 0x480000
s_add_u32 s30, s30, s3
s_mul_i32 s3, s23, 0x9000
s_add_u32 s30, s30, s3
s_mov_b32 s31, 0x201a000
s_mul_i32 s3, s22, 0x800000
s_add_u32 s31, s31, s3
s_mul_i32 s3, s23, 0x20000
s_add_u32 s31, s31, s3
s_mov_b32 s39, 0x7fff0000
s_mov_b32 s85, 0
s_waitcnt vmcnt(0) lgkmcnt(0)
s_cmp_lg_u32 s20, 0
s_cbranch_scc1 L_walld_94
s_mov_b32 s91, 0
L_wall_93:
buffer_load_dword v15, off, s[16:19], 0 sc1
s_add_u32 s91, s91, 1
s_cmp_gt_u32 s91, 200000
s_cbranch_scc1 L_FAIL
s_waitcnt vmcnt(0)
v_cmp_gt_u32 vcc, 32, v15
s_nop 0
s_nop 2
s_cbranch_vccz L_walld_94
s_sleep 4
s_branch L_wall_93
L_walld_94:
s_barrier
L_aqxv_top:
s_cmp_lg_u32 s85, 0
s_cbranch_scc1 L_warm_95
buffer_load_dword v15, off, s[4:7], s28 sc1
s_mov_b32 s91, 0
s_waitcnt vmcnt(0)
s_mov_b64 exec, 1
v_mov_b32 v13, 1
buffer_atomic_add v13, off, s[4:7], s39 sc1
s_mov_b64 exec, -1
v_cmp_gt_u32 vcc, 4, v15
s_nop 0
s_nop 2
s_cbranch_vccz L_spd_97
L_sp_96:
buffer_load_dword v15, off, s[4:7], s28 sc1
s_add_u32 s91, s91, 1
s_cmp_gt_u32 s91, 200000
s_cbranch_scc1 L_FAIL
s_waitcnt vmcnt(0)
v_cmp_gt_u32 vcc, 4, v15
s_nop 0
s_nop 2
s_cbranch_vccnz L_sp_96
L_spd_97:
s_mov_b32 s39, 0x7fff0000
s_add_u32 s27, s30, 0x0
buffer_load_dwordx4 a[0:3], v2, s[4:7], s27 offen offset:0
buffer_load_dwordx4 a[4:7], v2, s[4:7], s27 offen offset:1024
buffer_load_dwordx4 a[8:11], v2, s[4:7], s27 offen offset:2048
buffer_load_dwordx4 a[12:15], v2, s[4:7], s27 offen offset:3072
s_add_u32 s27, s30, 0x1000
buffer_load_dwordx4 a[16:19], v2, s[4:7], s27 offen offset:0
buffer_load_dwordx4 a[20:23], v2, s[4:7], s27 offen offset:1024
buffer_load_dwordx4 a[24:27], v2, s[4:7], s27 offen offset:2048
buffer_load_dwordx4 a[28:31], v2, s[4:7], s27 offen offset:3072
s_waitcnt vmcnt(0)
L_warm_95:
ds_read_b128 v[128:131], v2 offset:0
ds_read_b128 v[132:135], v2 offset:1024
ds_read_b128 v[136:139], v2 offset:2048
ds_read_b128 v[140:143], v2 offset:3072
s_waitcnt lgkmcnt(2)
v_mfma_f32_32x32x16_bf16 v[64:79], a[0:3], v[128:131], 0
ds_read_b128 v[144:147], v2 offset:4096
s_add_u32 s27, s30, 8192
buffer_load_dwordx4 a[32:35], v2, s[4:7], s27 offen offset:0
v_mfma_f32_32x32x16_bf16 v[80:95], a[0:3], v[132:135], 0
ds_read_b128 v[148:151], v2 offset:5120
buffer_load_dwordx4 a[36:39], v2, s[4:7], s27 offen offset:1024
s_waitcnt lgkmcnt(2)
v_mfma_f32_32x32x16_bf16 v[64:79], a[4:7], v[136:139], v[64:79]
ds_read_b128 v[128:131], v2 offset:6144
buffer_load_dwordx4 a[40:43], v2, s[4:7], s27 offen offset:2048
v_mfma_f32_32x32x16_bf16 v[80:95], a[4:7], v[140:143], v[80:95]
ds_read_b128 v[132:135], v2 offset:7168
buffer_load_dwordx4 a[44:47], v2, s[4:7], s27 offen offset:3072
s_waitcnt lgkmcnt(2)
v_mfma_f32_32x32x16_bf16 v[64:79], a[8:11], v[144:147], v[64:79]
ds_read_b128 v[136:139], v2 offset:8192
s_add_u32 s27, s30, 12288
buffer_load_dwordx4 a[48:51], v2, s[4:7], s27 offen offset:0
v_mfma_f32_32x32x16_bf16 v[80:95], a[8:11], v[148:151], v[80:95]
ds_read_b128 v[140:143], v2 offset:9216
buffer_load_dwordx4 a[52:55], v2, s[4:7], s27 offen offset:1024
s_waitcnt lgkmcnt(2)
v_mfma_f32_32x32x16_bf16 v[64:79], a[12:15], v[128:131], v[64:79]
ds_read_b128 v[144:147], v2 offset:10240
buffer_load_dwordx4 a[56:59], v2, s[4:7], s27 offen offset:2048
v_mfma_f32_32x32x16_bf16 v[80:95], a[12:15], v[132:135], v[80:95]
ds_read_b128 v[148:151], v2 offset:11264
buffer_load_dwordx4 a[60:63], v2, s[4:7], s27 offen offset:3072
s_waitcnt lgkmcnt(2)
v_mfma_f32_32x32x16_bf16 v[64:79], a[16:19], v[136:139], v[64:79]
ds_read_b128 v[128:131], v2 offset:12288
s_add_u32 s27, s30, 16384
buffer_load_dwordx4 a[64:67], v2, s[4:7], s27 offen offset:0
v_mfma_f32_32x32x16_bf16 v[80:95], a[16:19], v[140:143], v[80:95]
ds_read_b128 v[132:135], v2 offset:13312
buffer_load_dwordx4 a[68:71], v2, s[4:7], s27 offen offset:1024
s_waitcnt lgkmcnt(2)
v_mfma_f32_32x32x16_bf16 v[64:79], a[20:23], v[144:147], v[64:79]
ds_read_b128 v[136:139], v2 offset:14336
buffer_load_dwordx4 a[72:75], v2, s[4:7], s27 offen offset:2048
v_mfma_f32_32x32x16_bf16 v[80:95], a[20:23], v[148:151], v[80:95]
ds_read_b128 v[140:143], v2 offset:15360
buffer_load_dwordx4 a[76:79], v2, s[4:7], s27 offen offset:3072
s_waitcnt lgkmcnt(2)
v_mfma_f32_32x32x16_bf16 v[64:79], a[24:27], v[128:131], v[64:79]
ds_read_b128 v[144:147], v2 offset:16384
s_add_u32 s27, s30, 20480
buffer_load_dwordx4 a[80:83], v2, s[4:7], s27 offen offset:0
v_mfma_f32_32x32x16_bf16 v[80:95], a[24:27], v[132:135], v[80:95]
ds_read_b128 v[148:151], v2 offset:17408
buffer_load_dwordx4 a[84:87], v2, s[4:7], s27 offen offset:1024
s_waitcnt lgkmcnt(2)
v_mfma_f32_32x32x16_bf16 v[64:79], a[28:31], v[136:139], v[64:79]
ds_read_b128 v[128:131], v2 offset:18432
buffer_load_dwordx4 a[88:91], v2, s[4:7], s27 offen offset:2048
v_mfma_f32_32x32x16_bf16 v[80:95], a[28:31], v[140:143], v[80:95]
ds_read_b128 v[132:135], v2 offset:19456
buffer_load_dwordx4 a[92:95], v2, s[4:7], s27 offen offset:3072
s_waitcnt vmcnt(15) lgkmcnt(2)
v_mfma_f32_32x32x16_bf16 v[64:79], a[32:35], v[144:147], v[64:79]
ds_read_b128 v[136:139], v2 offset:20480
s_add_u32 s27, s30, 24576
buffer_load_dwordx4 a[96:99], v2, s[4:7], s27 offen offset:0
s_mov_b64 exec, 1
v_mov_b32 v13, 1
buffer_atomic_add v13, off, s[4:7], s39 sc1
s_mov_b64 exec, -1
v_mfma_f32_32x32x16_bf16 v[80:95], a[32:35], v[148:151], v[80:95]
ds_read_b128 v[140:143], v2 offset:21504
buffer_load_dwordx4 a[100:103], v2, s[4:7], s27 offen offset:1024
s_waitcnt vmcnt(17) lgkmcnt(2)
v_mfma_f32_32x32x16_bf16 v[64:79], a[36:39], v[128:131], v[64:79]
ds_read_b128 v[144:147], v2 offset:22528
buffer_load_dwordx4 a[104:107], v2, s[4:7], s27 offen offset:2048
v_mfma_f32_32x32x16_bf16 v[80:95], a[36:39], v[132:135], v[80:95]
ds_read_b128 v[148:151], v2 offset:23552
buffer_load_dwordx4 a[108:111], v2, s[4:7], s27 offen offset:3072
s_waitcnt vmcnt(18) lgkmcnt(2)
v_mfma_f32_32x32x16_bf16 v[64:79], a[40:43], v[136:139], v[64:79]
ds_read_b128 v[128:131], v2 offset:24576
s_add_u32 s27, s30, 28672
buffer_load_dwordx4 a[112:115], v2, s[4:7], s27 offen offset:0
v_mfma_f32_32x32x16_bf16 v[80:95], a[40:43], v[140:143], v[80:95]
ds_read_b128 v[132:135], v2 offset:25600
buffer_load_dwordx4 a[116:119], v2, s[4:7], s27 offen offset:1024
s_waitcnt vmcnt(19) lgkmcnt(2)
v_mfma_f32_32x32x16_bf16 v[64:79], a[44:47], v[144:147], v[64:79]
ds_read_b128 v[136:139], v2 offset:26624
buffer_load_dwordx4 a[120:123], v2, s[4:7], s27 offen offset:2048
v_mfma_f32_32x32x16_bf16 v[80:95], a[44:47], v[148:151], v[80:95]
ds_read_b128 v[140:143], v2 offset:27648
buffer_load_dwordx4 a[124:127], v2, s[4:7], s27 offen offset:3072
s_waitcnt vmcnt(20) lgkmcnt(2)
v_mfma_f32_32x32x16_bf16 v[64:79], a[48:51], v[128:131], v[64:79]
ds_read_b128 v[144:147], v2 offset:28672
s_add_u32 s27, s30, 32768
buffer_load_dwordx4 a[128:131], v2, s[4:7], s27 offen offset:0
v_mfma_f32_32x32x16_bf16 v[80:95], a[48:51], v[132:135], v[80:95]
ds_read_b128 v[148:151], v2 offset:29696
buffer_load_dwordx4 a[132:135], v2, s[4:7], s27 offen offset:1024
s_waitcnt vmcnt(21) lgkmcnt(2)
v_mfma_f32_32x32x16_bf16 v[64:79], a[52:55], v[136:139], v[64:79]
ds_read_b128 v[128:131], v2 offset:30720
buffer_load_dwordx4 a[136:139], v2, s[4:7], s27 offen offset:2048
v_mfma_f32_32x32x16_bf16 v[80:95], a[52:55], v[140:143], v[80:95]
ds_read_b128 v[132:135], v2 offset:31744
buffer_load_dwordx4 a[140:143], v2, s[4:7], s27 offen offset:3072
s_waitcnt vmcnt(22) lgkmcnt(2)
v_mfma_f32_32x32x16_bf16 v[64:79], a[56:59], v[144:147], v[64:79]
ds_read_b128 v[136:139], v2 offset:32768
v_mfma_f32_32x32x16_bf16 v[80:95], a[56:59], v[148:151], v[80:95]
ds_read_b128 v[140:143], v2 offset:33792
s_waitcnt vmcnt(21) lgkmcnt(2)
v_mfma_f32_32x32x16_bf16 v[64:79], a[60:63], v[128:131], v[64:79]
ds_read_b128 v[144:147], v2 offset:34816
v_mfma_f32_32x32x16_bf16 v[80:95], a[60:63], v[132:135], v[80:95]
ds_read_b128 v[148:151], v2 offset:35840
s_waitcnt vmcnt(20) lgkmcnt(2)
v_mfma_f32_32x32x16_bf16 v[64:79], a[64:67], v[136:139], v[64:79]
ds_read_b128 v[128:131], v2 offset:36864
v_mfma_f32_32x32x16_bf16 v[80:95], a[64:67], v[140:143], v[80:95]
ds_read_b128 v[132:135], v2 offset:37888
s_add_u32 s3, s28, 0x80
buffer_load_dword v14, off, s[4:7], s3 sc1
s_waitcnt vmcnt(20) lgkmcnt(2)
v_mfma_f32_32x32x16_bf16 v[64:79], a[68:71], v[144:147], v[64:79]
ds_read_b128 v[136:139], v2 offset:38912
v_mfma_f32_32x32x16_bf16 v[80:95], a[68:71], v[148:151], v[80:95]
ds_read_b128 v[140:143], v2 offset:39936
s_waitcnt vmcnt(19) lgkmcnt(2)
v_mfma_f32_32x32x16_bf16 v[64:79], a[72:75], v[128:131], v[64:79]
ds_read_b128 v[144:147], v2 offset:40960
v_mfma_f32_32x32x16_bf16 v[80:95], a[72:75], v[132:135], v[80:95]
ds_read_b128 v[148:151], v2 offset:41984
s_waitcnt vmcnt(18) lgkmcnt(2)
v_mfma_f32_32x32x16_bf16 v[64:79], a[76:79], v[136:139], v[64:79]
ds_read_b128 v[128:131], v2 offset:43008
v_mfma_f32_32x32x16_bf16 v[80:95], a[76:79], v[140:143], v[80:95]
ds_read_b128 v[132:135], v2 offset:44032
s_waitcnt vmcnt(17) lgkmcnt(2)
v_mfma_f32_32x32x16_bf16 v[64:79], a[80:83], v[144:147], v[64:79]
ds_read_b128 v[136:139], v2 offset:45056
v_mfma_f32_32x32x16_bf16 v[80:95], a[80:83], v[148:151], v[80:95]
ds_read_b128 v[140:143], v2 offset:46080
s_waitcnt vmcnt(16) lgkmcnt(2)
v_mfma_f32_32x32x16_bf16 v[64:79], a[84:87], v[128:131], v[64:79]
ds_read_b128 v[144:147], v2 offset:47104
v_mfma_f32_32x32x16_bf16 v[80:95], a[84:87], v[132:135], v[80:95]
ds_read_b128 v[148:151], v2 offset:48128
s_waitcnt vmcnt(15) lgkmcnt(2)
v_mfma_f32_32x32x16_bf16 v[64:79], a[88:91], v[136:139], v[64:79]
ds_read_b128 v[128:131], v2 offset:49152
v_mfma_f32_32x32x16_bf16 v[80:95], a[88:91], v[140:143], v[80:95]
ds_read_b128 v[132:135], v2 offset:50176
s_waitcnt vmcnt(14) lgkmcnt(2)
v_mfma_f32_32x32x16_bf16 v[64:79], a[92:95], v[144:147], v[64:79]
ds_read_b128 v[136:139], v2 offset:51200
v_mfma_f32_32x32x16_bf16 v[80:95], a[92:95], v[148:151], v[80:95]
ds_read_b128 v[140:143], v2 offset:52224
s_waitcnt vmcnt(13) lgkmcnt(2)
v_mfma_f32_32x32x16_bf16 v[64:79], a[96:99], v[128:131], v[64:79]
ds_read_b128 v[144:147], v2 offset:53248
v_mfma_f32_32x32x16_bf16 v[80:95], a[96:99], v[132:135], v[80:95]
ds_read_b128 v[148:151], v2 offset:54272
s_waitcnt vmcnt(11) lgkmcnt(2)
v_mfma_f32_32x32x16_bf16 v[64:79], a[100:103], v[136:139], v[64:79]
ds_read_b128 v[128:131], v2 offset:55296
v_mfma_f32_32x32x16_bf16 v[80:95], a[100:103], v[140:143], v[80:95]
ds_read_b128 v[132:135], v2 offset:56320
s_waitcnt vmcnt(10) lgkmcnt(2)
v_mfma_f32_32x32x16_bf16 v[64:79], a[104:107], v[144:147], v[64:79]
ds_read_b128 v[136:139], v2 offset:57344
v_mfma_f32_32x32x16_bf16 v[80:95], a[104:107], v[148:151], v[80:95]
ds_read_b128 v[140:143], v2 offset:58368
s_waitcnt vmcnt(9) lgkmcnt(2)
v_mfma_f32_32x32x16_bf16 v[64:79], a[108:111], v[128:131], v[64:79]
ds_read_b128 v[144:147], v2 offset:59392
v_mfma_f32_32x32x16_bf16 v[80:95], a[108:111], v[132:135], v[80:95]
ds_read_b128 v[148:151], v2 offset:60416
s_waitcnt vmcnt(8) lgkmcnt(2)
v_mfma_f32_32x32x16_bf16 v[64:79], a[112:115], v[136:139], v[64:79]
ds_read_b128 v[128:131], v3 offset:0
v_mfma_f32_32x32x16_bf16 v[80:95], a[112:115], v[140:143], v[80:95]
ds_read_b128 v[132:135], v3 offset:1024
s_waitcnt vmcnt(7) lgkmcnt(2)
v_mfma_f32_32x32x16_bf16 v[64:79], a[116:119], v[144:147], v[64:79]
ds_read_b128 v[136:139], v3 offset:2048
v_mfma_f32_32x32x16_bf16 v[80:95], a[116:119], v[148:151], v[80:95]
ds_read_b128 v[140:143], v3 offset:3072
s_waitcnt vmcnt(6) lgkmcnt(2)
v_mfma_f32_32x32x16_bf16 v[64:79], a[120:123], v[128:131], v[64:79]
ds_read_b128 v[144:147], v3 offset:4096
v_mfma_f32_32x32x16_bf16 v[80:95], a[120:123], v[132:135], v[80:95]
ds_read_b128 v[148:151], v3 offset:5120
s_waitcnt vmcnt(0)
v_cmp_le_u32 vcc, 4, v14
s_nop 3
s_and_b32 s85, vcc_lo, 1
s_cmp_lt_u32 s23, 62
s_cselect_b32 s85, s85, 0
s_add_u32 s86, s30, 0x12000
s_cmp_lg_u32 s85, 0
s_cselect_b32 s86, s86, 0x7fff0000
s_add_u32 s87, s86, 4096
s_waitcnt vmcnt(5) lgkmcnt(2)
v_mfma_f32_32x32x16_bf16 v[64:79], a[124:127], v[136:139], v[64:79]
ds_read_b128 v[128:131], v3 offset:6144
buffer_load_dwordx4 a[0:3], v2, s[4:7], s86 offen offset:0
v_mfma_f32_32x32x16_bf16 v[80:95], a[124:127], v[140:143], v[80:95]
ds_read_b128 v[132:135], v3 offset:7168
buffer_load_dwordx4 a[4:7], v2, s[4:7], s86 offen offset:1024
s_waitcnt vmcnt(6) lgkmcnt(2)
v_mfma_f32_32x32x16_bf16 v[64:79], a[128:131], v[144:147], v[64:79]
ds_read_b128 v[136:139], v3 offset:8192
buffer_load_dwordx4 a[8:11], v2, s[4:7], s86 offen offset:2048
v_mfma_f32_32x32x16_bf16 v[80:95], a[128:131], v[148:151], v[80:95]
ds_read_b128 v[140:143], v3 offset:9216
buffer_load_dwordx4 a[12:15], v2, s[4:7], s86 offen offset:3072
s_waitcnt vmcnt(7) lgkmcnt(2)
v_mfma_f32_32x32x16_bf16 v[64:79], a[132:135], v[128:131], v[64:79]
ds_read_b128 v[144:147], v3 offset:10240
buffer_load_dwordx4 a[16:19], v2, s[4:7], s87 offen offset:0
v_mfma_f32_32x32x16_bf16 v[80:95], a[132:135], v[132:135], v[80:95]
ds_read_b128 v[148:151], v3 offset:11264
buffer_load_dwordx4 a[20:23], v2, s[4:7], s87 offen offset:1024
s_waitcnt vmcnt(8) lgkmcnt(2)
v_mfma_f32_32x32x16_bf16 v[64:79], a[136:139], v[136:139], v[64:79]
buffer_load_dwordx4 a[24:27], v2, s[4:7], s87 offen offset:2048
v_mfma_f32_32x32x16_bf16 v[80:95], a[136:139], v[140:143], v[80:95]
buffer_load_dwordx4 a[28:31], v2, s[4:7], s87 offen offset:3072
s_waitcnt vmcnt(9) lgkmcnt(0)
v_mfma_f32_32x32x16_bf16 v[64:79], a[140:143], v[144:147], v[64:79]
v_mfma_f32_32x32x16_bf16 v[80:95], a[140:143], v[148:151], v[80:95]
s_nop 3
v_cvt_pk_bf16_f32 v16, v64, v65
v_cvt_pk_bf16_f32 v17, v66, v67
v_cvt_pk_bf16_f32 v18, v68, v69
v_cvt_pk_bf16_f32 v19, v70, v71
buffer_store_dwordx4 v[16:19], v2, s[4:7], s31 offen offset:0 sc1
v_cvt_pk_bf16_f32 v20, v72, v73
v_cvt_pk_bf16_f32 v21, v74, v75
v_cvt_pk_bf16_f32 v22, v76, v77
v_cvt_pk_bf16_f32 v23, v78, v79
buffer_store_dwordx4 v[20:23], v2, s[4:7], s31 offen offset:1024 sc1
v_cvt_pk_bf16_f32 v24, v80, v81
v_cvt_pk_bf16_f32 v25, v82, v83
v_cvt_pk_bf16_f32 v26, v84, v85
v_cvt_pk_bf16_f32 v27, v86, v87
buffer_store_dwordx4 v[24:27], v2, s[4:7], s31 offen offset:2048 sc1
v_cvt_pk_bf16_f32 v28, v88, v89
v_cvt_pk_bf16_f32 v29, v90, v91
v_cvt_pk_bf16_f32 v30, v92, v93
v_cvt_pk_bf16_f32 v31, v94, v95
buffer_store_dwordx4 v[28:31], v2, s[4:7], s31 offen offset:3072 sc1
v_mov_b32 v40, 0x3f803f80
v_mov_b32 v41, 0x3f803f80
v_mov_b32 v42, 0x3f803f80
v_mov_b32 v43, 0x3f803f80
s_add_u32 s37, s31, 4096
buffer_store_dwordx4 v[40:43], v2, s[4:7], s37 offen sc1
buffer_store_dwordx4 v[40:43], v2, s[4:7], s37 offen offset:1024 sc1
s_waitcnt vmcnt(6)
s_mov_b32 s39, s29
s_add_u32 s28, s28, 0x80
s_add_u32 s29, s29, 0x80
s_add_u32 s30, s30, 0x12000
s_add_u32 s31, s31, 0x40000
s_add_u32 s23, s23, 2
s_cmp_lt_u32 s23, 64
s_cbranch_scc1 L_aqxv_top
s_waitcnt vmcnt(0)
s_mov_b64 exec, 1
v_mov_b32 v13, 1
buffer_atomic_add v13, off, s[4:7], s39 sc1
s_mov_b64 exec, -1
s_waitcnt vmcnt(0)
s_branch L_END
s_endpgm
L_R_aa:
v_and_b32 v1, 63, v0
v_lshlrev_b32 v2, 4, v1
v_add_u32 v3, 61440, v2
v_add_u32 v4, 122880, v2
s_mov_b32 s32, 0x05040100
s_mov_b32 s33, 0x07060302
v_and_b32 v8, 31, v1
v_lshrrev_b32 v9, 5, v1
v_lshlrev_b32 v9, 2, v9
v_sub_u32 v8, v8, v9
v_cmp_le_i32_e64 s[40:41], 0, v8
v_cmp_le_i32_e64 s[42:43], 1, v8
v_cmp_le_i32_e64 s[44:45], 2, v8
v_cmp_le_i32_e64 s[46:47], 3, v8
v_cmp_le_i32_e64 s[48:49], 8, v8
v_cmp_le_i32_e64 s[50:51], 9, v8
v_cmp_le_i32_e64 s[52:53], 10, v8
v_cmp_le_i32_e64 s[54:55], 11, v8
v_cmp_le_i32_e64 s[64:65], 16, v8
v_cmp_le_i32_e64 s[66:67], 17, v8
v_cmp_le_i32_e64 s[68:69], 18, v8
v_cmp_le_i32_e64 s[70:71], 19, v8
v_cmp_le_i32_e64 s[72:73], 24, v8
v_cmp_le_i32_e64 s[74:75], 25, v8
v_cmp_le_i32_e64 s[76:77], 26, v8
v_cmp_le_i32_e64 s[78:79], 27, v8
v_mov_b32 v5, 0xff800000
v_and_b32 v11, 31, v1
v_lshrrev_b32 v12, 5, v1
v_lshlrev_b32 v10, 4, v11
s_mov_b32 s3, 0x7fff0000
v_mul_lo_u32 v13, v12, s3
v_add_u32 v9, v13, v10
v_and_b32 v13, 3, v11
v_lshlrev_b32 v13, 11, v13
v_lshrrev_b32 v14, 2, v11
v_lshl_add_u32 v14, v12, 5, v14
v_lshl_add_u32 v13, v14, 4, v13
v_add_u32 v13, 65536, v13
v_subrev_u32 v14, 16, v11
v_lshlrev_b32 v14, 11, v14
v_lshl_add_u32 v14, v12, 9, v14
v_add_u32 v14, 106496, v14
v_add_u32 v15, 110592, v2
v_cmp_gt_u32 vcc, 16, v11
s_nop 1
v_cndmask_b32_e64 v7, 0, 1, vcc
v_cmp_gt_u32_e64 s[90:91], 18, v11
s_nop 1
v_cndmask_b32_e64 v15, v15, v14, s[90:91]
v_cndmask_b32_e64 v6, v15, v13, vcc
v_cndmask_b32_e64 v8, 0, 1, s[90:91]
v_sub_u32 v8, v8, v7
v_mov_b32 v21, 0
v_accvgpr_write_b32 a37, 0
v_accvgpr_write_b32 a39, 0
v_accvgpr_write_b32 a41, 0
v_accvgpr_write_b32 a43, 0
v_accvgpr_write_b32 a45, 0
v_accvgpr_write_b32 a47, 0
v_accvgpr_write_b32 a49, 0
v_accvgpr_write_b32 a51, 0
v_accvgpr_write_b32 a53, 0
s_lshl_b32 s62, s60, 2
s_add_u32 s62, s62, s20
s_and_b32 s22, s62, 1
s_lshr_b32 s62, s62, 1
s_mov_b32 s39, 0x7fff0000
s_mov_b32 s85, 0
s_waitcnt vmcnt(0) lgkmcnt(0)
s_cmp_lg_u32 s20, 0
s_cbranch_scc1 L_walld_99
s_mov_b32 s91, 0
L_wall_98:
buffer_load_dword v15, off, s[16:19], 0 sc1
s_add_u32 s91, s91, 1
s_cmp_gt_u32 s91, 200000
s_cbranch_scc1 L_FAIL
s_waitcnt vmcnt(0)
v_cmp_gt_u32 vcc, 32, v15
s_nop 0
s_nop 2
s_cbranch_vccz L_walld_99
s_sleep 4
s_branch L_wall_98
L_walld_99:
s_barrier
L_aa_top:
s_lshr_b32 s23, s62, 5
s_and_b32 s63, s62, 31
s_lshl_b32 s34, s22, 6
s_add_u32 s34, s34, s23
s_lshl_b32 s80, s34, 6
s_add_u32 s29, s80, 24576
s_add_u32 s80, s80, 16384
s_lshl_b32 s35, s22, 6
s_sub_i32 s3, s23, 8
s_max_i32 s3, s3, 0
s_add_u32 s3, s3, s35
s_lshl_b32 s3, s3, 17
s_add_u32 s81, s3, 0x2000000
s_sub_i32 s3, s23, 7
s_max_i32 s3, s3, 0
s_add_u32 s3, s3, s35
s_lshl_b32 s3, s3, 17
s_add_u32 s82, s3, 0x2000000
s_sub_i32 s3, s23, 6
s_max_i32 s3, s3, 0
s_add_u32 s3, s3, s35
s_lshl_b32 s3, s3, 17
s_add_u32 s83, s3, 0x2000000
s_sub_i32 s3, s23, 5
s_max_i32 s3, s3, 0
s_add_u32 s3, s3, s35
s_lshl_b32 s3, s3, 17
s_add_u32 s84, s3, 0x2000000
s_sub_i32 s3, s23, 4
s_max_i32 s3, s3, 0
s_add_u32 s3, s3, s35
s_lshl_b32 s3, s3, 17
s_add_u32 s85, s3, 0x2000000
s_sub_i32 s3, s23, 3
s_max_i32 s3, s3, 0
s_add_u32 s3, s3, s35
s_lshl_b32 s3, s3, 17
s_add_u32 s86, s3, 0x2000000
s_sub_i32 s3, s23, 2
s_max_i32 s3, s3, 0
s_add_u32 s3, s3, s35
s_lshl_b32 s3, s3, 17
s_add_u32 s87, s3, 0x2000000
s_sub_i32 s3, s23, 1
s_max_i32 s3, s3, 0
s_add_u32 s3, s3, s35
s_lshl_b32 s3, s3, 17
s_add_u32 s88, s3, 0x2000000
s_sub_i32 s3, s23, 0
s_max_i32 s3, s3, 0
s_add_u32 s3, s3, s35
s_lshl_b32 s3, s3, 17
s_add_u32 s89, s3, 0x2000000
s_mul_i32 s31, s34, 36864
s_add_u32 s31, s31, 0x1a00000
s_lshl_b32 s91, s63, 10
v_add_u32 v22, s91, v2
v_add_u32 v23, 32768, v22
s_lshr_b32 s92, s63, 3
s_lshl_b32 s93, s92, 10
s_bfe_u32 s94, s63, 0x10002
s_lshl_b32 s94, s94, 9
s_add_u32 s93, s93, s94
s_and_b32 s94, s63, 3
s_lshl_b32 s94, s94, 2
s_add_u32 s93, s93, s94
s_add_u32 s94, s93, 98304
v_add_u32 v24, s94, v9
v_add_u32 v25, 4096, v24
s_add_u32 s94, s93, 32768
v_add_u32 v27, s94, v9
s_lshl_b32 s92, s92, 13
s_and_b32 s94, s63, 7
s_lshl_b32 s94, s94, 6
s_add_u32 s92, s92, s94
s_lshl_b32 s94, s63, 4
v_mad_u32_u24 v26, v7, s92, v6
v_mad_u32_u24 v26, v8, s94, v26
s_cmp_eq_u32 s23, 0
s_cselect_b32 s3, 0, 64
s_sub_u32 s80, s80, s3
v_lshrrev_b32 v14, 5, v1
v_mul_u32_u24 v14, s3, v14
s_cmp_ge_u32 s62, 60
s_cbranch_scc1 L_aa_nf_100
s_mov_b32 s91, 0
L_sp_103:
buffer_load_dword v15, v14, s[4:7], s80 offen sc1
s_add_u32 s91, s91, 1
s_cmp_gt_u32 s91, 200000
s_cbranch_scc1 L_FAIL
s_waitcnt vmcnt(0)
v_cmp_gt_u32 vcc, 15, v15
s_nop 0
s_nop 2
s_cbranch_vccz L_spd_104
s_sleep 1
s_branch L_sp_103
L_spd_104:
L_aa_nf_100:
buffer_load_dword v15, v14, s[4:7], s80 offen sc1
buffer_load_dwordx4 a[24:27], v23, s[4:7], s87 offen
buffer_load_dword a48, v25, s[4:7], s87 offen
buffer_load_dwordx4 a[20:23], v23, s[4:7], s86 offen
buffer_load_dword a46, v25, s[4:7], s86 offen
buffer_load_dwordx4 a[16:19], v23, s[4:7], s85 offen
buffer_load_dword a44, v25, s[4:7], s85 offen
buffer_load_dwordx4 a[12:15], v23, s[4:7], s84 offen
buffer_load_dword a42, v25, s[4:7], s84 offen
buffer_load_dwordx4 a[8:11], v23, s[4:7], s83 offen
buffer_load_dword a40, v25, s[4:7], s83 offen
buffer_load_dwordx4 a[4:7], v23, s[4:7], s82 offen
buffer_load_dword a38, v25, s[4:7], s82 offen
buffer_load_dwordx4 a[0:3], v23, s[4:7], s81 offen
buffer_load_dword a36, v25, s[4:7], s81 offen
buffer_load_dwordx4 a[112:115], v26, s[4:7], s87 offen
buffer_load_dwordx4 a[116:119], v26, s[4:7], s87 offen offset:1024
buffer_load_dwordx4 a[104:107], v26, s[4:7], s86 offen
buffer_load_dwordx4 a[108:111], v26, s[4:7], s86 offen offset:1024
buffer_load_dwordx4 a[96:99], v26, s[4:7], s85 offen
buffer_load_dwordx4 a[100:103], v26, s[4:7], s85 offen offset:1024
buffer_load_dwordx4 a[88:91], v26, s[4:7], s84 offen
buffer_load_dwordx4 a[92:95], v26, s[4:7], s84 offen offset:1024
buffer_load_dwordx4 a[80:83], v26, s[4:7], s83 offen
buffer_load_dwordx4 a[84:87], v26, s[4:7], s83 offen offset:1024
buffer_load_dwordx4 a[72:75], v26, s[4:7], s82 offen
buffer_load_dwordx4 a[76:79], v26, s[4:7], s82 offen offset:1024
buffer_load_dwordx4 a[64:67], v26, s[4:7], s81 offen
buffer_load_dwordx4 a[68:71], v26, s[4:7], s81 offen offset:1024
s_waitcnt vmcnt(28)
s_mov_b64 exec, 1
v_mov_b32 v13, 1
buffer_atomic_add v13, off, s[4:7], s39 sc1
s_mov_b64 exec, -1
v_cmp_gt_u32 vcc, 15, v15
s_nop 0
s_nop 2
s_cbranch_vccz L_aa_sd_102
s_mov_b32 s91, 0
L_sp_105:
buffer_load_dword v15, v14, s[4:7], s80 offen sc1
s_add_u32 s91, s91, 1
s_cmp_gt_u32 s91, 200000
s_cbranch_scc1 L_FAIL
s_waitcnt vmcnt(0)
v_cmp_gt_u32 vcc, 15, v15
s_nop 0
s_nop 2
s_cbranch_vccz L_spd_106
s_sleep 1
s_branch L_sp_105
L_spd_106:
L_aa_sd_102:
buffer_load_dwordx4 v[16:19], v22, s[4:7], s89 offen
buffer_load_dword v20, v24, s[4:7], s89 offen
buffer_load_dwordx4 a[32:35], v23, s[4:7], s89 offen
buffer_load_dword a52, v25, s[4:7], s89 offen
buffer_load_dwordx4 a[28:31], v23, s[4:7], s88 offen
buffer_load_dword a50, v25, s[4:7], s88 offen
buffer_load_dwordx4 a[128:131], v26, s[4:7], s89 offen
buffer_load_dwordx4 a[132:135], v26, s[4:7], s89 offen offset:1024
buffer_load_dwordx4 a[120:123], v26, s[4:7], s88 offen
buffer_load_dwordx4 a[124:127], v26, s[4:7], s88 offen offset:1024
s_waitcnt vmcnt(6)
v_mfma_f32_32x32x16_bf16 v[192:207], a[32:35], v[16:19], 0
v_mfma_f32_32x32x8bf16_1k v[192:207], a[52:53], v[20:21], v[192:207]
s_waitcnt vmcnt(4)
v_mfma_f32_32x32x16_bf16 v[176:191], a[28:31], v[16:19], 0
v_mfma_f32_32x32x8bf16_1k v[176:191], a[50:51], v[20:21], v[176:191]
v_mfma_f32_32x32x16_bf16 v[160:175], a[24:27], v[16:19], 0
v_mfma_f32_32x32x8bf16_1k v[160:175], a[48:49], v[20:21], v[160:175]
v_cndmask_b32_e64 v192, v5, v192, s[40:41]
v_cndmask_b32_e64 v193, v5, v193, s[42:43]
v_cndmask_b32_e64 v194, v5, v194, s[44:45]
v_cndmask_b32_e64 v195, v5, v195, s[46:47]
v_cndmask_b32_e64 v196, v5, v196, s[48:49]
v_cndmask_b32_e64 v197, v5, v197, s[50:51]
v_cndmask_b32_e64 v198, v5, v198, s[52:53]
v_cndmask_b32_e64 v199, v5, v199, s[54:55]
v_cndmask_b32_e64 v200, v5, v200, s[64:65]
v_cndmask_b32_e64 v201, v5, v201, s[66:67]
v_cndmask_b32_e64 v202, v5, v202, s[68:69]
v_cndmask_b32_e64 v203, v5, v203, s[70:71]
v_cndmask_b32_e64 v204, v5, v204, s[72:73]
v_cndmask_b32_e64 v205, v5, v205, s[74:75]
v_cndmask_b32_e64 v206, v5, v206, s[76:77]
v_cndmask_b32_e64 v207, v5, v207, s[78:79]
v_mfma_f32_32x32x16_bf16 v[144:159], a[20:23], v[16:19], 0
v_mfma_f32_32x32x8bf16_1k v[144:159], a[46:47], v[20:21], v[144:159]
v_mfma_f32_32x32x16_bf16 v[128:143], a[16:19], v[16:19], 0
v_mfma_f32_32x32x8bf16_1k v[128:143], a[44:45], v[20:21], v[128:143]
v_mfma_f32_32x32x16_bf16 v[112:127], a[12:15], v[16:19], 0
v_mfma_f32_32x32x8bf16_1k v[112:127], a[42:43], v[20:21], v[112:127]
v_mfma_f32_32x32x16_bf16 v[96:111], a[8:11], v[16:19], 0
v_mfma_f32_32x32x8bf16_1k v[96:111], a[40:41], v[20:21], v[96:111]
v_mfma_f32_32x32x16_bf16 v[80:95], a[4:7], v[16:19], 0
v_mfma_f32_32x32x8bf16_1k v[80:95], a[38:39], v[20:21], v[80:95]
v_mfma_f32_32x32x16_bf16 v[64:79], a[0:3], v[16:19], 0
v_mfma_f32_32x32x8bf16_1k v[64:79], a[36:37], v[20:21], v[64:79]
s_nop 11
v_cndmask_b32_e64 v64, v64, v5, s[40:41]
v_cndmask_b32_e64 v65, v65, v5, s[42:43]
v_cndmask_b32_e64 v66, v66, v5, s[44:45]
v_cndmask_b32_e64 v67, v67, v5, s[46:47]
v_cndmask_b32_e64 v68, v68, v5, s[48:49]
v_cndmask_b32_e64 v69, v69, v5, s[50:51]
v_cndmask_b32_e64 v70, v70, v5, s[52:53]
v_cndmask_b32_e64 v71, v71, v5, s[54:55]
v_cndmask_b32_e64 v72, v72, v5, s[64:65]
v_cndmask_b32_e64 v73, v73, v5, s[66:67]
v_cndmask_b32_e64 v74, v74, v5, s[68:69]
v_cndmask_b32_e64 v75, v75, v5, s[70:71]
v_cndmask_b32_e64 v76, v76, v5, s[72:73]
v_cndmask_b32_e64 v77, v77, v5, s[74:75]
v_cndmask_b32_e64 v78, v78, v5, s[76:77]
v_cndmask_b32_e64 v79, v79, v5, s[78:79]
s_cmp_lt_u32 s23, 8
s_cbranch_scc1 L_aa_fix_107
L_aa_back_108:
v_max3_f32 v28, v64, v68, v72
v_max3_f32 v29, v65, v69, v73
v_max3_f32 v30, v66, v70, v74
v_max3_f32 v31, v67, v71, v75
v_max3_f32 v28, v28, v76, v80
v_max3_f32 v29, v29, v77, v81
v_max3_f32 v30, v30, v78, v82
v_max3_f32 v31, v31, v79, v83
v_max3_f32 v28, v28, v84, v88
v_max3_f32 v29, v29, v85, v89
v_max3_f32 v30, v30, v86, v90
v_max3_f32 v31, v31, v87, v91
v_max3_f32 v28, v28, v92, v96
v_max3_f32 v29, v29, v93, v97
v_max3_f32 v30, v30, v94, v98
v_max3_f32 v31, v31, v95, v99
v_max3_f32 v28, v28, v100, v104
v_max3_f32 v29, v29, v101, v105
v_max3_f32 v30, v30, v102, v106
v_max3_f32 v31, v31, v103, v107
v_max3_f32 v28, v28, v108, v112
v_max3_f32 v29, v29, v109, v113
v_max3_f32 v30, v30, v110, v114
v_max3_f32 v31, v31, v111, v115
v_max3_f32 v28, v28, v116, v120
v_max3_f32 v29, v29, v117, v121
v_max3_f32 v30, v30, v118, v122
v_max3_f32 v31, v31, v119, v123
v_max3_f32 v28, v28, v124, v128
v_max3_f32 v29, v29, v125, v129
v_max3_f32 v30, v30, v126, v130
v_max3_f32 v31, v31, v127, v131
v_max3_f32 v28, v28, v132, v136
v_max3_f32 v29, v29, v133, v137
v_max3_f32 v30, v30, v134, v138
v_max3_f32 v31, v31, v135, v139
v_max3_f32 v28, v28, v140, v144
v_max3_f32 v29, v29, v141, v145
v_max3_f32 v30, v30, v142, v146
v_max3_f32 v31, v31, v143, v147
v_max3_f32 v28, v28, v148, v152
v_max3_f32 v29, v29, v149, v153
v_max3_f32 v30, v30, v150, v154
v_max3_f32 v31, v31, v151, v155
v_max3_f32 v28, v28, v156, v160
v_max3_f32 v29, v29, v157, v161
v_max3_f32 v30, v30, v158, v162
v_max3_f32 v31, v31, v159, v163
v_max3_f32 v28, v28, v164, v168
v_max3_f32 v29, v29, v165, v169
v_max3_f32 v30, v30, v166, v170
v_max3_f32 v31, v31, v167, v171
v_max3_f32 v28, v28, v172, v176
v_max3_f32 v29, v29, v173, v177
v_max3_f32 v30, v30, v174, v178
v_max3_f32 v31, v31, v175, v179
v_max3_f32 v28, v28, v180, v184
v_max3_f32 v29, v29, v181, v185
v_max3_f32 v30, v30, v182, v186
v_max3_f32 v31, v31, v183, v187
v_max3_f32 v28, v28, v188, v192
v_max3_f32 v29, v29, v189, v193
v_max3_f32 v30, v30, v190, v194
v_max3_f32 v31, v31, v191, v195
v_max3_f32 v28, v28, v196, v200
v_max3_f32 v29, v29, v197, v201
v_max3_f32 v30, v30, v198, v202
v_max3_f32 v31, v31, v199, v203
v_max_f32 v28, v28, v204
v_max_f32 v29, v29, v205
v_max_f32 v30, v30, v206
v_max_f32 v31, v31, v207
v_max3_f32 v28, v28, v29, v30
v_max_f32 v28, v28, v31
v_mov_b32 v32, v28
s_nop 1
v_permlane32_swap_b32 v28, v32
v_max_f32 v28, v28, v32
v_sub_f32 v32, 0, v28
v_mov_b32 v33, v32
v_pk_add_f32 v[192:193], v[192:193], v[32:33]
v_pk_add_f32 v[194:195], v[194:195], v[32:33]
v_pk_add_f32 v[196:197], v[196:197], v[32:33]
v_pk_add_f32 v[198:199], v[198:199], v[32:33]
v_pk_add_f32 v[200:201], v[200:201], v[32:33]
v_pk_add_f32 v[202:203], v[202:203], v[32:33]
v_pk_add_f32 v[204:205], v[204:205], v[32:33]
v_pk_add_f32 v[206:207], v[206:207], v[32:33]
v_exp_f32 v192, v192
v_exp_f32 v193, v193
v_exp_f32 v194, v194
v_exp_f32 v195, v195
v_exp_f32 v196, v196
v_exp_f32 v197, v197
v_exp_f32 v198, v198
v_exp_f32 v199, v199
v_exp_f32 v200, v200
v_exp_f32 v201, v201
v_exp_f32 v202, v202
v_exp_f32 v203, v203
v_exp_f32 v204, v204
v_exp_f32 v205, v205
v_exp_f32 v206, v206
v_exp_f32 v207, v207
v_cvt_pk_bf16_f32 v192, v192, v193
v_cvt_pk_bf16_f32 v193, v194, v195
v_cvt_pk_bf16_f32 v194, v196, v197
v_cvt_pk_bf16_f32 v195, v198, v199
v_cvt_pk_bf16_f32 v200, v200, v201
v_cvt_pk_bf16_f32 v201, v202, v203
v_cvt_pk_bf16_f32 v202, v204, v205
v_cvt_pk_bf16_f32 v203, v206, v207
s_waitcnt vmcnt(2)
v_mfma_f32_32x32x16_bf16 v[40:55], a[128:131], v[192:195], 0
v_mfma_f32_32x32x16_bf16 v[40:55], a[132:135], v[200:203], v[40:55]
v_pk_add_f32 v[176:177], v[176:177], v[32:33]
v_pk_add_f32 v[178:179], v[178:179], v[32:33]
v_pk_add_f32 v[180:181], v[180:181], v[32:33]
v_pk_add_f32 v[182:183], v[182:183], v[32:33]
v_pk_add_f32 v[184:185], v[184:185], v[32:33]
v_pk_add_f32 v[186:187], v[186:187], v[32:33]
v_pk_add_f32 v[188:189], v[188:189], v[32:33]
v_pk_add_f32 v[190:191], v[190:191], v[32:33]
v_exp_f32 v176, v176
v_exp_f32 v177, v177
v_exp_f32 v178, v178
v_exp_f32 v179, v179
v_exp_f32 v180, v180
v_exp_f32 v181, v181
v_exp_f32 v182, v182
v_exp_f32 v183, v183
v_exp_f32 v184, v184
v_exp_f32 v185, v185
v_exp_f32 v186, v186
v_exp_f32 v187, v187
v_exp_f32 v188, v188
v_exp_f32 v189, v189
v_exp_f32 v190, v190
v_exp_f32 v191, v191
v_cvt_pk_bf16_f32 v176, v176, v177
v_cvt_pk_bf16_f32 v177, v178, v179
v_cvt_pk_bf16_f32 v178, v180, v181
v_cvt_pk_bf16_f32 v179, v182, v183
v_cvt_pk_bf16_f32 v184, v184, v185
v_cvt_pk_bf16_f32 v185, v186, v187
v_cvt_pk_bf16_f32 v186, v188, v189
v_cvt_pk_bf16_f32 v187, v190, v191
s_waitcnt vmcnt(0)
v_mfma_f32_32x32x16_bf16 v[40:55], a[120:123], v[176:179], v[40:55]
v_mfma_f32_32x32x16_bf16 v[40:55], a[124:127], v[184:187], v[40:55]
v_pk_add_f32 v[160:161], v[160:161], v[32:33]
v_pk_add_f32 v[162:163], v[162:163], v[32:33]
v_pk_add_f32 v[164:165], v[164:165], v[32:33]
v_pk_add_f32 v[166:167], v[166:167], v[32:33]
v_pk_add_f32 v[168:169], v[168:169], v[32:33]
v_pk_add_f32 v[170:171], v[170:171], v[32:33]
v_pk_add_f32 v[172:173], v[172:173], v[32:33]
v_pk_add_f32 v[174:175], v[174:175], v[32:33]
v_exp_f32 v160, v160
v_exp_f32 v161, v161
v_exp_f32 v162, v162
v_exp_f32 v163, v163
v_exp_f32 v164, v164
v_exp_f32 v165, v165
v_exp_f32 v166, v166
v_exp_f32 v167, v167
v_exp_f32 v168, v168
v_exp_f32 v169, v169
v_exp_f32 v170, v170
v_exp_f32 v171, v171
v_exp_f32 v172, v172
v_exp_f32 v173, v173
v_exp_f32 v174, v174
v_exp_f32 v175, v175
v_cvt_pk_bf16_f32 v160, v160, v161
v_cvt_pk_bf16_f32 v161, v162, v163
v_cvt_pk_bf16_f32 v162, v164, v165
v_cvt_pk_bf16_f32 v163, v166, v167
v_cvt_pk_bf16_f32 v168, v168, v169
v_cvt_pk_bf16_f32 v169, v170, v171
v_cvt_pk_bf16_f32 v170, v172, v173
v_cvt_pk_bf16_f32 v171, v174, v175
v_mfma_f32_32x32x16_bf16 v[40:55], a[112:115], v[160:163], v[40:55]
s_nop 0
v_mfma_f32_32x32x16_bf16 v[40:55], a[116:119], v[168:171], v[40:55]
v_pk_add_f32 v[144:145], v[144:145], v[32:33]
v_pk_add_f32 v[146:147], v[146:147], v[32:33]
v_pk_add_f32 v[148:149], v[148:149], v[32:33]
v_pk_add_f32 v[150:151], v[150:151], v[32:33]
v_pk_add_f32 v[152:153], v[152:153], v[32:33]
v_pk_add_f32 v[154:155], v[154:155], v[32:33]
v_pk_add_f32 v[156:157], v[156:157], v[32:33]
v_pk_add_f32 v[158:159], v[158:159], v[32:33]
v_exp_f32 v144, v144
v_exp_f32 v145, v145
v_exp_f32 v146, v146
v_exp_f32 v147, v147
v_exp_f32 v148, v148
v_exp_f32 v149, v149
v_exp_f32 v150, v150
v_exp_f32 v151, v151
v_exp_f32 v152, v152
v_exp_f32 v153, v153
v_exp_f32 v154, v154
v_exp_f32 v155, v155
v_exp_f32 v156, v156
v_exp_f32 v157, v157
v_exp_f32 v158, v158
v_exp_f32 v159, v159
v_cvt_pk_bf16_f32 v144, v144, v145
v_cvt_pk_bf16_f32 v145, v146, v147
v_cvt_pk_bf16_f32 v146, v148, v149
v_cvt_pk_bf16_f32 v147, v150, v151
v_cvt_pk_bf16_f32 v152, v152, v153
v_cvt_pk_bf16_f32 v153, v154, v155
v_cvt_pk_bf16_f32 v154, v156, v157
v_cvt_pk_bf16_f32 v155, v158, v159
v_mfma_f32_32x32x16_bf16 v[40:55], a[104:107], v[144:147], v[40:55]
s_nop 0
v_mfma_f32_32x32x16_bf16 v[40:55], a[108:111], v[152:155], v[40:55]
v_pk_add_f32 v[128:129], v[128:129], v[32:33]
v_pk_add_f32 v[130:131], v[130:131], v[32:33]
v_pk_add_f32 v[132:133], v[132:133], v[32:33]
v_pk_add_f32 v[134:135], v[134:135], v[32:33]
v_pk_add_f32 v[136:137], v[136:137], v[32:33]
v_pk_add_f32 v[138:139], v[138:139], v[32:33]
v_pk_add_f32 v[140:141], v[140:141], v[32:33]
v_pk_add_f32 v[142:143], v[142:143], v[32:33]
v_exp_f32 v128, v128
v_exp_f32 v129, v129
v_exp_f32 v130, v130
v_exp_f32 v131, v131
v_exp_f32 v132, v132
v_exp_f32 v133, v133
v_exp_f32 v134, v134
v_exp_f32 v135, v135
v_exp_f32 v136, v136
v_exp_f32 v137, v137
v_exp_f32 v138, v138
v_exp_f32 v139, v139
v_exp_f32 v140, v140
v_exp_f32 v141, v141
v_exp_f32 v142, v142
v_exp_f32 v143, v143
v_cvt_pk_bf16_f32 v128, v128, v129
v_cvt_pk_bf16_f32 v129, v130, v131
v_cvt_pk_bf16_f32 v130, v132, v133
v_cvt_pk_bf16_f32 v131, v134, v135
v_cvt_pk_bf16_f32 v136, v136, v137
v_cvt_pk_bf16_f32 v137, v138, v139
v_cvt_pk_bf16_f32 v138, v140, v141
v_cvt_pk_bf16_f32 v139, v142, v143
v_mfma_f32_32x32x16_bf16 v[40:55], a[96:99], v[128:131], v[40:55]
s_nop 0
v_mfma_f32_32x32x16_bf16 v[40:55], a[100:103], v[136:139], v[40:55]
v_pk_add_f32 v[112:113], v[112:113], v[32:33]
v_pk_add_f32 v[114:115], v[114:115], v[32:33]
v_pk_add_f32 v[116:117], v[116:117], v[32:33]
v_pk_add_f32 v[118:119], v[118:119], v[32:33]
v_pk_add_f32 v[120:121], v[120:121], v[32:33]
v_pk_add_f32 v[122:123], v[122:123], v[32:33]
v_pk_add_f32 v[124:125], v[124:125], v[32:33]
v_pk_add_f32 v[126:127], v[126:127], v[32:33]
v_exp_f32 v112, v112
v_exp_f32 v113, v113
v_exp_f32 v114, v114
v_exp_f32 v115, v115
v_exp_f32 v116, v116
v_exp_f32 v117, v117
v_exp_f32 v118, v118
v_exp_f32 v119, v119
v_exp_f32 v120, v120
v_exp_f32 v121, v121
v_exp_f32 v122, v122
v_exp_f32 v123, v123
v_exp_f32 v124, v124
v_exp_f32 v125, v125
v_exp_f32 v126, v126
v_exp_f32 v127, v127
v_cvt_pk_bf16_f32 v112, v112, v113
v_cvt_pk_bf16_f32 v113, v114, v115
v_cvt_pk_bf16_f32 v114, v116, v117
v_cvt_pk_bf16_f32 v115, v118, v119
v_cvt_pk_bf16_f32 v120, v120, v121
v_cvt_pk_bf16_f32 v121, v122, v123
v_cvt_pk_bf16_f32 v122, v124, v125
v_cvt_pk_bf16_f32 v123, v126, v127
v_mfma_f32_32x32x16_bf16 v[40:55], a[88:91], v[112:115], v[40:55]
s_nop 0
v_mfma_f32_32x32x16_bf16 v[40:55], a[92:95], v[120:123], v[40:55]
v_pk_add_f32 v[96:97], v[96:97], v[32:33]
v_pk_add_f32 v[98:99], v[98:99], v[32:33]
v_pk_add_f32 v[100:101], v[100:101], v[32:33]
v_pk_add_f32 v[102:103], v[102:103], v[32:33]
v_pk_add_f32 v[104:105], v[104:105], v[32:33]
v_pk_add_f32 v[106:107], v[106:107], v[32:33]
v_pk_add_f32 v[108:109], v[108:109], v[32:33]
v_pk_add_f32 v[110:111], v[110:111], v[32:33]
v_exp_f32 v96, v96
v_exp_f32 v97, v97
v_exp_f32 v98, v98
v_exp_f32 v99, v99
v_exp_f32 v100, v100
v_exp_f32 v101, v101
v_exp_f32 v102, v102
v_exp_f32 v103, v103
v_exp_f32 v104, v104
v_exp_f32 v105, v105
v_exp_f32 v106, v106
v_exp_f32 v107, v107
v_exp_f32 v108, v108
v_exp_f32 v109, v109
v_exp_f32 v110, v110
v_exp_f32 v111, v111
v_cvt_pk_bf16_f32 v96, v96, v97
v_cvt_pk_bf16_f32 v97, v98, v99
v_cvt_pk_bf16_f32 v98, v100, v101
v_cvt_pk_bf16_f32 v99, v102, v103
v_cvt_pk_bf16_f32 v104, v104, v105
v_cvt_pk_bf16_f32 v105, v106, v107
v_cvt_pk_bf16_f32 v106, v108, v109
v_cvt_pk_bf16_f32 v107, v110, v111
v_mfma_f32_32x32x16_bf16 v[40:55], a[80:83], v[96:99], v[40:55]
s_nop 0
v_mfma_f32_32x32x16_bf16 v[40:55], a[84:87], v[104:107], v[40:55]
v_pk_add_f32 v[80:81], v[80:81], v[32:33]
v_pk_add_f32 v[82:83], v[82:83], v[32:33]
v_pk_add_f32 v[84:85], v[84:85], v[32:33]
v_pk_add_f32 v[86:87], v[86:87], v[32:33]
v_pk_add_f32 v[88:89], v[88:89], v[32:33]
v_pk_add_f32 v[90:91], v[90:91], v[32:33]
v_pk_add_f32 v[92:93], v[92:93], v[32:33]
v_pk_add_f32 v[94:95], v[94:95], v[32:33]
v_exp_f32 v80, v80
v_exp_f32 v81, v81
v_exp_f32 v82, v82
v_exp_f32 v83, v83
v_exp_f32 v84, v84
v_exp_f32 v85, v85
v_exp_f32 v86, v86
v_exp_f32 v87, v87
v_exp_f32 v88, v88
v_exp_f32 v89, v89
v_exp_f32 v90, v90
v_exp_f32 v91, v91
v_exp_f32 v92, v92
v_exp_f32 v93, v93
v_exp_f32 v94, v94
v_exp_f32 v95, v95
v_cvt_pk_bf16_f32 v80, v80, v81
v_cvt_pk_bf16_f32 v81, v82, v83
v_cvt_pk_bf16_f32 v82, v84, v85
v_cvt_pk_bf16_f32 v83, v86, v87
v_cvt_pk_bf16_f32 v88, v88, v89
v_cvt_pk_bf16_f32 v89, v90, v91
v_cvt_pk_bf16_f32 v90, v92, v93
v_cvt_pk_bf16_f32 v91, v94, v95
v_mfma_f32_32x32x16_bf16 v[40:55], a[72:75], v[80:83], v[40:55]
s_nop 0
v_mfma_f32_32x32x16_bf16 v[40:55], a[76:79], v[88:91], v[40:55]
v_pk_add_f32 v[64:65], v[64:65], v[32:33]
v_pk_add_f32 v[66:67], v[66:67], v[32:33]
v_pk_add_f32 v[68:69], v[68:69], v[32:33]
v_pk_add_f32 v[70:71], v[70:71], v[32:33]
v_pk_add_f32 v[72:73], v[72:73], v[32:33]
v_pk_add_f32 v[74:75], v[74:75], v[32:33]
v_pk_add_f32 v[76:77], v[76:77], v[32:33]
v_pk_add_f32 v[78:79], v[78:79], v[32:33]
v_exp_f32 v64, v64
v_exp_f32 v65, v65
v_exp_f32 v66, v66
v_exp_f32 v67, v67
v_exp_f32 v68, v68
v_exp_f32 v69, v69
v_exp_f32 v70, v70
v_exp_f32 v71, v71
v_exp_f32 v72, v72
v_exp_f32 v73, v73
v_exp_f32 v74, v74
v_exp_f32 v75, v75
v_exp_f32 v76, v76
v_exp_f32 v77, v77
v_exp_f32 v78, v78
v_exp_f32 v79, v79
v_cvt_pk_bf16_f32 v64, v64, v65
v_cvt_pk_bf16_f32 v65, v66, v67
v_cvt_pk_bf16_f32 v66, v68, v69
v_cvt_pk_bf16_f32 v67, v70, v71
v_cvt_pk_bf16_f32 v72, v72, v73
v_cvt_pk_bf16_f32 v73, v74, v75
v_cvt_pk_bf16_f32 v74, v76, v77
v_cvt_pk_bf16_f32 v75, v78, v79
v_mfma_f32_32x32x16_bf16 v[40:55], a[64:67], v[64:67], v[40:55]
s_nop 0
v_mfma_f32_32x32x16_bf16 v[40:55], a[68:71], v[72:75], v[40:55]
s_nop 11
v_rcp_f32 v34, v50
s_nop 0
v_mul_f32 v40, v40, v34
v_mul_f32 v41, v41, v34
v_mul_f32 v42, v42, v34
v_mul_f32 v43, v43, v34
v_mul_f32 v44, v44, v34
v_mul_f32 v45, v45, v34
v_mul_f32 v46, v46, v34
v_mul_f32 v47, v47, v34
v_mul_f32 v48, v48, v34
v_mul_f32 v49, v49, v34
v_cvt_pk_bf16_f32 v36, v40, v41
v_cvt_pk_bf16_f32 v37, v42, v43
v_cvt_pk_bf16_f32 v38, v44, v45
v_cvt_pk_bf16_f32 v39, v46, v47
v_cvt_pk_bf16_f32 v35, v48, v49
buffer_store_dwordx4 v[36:39], v22, s[4:7], s31 offen sc1
buffer_store_dword v35, v27, s[4:7], s31 offen sc1
s_mov_b32 s39, s29
s_add_u32 s62, s62, 60
s_cmp_lt_u32 s62, 2048
s_cbranch_scc1 L_aa_top
s_waitcnt vmcnt(0)
s_mov_b64 exec, 1
v_mov_b32 v13, 1
buffer_atomic_add v13, off, s[4:7], s39 sc1
s_mov_b64 exec, -1
s_waitcnt vmcnt(0)
s_branch L_END
L_aa_fix_107:
s_add_u32 s3, s23, 0
s_cmp_ge_u32 s3, 8
s_cbranch_scc1 L_aa_fs_109
v_mov_b32 v64, v5
v_mov_b32 v65, v5
v_mov_b32 v66, v5
v_mov_b32 v67, v5
v_mov_b32 v68, v5
v_mov_b32 v69, v5
v_mov_b32 v70, v5
v_mov_b32 v71, v5
v_mov_b32 v72, v5
v_mov_b32 v73, v5
v_mov_b32 v74, v5
v_mov_b32 v75, v5
v_mov_b32 v76, v5
v_mov_b32 v77, v5
v_mov_b32 v78, v5
v_mov_b32 v79, v5
L_aa_fs_109:
s_add_u32 s3, s23, 1
s_cmp_ge_u32 s3, 8
s_cbranch_scc1 L_aa_fs_110
v_mov_b32 v80, v5
v_mov_b32 v81, v5
v_mov_b32 v82, v5
v_mov_b32 v83, v5
v_mov_b32 v84, v5
v_mov_b32 v85, v5
v_mov_b32 v86, v5
v_mov_b32 v87, v5
v_mov_b32 v88, v5
v_mov_b32 v89, v5
v_mov_b32 v90, v5
v_mov_b32 v91, v5
v_mov_b32 v92, v5
v_mov_b32 v93, v5
v_mov_b32 v94, v5
v_mov_b32 v95, v5
L_aa_fs_110:
s_add_u32 s3, s23, 2
s_cmp_ge_u32 s3, 8
s_cbranch_scc1 L_aa_fs_111
v_mov_b32 v96, v5
v_mov_b32 v97, v5
v_mov_b32 v98, v5
v_mov_b32 v99, v5
v_mov_b32 v100, v5
v_mov_b32 v101, v5
v_mov_b32 v102, v5
v_mov_b32 v103, v5
v_mov_b32 v104, v5
v_mov_b32 v105, v5
v_mov_b32 v106, v5
v_mov_b32 v107, v5
v_mov_b32 v108, v5
v_mov_b32 v109, v5
v_mov_b32 v110, v5
v_mov_b32 v111, v5
L_aa_fs_111:
s_add_u32 s3, s23, 3
s_cmp_ge_u32 s3, 8
s_cbranch_scc1 L_aa_fs_112
v_mov_b32 v112, v5
v_mov_b32 v113, v5
v_mov_b32 v114, v5
v_mov_b32 v115, v5
v_mov_b32 v116, v5
v_mov_b32 v117, v5
v_mov_b32 v118, v5
v_mov_b32 v119, v5
v_mov_b32 v120, v5
v_mov_b32 v121, v5
v_mov_b32 v122, v5
v_mov_b32 v123, v5
v_mov_b32 v124, v5
v_mov_b32 v125, v5
v_mov_b32 v126, v5
v_mov_b32 v127, v5
L_aa_fs_112:
s_add_u32 s3, s23, 4
s_cmp_ge_u32 s3, 8
s_cbranch_scc1 L_aa_fs_113
v_mov_b32 v128, v5
v_mov_b32 v129, v5
v_mov_b32 v130, v5
v_mov_b32 v131, v5
v_mov_b32 v132, v5
v_mov_b32 v133, v5
v_mov_b32 v134, v5
v_mov_b32 v135, v5
v_mov_b32 v136, v5
v_mov_b32 v137, v5
v_mov_b32 v138, v5
v_mov_b32 v139, v5
v_mov_b32 v140, v5
v_mov_b32 v141, v5
v_mov_b32 v142, v5
v_mov_b32 v143, v5
L_aa_fs_113:
s_add_u32 s3, s23, 5
s_cmp_ge_u32 s3, 8
s_cbranch_scc1 L_aa_fs_114
v_mov_b32 v144, v5
v_mov_b32 v145, v5
v_mov_b32 v146, v5
v_mov_b32 v147, v5
v_mov_b32 v148, v5
v_mov_b32 v149, v5
v_mov_b32 v150, v5
v_mov_b32 v151, v5
v_mov_b32 v152, v5
v_mov_b32 v153, v5
v_mov_b32 v154, v5
v_mov_b32 v155, v5
v_mov_b32 v156, v5
v_mov_b32 v157, v5
v_mov_b32 v158, v5
v_mov_b32 v159, v5
L_aa_fs_114:
s_add_u32 s3, s23, 6
s_cmp_ge_u32 s3, 8
s_cbranch_scc1 L_aa_fs_115
v_mov_b32 v160, v5
v_mov_b32 v161, v5
v_mov_b32 v162, v5
v_mov_b32 v163, v5
v_mov_b32 v164, v5
v_mov_b32 v165, v5
v_mov_b32 v166, v5
v_mov_b32 v167, v5
v_mov_b32 v168, v5
v_mov_b32 v169, v5
v_mov_b32 v170, v5
v_mov_b32 v171, v5
v_mov_b32 v172, v5
v_mov_b32 v173, v5
v_mov_b32 v174, v5
v_mov_b32 v175, v5
L_aa_fs_115:
s_add_u32 s3, s23, 7
s_cmp_ge_u32 s3, 8
s_cbranch_scc1 L_aa_fs_116
v_mov_b32 v176, v5
v_mov_b32 v177, v5
v_mov_b32 v178, v5
v_mov_b32 v179, v5
v_mov_b32 v180, v5
v_mov_b32 v181, v5
v_mov_b32 v182, v5
v_mov_b32 v183, v5
v_mov_b32 v184, v5
v_mov_b32 v185, v5
v_mov_b32 v186, v5
v_mov_b32 v187, v5
v_mov_b32 v188, v5
v_mov_b32 v189, v5
v_mov_b32 v190, v5
v_mov_b32 v191, v5
L_aa_fs_116:
s_nop 0
s_branch L_aa_back_108
s_endpgm
L_R_fin:
v_and_b32 v1, 63, v0
v_lshlrev_b32 v2, 4, v1
v_add_u32 v3, 61440, v2
v_add_u32 v4, 122880, v2
s_mov_b32 s32, 0x05040100
s_mov_b32 s33, 0x07060302
s_mov_b32 s64, 0x00003f80
s_mov_b32 s65, 0x3f800000
s_mov_b32 s66, 0x3f803f80
s_mov_b32 s67, 0xffff0000
s_mov_b32 s68, 0x3ae38e39
s_mov_b32 s69, 0x3727c5ac
s_load_dwordx2 s[90:91], s[0:1], 0
s_waitcnt lgkmcnt(0)
s_mov_b32 s8, s90
s_and_b32 s9, s91, 0xffff
s_mov_b32 s10, 0x240000
s_mov_b32 s11, 0x20000
s_load_dwordx2 s[90:91], s[0:1], 80
s_waitcnt lgkmcnt(0)
s_mov_b32 s12, s90
s_and_b32 s13, s91, 0xffff
s_mov_b32 s14, 0x240000
s_mov_b32 s15, 0x20000
s_mov_b32 s39, 0x7fff0000
s_cmp_lt_u32 s60, 2
s_cbranch_scc1 L_fin_sync
s_sub_u32 s3, s60, 2
s_mul_i32 s23, s20, 8
s_add_u32 s3, s3, s23
s_lshr_b32 s23, s3, 2
s_and_b32 s3, s3, 3
s_lshl_b32 s3, s3, 3
v_and_b32 v8, 7, v1
v_add_u32 v8, s3, v8
v_lshrrev_b32 v9, 3, v1
v_lshrrev_b32 v10, 1, v9
v_lshlrev_b32 v10, 10, v10
v_and_b32 v11, 1, v9
v_lshl_add_u32 v10, v11, 9, v10
v_lshl_add_u32 v5, v8, 4, v10
v_mul_u32_u24 v10, 1152, v8
v_lshl_add_u32 v6, v9, 4, v10
s_mov_b32 s70, 0x0
s_mul_i32 s3, s23, 0x9000
s_add_u32 s70, s70, s3
s_mov_b32 s73, 0x500000
s_mul_i32 s3, s23, 0x9000
s_add_u32 s73, s73, s3
s_mov_b32 s29, 0x0
s_mul_i32 s3, s23, 0x40
s_add_u32 s29, s29, s3
s_mov_b32 s62, 0
L_fin_top0:
s_cmp_lg_u32 s62, 1
s_cbranch_scc1 L_fin_ns_117
s_mov_b32 s63, s39
s_mov_b32 s39, 0x7fff0000
s_mov_b32 s85, 0
s_waitcnt vmcnt(0) lgkmcnt(0)
s_cmp_lg_u32 s20, 0
s_cbranch_scc1 L_walld_119
s_mov_b32 s91, 0
L_wall_118:
buffer_load_dword v15, off, s[16:19], 0 sc1
s_add_u32 s91, s91, 1
s_cmp_gt_u32 s91, 200000
s_cbranch_scc1 L_FAIL
s_waitcnt vmcnt(0)
v_cmp_gt_u32 vcc, 32, v15
s_nop 0
s_nop 2
s_cbranch_vccz L_walld_119
s_sleep 4
s_branch L_wall_118
L_walld_119:
s_barrier
s_mov_b32 s39, s63
L_fin_ns_117:
s_add_u32 s62, s62, 1
s_waitcnt vmcnt(0)
s_mov_b64 exec, 1
v_mov_b32 v13, 1
buffer_atomic_add v13, off, s[4:7], s39 sc1
s_mov_b64 exec, -1
buffer_load_dwordx4 v[16:19], v6, s[8:11], s70 offen offset:0
buffer_load_dwordx4 v[20:23], v6, s[8:11], s70 offen offset:128
buffer_load_dwordx4 v[24:27], v6, s[8:11], s70 offen offset:256
buffer_load_dwordx4 v[28:31], v6, s[8:11], s70 offen offset:384
buffer_load_dwordx4 v[32:35], v6, s[8:11], s70 offen offset:512
buffer_load_dwordx4 v[36:39], v6, s[8:11], s70 offen offset:640
buffer_load_dwordx4 v[40:43], v6, s[8:11], s70 offen offset:768
buffer_load_dwordx4 v[44:47], v6, s[8:11], s70 offen offset:896
buffer_load_dwordx4 v[48:51], v6, s[8:11], s70 offen offset:1024
s_waitcnt vmcnt(8)
v_lshlrev_b32 v128, 16, v16
v_and_b32 v129, s67, v16
v_lshlrev_b32 v130, 16, v17
v_and_b32 v131, s67, v17
v_lshlrev_b32 v132, 16, v18
v_and_b32 v133, s67, v18
v_lshlrev_b32 v134, 16, v19
v_and_b32 v135, s67, v19
s_waitcnt vmcnt(7)
v_lshlrev_b32 v136, 16, v20
v_and_b32 v137, s67, v20
v_lshlrev_b32 v138, 16, v21
v_and_b32 v139, s67, v21
v_lshlrev_b32 v140, 16, v22
v_and_b32 v141, s67, v22
v_lshlrev_b32 v142, 16, v23
v_and_b32 v143, s67, v23
s_waitcnt vmcnt(6)
v_lshlrev_b32 v144, 16, v24
v_and_b32 v145, s67, v24
v_lshlrev_b32 v146, 16, v25
v_and_b32 v147, s67, v25
v_lshlrev_b32 v148, 16, v26
v_and_b32 v149, s67, v26
v_lshlrev_b32 v150, 16, v27
v_and_b32 v151, s67, v27
s_waitcnt vmcnt(5)
v_lshlrev_b32 v152, 16, v28
v_and_b32 v153, s67, v28
v_lshlrev_b32 v154, 16, v29
v_and_b32 v155, s67, v29
v_lshlrev_b32 v156, 16, v30
v_and_b32 v157, s67, v30
v_lshlrev_b32 v158, 16, v31
v_and_b32 v159, s67, v31
s_waitcnt vmcnt(4)
v_lshlrev_b32 v160, 16, v32
v_and_b32 v161, s67, v32
v_lshlrev_b32 v162, 16, v33
v_and_b32 v163, s67, v33
v_lshlrev_b32 v164, 16, v34
v_and_b32 v165, s67, v34
v_lshlrev_b32 v166, 16, v35
v_and_b32 v167, s67, v35
s_waitcnt vmcnt(3)
v_lshlrev_b32 v168, 16, v36
v_and_b32 v169, s67, v36
v_lshlrev_b32 v170, 16, v37
v_and_b32 v171, s67, v37
v_lshlrev_b32 v172, 16, v38
v_and_b32 v173, s67, v38
v_lshlrev_b32 v174, 16, v39
v_and_b32 v175, s67, v39
s_waitcnt vmcnt(2)
v_lshlrev_b32 v176, 16, v40
v_and_b32 v177, s67, v40
v_lshlrev_b32 v178, 16, v41
v_and_b32 v179, s67, v41
v_lshlrev_b32 v180, 16, v42
v_and_b32 v181, s67, v42
v_lshlrev_b32 v182, 16, v43
v_and_b32 v183, s67, v43
s_waitcnt vmcnt(1)
v_lshlrev_b32 v184, 16, v44
v_and_b32 v185, s67, v44
v_lshlrev_b32 v186, 16, v45
v_and_b32 v187, s67, v45
v_lshlrev_b32 v188, 16, v46
v_and_b32 v189, s67, v46
v_lshlrev_b32 v190, 16, v47
v_and_b32 v191, s67, v47
s_waitcnt vmcnt(0)
v_lshlrev_b32 v192, 16, v48
v_and_b32 v193, s67, v48
v_lshlrev_b32 v194, 16, v49
v_and_b32 v195, s67, v49
v_lshlrev_b32 v196, 16, v50
v_and_b32 v197, s67, v50
v_lshlrev_b32 v198, 16, v51
v_and_b32 v199, s67, v51
v_pk_add_f32 v[208:209], v[128:129], v[136:137]
v_pk_add_f32 v[210:211], v[130:131], v[138:139]
v_pk_add_f32 v[212:213], v[132:133], v[140:141]
v_pk_add_f32 v[214:215], v[134:135], v[142:143]
v_pk_add_f32 v[208:209], v[208:209], v[144:145]
v_pk_add_f32 v[210:211], v[210:211], v[146:147]
v_pk_add_f32 v[212:213], v[212:213], v[148:149]
v_pk_add_f32 v[214:215], v[214:215], v[150:151]
v_pk_add_f32 v[208:209], v[208:209], v[152:153]
v_pk_add_f32 v[210:211], v[210:211], v[154:155]
v_pk_add_f32 v[212:213], v[212:213], v[156:157]
v_pk_add_f32 v[214:215], v[214:215], v[158:159]
v_pk_add_f32 v[208:209], v[208:209], v[160:161]
v_pk_add_f32 v[210:211], v[210:211], v[162:163]
v_pk_add_f32 v[212:213], v[212:213], v[164:165]
v_pk_add_f32 v[214:215], v[214:215], v[166:167]
v_pk_add_f32 v[208:209], v[208:209], v[168:169]
v_pk_add_f32 v[210:211], v[210:211], v[170:171]
v_pk_add_f32 v[212:213], v[212:213], v[172:173]
v_pk_add_f32 v[214:215], v[214:215], v[174:175]
v_pk_add_f32 v[208:209], v[208:209], v[176:177]
v_pk_add_f32 v[210:211], v[210:211], v[178:179]
v_pk_add_f32 v[212:213], v[212:213], v[180:181]
v_pk_add_f32 v[214:215], v[214:215], v[182:183]
v_pk_add_f32 v[208:209], v[208:209], v[184:185]
v_pk_add_f32 v[210:211], v[210:211], v[186:187]
v_pk_add_f32 v[212:213], v[212:213], v[188:189]
v_pk_add_f32 v[214:215], v[214:215], v[190:191]
v_pk_add_f32 v[208:209], v[208:209], v[192:193]
v_pk_add_f32 v[210:211], v[210:211], v[194:195]
v_pk_add_f32 v[212:213], v[212:213], v[196:197]
v_pk_add_f32 v[214:215], v[214:215], v[198:199]
v_pk_add_f32 v[208:209], v[208:209], v[210:211]
v_pk_add_f32 v[212:213], v[212:213], v[214:215]
v_pk_add_f32 v[208:209], v[208:209], v[212:213]
v_add_f32 v208, v208, v209
s_nop 1
v_add_f32_dpp v208, v208, v208 row_ror:8 row_mask:0xf bank_mask:0xf
v_mov_b32 v209, v208
s_nop 1
v_permlane16_swap_b32 v208, v209
v_add_f32 v208, v208, v209
v_mov_b32 v209, v208
s_nop 1
v_permlane32_swap_b32 v208, v209
v_add_f32 v208, v208, v209
v_mul_f32 v208, s68, v208
v_sub_f32 v216, 0, v208
v_mov_b32 v217, v216
v_pk_add_f32 v[128:129], v[128:129], v[216:217]
v_pk_add_f32 v[130:131], v[130:131], v[216:217]
v_pk_add_f32 v[132:133], v[132:133], v[216:217]
v_pk_add_f32 v[134:135], v[134:135], v[216:217]
v_pk_add_f32 v[136:137], v[136:137], v[216:217]
v_pk_add_f32 v[138:139], v[138:139], v[216:217]
v_pk_add_f32 v[140:141], v[140:141], v[216:217]
v_pk_add_f32 v[142:143], v[142:143], v[216:217]
v_pk_add_f32 v[144:145], v[144:145], v[216:217]
v_pk_add_f32 v[146:147], v[146:147], v[216:217]
v_pk_add_f32 v[148:149], v[148:149], v[216:217]
v_pk_add_f32 v[150:151], v[150:151], v[216:217]
v_pk_add_f32 v[152:153], v[152:153], v[216:217]
v_pk_add_f32 v[154:155], v[154:155], v[216:217]
v_pk_add_f32 v[156:157], v[156:157], v[216:217]
v_pk_add_f32 v[158:159], v[158:159], v[216:217]
v_pk_add_f32 v[160:161], v[160:161], v[216:217]
v_pk_add_f32 v[162:163], v[162:163], v[216:217]
v_pk_add_f32 v[164:165], v[164:165], v[216:217]
v_pk_add_f32 v[166:167], v[166:167], v[216:217]
v_pk_add_f32 v[168:169], v[168:169], v[216:217]
v_pk_add_f32 v[170:171], v[170:171], v[216:217]
v_pk_add_f32 v[172:173], v[172:173], v[216:217]
v_pk_add_f32 v[174:175], v[174:175], v[216:217]
v_pk_add_f32 v[176:177], v[176:177], v[216:217]
v_pk_add_f32 v[178:179], v[178:179], v[216:217]
v_pk_add_f32 v[180:181], v[180:181], v[216:217]
v_pk_add_f32 v[182:183], v[182:183], v[216:217]
v_pk_add_f32 v[184:185], v[184:185], v[216:217]
v_pk_add_f32 v[186:187], v[186:187], v[216:217]
v_pk_add_f32 v[188:189], v[188:189], v[216:217]
v_pk_add_f32 v[190:191], v[190:191], v[216:217]
v_pk_add_f32 v[192:193], v[192:193], v[216:217]
v_pk_add_f32 v[194:195], v[194:195], v[216:217]
v_pk_add_f32 v[196:197], v[196:197], v[216:217]
v_pk_add_f32 v[198:199], v[198:199], v[216:217]
v_pk_mul_f32 v[208:209], v[128:129], v[128:129]
v_pk_mul_f32 v[210:211], v[130:131], v[130:131]
v_pk_mul_f32 v[212:213], v[132:133], v[132:133]
v_pk_mul_f32 v[214:215], v[134:135], v[134:135]
v_pk_fma_f32 v[208:209], v[136:137], v[136:137], v[208:209]
v_pk_fma_f32 v[210:211], v[138:139], v[138:139], v[210:211]
v_pk_fma_f32 v[212:213], v[140:141], v[140:141], v[212:213]
v_pk_fma_f32 v[214:215], v[142:143], v[142:143], v[214:215]
v_pk_fma_f32 v[208:209], v[144:145], v[144:145], v[208:209]
v_pk_fma_f32 v[210:211], v[146:147], v[146:147], v[210:211]
v_pk_fma_f32 v[212:213], v[148:149], v[148:149], v[212:213]
v_pk_fma_f32 v[214:215], v[150:151], v[150:151], v[214:215]
v_pk_fma_f32 v[208:209], v[152:153], v[152:153], v[208:209]
v_pk_fma_f32 v[210:211], v[154:155], v[154:155], v[210:211]
v_pk_fma_f32 v[212:213], v[156:157], v[156:157], v[212:213]
v_pk_fma_f32 v[214:215], v[158:159], v[158:159], v[214:215]
v_pk_fma_f32 v[208:209], v[160:161], v[160:161], v[208:209]
v_pk_fma_f32 v[210:211], v[162:163], v[162:163], v[210:211]
v_pk_fma_f32 v[212:213], v[164:165], v[164:165], v[212:213]
v_pk_fma_f32 v[214:215], v[166:167], v[166:167], v[214:215]
v_pk_fma_f32 v[208:209], v[168:169], v[168:169], v[208:209]
v_pk_fma_f32 v[210:211], v[170:171], v[170:171], v[210:211]
v_pk_fma_f32 v[212:213], v[172:173], v[172:173], v[212:213]
v_pk_fma_f32 v[214:215], v[174:175], v[174:175], v[214:215]
v_pk_fma_f32 v[208:209], v[176:177], v[176:177], v[208:209]
v_pk_fma_f32 v[210:211], v[178:179], v[178:179], v[210:211]
v_pk_fma_f32 v[212:213], v[180:181], v[180:181], v[212:213]
v_pk_fma_f32 v[214:215], v[182:183], v[182:183], v[214:215]
v_pk_fma_f32 v[208:209], v[184:185], v[184:185], v[208:209]
v_pk_fma_f32 v[210:211], v[186:187], v[186:187], v[210:211]
v_pk_fma_f32 v[212:213], v[188:189], v[188:189], v[212:213]
v_pk_fma_f32 v[214:215], v[190:191], v[190:191], v[214:215]
v_pk_fma_f32 v[208:209], v[192:193], v[192:193], v[208:209]
v_pk_fma_f32 v[210:211], v[194:195], v[194:195], v[210:211]
v_pk_fma_f32 v[212:213], v[196:197], v[196:197], v[212:213]
v_pk_fma_f32 v[214:215], v[198:199], v[198:199], v[214:215]
v_pk_add_f32 v[208:209], v[208:209], v[210:211]
v_pk_add_f32 v[212:213], v[212:213], v[214:215]
v_pk_add_f32 v[208:209], v[208:209], v[212:213]
v_add_f32 v208, v208, v209
s_nop 1
v_add_f32_dpp v208, v208, v208 row_ror:8 row_mask:0xf bank_mask:0xf
v_mov_b32 v209, v208
s_nop 1
v_permlane16_swap_b32 v208, v209
v_add_f32 v208, v208, v209
v_mov_b32 v209, v208
s_nop 1
v_permlane32_swap_b32 v208, v209
v_add_f32 v208, v208, v209
v_mov_b32 v209, s69
v_fma_f32 v208, v208, s68, v209
v_rsq_f32 v216, v208
s_nop 0
v_mov_b32 v217, v216
v_pk_mul_f32 v[128:129], v[128:129], v[216:217]
v_pk_mul_f32 v[130:131], v[130:131], v[216:217]
v_pk_mul_f32 v[132:133], v[132:133], v[216:217]
v_pk_mul_f32 v[134:135], v[134:135], v[216:217]
v_cvt_pk_bf16_f32 v64, v128, v129
v_cvt_pk_bf16_f32 v65, v130, v131
v_cvt_pk_bf16_f32 v66, v132, v133
v_cvt_pk_bf16_f32 v67, v134, v135
s_add_u32 s34, s73, 0
buffer_store_dwordx4 v[64:67], v5, s[4:7], s34 offen sc1
v_pk_mul_f32 v[136:137], v[136:137], v[216:217]
v_pk_mul_f32 v[138:139], v[138:139], v[216:217]
v_pk_mul_f32 v[140:141], v[140:141], v[216:217]
v_pk_mul_f32 v[142:143], v[142:143], v[216:217]
v_cvt_pk_bf16_f32 v68, v136, v137
v_cvt_pk_bf16_f32 v69, v138, v139
v_cvt_pk_bf16_f32 v70, v140, v141
v_cvt_pk_bf16_f32 v71, v142, v143
s_add_u32 s34, s73, 4096
buffer_store_dwordx4 v[68:71], v5, s[4:7], s34 offen sc1
v_pk_mul_f32 v[144:145], v[144:145], v[216:217]
v_pk_mul_f32 v[146:147], v[146:147], v[216:217]
v_pk_mul_f32 v[148:149], v[148:149], v[216:217]
v_pk_mul_f32 v[150:151], v[150:151], v[216:217]
v_cvt_pk_bf16_f32 v72, v144, v145
v_cvt_pk_bf16_f32 v73, v146, v147
v_cvt_pk_bf16_f32 v74, v148, v149
v_cvt_pk_bf16_f32 v75, v150, v151
s_add_u32 s34, s73, 8192
buffer_store_dwordx4 v[72:75], v5, s[4:7], s34 offen sc1
v_pk_mul_f32 v[152:153], v[152:153], v[216:217]
v_pk_mul_f32 v[154:155], v[154:155], v[216:217]
v_pk_mul_f32 v[156:157], v[156:157], v[216:217]
v_pk_mul_f32 v[158:159], v[158:159], v[216:217]
v_cvt_pk_bf16_f32 v76, v152, v153
v_cvt_pk_bf16_f32 v77, v154, v155
v_cvt_pk_bf16_f32 v78, v156, v157
v_cvt_pk_bf16_f32 v79, v158, v159
s_add_u32 s34, s73, 12288
buffer_store_dwordx4 v[76:79], v5, s[4:7], s34 offen sc1
v_pk_mul_f32 v[160:161], v[160:161], v[216:217]
v_pk_mul_f32 v[162:163], v[162:163], v[216:217]
v_pk_mul_f32 v[164:165], v[164:165], v[216:217]
v_pk_mul_f32 v[166:167], v[166:167], v[216:217]
v_cvt_pk_bf16_f32 v80, v160, v161
v_cvt_pk_bf16_f32 v81, v162, v163
v_cvt_pk_bf16_f32 v82, v164, v165
v_cvt_pk_bf16_f32 v83, v166, v167
s_add_u32 s34, s73, 16384
buffer_store_dwordx4 v[80:83], v5, s[4:7], s34 offen sc1
v_pk_mul_f32 v[168:169], v[168:169], v[216:217]
v_pk_mul_f32 v[170:171], v[170:171], v[216:217]
v_pk_mul_f32 v[172:173], v[172:173], v[216:217]
v_pk_mul_f32 v[174:175], v[174:175], v[216:217]
v_cvt_pk_bf16_f32 v84, v168, v169
v_cvt_pk_bf16_f32 v85, v170, v171
v_cvt_pk_bf16_f32 v86, v172, v173
v_cvt_pk_bf16_f32 v87, v174, v175
s_add_u32 s34, s73, 20480
buffer_store_dwordx4 v[84:87], v5, s[4:7], s34 offen sc1
v_pk_mul_f32 v[176:177], v[176:177], v[216:217]
v_pk_mul_f32 v[178:179], v[178:179], v[216:217]
v_pk_mul_f32 v[180:181], v[180:181], v[216:217]
v_pk_mul_f32 v[182:183], v[182:183], v[216:217]
v_cvt_pk_bf16_f32 v88, v176, v177
v_cvt_pk_bf16_f32 v89, v178, v179
v_cvt_pk_bf16_f32 v90, v180, v181
v_cvt_pk_bf16_f32 v91, v182, v183
s_add_u32 s34, s73, 24576
buffer_store_dwordx4 v[88:91], v5, s[4:7], s34 offen sc1
v_pk_mul_f32 v[184:185], v[184:185], v[216:217]
v_pk_mul_f32 v[186:187], v[186:187], v[216:217]
v_pk_mul_f32 v[188:189], v[188:189], v[216:217]
v_pk_mul_f32 v[190:191], v[190:191], v[216:217]
v_cvt_pk_bf16_f32 v92, v184, v185
v_cvt_pk_bf16_f32 v93, v186, v187
v_cvt_pk_bf16_f32 v94, v188, v189
v_cvt_pk_bf16_f32 v95, v190, v191
s_add_u32 s34, s73, 28672
buffer_store_dwordx4 v[92:95], v5, s[4:7], s34 offen sc1
v_pk_mul_f32 v[192:193], v[192:193], v[216:217]
v_pk_mul_f32 v[194:195], v[194:195], v[216:217]
v_pk_mul_f32 v[196:197], v[196:197], v[216:217]
v_pk_mul_f32 v[198:199], v[198:199], v[216:217]
v_cvt_pk_bf16_f32 v96, v192, v193
v_cvt_pk_bf16_f32 v97, v194, v195
v_cvt_pk_bf16_f32 v98, v196, v197
v_cvt_pk_bf16_f32 v99, v198, v199
s_add_u32 s34, s73, 32768
buffer_store_dwordx4 v[96:99], v5, s[4:7], s34 offen sc1
s_mov_b32 s39, s29
s_add_u32 s70, s70, 294912
s_add_u32 s73, s73, 294912
s_add_u32 s29, s29, 512
s_add_u32 s23, s23, 8
s_cmp_lt_u32 s23, 64
s_cbranch_scc1 L_fin_top0
s_waitcnt vmcnt(0)
s_mov_b64 exec, 1
v_mov_b32 v13, 1
buffer_atomic_add v13, off, s[4:7], s39 sc1
s_mov_b64 exec, -1
s_mov_b32 s39, 0x7fff0000
s_branch L_fin_go
L_fin_sync:
s_mov_b32 s39, 0x7fff0000
s_mov_b32 s85, 0
s_waitcnt vmcnt(0) lgkmcnt(0)
s_cmp_lg_u32 s20, 0
s_cbranch_scc1 L_walld_121
s_mov_b32 s91, 0
L_wall_120:
buffer_load_dword v15, off, s[16:19], 0 sc1
s_add_u32 s91, s91, 1
s_cmp_gt_u32 s91, 200000
s_cbranch_scc1 L_FAIL
s_waitcnt vmcnt(0)
v_cmp_gt_u32 vcc, 32, v15
s_nop 0
s_nop 2
s_cbranch_vccz L_walld_121
s_sleep 4
s_branch L_wall_120
L_walld_121:
s_barrier
L_fin_go:
s_cmp_ge_u32 s60, 2
s_cbranch_scc1 L_fin_n1
s_sub_u32 s3, s60, 0
s_mul_i32 s23, s20, 2
s_add_u32 s3, s3, s23
s_lshr_b32 s23, s3, 2
s_and_b32 s3, s3, 3
s_lshl_b32 s3, s3, 3
v_and_b32 v8, 7, v1
v_add_u32 v8, s3, v8
v_lshrrev_b32 v9, 3, v1
v_lshrrev_b32 v10, 1, v9
v_lshlrev_b32 v10, 10, v10
v_and_b32 v11, 1, v9
v_lshl_add_u32 v10, v11, 9, v10
v_lshl_add_u32 v5, v8, 4, v10
v_mul_u32_u24 v10, 1152, v8
v_lshl_add_u32 v6, v9, 4, v10
s_mov_b32 s70, 0x0
s_mul_i32 s3, s23, 0x9000
s_add_u32 s70, s70, s3
s_mov_b32 s71, 0x1500000
s_mul_i32 s3, s23, 0x9000
s_add_u32 s71, s71, s3
s_mov_b32 s28, 0x8000
s_mul_i32 s3, s23, 0x40
s_add_u32 s28, s28, s3
s_mov_b32 s72, 0xe00000
s_mul_i32 s3, s23, 0x9000
s_add_u32 s72, s72, s3
s_mov_b32 s73, 0x740000
s_mul_i32 s3, s23, 0x9000
s_add_u32 s73, s73, s3
s_mov_b32 s29, 0x1000
s_mul_i32 s3, s23, 0x40
s_add_u32 s29, s29, s3
L_fin_top1:
buffer_load_dword v15, off, s[4:7], s28 sc1
s_mov_b32 s91, 0
s_waitcnt vmcnt(0)
s_mov_b64 exec, 1
v_mov_b32 v13, 1
buffer_atomic_add v13, off, s[4:7], s39 sc1
s_mov_b64 exec, -1
v_cmp_gt_u32 vcc, 5, v15
s_nop 0
s_nop 2
s_cbranch_vccz L_spd_123
L_sp_122:
buffer_load_dword v15, off, s[4:7], s28 sc1
s_add_u32 s91, s91, 1
s_cmp_gt_u32 s91, 200000
s_cbranch_scc1 L_FAIL
s_waitcnt vmcnt(0)
v_cmp_gt_u32 vcc, 5, v15
s_nop 0
s_nop 2
s_cbranch_vccnz L_sp_122
L_spd_123:
buffer_load_dwordx4 v[16:19], v6, s[8:11], s70 offen offset:0
buffer_load_dwordx4 v[20:23], v6, s[8:11], s70 offen offset:128
buffer_load_dwordx4 v[24:27], v6, s[8:11], s70 offen offset:256
buffer_load_dwordx4 v[28:31], v6, s[8:11], s70 offen offset:384
buffer_load_dwordx4 v[32:35], v6, s[8:11], s70 offen offset:512
buffer_load_dwordx4 v[36:39], v6, s[8:11], s70 offen offset:640
buffer_load_dwordx4 v[40:43], v6, s[8:11], s70 offen offset:768
buffer_load_dwordx4 v[44:47], v6, s[8:11], s70 offen offset:896
buffer_load_dwordx4 v[48:51], v6, s[8:11], s70 offen offset:1024
s_add_u32 s34, s71, 0
buffer_load_dwordx4 v[64:67], v5, s[4:7], s34 offen
s_add_u32 s34, s71, 4096
buffer_load_dwordx4 v[68:71], v5, s[4:7], s34 offen
s_add_u32 s34, s71, 8192
buffer_load_dwordx4 v[72:75], v5, s[4:7], s34 offen
s_add_u32 s34, s71, 12288
buffer_load_dwordx4 v[76:79], v5, s[4:7], s34 offen
s_add_u32 s34, s71, 16384
buffer_load_dwordx4 v[80:83], v5, s[4:7], s34 offen
s_add_u32 s34, s71, 20480
buffer_load_dwordx4 v[84:87], v5, s[4:7], s34 offen
s_add_u32 s34, s71, 24576
buffer_load_dwordx4 v[88:91], v5, s[4:7], s34 offen
s_add_u32 s34, s71, 28672
buffer_load_dwordx4 v[92:95], v5, s[4:7], s34 offen
s_add_u32 s34, s71, 32768
buffer_load_dwordx4 v[96:99], v5, s[4:7], s34 offen
s_waitcnt vmcnt(8)
v_lshlrev_b32 v128, 16, v16
v_and_b32 v129, s67, v16
v_lshlrev_b32 v130, 16, v17
v_and_b32 v131, s67, v17
v_lshlrev_b32 v132, 16, v18
v_and_b32 v133, s67, v18
v_lshlrev_b32 v134, 16, v19
v_and_b32 v135, s67, v19
v_dot2_f32_bf16 v128, v64, s64, v128
v_dot2_f32_bf16 v129, v64, s65, v129
v_dot2_f32_bf16 v130, v65, s64, v130
v_dot2_f32_bf16 v131, v65, s65, v131
v_dot2_f32_bf16 v132, v66, s64, v132
v_dot2_f32_bf16 v133, v66, s65, v133
v_dot2_f32_bf16 v134, v67, s64, v134
v_dot2_f32_bf16 v135, v67, s65, v135
v_cvt_pk_bf16_f32 v16, v128, v129
v_cvt_pk_bf16_f32 v17, v130, v131
v_cvt_pk_bf16_f32 v18, v132, v133
v_cvt_pk_bf16_f32 v19, v134, v135
s_add_u32 s34, s72, 0
buffer_store_dwordx4 v[16:19], v5, s[4:7], s34 offen sc1
v_lshlrev_b32 v128, 16, v16
v_and_b32 v129, s67, v16
v_lshlrev_b32 v130, 16, v17
v_and_b32 v131, s67, v17
v_lshlrev_b32 v132, 16, v18
v_and_b32 v133, s67, v18
v_lshlrev_b32 v134, 16, v19
v_and_b32 v135, s67, v19
s_waitcnt vmcnt(8)
v_lshlrev_b32 v136, 16, v20
v_and_b32 v137, s67, v20
v_lshlrev_b32 v138, 16, v21
v_and_b32 v139, s67, v21
v_lshlrev_b32 v140, 16, v22
v_and_b32 v141, s67, v22
v_lshlrev_b32 v142, 16, v23
v_and_b32 v143, s67, v23
v_dot2_f32_bf16 v136, v68, s64, v136
v_dot2_f32_bf16 v137, v68, s65, v137
v_dot2_f32_bf16 v138, v69, s64, v138
v_dot2_f32_bf16 v139, v69, s65, v139
v_dot2_f32_bf16 v140, v70, s64, v140
v_dot2_f32_bf16 v141, v70, s65, v141
v_dot2_f32_bf16 v142, v71, s64, v142
v_dot2_f32_bf16 v143, v71, s65, v143
v_cvt_pk_bf16_f32 v20, v136, v137
v_cvt_pk_bf16_f32 v21, v138, v139
v_cvt_pk_bf16_f32 v22, v140, v141
v_cvt_pk_bf16_f32 v23, v142, v143
s_add_u32 s34, s72, 4096
buffer_store_dwordx4 v[20:23], v5, s[4:7], s34 offen sc1
v_lshlrev_b32 v136, 16, v20
v_and_b32 v137, s67, v20
v_lshlrev_b32 v138, 16, v21
v_and_b32 v139, s67, v21
v_lshlrev_b32 v140, 16, v22
v_and_b32 v141, s67, v22
v_lshlrev_b32 v142, 16, v23
v_and_b32 v143, s67, v23
s_waitcnt vmcnt(8)
v_lshlrev_b32 v144, 16, v24
v_and_b32 v145, s67, v24
v_lshlrev_b32 v146, 16, v25
v_and_b32 v147, s67, v25
v_lshlrev_b32 v148, 16, v26
v_and_b32 v149, s67, v26
v_lshlrev_b32 v150, 16, v27
v_and_b32 v151, s67, v27
v_dot2_f32_bf16 v144, v72, s64, v144
v_dot2_f32_bf16 v145, v72, s65, v145
v_dot2_f32_bf16 v146, v73, s64, v146
v_dot2_f32_bf16 v147, v73, s65, v147
v_dot2_f32_bf16 v148, v74, s64, v148
v_dot2_f32_bf16 v149, v74, s65, v149
v_dot2_f32_bf16 v150, v75, s64, v150
v_dot2_f32_bf16 v151, v75, s65, v151
v_cvt_pk_bf16_f32 v24, v144, v145
v_cvt_pk_bf16_f32 v25, v146, v147
v_cvt_pk_bf16_f32 v26, v148, v149
v_cvt_pk_bf16_f32 v27, v150, v151
s_add_u32 s34, s72, 8192
buffer_store_dwordx4 v[24:27], v5, s[4:7], s34 offen sc1
v_lshlrev_b32 v144, 16, v24
v_and_b32 v145, s67, v24
v_lshlrev_b32 v146, 16, v25
v_and_b32 v147, s67, v25
v_lshlrev_b32 v148, 16, v26
v_and_b32 v149, s67, v26
v_lshlrev_b32 v150, 16, v27
v_and_b32 v151, s67, v27
s_waitcnt vmcnt(8)
v_lshlrev_b32 v152, 16, v28
v_and_b32 v153, s67, v28
v_lshlrev_b32 v154, 16, v29
v_and_b32 v155, s67, v29
v_lshlrev_b32 v156, 16, v30
v_and_b32 v157, s67, v30
v_lshlrev_b32 v158, 16, v31
v_and_b32 v159, s67, v31
v_dot2_f32_bf16 v152, v76, s64, v152
v_dot2_f32_bf16 v153, v76, s65, v153
v_dot2_f32_bf16 v154, v77, s64, v154
v_dot2_f32_bf16 v155, v77, s65, v155
v_dot2_f32_bf16 v156, v78, s64, v156
v_dot2_f32_bf16 v157, v78, s65, v157
v_dot2_f32_bf16 v158, v79, s64, v158
v_dot2_f32_bf16 v159, v79, s65, v159
v_cvt_pk_bf16_f32 v28, v152, v153
v_cvt_pk_bf16_f32 v29, v154, v155
v_cvt_pk_bf16_f32 v30, v156, v157
v_cvt_pk_bf16_f32 v31, v158, v159
s_add_u32 s34, s72, 12288
buffer_store_dwordx4 v[28:31], v5, s[4:7], s34 offen sc1
v_lshlrev_b32 v152, 16, v28
v_and_b32 v153, s67, v28
v_lshlrev_b32 v154, 16, v29
v_and_b32 v155, s67, v29
v_lshlrev_b32 v156, 16, v30
v_and_b32 v157, s67, v30
v_lshlrev_b32 v158, 16, v31
v_and_b32 v159, s67, v31
s_waitcnt vmcnt(8)
v_lshlrev_b32 v160, 16, v32
v_and_b32 v161, s67, v32
v_lshlrev_b32 v162, 16, v33
v_and_b32 v163, s67, v33
v_lshlrev_b32 v164, 16, v34
v_and_b32 v165, s67, v34
v_lshlrev_b32 v166, 16, v35
v_and_b32 v167, s67, v35
v_dot2_f32_bf16 v160, v80, s64, v160
v_dot2_f32_bf16 v161, v80, s65, v161
v_dot2_f32_bf16 v162, v81, s64, v162
v_dot2_f32_bf16 v163, v81, s65, v163
v_dot2_f32_bf16 v164, v82, s64, v164
v_dot2_f32_bf16 v165, v82, s65, v165
v_dot2_f32_bf16 v166, v83, s64, v166
v_dot2_f32_bf16 v167, v83, s65, v167
v_cvt_pk_bf16_f32 v32, v160, v161
v_cvt_pk_bf16_f32 v33, v162, v163
v_cvt_pk_bf16_f32 v34, v164, v165
v_cvt_pk_bf16_f32 v35, v166, v167
s_add_u32 s34, s72, 16384
buffer_store_dwordx4 v[32:35], v5, s[4:7], s34 offen sc1
v_lshlrev_b32 v160, 16, v32
v_and_b32 v161, s67, v32
v_lshlrev_b32 v162, 16, v33
v_and_b32 v163, s67, v33
v_lshlrev_b32 v164, 16, v34
v_and_b32 v165, s67, v34
v_lshlrev_b32 v166, 16, v35
v_and_b32 v167, s67, v35
s_waitcnt vmcnt(8)
v_lshlrev_b32 v168, 16, v36
v_and_b32 v169, s67, v36
v_lshlrev_b32 v170, 16, v37
v_and_b32 v171, s67, v37
v_lshlrev_b32 v172, 16, v38
v_and_b32 v173, s67, v38
v_lshlrev_b32 v174, 16, v39
v_and_b32 v175, s67, v39
v_dot2_f32_bf16 v168, v84, s64, v168
v_dot2_f32_bf16 v169, v84, s65, v169
v_dot2_f32_bf16 v170, v85, s64, v170
v_dot2_f32_bf16 v171, v85, s65, v171
v_dot2_f32_bf16 v172, v86, s64, v172
v_dot2_f32_bf16 v173, v86, s65, v173
v_dot2_f32_bf16 v174, v87, s64, v174
v_dot2_f32_bf16 v175, v87, s65, v175
v_cvt_pk_bf16_f32 v36, v168, v169
v_cvt_pk_bf16_f32 v37, v170, v171
v_cvt_pk_bf16_f32 v38, v172, v173
v_cvt_pk_bf16_f32 v39, v174, v175
s_add_u32 s34, s72, 20480
buffer_store_dwordx4 v[36:39], v5, s[4:7], s34 offen sc1
v_lshlrev_b32 v168, 16, v36
v_and_b32 v169, s67, v36
v_lshlrev_b32 v170, 16, v37
v_and_b32 v171, s67, v37
v_lshlrev_b32 v172, 16, v38
v_and_b32 v173, s67, v38
v_lshlrev_b32 v174, 16, v39
v_and_b32 v175, s67, v39
s_waitcnt vmcnt(8)
v_lshlrev_b32 v176, 16, v40
v_and_b32 v177, s67, v40
v_lshlrev_b32 v178, 16, v41
v_and_b32 v179, s67, v41
v_lshlrev_b32 v180, 16, v42
v_and_b32 v181, s67, v42
v_lshlrev_b32 v182, 16, v43
v_and_b32 v183, s67, v43
v_dot2_f32_bf16 v176, v88, s64, v176
v_dot2_f32_bf16 v177, v88, s65, v177
v_dot2_f32_bf16 v178, v89, s64, v178
v_dot2_f32_bf16 v179, v89, s65, v179
v_dot2_f32_bf16 v180, v90, s64, v180
v_dot2_f32_bf16 v181, v90, s65, v181
v_dot2_f32_bf16 v182, v91, s64, v182
v_dot2_f32_bf16 v183, v91, s65, v183
v_cvt_pk_bf16_f32 v40, v176, v177
v_cvt_pk_bf16_f32 v41, v178, v179
v_cvt_pk_bf16_f32 v42, v180, v181
v_cvt_pk_bf16_f32 v43, v182, v183
s_add_u32 s34, s72, 24576
buffer_store_dwordx4 v[40:43], v5, s[4:7], s34 offen sc1
v_lshlrev_b32 v176, 16, v40
v_and_b32 v177, s67, v40
v_lshlrev_b32 v178, 16, v41
v_and_b32 v179, s67, v41
v_lshlrev_b32 v180, 16, v42
v_and_b32 v181, s67, v42
v_lshlrev_b32 v182, 16, v43
v_and_b32 v183, s67, v43
s_waitcnt vmcnt(8)
v_lshlrev_b32 v184, 16, v44
v_and_b32 v185, s67, v44
v_lshlrev_b32 v186, 16, v45
v_and_b32 v187, s67, v45
v_lshlrev_b32 v188, 16, v46
v_and_b32 v189, s67, v46
v_lshlrev_b32 v190, 16, v47
v_and_b32 v191, s67, v47
v_dot2_f32_bf16 v184, v92, s64, v184
v_dot2_f32_bf16 v185, v92, s65, v185
v_dot2_f32_bf16 v186, v93, s64, v186
v_dot2_f32_bf16 v187, v93, s65, v187
v_dot2_f32_bf16 v188, v94, s64, v188
v_dot2_f32_bf16 v189, v94, s65, v189
v_dot2_f32_bf16 v190, v95, s64, v190
v_dot2_f32_bf16 v191, v95, s65, v191
v_cvt_pk_bf16_f32 v44, v184, v185
v_cvt_pk_bf16_f32 v45, v186, v187
v_cvt_pk_bf16_f32 v46, v188, v189
v_cvt_pk_bf16_f32 v47, v190, v191
s_add_u32 s34, s72, 28672
buffer_store_dwordx4 v[44:47], v5, s[4:7], s34 offen sc1
v_lshlrev_b32 v184, 16, v44
v_and_b32 v185, s67, v44
v_lshlrev_b32 v186, 16, v45
v_and_b32 v187, s67, v45
v_lshlrev_b32 v188, 16, v46
v_and_b32 v189, s67, v46
v_lshlrev_b32 v190, 16, v47
v_and_b32 v191, s67, v47
s_waitcnt vmcnt(8)
v_lshlrev_b32 v192, 16, v48
v_and_b32 v193, s67, v48
v_lshlrev_b32 v194, 16, v49
v_and_b32 v195, s67, v49
v_lshlrev_b32 v196, 16, v50
v_and_b32 v197, s67, v50
v_lshlrev_b32 v198, 16, v51
v_and_b32 v199, s67, v51
v_dot2_f32_bf16 v192, v96, s64, v192
v_dot2_f32_bf16 v193, v96, s65, v193
v_dot2_f32_bf16 v194, v97, s64, v194
v_dot2_f32_bf16 v195, v97, s65, v195
v_dot2_f32_bf16 v196, v98, s64, v196
v_dot2_f32_bf16 v197, v98, s65, v197
v_dot2_f32_bf16 v198, v99, s64, v198
v_dot2_f32_bf16 v199, v99, s65, v199
v_cvt_pk_bf16_f32 v48, v192, v193
v_cvt_pk_bf16_f32 v49, v194, v195
v_cvt_pk_bf16_f32 v50, v196, v197
v_cvt_pk_bf16_f32 v51, v198, v199
s_add_u32 s34, s72, 32768
buffer_store_dwordx4 v[48:51], v5, s[4:7], s34 offen sc1
v_lshlrev_b32 v192, 16, v48
v_and_b32 v193, s67, v48
v_lshlrev_b32 v194, 16, v49
v_and_b32 v195, s67, v49
v_lshlrev_b32 v196, 16, v50
v_and_b32 v197, s67, v50
v_lshlrev_b32 v198, 16, v51
v_and_b32 v199, s67, v51
v_pk_add_f32 v[208:209], v[128:129], v[136:137]
v_pk_add_f32 v[210:211], v[130:131], v[138:139]
v_pk_add_f32 v[212:213], v[132:133], v[140:141]
v_pk_add_f32 v[214:215], v[134:135], v[142:143]
v_pk_add_f32 v[208:209], v[208:209], v[144:145]
v_pk_add_f32 v[210:211], v[210:211], v[146:147]
v_pk_add_f32 v[212:213], v[212:213], v[148:149]
v_pk_add_f32 v[214:215], v[214:215], v[150:151]
v_pk_add_f32 v[208:209], v[208:209], v[152:153]
v_pk_add_f32 v[210:211], v[210:211], v[154:155]
v_pk_add_f32 v[212:213], v[212:213], v[156:157]
v_pk_add_f32 v[214:215], v[214:215], v[158:159]
v_pk_add_f32 v[208:209], v[208:209], v[160:161]
v_pk_add_f32 v[210:211], v[210:211], v[162:163]
v_pk_add_f32 v[212:213], v[212:213], v[164:165]
v_pk_add_f32 v[214:215], v[214:215], v[166:167]
v_pk_add_f32 v[208:209], v[208:209], v[168:169]
v_pk_add_f32 v[210:211], v[210:211], v[170:171]
v_pk_add_f32 v[212:213], v[212:213], v[172:173]
v_pk_add_f32 v[214:215], v[214:215], v[174:175]
v_pk_add_f32 v[208:209], v[208:209], v[176:177]
v_pk_add_f32 v[210:211], v[210:211], v[178:179]
v_pk_add_f32 v[212:213], v[212:213], v[180:181]
v_pk_add_f32 v[214:215], v[214:215], v[182:183]
v_pk_add_f32 v[208:209], v[208:209], v[184:185]
v_pk_add_f32 v[210:211], v[210:211], v[186:187]
v_pk_add_f32 v[212:213], v[212:213], v[188:189]
v_pk_add_f32 v[214:215], v[214:215], v[190:191]
v_pk_add_f32 v[208:209], v[208:209], v[192:193]
v_pk_add_f32 v[210:211], v[210:211], v[194:195]
v_pk_add_f32 v[212:213], v[212:213], v[196:197]
v_pk_add_f32 v[214:215], v[214:215], v[198:199]
v_pk_add_f32 v[208:209], v[208:209], v[210:211]
v_pk_add_f32 v[212:213], v[212:213], v[214:215]
v_pk_add_f32 v[208:209], v[208:209], v[212:213]
v_add_f32 v208, v208, v209
s_nop 1
v_add_f32_dpp v208, v208, v208 row_ror:8 row_mask:0xf bank_mask:0xf
v_mov_b32 v209, v208
s_nop 1
v_permlane16_swap_b32 v208, v209
v_add_f32 v208, v208, v209
v_mov_b32 v209, v208
s_nop 1
v_permlane32_swap_b32 v208, v209
v_add_f32 v208, v208, v209
v_mul_f32 v208, s68, v208
v_sub_f32 v216, 0, v208
v_mov_b32 v217, v216
v_pk_add_f32 v[128:129], v[128:129], v[216:217]
v_pk_add_f32 v[130:131], v[130:131], v[216:217]
v_pk_add_f32 v[132:133], v[132:133], v[216:217]
v_pk_add_f32 v[134:135], v[134:135], v[216:217]
v_pk_add_f32 v[136:137], v[136:137], v[216:217]
v_pk_add_f32 v[138:139], v[138:139], v[216:217]
v_pk_add_f32 v[140:141], v[140:141], v[216:217]
v_pk_add_f32 v[142:143], v[142:143], v[216:217]
v_pk_add_f32 v[144:145], v[144:145], v[216:217]
v_pk_add_f32 v[146:147], v[146:147], v[216:217]
v_pk_add_f32 v[148:149], v[148:149], v[216:217]
v_pk_add_f32 v[150:151], v[150:151], v[216:217]
v_pk_add_f32 v[152:153], v[152:153], v[216:217]
v_pk_add_f32 v[154:155], v[154:155], v[216:217]
v_pk_add_f32 v[156:157], v[156:157], v[216:217]
v_pk_add_f32 v[158:159], v[158:159], v[216:217]
v_pk_add_f32 v[160:161], v[160:161], v[216:217]
v_pk_add_f32 v[162:163], v[162:163], v[216:217]
v_pk_add_f32 v[164:165], v[164:165], v[216:217]
v_pk_add_f32 v[166:167], v[166:167], v[216:217]
v_pk_add_f32 v[168:169], v[168:169], v[216:217]
v_pk_add_f32 v[170:171], v[170:171], v[216:217]
v_pk_add_f32 v[172:173], v[172:173], v[216:217]
v_pk_add_f32 v[174:175], v[174:175], v[216:217]
v_pk_add_f32 v[176:177], v[176:177], v[216:217]
v_pk_add_f32 v[178:179], v[178:179], v[216:217]
v_pk_add_f32 v[180:181], v[180:181], v[216:217]
v_pk_add_f32 v[182:183], v[182:183], v[216:217]
v_pk_add_f32 v[184:185], v[184:185], v[216:217]
v_pk_add_f32 v[186:187], v[186:187], v[216:217]
v_pk_add_f32 v[188:189], v[188:189], v[216:217]
v_pk_add_f32 v[190:191], v[190:191], v[216:217]
v_pk_add_f32 v[192:193], v[192:193], v[216:217]
v_pk_add_f32 v[194:195], v[194:195], v[216:217]
v_pk_add_f32 v[196:197], v[196:197], v[216:217]
v_pk_add_f32 v[198:199], v[198:199], v[216:217]
v_pk_mul_f32 v[208:209], v[128:129], v[128:129]
v_pk_mul_f32 v[210:211], v[130:131], v[130:131]
v_pk_mul_f32 v[212:213], v[132:133], v[132:133]
v_pk_mul_f32 v[214:215], v[134:135], v[134:135]
v_pk_fma_f32 v[208:209], v[136:137], v[136:137], v[208:209]
v_pk_fma_f32 v[210:211], v[138:139], v[138:139], v[210:211]
v_pk_fma_f32 v[212:213], v[140:141], v[140:141], v[212:213]
v_pk_fma_f32 v[214:215], v[142:143], v[142:143], v[214:215]
v_pk_fma_f32 v[208:209], v[144:145], v[144:145], v[208:209]
v_pk_fma_f32 v[210:211], v[146:147], v[146:147], v[210:211]
v_pk_fma_f32 v[212:213], v[148:149], v[148:149], v[212:213]
v_pk_fma_f32 v[214:215], v[150:151], v[150:151], v[214:215]
v_pk_fma_f32 v[208:209], v[152:153], v[152:153], v[208:209]
v_pk_fma_f32 v[210:211], v[154:155], v[154:155], v[210:211]
v_pk_fma_f32 v[212:213], v[156:157], v[156:157], v[212:213]
v_pk_fma_f32 v[214:215], v[158:159], v[158:159], v[214:215]
v_pk_fma_f32 v[208:209], v[160:161], v[160:161], v[208:209]
v_pk_fma_f32 v[210:211], v[162:163], v[162:163], v[210:211]
v_pk_fma_f32 v[212:213], v[164:165], v[164:165], v[212:213]
v_pk_fma_f32 v[214:215], v[166:167], v[166:167], v[214:215]
v_pk_fma_f32 v[208:209], v[168:169], v[168:169], v[208:209]
v_pk_fma_f32 v[210:211], v[170:171], v[170:171], v[210:211]
v_pk_fma_f32 v[212:213], v[172:173], v[172:173], v[212:213]
v_pk_fma_f32 v[214:215], v[174:175], v[174:175], v[214:215]
v_pk_fma_f32 v[208:209], v[176:177], v[176:177], v[208:209]
v_pk_fma_f32 v[210:211], v[178:179], v[178:179], v[210:211]
v_pk_fma_f32 v[212:213], v[180:181], v[180:181], v[212:213]
v_pk_fma_f32 v[214:215], v[182:183], v[182:183], v[214:215]
v_pk_fma_f32 v[208:209], v[184:185], v[184:185], v[208:209]
v_pk_fma_f32 v[210:211], v[186:187], v[186:187], v[210:211]
v_pk_fma_f32 v[212:213], v[188:189], v[188:189], v[212:213]
v_pk_fma_f32 v[214:215], v[190:191], v[190:191], v[214:215]
v_pk_fma_f32 v[208:209], v[192:193], v[192:193], v[208:209]
v_pk_fma_f32 v[210:211], v[194:195], v[194:195], v[210:211]
v_pk_fma_f32 v[212:213], v[196:197], v[196:197], v[212:213]
v_pk_fma_f32 v[214:215], v[198:199], v[198:199], v[214:215]
v_pk_add_f32 v[208:209], v[208:209], v[210:211]
v_pk_add_f32 v[212:213], v[212:213], v[214:215]
v_pk_add_f32 v[208:209], v[208:209], v[212:213]
v_add_f32 v208, v208, v209
s_nop 1
v_add_f32_dpp v208, v208, v208 row_ror:8 row_mask:0xf bank_mask:0xf
v_mov_b32 v209, v208
s_nop 1
v_permlane16_swap_b32 v208, v209
v_add_f32 v208, v208, v209
v_mov_b32 v209, v208
s_nop 1
v_permlane32_swap_b32 v208, v209
v_add_f32 v208, v208, v209
v_mov_b32 v209, s69
v_fma_f32 v208, v208, s68, v209
v_rsq_f32 v216, v208
s_nop 0
v_mov_b32 v217, v216
v_pk_mul_f32 v[128:129], v[128:129], v[216:217]
v_pk_mul_f32 v[130:131], v[130:131], v[216:217]
v_pk_mul_f32 v[132:133], v[132:133], v[216:217]
v_pk_mul_f32 v[134:135], v[134:135], v[216:217]
v_cvt_pk_bf16_f32 v64, v128, v129
v_cvt_pk_bf16_f32 v65, v130, v131
v_cvt_pk_bf16_f32 v66, v132, v133
v_cvt_pk_bf16_f32 v67, v134, v135
s_add_u32 s34, s73, 0
buffer_store_dwordx4 v[64:67], v5, s[4:7], s34 offen sc1
v_pk_mul_f32 v[136:137], v[136:137], v[216:217]
v_pk_mul_f32 v[138:139], v[138:139], v[216:217]
v_pk_mul_f32 v[140:141], v[140:141], v[216:217]
v_pk_mul_f32 v[142:143], v[142:143], v[216:217]
v_cvt_pk_bf16_f32 v68, v136, v137
v_cvt_pk_bf16_f32 v69, v138, v139
v_cvt_pk_bf16_f32 v70, v140, v141
v_cvt_pk_bf16_f32 v71, v142, v143
s_add_u32 s34, s73, 4096
buffer_store_dwordx4 v[68:71], v5, s[4:7], s34 offen sc1
v_pk_mul_f32 v[144:145], v[144:145], v[216:217]
v_pk_mul_f32 v[146:147], v[146:147], v[216:217]
v_pk_mul_f32 v[148:149], v[148:149], v[216:217]
v_pk_mul_f32 v[150:151], v[150:151], v[216:217]
v_cvt_pk_bf16_f32 v72, v144, v145
v_cvt_pk_bf16_f32 v73, v146, v147
v_cvt_pk_bf16_f32 v74, v148, v149
v_cvt_pk_bf16_f32 v75, v150, v151
s_add_u32 s34, s73, 8192
buffer_store_dwordx4 v[72:75], v5, s[4:7], s34 offen sc1
v_pk_mul_f32 v[152:153], v[152:153], v[216:217]
v_pk_mul_f32 v[154:155], v[154:155], v[216:217]
v_pk_mul_f32 v[156:157], v[156:157], v[216:217]
v_pk_mul_f32 v[158:159], v[158:159], v[216:217]
v_cvt_pk_bf16_f32 v76, v152, v153
v_cvt_pk_bf16_f32 v77, v154, v155
v_cvt_pk_bf16_f32 v78, v156, v157
v_cvt_pk_bf16_f32 v79, v158, v159
s_add_u32 s34, s73, 12288
buffer_store_dwordx4 v[76:79], v5, s[4:7], s34 offen sc1
v_pk_mul_f32 v[160:161], v[160:161], v[216:217]
v_pk_mul_f32 v[162:163], v[162:163], v[216:217]
v_pk_mul_f32 v[164:165], v[164:165], v[216:217]
v_pk_mul_f32 v[166:167], v[166:167], v[216:217]
v_cvt_pk_bf16_f32 v80, v160, v161
v_cvt_pk_bf16_f32 v81, v162, v163
v_cvt_pk_bf16_f32 v82, v164, v165
v_cvt_pk_bf16_f32 v83, v166, v167
s_add_u32 s34, s73, 16384
buffer_store_dwordx4 v[80:83], v5, s[4:7], s34 offen sc1
v_pk_mul_f32 v[168:169], v[168:169], v[216:217]
v_pk_mul_f32 v[170:171], v[170:171], v[216:217]
v_pk_mul_f32 v[172:173], v[172:173], v[216:217]
v_pk_mul_f32 v[174:175], v[174:175], v[216:217]
v_cvt_pk_bf16_f32 v84, v168, v169
v_cvt_pk_bf16_f32 v85, v170, v171
v_cvt_pk_bf16_f32 v86, v172, v173
v_cvt_pk_bf16_f32 v87, v174, v175
s_add_u32 s34, s73, 20480
buffer_store_dwordx4 v[84:87], v5, s[4:7], s34 offen sc1
v_pk_mul_f32 v[176:177], v[176:177], v[216:217]
v_pk_mul_f32 v[178:179], v[178:179], v[216:217]
v_pk_mul_f32 v[180:181], v[180:181], v[216:217]
v_pk_mul_f32 v[182:183], v[182:183], v[216:217]
v_cvt_pk_bf16_f32 v88, v176, v177
v_cvt_pk_bf16_f32 v89, v178, v179
v_cvt_pk_bf16_f32 v90, v180, v181
v_cvt_pk_bf16_f32 v91, v182, v183
s_add_u32 s34, s73, 24576
buffer_store_dwordx4 v[88:91], v5, s[4:7], s34 offen sc1
v_pk_mul_f32 v[184:185], v[184:185], v[216:217]
v_pk_mul_f32 v[186:187], v[186:187], v[216:217]
v_pk_mul_f32 v[188:189], v[188:189], v[216:217]
v_pk_mul_f32 v[190:191], v[190:191], v[216:217]
v_cvt_pk_bf16_f32 v92, v184, v185
v_cvt_pk_bf16_f32 v93, v186, v187
v_cvt_pk_bf16_f32 v94, v188, v189
v_cvt_pk_bf16_f32 v95, v190, v191
s_add_u32 s34, s73, 28672
buffer_store_dwordx4 v[92:95], v5, s[4:7], s34 offen sc1
v_pk_mul_f32 v[192:193], v[192:193], v[216:217]
v_pk_mul_f32 v[194:195], v[194:195], v[216:217]
v_pk_mul_f32 v[196:197], v[196:197], v[216:217]
v_pk_mul_f32 v[198:199], v[198:199], v[216:217]
v_cvt_pk_bf16_f32 v96, v192, v193
v_cvt_pk_bf16_f32 v97, v194, v195
v_cvt_pk_bf16_f32 v98, v196, v197
v_cvt_pk_bf16_f32 v99, v198, v199
s_add_u32 s34, s73, 32768
buffer_store_dwordx4 v[96:99], v5, s[4:7], s34 offen sc1
s_mov_b32 s39, s29
s_add_u32 s70, s70, 73728
s_add_u32 s71, s71, 73728
s_add_u32 s28, s28, 128
s_add_u32 s72, s72, 73728
s_add_u32 s73, s73, 73728
s_add_u32 s29, s29, 128
s_add_u32 s23, s23, 2
s_cmp_lt_u32 s23, 64
s_cbranch_scc1 L_fin_top1
s_waitcnt vmcnt(0)
s_mov_b64 exec, 1
v_mov_b32 v13, 1
buffer_atomic_add v13, off, s[4:7], s39 sc1
s_mov_b64 exec, -1
s_waitcnt vmcnt(0)
s_branch L_END
L_fin_n1:
s_cmp_ge_u32 s60, 5
s_cbranch_scc1 L_fin_n2
s_sub_u32 s3, s60, 2
s_mul_i32 s23, s20, 3
s_add_u32 s3, s3, s23
s_lshr_b32 s23, s3, 2
s_and_b32 s3, s3, 3
s_lshl_b32 s3, s3, 3
v_and_b32 v8, 7, v1
v_add_u32 v8, s3, v8
v_lshrrev_b32 v9, 3, v1
v_lshrrev_b32 v10, 1, v9
v_lshlrev_b32 v10, 10, v10
v_and_b32 v11, 1, v9
v_lshl_add_u32 v10, v11, 9, v10
v_lshl_add_u32 v5, v8, 4, v10
v_mul_u32_u24 v10, 1152, v8
v_lshl_add_u32 v6, v9, 4, v10
s_mov_b32 s70, 0xe00000
s_mul_i32 s3, s23, 0x9000
s_add_u32 s70, s70, s3
s_mov_b32 s71, 0x4000000
s_mul_i32 s3, s23, 0x24000
s_add_u32 s71, s71, s3
s_mov_b32 s28, 0xa000
s_mul_i32 s3, s23, 0x40
s_add_u32 s28, s28, s3
s_mov_b32 s72, 0x1040000
s_mul_i32 s3, s23, 0x9000
s_add_u32 s72, s72, s3
s_mov_b32 s73, 0x980000
s_mul_i32 s3, s23, 0x9000
s_add_u32 s73, s73, s3
s_mov_b32 s29, 0x2000
s_mul_i32 s3, s23, 0x40
s_add_u32 s29, s29, s3
L_fin_top2:
buffer_load_dword v15, off, s[4:7], s28 sc1
s_mov_b32 s91, 0
s_waitcnt vmcnt(0)
s_mov_b64 exec, 1
v_mov_b32 v13, 1
buffer_atomic_add v13, off, s[4:7], s39 sc1
s_mov_b64 exec, -1
v_cmp_gt_u32 vcc, 36, v15
s_nop 0
s_nop 2
s_cbranch_vccz L_spd_125
L_sp_124:
buffer_load_dword v15, off, s[4:7], s28 sc1
s_add_u32 s91, s91, 1
s_cmp_gt_u32 s91, 200000
s_cbranch_scc1 L_FAIL
s_waitcnt vmcnt(0)
v_cmp_gt_u32 vcc, 36, v15
s_nop 0
s_nop 2
s_cbranch_vccnz L_sp_124
L_spd_125:
s_add_u32 s34, s70, 0
buffer_load_dwordx4 v[16:19], v5, s[4:7], s34 offen
s_add_u32 s34, s70, 4096
buffer_load_dwordx4 v[20:23], v5, s[4:7], s34 offen
s_add_u32 s34, s70, 8192
buffer_load_dwordx4 v[24:27], v5, s[4:7], s34 offen
s_add_u32 s34, s70, 12288
buffer_load_dwordx4 v[28:31], v5, s[4:7], s34 offen
s_add_u32 s34, s70, 16384
buffer_load_dwordx4 v[32:35], v5, s[4:7], s34 offen
s_add_u32 s34, s70, 20480
buffer_load_dwordx4 v[36:39], v5, s[4:7], s34 offen
s_add_u32 s34, s70, 24576
buffer_load_dwordx4 v[40:43], v5, s[4:7], s34 offen
s_add_u32 s34, s70, 28672
buffer_load_dwordx4 v[44:47], v5, s[4:7], s34 offen
s_add_u32 s34, s70, 32768
buffer_load_dwordx4 v[48:51], v5, s[4:7], s34 offen
s_add_u32 s34, s71, 0
buffer_load_dwordx4 v[64:67], v5, s[4:7], s34 offen
s_add_u32 s34, s71, 4096
buffer_load_dwordx4 v[68:71], v5, s[4:7], s34 offen
s_add_u32 s34, s71, 8192
buffer_load_dwordx4 v[72:75], v5, s[4:7], s34 offen
s_add_u32 s34, s71, 12288
buffer_load_dwordx4 v[76:79], v5, s[4:7], s34 offen
s_add_u32 s34, s71, 16384
buffer_load_dwordx4 v[80:83], v5, s[4:7], s34 offen
s_add_u32 s34, s71, 20480
buffer_load_dwordx4 v[84:87], v5, s[4:7], s34 offen
s_add_u32 s34, s71, 24576
buffer_load_dwordx4 v[88:91], v5, s[4:7], s34 offen
s_add_u32 s34, s71, 28672
buffer_load_dwordx4 v[92:95], v5, s[4:7], s34 offen
s_add_u32 s34, s71, 32768
buffer_load_dwordx4 v[96:99], v5, s[4:7], s34 offen
s_add_u32 s34, s71, 36864
buffer_load_dwordx4 v[100:103], v5, s[4:7], s34 offen
s_add_u32 s34, s71, 40960
buffer_load_dwordx4 v[104:107], v5, s[4:7], s34 offen
s_add_u32 s34, s71, 45056
buffer_load_dwordx4 v[108:111], v5, s[4:7], s34 offen
s_add_u32 s34, s71, 49152
buffer_load_dwordx4 v[112:115], v5, s[4:7], s34 offen
s_add_u32 s34, s71, 53248
buffer_load_dwordx4 v[116:119], v5, s[4:7], s34 offen
s_add_u32 s34, s71, 57344
buffer_load_dwordx4 v[120:123], v5, s[4:7], s34 offen
s_add_u32 s34, s71, 61440
buffer_load_dwordx4 v[124:127], v5, s[4:7], s34 offen
s_add_u32 s34, s71, 65536
buffer_load_dwordx4 v[128:131], v5, s[4:7], s34 offen
s_add_u32 s34, s71, 69632
buffer_load_dwordx4 v[132:135], v5, s[4:7], s34 offen
s_add_u32 s34, s71, 73728
buffer_load_dwordx4 v[136:139], v5, s[4:7], s34 offen
s_add_u32 s34, s71, 77824
buffer_load_dwordx4 v[140:143], v5, s[4:7], s34 offen
s_add_u32 s34, s71, 81920
buffer_load_dwordx4 v[144:147], v5, s[4:7], s34 offen
s_add_u32 s34, s71, 86016
buffer_load_dwordx4 v[148:151], v5, s[4:7], s34 offen
s_add_u32 s34, s71, 90112
buffer_load_dwordx4 v[152:155], v5, s[4:7], s34 offen
s_add_u32 s34, s71, 94208
buffer_load_dwordx4 v[156:159], v5, s[4:7], s34 offen
s_add_u32 s34, s71, 98304
buffer_load_dwordx4 v[160:163], v5, s[4:7], s34 offen
s_add_u32 s34, s71, 102400
buffer_load_dwordx4 v[164:167], v5, s[4:7], s34 offen
s_add_u32 s34, s71, 106496
buffer_load_dwordx4 v[168:171], v5, s[4:7], s34 offen
s_add_u32 s34, s71, 110592
buffer_load_dwordx4 v[172:175], v5, s[4:7], s34 offen
s_add_u32 s34, s71, 114688
buffer_load_dwordx4 v[176:179], v5, s[4:7], s34 offen
s_add_u32 s34, s71, 118784
buffer_load_dwordx4 v[180:183], v5, s[4:7], s34 offen
s_add_u32 s34, s71, 122880
buffer_load_dwordx4 v[184:187], v5, s[4:7], s34 offen
s_add_u32 s34, s71, 126976
buffer_load_dwordx4 v[188:191], v5, s[4:7], s34 offen
s_add_u32 s34, s71, 131072
buffer_load_dwordx4 v[192:195], v5, s[4:7], s34 offen
s_add_u32 s34, s71, 135168
buffer_load_dwordx4 v[196:199], v5, s[4:7], s34 offen
s_add_u32 s34, s71, 139264
buffer_load_dwordx4 v[200:203], v5, s[4:7], s34 offen
s_add_u32 s34, s71, 143360
buffer_load_dwordx4 v[204:207], v5, s[4:7], s34 offen
s_waitcnt vmcnt(8)
v_lshlrev_b32 v208, 16, v64
v_and_b32 v209, s67, v64
v_lshlrev_b32 v210, 16, v65
v_and_b32 v211, s67, v65
v_lshlrev_b32 v212, 16, v66
v_and_b32 v213, s67, v66
v_lshlrev_b32 v214, 16, v67
v_and_b32 v215, s67, v67
v_dot2_f32_bf16 v208, v100, s64, v208
v_dot2_f32_bf16 v209, v100, s65, v209
v_dot2_f32_bf16 v210, v101, s64, v210
v_dot2_f32_bf16 v211, v101, s65, v211
v_dot2_f32_bf16 v212, v102, s64, v212
v_dot2_f32_bf16 v213, v102, s65, v213
v_dot2_f32_bf16 v214, v103, s64, v214
v_dot2_f32_bf16 v215, v103, s65, v215
v_dot2_f32_bf16 v208, v136, s64, v208
v_dot2_f32_bf16 v209, v136, s65, v209
v_dot2_f32_bf16 v210, v137, s64, v210
v_dot2_f32_bf16 v211, v137, s65, v211
v_dot2_f32_bf16 v212, v138, s64, v212
v_dot2_f32_bf16 v213, v138, s65, v213
v_dot2_f32_bf16 v214, v139, s64, v214
v_dot2_f32_bf16 v215, v139, s65, v215
v_dot2_f32_bf16 v208, v172, s64, v208
v_dot2_f32_bf16 v209, v172, s65, v209
v_dot2_f32_bf16 v210, v173, s64, v210
v_dot2_f32_bf16 v211, v173, s65, v211
v_dot2_f32_bf16 v212, v174, s64, v212
v_dot2_f32_bf16 v213, v174, s65, v213
v_dot2_f32_bf16 v214, v175, s64, v214
v_dot2_f32_bf16 v215, v175, s65, v215
v_cvt_pk_bf16_f32 v64, v208, v209
v_cvt_pk_bf16_f32 v65, v210, v211
v_cvt_pk_bf16_f32 v66, v212, v213
v_cvt_pk_bf16_f32 v67, v214, v215
s_waitcnt vmcnt(7)
v_lshlrev_b32 v208, 16, v68
v_and_b32 v209, s67, v68
v_lshlrev_b32 v210, 16, v69
v_and_b32 v211, s67, v69
v_lshlrev_b32 v212, 16, v70
v_and_b32 v213, s67, v70
v_lshlrev_b32 v214, 16, v71
v_and_b32 v215, s67, v71
v_dot2_f32_bf16 v208, v104, s64, v208
v_dot2_f32_bf16 v209, v104, s65, v209
v_dot2_f32_bf16 v210, v105, s64, v210
v_dot2_f32_bf16 v211, v105, s65, v211
v_dot2_f32_bf16 v212, v106, s64, v212
v_dot2_f32_bf16 v213, v106, s65, v213
v_dot2_f32_bf16 v214, v107, s64, v214
v_dot2_f32_bf16 v215, v107, s65, v215
v_dot2_f32_bf16 v208, v140, s64, v208
v_dot2_f32_bf16 v209, v140, s65, v209
v_dot2_f32_bf16 v210, v141, s64, v210
v_dot2_f32_bf16 v211, v141, s65, v211
v_dot2_f32_bf16 v212, v142, s64, v212
v_dot2_f32_bf16 v213, v142, s65, v213
v_dot2_f32_bf16 v214, v143, s64, v214
v_dot2_f32_bf16 v215, v143, s65, v215
v_dot2_f32_bf16 v208, v176, s64, v208
v_dot2_f32_bf16 v209, v176, s65, v209
v_dot2_f32_bf16 v210, v177, s64, v210
v_dot2_f32_bf16 v211, v177, s65, v211
v_dot2_f32_bf16 v212, v178, s64, v212
v_dot2_f32_bf16 v213, v178, s65, v213
v_dot2_f32_bf16 v214, v179, s64, v214
v_dot2_f32_bf16 v215, v179, s65, v215
v_cvt_pk_bf16_f32 v68, v208, v209
v_cvt_pk_bf16_f32 v69, v210, v211
v_cvt_pk_bf16_f32 v70, v212, v213
v_cvt_pk_bf16_f32 v71, v214, v215
s_waitcnt vmcnt(6)
v_lshlrev_b32 v208, 16, v72
v_and_b32 v209, s67, v72
v_lshlrev_b32 v210, 16, v73
v_and_b32 v211, s67, v73
v_lshlrev_b32 v212, 16, v74
v_and_b32 v213, s67, v74
v_lshlrev_b32 v214, 16, v75
v_and_b32 v215, s67, v75
v_dot2_f32_bf16 v208, v108, s64, v208
v_dot2_f32_bf16 v209, v108, s65, v209
v_dot2_f32_bf16 v210, v109, s64, v210
v_dot2_f32_bf16 v211, v109, s65, v211
v_dot2_f32_bf16 v212, v110, s64, v212
v_dot2_f32_bf16 v213, v110, s65, v213
v_dot2_f32_bf16 v214, v111, s64, v214
v_dot2_f32_bf16 v215, v111, s65, v215
v_dot2_f32_bf16 v208, v144, s64, v208
v_dot2_f32_bf16 v209, v144, s65, v209
v_dot2_f32_bf16 v210, v145, s64, v210
v_dot2_f32_bf16 v211, v145, s65, v211
v_dot2_f32_bf16 v212, v146, s64, v212
v_dot2_f32_bf16 v213, v146, s65, v213
v_dot2_f32_bf16 v214, v147, s64, v214
v_dot2_f32_bf16 v215, v147, s65, v215
v_dot2_f32_bf16 v208, v180, s64, v208
v_dot2_f32_bf16 v209, v180, s65, v209
v_dot2_f32_bf16 v210, v181, s64, v210
v_dot2_f32_bf16 v211, v181, s65, v211
v_dot2_f32_bf16 v212, v182, s64, v212
v_dot2_f32_bf16 v213, v182, s65, v213
v_dot2_f32_bf16 v214, v183, s64, v214
v_dot2_f32_bf16 v215, v183, s65, v215
v_cvt_pk_bf16_f32 v72, v208, v209
v_cvt_pk_bf16_f32 v73, v210, v211
v_cvt_pk_bf16_f32 v74, v212, v213
v_cvt_pk_bf16_f32 v75, v214, v215
s_waitcnt vmcnt(5)
v_lshlrev_b32 v208, 16, v76
v_and_b32 v209, s67, v76
v_lshlrev_b32 v210, 16, v77
v_and_b32 v211, s67, v77
v_lshlrev_b32 v212, 16, v78
v_and_b32 v213, s67, v78
v_lshlrev_b32 v214, 16, v79
v_and_b32 v215, s67, v79
v_dot2_f32_bf16 v208, v112, s64, v208
v_dot2_f32_bf16 v209, v112, s65, v209
v_dot2_f32_bf16 v210, v113, s64, v210
v_dot2_f32_bf16 v211, v113, s65, v211
v_dot2_f32_bf16 v212, v114, s64, v212
v_dot2_f32_bf16 v213, v114, s65, v213
v_dot2_f32_bf16 v214, v115, s64, v214
v_dot2_f32_bf16 v215, v115, s65, v215
v_dot2_f32_bf16 v208, v148, s64, v208
v_dot2_f32_bf16 v209, v148, s65, v209
v_dot2_f32_bf16 v210, v149, s64, v210
v_dot2_f32_bf16 v211, v149, s65, v211
v_dot2_f32_bf16 v212, v150, s64, v212
v_dot2_f32_bf16 v213, v150, s65, v213
v_dot2_f32_bf16 v214, v151, s64, v214
v_dot2_f32_bf16 v215, v151, s65, v215
v_dot2_f32_bf16 v208, v184, s64, v208
v_dot2_f32_bf16 v209, v184, s65, v209
v_dot2_f32_bf16 v210, v185, s64, v210
v_dot2_f32_bf16 v211, v185, s65, v211
v_dot2_f32_bf16 v212, v186, s64, v212
v_dot2_f32_bf16 v213, v186, s65, v213
v_dot2_f32_bf16 v214, v187, s64, v214
v_dot2_f32_bf16 v215, v187, s65, v215
v_cvt_pk_bf16_f32 v76, v208, v209
v_cvt_pk_bf16_f32 v77, v210, v211
v_cvt_pk_bf16_f32 v78, v212, v213
v_cvt_pk_bf16_f32 v79, v214, v215
s_waitcnt vmcnt(4)
v_lshlrev_b32 v208, 16, v80
v_and_b32 v209, s67, v80
v_lshlrev_b32 v210, 16, v81
v_and_b32 v211, s67, v81
v_lshlrev_b32 v212, 16, v82
v_and_b32 v213, s67, v82
v_lshlrev_b32 v214, 16, v83
v_and_b32 v215, s67, v83
v_dot2_f32_bf16 v208, v116, s64, v208
v_dot2_f32_bf16 v209, v116, s65, v209
v_dot2_f32_bf16 v210, v117, s64, v210
v_dot2_f32_bf16 v211, v117, s65, v211
v_dot2_f32_bf16 v212, v118, s64, v212
v_dot2_f32_bf16 v213, v118, s65, v213
v_dot2_f32_bf16 v214, v119, s64, v214
v_dot2_f32_bf16 v215, v119, s65, v215
v_dot2_f32_bf16 v208, v152, s64, v208
v_dot2_f32_bf16 v209, v152, s65, v209
v_dot2_f32_bf16 v210, v153, s64, v210
v_dot2_f32_bf16 v211, v153, s65, v211
v_dot2_f32_bf16 v212, v154, s64, v212
v_dot2_f32_bf16 v213, v154, s65, v213
v_dot2_f32_bf16 v214, v155, s64, v214
v_dot2_f32_bf16 v215, v155, s65, v215
v_dot2_f32_bf16 v208, v188, s64, v208
v_dot2_f32_bf16 v209, v188, s65, v209
v_dot2_f32_bf16 v210, v189, s64, v210
v_dot2_f32_bf16 v211, v189, s65, v211
v_dot2_f32_bf16 v212, v190, s64, v212
v_dot2_f32_bf16 v213, v190, s65, v213
v_dot2_f32_bf16 v214, v191, s64, v214
v_dot2_f32_bf16 v215, v191, s65, v215
v_cvt_pk_bf16_f32 v80, v208, v209
v_cvt_pk_bf16_f32 v81, v210, v211
v_cvt_pk_bf16_f32 v82, v212, v213
v_cvt_pk_bf16_f32 v83, v214, v215
s_waitcnt vmcnt(3)
v_lshlrev_b32 v208, 16, v84
v_and_b32 v209, s67, v84
v_lshlrev_b32 v210, 16, v85
v_and_b32 v211, s67, v85
v_lshlrev_b32 v212, 16, v86
v_and_b32 v213, s67, v86
v_lshlrev_b32 v214, 16, v87
v_and_b32 v215, s67, v87
v_dot2_f32_bf16 v208, v120, s64, v208
v_dot2_f32_bf16 v209, v120, s65, v209
v_dot2_f32_bf16 v210, v121, s64, v210
v_dot2_f32_bf16 v211, v121, s65, v211
v_dot2_f32_bf16 v212, v122, s64, v212
v_dot2_f32_bf16 v213, v122, s65, v213
v_dot2_f32_bf16 v214, v123, s64, v214
v_dot2_f32_bf16 v215, v123, s65, v215
v_dot2_f32_bf16 v208, v156, s64, v208
v_dot2_f32_bf16 v209, v156, s65, v209
v_dot2_f32_bf16 v210, v157, s64, v210
v_dot2_f32_bf16 v211, v157, s65, v211
v_dot2_f32_bf16 v212, v158, s64, v212
v_dot2_f32_bf16 v213, v158, s65, v213
v_dot2_f32_bf16 v214, v159, s64, v214
v_dot2_f32_bf16 v215, v159, s65, v215
v_dot2_f32_bf16 v208, v192, s64, v208
v_dot2_f32_bf16 v209, v192, s65, v209
v_dot2_f32_bf16 v210, v193, s64, v210
v_dot2_f32_bf16 v211, v193, s65, v211
v_dot2_f32_bf16 v212, v194, s64, v212
v_dot2_f32_bf16 v213, v194, s65, v213
v_dot2_f32_bf16 v214, v195, s64, v214
v_dot2_f32_bf16 v215, v195, s65, v215
v_cvt_pk_bf16_f32 v84, v208, v209
v_cvt_pk_bf16_f32 v85, v210, v211
v_cvt_pk_bf16_f32 v86, v212, v213
v_cvt_pk_bf16_f32 v87, v214, v215
s_waitcnt vmcnt(2)
v_lshlrev_b32 v208, 16, v88
v_and_b32 v209, s67, v88
v_lshlrev_b32 v210, 16, v89
v_and_b32 v211, s67, v89
v_lshlrev_b32 v212, 16, v90
v_and_b32 v213, s67, v90
v_lshlrev_b32 v214, 16, v91
v_and_b32 v215, s67, v91
v_dot2_f32_bf16 v208, v124, s64, v208
v_dot2_f32_bf16 v209, v124, s65, v209
v_dot2_f32_bf16 v210, v125, s64, v210
v_dot2_f32_bf16 v211, v125, s65, v211
v_dot2_f32_bf16 v212, v126, s64, v212
v_dot2_f32_bf16 v213, v126, s65, v213
v_dot2_f32_bf16 v214, v127, s64, v214
v_dot2_f32_bf16 v215, v127, s65, v215
v_dot2_f32_bf16 v208, v160, s64, v208
v_dot2_f32_bf16 v209, v160, s65, v209
v_dot2_f32_bf16 v210, v161, s64, v210
v_dot2_f32_bf16 v211, v161, s65, v211
v_dot2_f32_bf16 v212, v162, s64, v212
v_dot2_f32_bf16 v213, v162, s65, v213
v_dot2_f32_bf16 v214, v163, s64, v214
v_dot2_f32_bf16 v215, v163, s65, v215
v_dot2_f32_bf16 v208, v196, s64, v208
v_dot2_f32_bf16 v209, v196, s65, v209
v_dot2_f32_bf16 v210, v197, s64, v210
v_dot2_f32_bf16 v211, v197, s65, v211
v_dot2_f32_bf16 v212, v198, s64, v212
v_dot2_f32_bf16 v213, v198, s65, v213
v_dot2_f32_bf16 v214, v199, s64, v214
v_dot2_f32_bf16 v215, v199, s65, v215
v_cvt_pk_bf16_f32 v88, v208, v209
v_cvt_pk_bf16_f32 v89, v210, v211
v_cvt_pk_bf16_f32 v90, v212, v213
v_cvt_pk_bf16_f32 v91, v214, v215
s_waitcnt vmcnt(1)
v_lshlrev_b32 v208, 16, v92
v_and_b32 v209, s67, v92
v_lshlrev_b32 v210, 16, v93
v_and_b32 v211, s67, v93
v_lshlrev_b32 v212, 16, v94
v_and_b32 v213, s67, v94
v_lshlrev_b32 v214, 16, v95
v_and_b32 v215, s67, v95
v_dot2_f32_bf16 v208, v128, s64, v208
v_dot2_f32_bf16 v209, v128, s65, v209
v_dot2_f32_bf16 v210, v129, s64, v210
v_dot2_f32_bf16 v211, v129, s65, v211
v_dot2_f32_bf16 v212, v130, s64, v212
v_dot2_f32_bf16 v213, v130, s65, v213
v_dot2_f32_bf16 v214, v131, s64, v214
v_dot2_f32_bf16 v215, v131, s65, v215
v_dot2_f32_bf16 v208, v164, s64, v208
v_dot2_f32_bf16 v209, v164, s65, v209
v_dot2_f32_bf16 v210, v165, s64, v210
v_dot2_f32_bf16 v211, v165, s65, v211
v_dot2_f32_bf16 v212, v166, s64, v212
v_dot2_f32_bf16 v213, v166, s65, v213
v_dot2_f32_bf16 v214, v167, s64, v214
v_dot2_f32_bf16 v215, v167, s65, v215
v_dot2_f32_bf16 v208, v200, s64, v208
v_dot2_f32_bf16 v209, v200, s65, v209
v_dot2_f32_bf16 v210, v201, s64, v210
v_dot2_f32_bf16 v211, v201, s65, v211
v_dot2_f32_bf16 v212, v202, s64, v212
v_dot2_f32_bf16 v213, v202, s65, v213
v_dot2_f32_bf16 v214, v203, s64, v214
v_dot2_f32_bf16 v215, v203, s65, v215
v_cvt_pk_bf16_f32 v92, v208, v209
v_cvt_pk_bf16_f32 v93, v210, v211
v_cvt_pk_bf16_f32 v94, v212, v213
v_cvt_pk_bf16_f32 v95, v214, v215
s_waitcnt vmcnt(0)
v_lshlrev_b32 v208, 16, v96
v_and_b32 v209, s67, v96
v_lshlrev_b32 v210, 16, v97
v_and_b32 v211, s67, v97
v_lshlrev_b32 v212, 16, v98
v_and_b32 v213, s67, v98
v_lshlrev_b32 v214, 16, v99
v_and_b32 v215, s67, v99
v_dot2_f32_bf16 v208, v132, s64, v208
v_dot2_f32_bf16 v209, v132, s65, v209
v_dot2_f32_bf16 v210, v133, s64, v210
v_dot2_f32_bf16 v211, v133, s65, v211
v_dot2_f32_bf16 v212, v134, s64, v212
v_dot2_f32_bf16 v213, v134, s65, v213
v_dot2_f32_bf16 v214, v135, s64, v214
v_dot2_f32_bf16 v215, v135, s65, v215
v_dot2_f32_bf16 v208, v168, s64, v208
v_dot2_f32_bf16 v209, v168, s65, v209
v_dot2_f32_bf16 v210, v169, s64, v210
v_dot2_f32_bf16 v211, v169, s65, v211
v_dot2_f32_bf16 v212, v170, s64, v212
v_dot2_f32_bf16 v213, v170, s65, v213
v_dot2_f32_bf16 v214, v171, s64, v214
v_dot2_f32_bf16 v215, v171, s65, v215
v_dot2_f32_bf16 v208, v204, s64, v208
v_dot2_f32_bf16 v209, v204, s65, v209
v_dot2_f32_bf16 v210, v205, s64, v210
v_dot2_f32_bf16 v211, v205, s65, v211
v_dot2_f32_bf16 v212, v206, s64, v212
v_dot2_f32_bf16 v213, v206, s65, v213
v_dot2_f32_bf16 v214, v207, s64, v214
v_dot2_f32_bf16 v215, v207, s65, v215
v_cvt_pk_bf16_f32 v96, v208, v209
v_cvt_pk_bf16_f32 v97, v210, v211
v_cvt_pk_bf16_f32 v98, v212, v213
v_cvt_pk_bf16_f32 v99, v214, v215
s_waitcnt vmcnt(44)
v_lshlrev_b32 v128, 16, v16
v_and_b32 v129, s67, v16
v_lshlrev_b32 v130, 16, v17
v_and_b32 v131, s67, v17
v_lshlrev_b32 v132, 16, v18
v_and_b32 v133, s67, v18
v_lshlrev_b32 v134, 16, v19
v_and_b32 v135, s67, v19
v_dot2_f32_bf16 v128, v64, s64, v128
v_dot2_f32_bf16 v129, v64, s65, v129
v_dot2_f32_bf16 v130, v65, s64, v130
v_dot2_f32_bf16 v131, v65, s65, v131
v_dot2_f32_bf16 v132, v66, s64, v132
v_dot2_f32_bf16 v133, v66, s65, v133
v_dot2_f32_bf16 v134, v67, s64, v134
v_dot2_f32_bf16 v135, v67, s65, v135
v_cvt_pk_bf16_f32 v16, v128, v129
v_cvt_pk_bf16_f32 v17, v130, v131
v_cvt_pk_bf16_f32 v18, v132, v133
v_cvt_pk_bf16_f32 v19, v134, v135
s_add_u32 s34, s72, 0
buffer_store_dwordx4 v[16:19], v5, s[4:7], s34 offen sc1
v_lshlrev_b32 v128, 16, v16
v_and_b32 v129, s67, v16
v_lshlrev_b32 v130, 16, v17
v_and_b32 v131, s67, v17
v_lshlrev_b32 v132, 16, v18
v_and_b32 v133, s67, v18
v_lshlrev_b32 v134, 16, v19
v_and_b32 v135, s67, v19
s_waitcnt vmcnt(44)
v_lshlrev_b32 v136, 16, v20
v_and_b32 v137, s67, v20
v_lshlrev_b32 v138, 16, v21
v_and_b32 v139, s67, v21
v_lshlrev_b32 v140, 16, v22
v_and_b32 v141, s67, v22
v_lshlrev_b32 v142, 16, v23
v_and_b32 v143, s67, v23
v_dot2_f32_bf16 v136, v68, s64, v136
v_dot2_f32_bf16 v137, v68, s65, v137
v_dot2_f32_bf16 v138, v69, s64, v138
v_dot2_f32_bf16 v139, v69, s65, v139
v_dot2_f32_bf16 v140, v70, s64, v140
v_dot2_f32_bf16 v141, v70, s65, v141
v_dot2_f32_bf16 v142, v71, s64, v142
v_dot2_f32_bf16 v143, v71, s65, v143
v_cvt_pk_bf16_f32 v20, v136, v137
v_cvt_pk_bf16_f32 v21, v138, v139
v_cvt_pk_bf16_f32 v22, v140, v141
v_cvt_pk_bf16_f32 v23, v142, v143
s_add_u32 s34, s72, 4096
buffer_store_dwordx4 v[20:23], v5, s[4:7], s34 offen sc1
v_lshlrev_b32 v136, 16, v20
v_and_b32 v137, s67, v20
v_lshlrev_b32 v138, 16, v21
v_and_b32 v139, s67, v21
v_lshlrev_b32 v140, 16, v22
v_and_b32 v141, s67, v22
v_lshlrev_b32 v142, 16, v23
v_and_b32 v143, s67, v23
s_waitcnt vmcnt(44)
v_lshlrev_b32 v144, 16, v24
v_and_b32 v145, s67, v24
v_lshlrev_b32 v146, 16, v25
v_and_b32 v147, s67, v25
v_lshlrev_b32 v148, 16, v26
v_and_b32 v149, s67, v26
v_lshlrev_b32 v150, 16, v27
v_and_b32 v151, s67, v27
v_dot2_f32_bf16 v144, v72, s64, v144
v_dot2_f32_bf16 v145, v72, s65, v145
v_dot2_f32_bf16 v146, v73, s64, v146
v_dot2_f32_bf16 v147, v73, s65, v147
v_dot2_f32_bf16 v148, v74, s64, v148
v_dot2_f32_bf16 v149, v74, s65, v149
v_dot2_f32_bf16 v150, v75, s64, v150
v_dot2_f32_bf16 v151, v75, s65, v151
v_cvt_pk_bf16_f32 v24, v144, v145
v_cvt_pk_bf16_f32 v25, v146, v147
v_cvt_pk_bf16_f32 v26, v148, v149
v_cvt_pk_bf16_f32 v27, v150, v151
s_add_u32 s34, s72, 8192
buffer_store_dwordx4 v[24:27], v5, s[4:7], s34 offen sc1
v_lshlrev_b32 v144, 16, v24
v_and_b32 v145, s67, v24
v_lshlrev_b32 v146, 16, v25
v_and_b32 v147, s67, v25
v_lshlrev_b32 v148, 16, v26
v_and_b32 v149, s67, v26
v_lshlrev_b32 v150, 16, v27
v_and_b32 v151, s67, v27
s_waitcnt vmcnt(44)
v_lshlrev_b32 v152, 16, v28
v_and_b32 v153, s67, v28
v_lshlrev_b32 v154, 16, v29
v_and_b32 v155, s67, v29
v_lshlrev_b32 v156, 16, v30
v_and_b32 v157, s67, v30
v_lshlrev_b32 v158, 16, v31
v_and_b32 v159, s67, v31
v_dot2_f32_bf16 v152, v76, s64, v152
v_dot2_f32_bf16 v153, v76, s65, v153
v_dot2_f32_bf16 v154, v77, s64, v154
v_dot2_f32_bf16 v155, v77, s65, v155
v_dot2_f32_bf16 v156, v78, s64, v156
v_dot2_f32_bf16 v157, v78, s65, v157
v_dot2_f32_bf16 v158, v79, s64, v158
v_dot2_f32_bf16 v159, v79, s65, v159
v_cvt_pk_bf16_f32 v28, v152, v153
v_cvt_pk_bf16_f32 v29, v154, v155
v_cvt_pk_bf16_f32 v30, v156, v157
v_cvt_pk_bf16_f32 v31, v158, v159
s_add_u32 s34, s72, 12288
buffer_store_dwordx4 v[28:31], v5, s[4:7], s34 offen sc1
v_lshlrev_b32 v152, 16, v28
v_and_b32 v153, s67, v28
v_lshlrev_b32 v154, 16, v29
v_and_b32 v155, s67, v29
v_lshlrev_b32 v156, 16, v30
v_and_b32 v157, s67, v30
v_lshlrev_b32 v158, 16, v31
v_and_b32 v159, s67, v31
s_waitcnt vmcnt(44)
v_lshlrev_b32 v160, 16, v32
v_and_b32 v161, s67, v32
v_lshlrev_b32 v162, 16, v33
v_and_b32 v163, s67, v33
v_lshlrev_b32 v164, 16, v34
v_and_b32 v165, s67, v34
v_lshlrev_b32 v166, 16, v35
v_and_b32 v167, s67, v35
v_dot2_f32_bf16 v160, v80, s64, v160
v_dot2_f32_bf16 v161, v80, s65, v161
v_dot2_f32_bf16 v162, v81, s64, v162
v_dot2_f32_bf16 v163, v81, s65, v163
v_dot2_f32_bf16 v164, v82, s64, v164
v_dot2_f32_bf16 v165, v82, s65, v165
v_dot2_f32_bf16 v166, v83, s64, v166
v_dot2_f32_bf16 v167, v83, s65, v167
v_cvt_pk_bf16_f32 v32, v160, v161
v_cvt_pk_bf16_f32 v33, v162, v163
v_cvt_pk_bf16_f32 v34, v164, v165
v_cvt_pk_bf16_f32 v35, v166, v167
s_add_u32 s34, s72, 16384
buffer_store_dwordx4 v[32:35], v5, s[4:7], s34 offen sc1
v_lshlrev_b32 v160, 16, v32
v_and_b32 v161, s67, v32
v_lshlrev_b32 v162, 16, v33
v_and_b32 v163, s67, v33
v_lshlrev_b32 v164, 16, v34
v_and_b32 v165, s67, v34
v_lshlrev_b32 v166, 16, v35
v_and_b32 v167, s67, v35
s_waitcnt vmcnt(44)
v_lshlrev_b32 v168, 16, v36
v_and_b32 v169, s67, v36
v_lshlrev_b32 v170, 16, v37
v_and_b32 v171, s67, v37
v_lshlrev_b32 v172, 16, v38
v_and_b32 v173, s67, v38
v_lshlrev_b32 v174, 16, v39
v_and_b32 v175, s67, v39
v_dot2_f32_bf16 v168, v84, s64, v168
v_dot2_f32_bf16 v169, v84, s65, v169
v_dot2_f32_bf16 v170, v85, s64, v170
v_dot2_f32_bf16 v171, v85, s65, v171
v_dot2_f32_bf16 v172, v86, s64, v172
v_dot2_f32_bf16 v173, v86, s65, v173
v_dot2_f32_bf16 v174, v87, s64, v174
v_dot2_f32_bf16 v175, v87, s65, v175
v_cvt_pk_bf16_f32 v36, v168, v169
v_cvt_pk_bf16_f32 v37, v170, v171
v_cvt_pk_bf16_f32 v38, v172, v173
v_cvt_pk_bf16_f32 v39, v174, v175
s_add_u32 s34, s72, 20480
buffer_store_dwordx4 v[36:39], v5, s[4:7], s34 offen sc1
v_lshlrev_b32 v168, 16, v36
v_and_b32 v169, s67, v36
v_lshlrev_b32 v170, 16, v37
v_and_b32 v171, s67, v37
v_lshlrev_b32 v172, 16, v38
v_and_b32 v173, s67, v38
v_lshlrev_b32 v174, 16, v39
v_and_b32 v175, s67, v39
s_waitcnt vmcnt(44)
v_lshlrev_b32 v176, 16, v40
v_and_b32 v177, s67, v40
v_lshlrev_b32 v178, 16, v41
v_and_b32 v179, s67, v41
v_lshlrev_b32 v180, 16, v42
v_and_b32 v181, s67, v42
v_lshlrev_b32 v182, 16, v43
v_and_b32 v183, s67, v43
v_dot2_f32_bf16 v176, v88, s64, v176
v_dot2_f32_bf16 v177, v88, s65, v177
v_dot2_f32_bf16 v178, v89, s64, v178
v_dot2_f32_bf16 v179, v89, s65, v179
v_dot2_f32_bf16 v180, v90, s64, v180
v_dot2_f32_bf16 v181, v90, s65, v181
v_dot2_f32_bf16 v182, v91, s64, v182
v_dot2_f32_bf16 v183, v91, s65, v183
v_cvt_pk_bf16_f32 v40, v176, v177
v_cvt_pk_bf16_f32 v41, v178, v179
v_cvt_pk_bf16_f32 v42, v180, v181
v_cvt_pk_bf16_f32 v43, v182, v183
s_add_u32 s34, s72, 24576
buffer_store_dwordx4 v[40:43], v5, s[4:7], s34 offen sc1
v_lshlrev_b32 v176, 16, v40
v_and_b32 v177, s67, v40
v_lshlrev_b32 v178, 16, v41
v_and_b32 v179, s67, v41
v_lshlrev_b32 v180, 16, v42
v_and_b32 v181, s67, v42
v_lshlrev_b32 v182, 16, v43
v_and_b32 v183, s67, v43
s_waitcnt vmcnt(44)
v_lshlrev_b32 v184, 16, v44
v_and_b32 v185, s67, v44
v_lshlrev_b32 v186, 16, v45
v_and_b32 v187, s67, v45
v_lshlrev_b32 v188, 16, v46
v_and_b32 v189, s67, v46
v_lshlrev_b32 v190, 16, v47
v_and_b32 v191, s67, v47
v_dot2_f32_bf16 v184, v92, s64, v184
v_dot2_f32_bf16 v185, v92, s65, v185
v_dot2_f32_bf16 v186, v93, s64, v186
v_dot2_f32_bf16 v187, v93, s65, v187
v_dot2_f32_bf16 v188, v94, s64, v188
v_dot2_f32_bf16 v189, v94, s65, v189
v_dot2_f32_bf16 v190, v95, s64, v190
v_dot2_f32_bf16 v191, v95, s65, v191
v_cvt_pk_bf16_f32 v44, v184, v185
v_cvt_pk_bf16_f32 v45, v186, v187
v_cvt_pk_bf16_f32 v46, v188, v189
v_cvt_pk_bf16_f32 v47, v190, v191
s_add_u32 s34, s72, 28672
buffer_store_dwordx4 v[44:47], v5, s[4:7], s34 offen sc1
v_lshlrev_b32 v184, 16, v44
v_and_b32 v185, s67, v44
v_lshlrev_b32 v186, 16, v45
v_and_b32 v187, s67, v45
v_lshlrev_b32 v188, 16, v46
v_and_b32 v189, s67, v46
v_lshlrev_b32 v190, 16, v47
v_and_b32 v191, s67, v47
s_waitcnt vmcnt(44)
v_lshlrev_b32 v192, 16, v48
v_and_b32 v193, s67, v48
v_lshlrev_b32 v194, 16, v49
v_and_b32 v195, s67, v49
v_lshlrev_b32 v196, 16, v50
v_and_b32 v197, s67, v50
v_lshlrev_b32 v198, 16, v51
v_and_b32 v199, s67, v51
v_dot2_f32_bf16 v192, v96, s64, v192
v_dot2_f32_bf16 v193, v96, s65, v193
v_dot2_f32_bf16 v194, v97, s64, v194
v_dot2_f32_bf16 v195, v97, s65, v195
v_dot2_f32_bf16 v196, v98, s64, v196
v_dot2_f32_bf16 v197, v98, s65, v197
v_dot2_f32_bf16 v198, v99, s64, v198
v_dot2_f32_bf16 v199, v99, s65, v199
v_cvt_pk_bf16_f32 v48, v192, v193
v_cvt_pk_bf16_f32 v49, v194, v195
v_cvt_pk_bf16_f32 v50, v196, v197
v_cvt_pk_bf16_f32 v51, v198, v199
s_add_u32 s34, s72, 32768
buffer_store_dwordx4 v[48:51], v5, s[4:7], s34 offen sc1
v_lshlrev_b32 v192, 16, v48
v_and_b32 v193, s67, v48
v_lshlrev_b32 v194, 16, v49
v_and_b32 v195, s67, v49
v_lshlrev_b32 v196, 16, v50
v_and_b32 v197, s67, v50
v_lshlrev_b32 v198, 16, v51
v_and_b32 v199, s67, v51
v_pk_add_f32 v[208:209], v[128:129], v[136:137]
v_pk_add_f32 v[210:211], v[130:131], v[138:139]
v_pk_add_f32 v[212:213], v[132:133], v[140:141]
v_pk_add_f32 v[214:215], v[134:135], v[142:143]
v_pk_add_f32 v[208:209], v[208:209], v[144:145]
v_pk_add_f32 v[210:211], v[210:211], v[146:147]
v_pk_add_f32 v[212:213], v[212:213], v[148:149]
v_pk_add_f32 v[214:215], v[214:215], v[150:151]
v_pk_add_f32 v[208:209], v[208:209], v[152:153]
v_pk_add_f32 v[210:211], v[210:211], v[154:155]
v_pk_add_f32 v[212:213], v[212:213], v[156:157]
v_pk_add_f32 v[214:215], v[214:215], v[158:159]
v_pk_add_f32 v[208:209], v[208:209], v[160:161]
v_pk_add_f32 v[210:211], v[210:211], v[162:163]
v_pk_add_f32 v[212:213], v[212:213], v[164:165]
v_pk_add_f32 v[214:215], v[214:215], v[166:167]
v_pk_add_f32 v[208:209], v[208:209], v[168:169]
v_pk_add_f32 v[210:211], v[210:211], v[170:171]
v_pk_add_f32 v[212:213], v[212:213], v[172:173]
v_pk_add_f32 v[214:215], v[214:215], v[174:175]
v_pk_add_f32 v[208:209], v[208:209], v[176:177]
v_pk_add_f32 v[210:211], v[210:211], v[178:179]
v_pk_add_f32 v[212:213], v[212:213], v[180:181]
v_pk_add_f32 v[214:215], v[214:215], v[182:183]
v_pk_add_f32 v[208:209], v[208:209], v[184:185]
v_pk_add_f32 v[210:211], v[210:211], v[186:187]
v_pk_add_f32 v[212:213], v[212:213], v[188:189]
v_pk_add_f32 v[214:215], v[214:215], v[190:191]
v_pk_add_f32 v[208:209], v[208:209], v[192:193]
v_pk_add_f32 v[210:211], v[210:211], v[194:195]
v_pk_add_f32 v[212:213], v[212:213], v[196:197]
v_pk_add_f32 v[214:215], v[214:215], v[198:199]
v_pk_add_f32 v[208:209], v[208:209], v[210:211]
v_pk_add_f32 v[212:213], v[212:213], v[214:215]
v_pk_add_f32 v[208:209], v[208:209], v[212:213]
v_add_f32 v208, v208, v209
s_nop 1
v_add_f32_dpp v208, v208, v208 row_ror:8 row_mask:0xf bank_mask:0xf
v_mov_b32 v209, v208
s_nop 1
v_permlane16_swap_b32 v208, v209
v_add_f32 v208, v208, v209
v_mov_b32 v209, v208
s_nop 1
v_permlane32_swap_b32 v208, v209
v_add_f32 v208, v208, v209
v_mul_f32 v208, s68, v208
v_sub_f32 v216, 0, v208
v_mov_b32 v217, v216
v_pk_add_f32 v[128:129], v[128:129], v[216:217]
v_pk_add_f32 v[130:131], v[130:131], v[216:217]
v_pk_add_f32 v[132:133], v[132:133], v[216:217]
v_pk_add_f32 v[134:135], v[134:135], v[216:217]
v_pk_add_f32 v[136:137], v[136:137], v[216:217]
v_pk_add_f32 v[138:139], v[138:139], v[216:217]
v_pk_add_f32 v[140:141], v[140:141], v[216:217]
v_pk_add_f32 v[142:143], v[142:143], v[216:217]
v_pk_add_f32 v[144:145], v[144:145], v[216:217]
v_pk_add_f32 v[146:147], v[146:147], v[216:217]
v_pk_add_f32 v[148:149], v[148:149], v[216:217]
v_pk_add_f32 v[150:151], v[150:151], v[216:217]
v_pk_add_f32 v[152:153], v[152:153], v[216:217]
v_pk_add_f32 v[154:155], v[154:155], v[216:217]
v_pk_add_f32 v[156:157], v[156:157], v[216:217]
v_pk_add_f32 v[158:159], v[158:159], v[216:217]
v_pk_add_f32 v[160:161], v[160:161], v[216:217]
v_pk_add_f32 v[162:163], v[162:163], v[216:217]
v_pk_add_f32 v[164:165], v[164:165], v[216:217]
v_pk_add_f32 v[166:167], v[166:167], v[216:217]
v_pk_add_f32 v[168:169], v[168:169], v[216:217]
v_pk_add_f32 v[170:171], v[170:171], v[216:217]
v_pk_add_f32 v[172:173], v[172:173], v[216:217]
v_pk_add_f32 v[174:175], v[174:175], v[216:217]
v_pk_add_f32 v[176:177], v[176:177], v[216:217]
v_pk_add_f32 v[178:179], v[178:179], v[216:217]
v_pk_add_f32 v[180:181], v[180:181], v[216:217]
v_pk_add_f32 v[182:183], v[182:183], v[216:217]
v_pk_add_f32 v[184:185], v[184:185], v[216:217]
v_pk_add_f32 v[186:187], v[186:187], v[216:217]
v_pk_add_f32 v[188:189], v[188:189], v[216:217]
v_pk_add_f32 v[190:191], v[190:191], v[216:217]
v_pk_add_f32 v[192:193], v[192:193], v[216:217]
v_pk_add_f32 v[194:195], v[194:195], v[216:217]
v_pk_add_f32 v[196:197], v[196:197], v[216:217]
v_pk_add_f32 v[198:199], v[198:199], v[216:217]
v_pk_mul_f32 v[208:209], v[128:129], v[128:129]
v_pk_mul_f32 v[210:211], v[130:131], v[130:131]
v_pk_mul_f32 v[212:213], v[132:133], v[132:133]
v_pk_mul_f32 v[214:215], v[134:135], v[134:135]
v_pk_fma_f32 v[208:209], v[136:137], v[136:137], v[208:209]
v_pk_fma_f32 v[210:211], v[138:139], v[138:139], v[210:211]
v_pk_fma_f32 v[212:213], v[140:141], v[140:141], v[212:213]
v_pk_fma_f32 v[214:215], v[142:143], v[142:143], v[214:215]
v_pk_fma_f32 v[208:209], v[144:145], v[144:145], v[208:209]
v_pk_fma_f32 v[210:211], v[146:147], v[146:147], v[210:211]
v_pk_fma_f32 v[212:213], v[148:149], v[148:149], v[212:213]
v_pk_fma_f32 v[214:215], v[150:151], v[150:151], v[214:215]
v_pk_fma_f32 v[208:209], v[152:153], v[152:153], v[208:209]
v_pk_fma_f32 v[210:211], v[154:155], v[154:155], v[210:211]
v_pk_fma_f32 v[212:213], v[156:157], v[156:157], v[212:213]
v_pk_fma_f32 v[214:215], v[158:159], v[158:159], v[214:215]
v_pk_fma_f32 v[208:209], v[160:161], v[160:161], v[208:209]
v_pk_fma_f32 v[210:211], v[162:163], v[162:163], v[210:211]
v_pk_fma_f32 v[212:213], v[164:165], v[164:165], v[212:213]
v_pk_fma_f32 v[214:215], v[166:167], v[166:167], v[214:215]
v_pk_fma_f32 v[208:209], v[168:169], v[168:169], v[208:209]
v_pk_fma_f32 v[210:211], v[170:171], v[170:171], v[210:211]
v_pk_fma_f32 v[212:213], v[172:173], v[172:173], v[212:213]
v_pk_fma_f32 v[214:215], v[174:175], v[174:175], v[214:215]
v_pk_fma_f32 v[208:209], v[176:177], v[176:177], v[208:209]
v_pk_fma_f32 v[210:211], v[178:179], v[178:179], v[210:211]
v_pk_fma_f32 v[212:213], v[180:181], v[180:181], v[212:213]
v_pk_fma_f32 v[214:215], v[182:183], v[182:183], v[214:215]
v_pk_fma_f32 v[208:209], v[184:185], v[184:185], v[208:209]
v_pk_fma_f32 v[210:211], v[186:187], v[186:187], v[210:211]
v_pk_fma_f32 v[212:213], v[188:189], v[188:189], v[212:213]
v_pk_fma_f32 v[214:215], v[190:191], v[190:191], v[214:215]
v_pk_fma_f32 v[208:209], v[192:193], v[192:193], v[208:209]
v_pk_fma_f32 v[210:211], v[194:195], v[194:195], v[210:211]
v_pk_fma_f32 v[212:213], v[196:197], v[196:197], v[212:213]
v_pk_fma_f32 v[214:215], v[198:199], v[198:199], v[214:215]
v_pk_add_f32 v[208:209], v[208:209], v[210:211]
v_pk_add_f32 v[212:213], v[212:213], v[214:215]
v_pk_add_f32 v[208:209], v[208:209], v[212:213]
v_add_f32 v208, v208, v209
s_nop 1
v_add_f32_dpp v208, v208, v208 row_ror:8 row_mask:0xf bank_mask:0xf
v_mov_b32 v209, v208
s_nop 1
v_permlane16_swap_b32 v208, v209
v_add_f32 v208, v208, v209
v_mov_b32 v209, v208
s_nop 1
v_permlane32_swap_b32 v208, v209
v_add_f32 v208, v208, v209
v_mov_b32 v209, s69
v_fma_f32 v208, v208, s68, v209
v_rsq_f32 v216, v208
s_nop 0
v_mov_b32 v217, v216
v_pk_mul_f32 v[128:129], v[128:129], v[216:217]
v_pk_mul_f32 v[130:131], v[130:131], v[216:217]
v_pk_mul_f32 v[132:133], v[132:133], v[216:217]
v_pk_mul_f32 v[134:135], v[134:135], v[216:217]
v_cvt_pk_bf16_f32 v64, v128, v129
v_cvt_pk_bf16_f32 v65, v130, v131
v_cvt_pk_bf16_f32 v66, v132, v133
v_cvt_pk_bf16_f32 v67, v134, v135
s_add_u32 s34, s73, 0
buffer_store_dwordx4 v[64:67], v5, s[4:7], s34 offen sc1
v_pk_mul_f32 v[136:137], v[136:137], v[216:217]
v_pk_mul_f32 v[138:139], v[138:139], v[216:217]
v_pk_mul_f32 v[140:141], v[140:141], v[216:217]
v_pk_mul_f32 v[142:143], v[142:143], v[216:217]
v_cvt_pk_bf16_f32 v68, v136, v137
v_cvt_pk_bf16_f32 v69, v138, v139
v_cvt_pk_bf16_f32 v70, v140, v141
v_cvt_pk_bf16_f32 v71, v142, v143
s_add_u32 s34, s73, 4096
buffer_store_dwordx4 v[68:71], v5, s[4:7], s34 offen sc1
v_pk_mul_f32 v[144:145], v[144:145], v[216:217]
v_pk_mul_f32 v[146:147], v[146:147], v[216:217]
v_pk_mul_f32 v[148:149], v[148:149], v[216:217]
v_pk_mul_f32 v[150:151], v[150:151], v[216:217]
v_cvt_pk_bf16_f32 v72, v144, v145
v_cvt_pk_bf16_f32 v73, v146, v147
v_cvt_pk_bf16_f32 v74, v148, v149
v_cvt_pk_bf16_f32 v75, v150, v151
s_add_u32 s34, s73, 8192
buffer_store_dwordx4 v[72:75], v5, s[4:7], s34 offen sc1
v_pk_mul_f32 v[152:153], v[152:153], v[216:217]
v_pk_mul_f32 v[154:155], v[154:155], v[216:217]
v_pk_mul_f32 v[156:157], v[156:157], v[216:217]
v_pk_mul_f32 v[158:159], v[158:159], v[216:217]
v_cvt_pk_bf16_f32 v76, v152, v153
v_cvt_pk_bf16_f32 v77, v154, v155
v_cvt_pk_bf16_f32 v78, v156, v157
v_cvt_pk_bf16_f32 v79, v158, v159
s_add_u32 s34, s73, 12288
buffer_store_dwordx4 v[76:79], v5, s[4:7], s34 offen sc1
v_pk_mul_f32 v[160:161], v[160:161], v[216:217]
v_pk_mul_f32 v[162:163], v[162:163], v[216:217]
v_pk_mul_f32 v[164:165], v[164:165], v[216:217]
v_pk_mul_f32 v[166:167], v[166:167], v[216:217]
v_cvt_pk_bf16_f32 v80, v160, v161
v_cvt_pk_bf16_f32 v81, v162, v163
v_cvt_pk_bf16_f32 v82, v164, v165
v_cvt_pk_bf16_f32 v83, v166, v167
s_add_u32 s34, s73, 16384
buffer_store_dwordx4 v[80:83], v5, s[4:7], s34 offen sc1
v_pk_mul_f32 v[168:169], v[168:169], v[216:217]
v_pk_mul_f32 v[170:171], v[170:171], v[216:217]
v_pk_mul_f32 v[172:173], v[172:173], v[216:217]
v_pk_mul_f32 v[174:175], v[174:175], v[216:217]
v_cvt_pk_bf16_f32 v84, v168, v169
v_cvt_pk_bf16_f32 v85, v170, v171
v_cvt_pk_bf16_f32 v86, v172, v173
v_cvt_pk_bf16_f32 v87, v174, v175
s_add_u32 s34, s73, 20480
buffer_store_dwordx4 v[84:87], v5, s[4:7], s34 offen sc1
v_pk_mul_f32 v[176:177], v[176:177], v[216:217]
v_pk_mul_f32 v[178:179], v[178:179], v[216:217]
v_pk_mul_f32 v[180:181], v[180:181], v[216:217]
v_pk_mul_f32 v[182:183], v[182:183], v[216:217]
v_cvt_pk_bf16_f32 v88, v176, v177
v_cvt_pk_bf16_f32 v89, v178, v179
v_cvt_pk_bf16_f32 v90, v180, v181
v_cvt_pk_bf16_f32 v91, v182, v183
s_add_u32 s34, s73, 24576
buffer_store_dwordx4 v[88:91], v5, s[4:7], s34 offen sc1
v_pk_mul_f32 v[184:185], v[184:185], v[216:217]
v_pk_mul_f32 v[186:187], v[186:187], v[216:217]
v_pk_mul_f32 v[188:189], v[188:189], v[216:217]
v_pk_mul_f32 v[190:191], v[190:191], v[216:217]
v_cvt_pk_bf16_f32 v92, v184, v185
v_cvt_pk_bf16_f32 v93, v186, v187
v_cvt_pk_bf16_f32 v94, v188, v189
v_cvt_pk_bf16_f32 v95, v190, v191
s_add_u32 s34, s73, 28672
buffer_store_dwordx4 v[92:95], v5, s[4:7], s34 offen sc1
v_pk_mul_f32 v[192:193], v[192:193], v[216:217]
v_pk_mul_f32 v[194:195], v[194:195], v[216:217]
v_pk_mul_f32 v[196:197], v[196:197], v[216:217]
v_pk_mul_f32 v[198:199], v[198:199], v[216:217]
v_cvt_pk_bf16_f32 v96, v192, v193
v_cvt_pk_bf16_f32 v97, v194, v195
v_cvt_pk_bf16_f32 v98, v196, v197
v_cvt_pk_bf16_f32 v99, v198, v199
s_add_u32 s34, s73, 32768
buffer_store_dwordx4 v[96:99], v5, s[4:7], s34 offen sc1
s_mov_b32 s39, s29
s_add_u32 s70, s70, 110592
s_add_u32 s71, s71, 442368
s_add_u32 s28, s28, 192
s_add_u32 s72, s72, 110592
s_add_u32 s73, s73, 110592
s_add_u32 s29, s29, 192
s_add_u32 s23, s23, 3
s_cmp_lt_u32 s23, 64
s_cbranch_scc1 L_fin_top2
s_waitcnt vmcnt(0)
s_mov_b64 exec, 1
v_mov_b32 v13, 1
buffer_atomic_add v13, off, s[4:7], s39 sc1
s_mov_b64 exec, -1
s_waitcnt vmcnt(0)
s_branch L_END
L_fin_n2:
s_cmp_ge_u32 s60, 7
s_cbranch_scc1 L_fin_n3
s_sub_u32 s3, s60, 5
s_mul_i32 s23, s20, 2
s_add_u32 s3, s3, s23
s_lshr_b32 s23, s3, 2
s_and_b32 s3, s3, 3
s_lshl_b32 s3, s3, 3
v_and_b32 v8, 7, v1
v_add_u32 v8, s3, v8
v_lshrrev_b32 v9, 3, v1
v_lshrrev_b32 v10, 1, v9
v_lshlrev_b32 v10, 10, v10
v_and_b32 v11, 1, v9
v_lshl_add_u32 v10, v11, 9, v10
v_lshl_add_u32 v5, v8, 4, v10
v_mul_u32_u24 v10, 1152, v8
v_lshl_add_u32 v6, v9, 4, v10
s_mov_b32 s70, 0x1040000
s_mul_i32 s3, s23, 0x9000
s_add_u32 s70, s70, s3
s_mov_b32 s71, 0x1740000
s_mul_i32 s3, s23, 0x9000
s_add_u32 s71, s71, s3
s_mov_b32 s28, 0x9000
s_mul_i32 s3, s23, 0x40
s_add_u32 s28, s28, s3
s_mov_b32 s72, 0x1280000
s_mul_i32 s3, s23, 0x9000
s_add_u32 s72, s72, s3
s_mov_b32 s73, 0xbc0000
s_mul_i32 s3, s23, 0x9000
s_add_u32 s73, s73, s3
s_mov_b32 s29, 0x3000
s_mul_i32 s3, s23, 0x40
s_add_u32 s29, s29, s3
L_fin_top3:
buffer_load_dword v15, off, s[4:7], s28 sc1
s_mov_b32 s91, 0
s_waitcnt vmcnt(0)
s_mov_b64 exec, 1
v_mov_b32 v13, 1
buffer_atomic_add v13, off, s[4:7], s39 sc1
s_mov_b64 exec, -1
v_cmp_gt_u32 vcc, 5, v15
s_nop 0
s_nop 2
s_cbranch_vccz L_spd_127
L_sp_126:
buffer_load_dword v15, off, s[4:7], s28 sc1
s_add_u32 s91, s91, 1
s_cmp_gt_u32 s91, 200000
s_cbranch_scc1 L_FAIL
s_waitcnt vmcnt(0)
v_cmp_gt_u32 vcc, 5, v15
s_nop 0
s_nop 2
s_cbranch_vccnz L_sp_126
L_spd_127:
s_add_u32 s34, s70, 0
buffer_load_dwordx4 v[16:19], v5, s[4:7], s34 offen
s_add_u32 s34, s70, 4096
buffer_load_dwordx4 v[20:23], v5, s[4:7], s34 offen
s_add_u32 s34, s70, 8192
buffer_load_dwordx4 v[24:27], v5, s[4:7], s34 offen
s_add_u32 s34, s70, 12288
buffer_load_dwordx4 v[28:31], v5, s[4:7], s34 offen
s_add_u32 s34, s70, 16384
buffer_load_dwordx4 v[32:35], v5, s[4:7], s34 offen
s_add_u32 s34, s70, 20480
buffer_load_dwordx4 v[36:39], v5, s[4:7], s34 offen
s_add_u32 s34, s70, 24576
buffer_load_dwordx4 v[40:43], v5, s[4:7], s34 offen
s_add_u32 s34, s70, 28672
buffer_load_dwordx4 v[44:47], v5, s[4:7], s34 offen
s_add_u32 s34, s70, 32768
buffer_load_dwordx4 v[48:51], v5, s[4:7], s34 offen
s_add_u32 s34, s71, 0
buffer_load_dwordx4 v[64:67], v5, s[4:7], s34 offen
s_add_u32 s34, s71, 4096
buffer_load_dwordx4 v[68:71], v5, s[4:7], s34 offen
s_add_u32 s34, s71, 8192
buffer_load_dwordx4 v[72:75], v5, s[4:7], s34 offen
s_add_u32 s34, s71, 12288
buffer_load_dwordx4 v[76:79], v5, s[4:7], s34 offen
s_add_u32 s34, s71, 16384
buffer_load_dwordx4 v[80:83], v5, s[4:7], s34 offen
s_add_u32 s34, s71, 20480
buffer_load_dwordx4 v[84:87], v5, s[4:7], s34 offen
s_add_u32 s34, s71, 24576
buffer_load_dwordx4 v[88:91], v5, s[4:7], s34 offen
s_add_u32 s34, s71, 28672
buffer_load_dwordx4 v[92:95], v5, s[4:7], s34 offen
s_add_u32 s34, s71, 32768
buffer_load_dwordx4 v[96:99], v5, s[4:7], s34 offen
s_waitcnt vmcnt(8)
v_lshlrev_b32 v128, 16, v16
v_and_b32 v129, s67, v16
v_lshlrev_b32 v130, 16, v17
v_and_b32 v131, s67, v17
v_lshlrev_b32 v132, 16, v18
v_and_b32 v133, s67, v18
v_lshlrev_b32 v134, 16, v19
v_and_b32 v135, s67, v19
v_dot2_f32_bf16 v128, v64, s64, v128
v_dot2_f32_bf16 v129, v64, s65, v129
v_dot2_f32_bf16 v130, v65, s64, v130
v_dot2_f32_bf16 v131, v65, s65, v131
v_dot2_f32_bf16 v132, v66, s64, v132
v_dot2_f32_bf16 v133, v66, s65, v133
v_dot2_f32_bf16 v134, v67, s64, v134
v_dot2_f32_bf16 v135, v67, s65, v135
v_cvt_pk_bf16_f32 v16, v128, v129
v_cvt_pk_bf16_f32 v17, v130, v131
v_cvt_pk_bf16_f32 v18, v132, v133
v_cvt_pk_bf16_f32 v19, v134, v135
s_add_u32 s34, s72, 0
buffer_store_dwordx4 v[16:19], v5, s[4:7], s34 offen sc1
v_lshlrev_b32 v128, 16, v16
v_and_b32 v129, s67, v16
v_lshlrev_b32 v130, 16, v17
v_and_b32 v131, s67, v17
v_lshlrev_b32 v132, 16, v18
v_and_b32 v133, s67, v18
v_lshlrev_b32 v134, 16, v19
v_and_b32 v135, s67, v19
s_waitcnt vmcnt(8)
v_lshlrev_b32 v136, 16, v20
v_and_b32 v137, s67, v20
v_lshlrev_b32 v138, 16, v21
v_and_b32 v139, s67, v21
v_lshlrev_b32 v140, 16, v22
v_and_b32 v141, s67, v22
v_lshlrev_b32 v142, 16, v23
v_and_b32 v143, s67, v23
v_dot2_f32_bf16 v136, v68, s64, v136
v_dot2_f32_bf16 v137, v68, s65, v137
v_dot2_f32_bf16 v138, v69, s64, v138
v_dot2_f32_bf16 v139, v69, s65, v139
v_dot2_f32_bf16 v140, v70, s64, v140
v_dot2_f32_bf16 v141, v70, s65, v141
v_dot2_f32_bf16 v142, v71, s64, v142
v_dot2_f32_bf16 v143, v71, s65, v143
v_cvt_pk_bf16_f32 v20, v136, v137
v_cvt_pk_bf16_f32 v21, v138, v139
v_cvt_pk_bf16_f32 v22, v140, v141
v_cvt_pk_bf16_f32 v23, v142, v143
s_add_u32 s34, s72, 4096
buffer_store_dwordx4 v[20:23], v5, s[4:7], s34 offen sc1
v_lshlrev_b32 v136, 16, v20
v_and_b32 v137, s67, v20
v_lshlrev_b32 v138, 16, v21
v_and_b32 v139, s67, v21
v_lshlrev_b32 v140, 16, v22
v_and_b32 v141, s67, v22
v_lshlrev_b32 v142, 16, v23
v_and_b32 v143, s67, v23
s_waitcnt vmcnt(8)
v_lshlrev_b32 v144, 16, v24
v_and_b32 v145, s67, v24
v_lshlrev_b32 v146, 16, v25
v_and_b32 v147, s67, v25
v_lshlrev_b32 v148, 16, v26
v_and_b32 v149, s67, v26
v_lshlrev_b32 v150, 16, v27
v_and_b32 v151, s67, v27
v_dot2_f32_bf16 v144, v72, s64, v144
v_dot2_f32_bf16 v145, v72, s65, v145
v_dot2_f32_bf16 v146, v73, s64, v146
v_dot2_f32_bf16 v147, v73, s65, v147
v_dot2_f32_bf16 v148, v74, s64, v148
v_dot2_f32_bf16 v149, v74, s65, v149
v_dot2_f32_bf16 v150, v75, s64, v150
v_dot2_f32_bf16 v151, v75, s65, v151
v_cvt_pk_bf16_f32 v24, v144, v145
v_cvt_pk_bf16_f32 v25, v146, v147
v_cvt_pk_bf16_f32 v26, v148, v149
v_cvt_pk_bf16_f32 v27, v150, v151
s_add_u32 s34, s72, 8192
buffer_store_dwordx4 v[24:27], v5, s[4:7], s34 offen sc1
v_lshlrev_b32 v144, 16, v24
v_and_b32 v145, s67, v24
v_lshlrev_b32 v146, 16, v25
v_and_b32 v147, s67, v25
v_lshlrev_b32 v148, 16, v26
v_and_b32 v149, s67, v26
v_lshlrev_b32 v150, 16, v27
v_and_b32 v151, s67, v27
s_waitcnt vmcnt(8)
v_lshlrev_b32 v152, 16, v28
v_and_b32 v153, s67, v28
v_lshlrev_b32 v154, 16, v29
v_and_b32 v155, s67, v29
v_lshlrev_b32 v156, 16, v30
v_and_b32 v157, s67, v30
v_lshlrev_b32 v158, 16, v31
v_and_b32 v159, s67, v31
v_dot2_f32_bf16 v152, v76, s64, v152
v_dot2_f32_bf16 v153, v76, s65, v153
v_dot2_f32_bf16 v154, v77, s64, v154
v_dot2_f32_bf16 v155, v77, s65, v155
v_dot2_f32_bf16 v156, v78, s64, v156
v_dot2_f32_bf16 v157, v78, s65, v157
v_dot2_f32_bf16 v158, v79, s64, v158
v_dot2_f32_bf16 v159, v79, s65, v159
v_cvt_pk_bf16_f32 v28, v152, v153
v_cvt_pk_bf16_f32 v29, v154, v155
v_cvt_pk_bf16_f32 v30, v156, v157
v_cvt_pk_bf16_f32 v31, v158, v159
s_add_u32 s34, s72, 12288
buffer_store_dwordx4 v[28:31], v5, s[4:7], s34 offen sc1
v_lshlrev_b32 v152, 16, v28
v_and_b32 v153, s67, v28
v_lshlrev_b32 v154, 16, v29
v_and_b32 v155, s67, v29
v_lshlrev_b32 v156, 16, v30
v_and_b32 v157, s67, v30
v_lshlrev_b32 v158, 16, v31
v_and_b32 v159, s67, v31
s_waitcnt vmcnt(8)
v_lshlrev_b32 v160, 16, v32
v_and_b32 v161, s67, v32
v_lshlrev_b32 v162, 16, v33
v_and_b32 v163, s67, v33
v_lshlrev_b32 v164, 16, v34
v_and_b32 v165, s67, v34
v_lshlrev_b32 v166, 16, v35
v_and_b32 v167, s67, v35
v_dot2_f32_bf16 v160, v80, s64, v160
v_dot2_f32_bf16 v161, v80, s65, v161
v_dot2_f32_bf16 v162, v81, s64, v162
v_dot2_f32_bf16 v163, v81, s65, v163
v_dot2_f32_bf16 v164, v82, s64, v164
v_dot2_f32_bf16 v165, v82, s65, v165
v_dot2_f32_bf16 v166, v83, s64, v166
v_dot2_f32_bf16 v167, v83, s65, v167
v_cvt_pk_bf16_f32 v32, v160, v161
v_cvt_pk_bf16_f32 v33, v162, v163
v_cvt_pk_bf16_f32 v34, v164, v165
v_cvt_pk_bf16_f32 v35, v166, v167
s_add_u32 s34, s72, 16384
buffer_store_dwordx4 v[32:35], v5, s[4:7], s34 offen sc1
v_lshlrev_b32 v160, 16, v32
v_and_b32 v161, s67, v32
v_lshlrev_b32 v162, 16, v33
v_and_b32 v163, s67, v33
v_lshlrev_b32 v164, 16, v34
v_and_b32 v165, s67, v34
v_lshlrev_b32 v166, 16, v35
v_and_b32 v167, s67, v35
s_waitcnt vmcnt(8)
v_lshlrev_b32 v168, 16, v36
v_and_b32 v169, s67, v36
v_lshlrev_b32 v170, 16, v37
v_and_b32 v171, s67, v37
v_lshlrev_b32 v172, 16, v38
v_and_b32 v173, s67, v38
v_lshlrev_b32 v174, 16, v39
v_and_b32 v175, s67, v39
v_dot2_f32_bf16 v168, v84, s64, v168
v_dot2_f32_bf16 v169, v84, s65, v169
v_dot2_f32_bf16 v170, v85, s64, v170
v_dot2_f32_bf16 v171, v85, s65, v171
v_dot2_f32_bf16 v172, v86, s64, v172
v_dot2_f32_bf16 v173, v86, s65, v173
v_dot2_f32_bf16 v174, v87, s64, v174
v_dot2_f32_bf16 v175, v87, s65, v175
v_cvt_pk_bf16_f32 v36, v168, v169
v_cvt_pk_bf16_f32 v37, v170, v171
v_cvt_pk_bf16_f32 v38, v172, v173
v_cvt_pk_bf16_f32 v39, v174, v175
s_add_u32 s34, s72, 20480
buffer_store_dwordx4 v[36:39], v5, s[4:7], s34 offen sc1
v_lshlrev_b32 v168, 16, v36
v_and_b32 v169, s67, v36
v_lshlrev_b32 v170, 16, v37
v_and_b32 v171, s67, v37
v_lshlrev_b32 v172, 16, v38
v_and_b32 v173, s67, v38
v_lshlrev_b32 v174, 16, v39
v_and_b32 v175, s67, v39
s_waitcnt vmcnt(8)
v_lshlrev_b32 v176, 16, v40
v_and_b32 v177, s67, v40
v_lshlrev_b32 v178, 16, v41
v_and_b32 v179, s67, v41
v_lshlrev_b32 v180, 16, v42
v_and_b32 v181, s67, v42
v_lshlrev_b32 v182, 16, v43
v_and_b32 v183, s67, v43
v_dot2_f32_bf16 v176, v88, s64, v176
v_dot2_f32_bf16 v177, v88, s65, v177
v_dot2_f32_bf16 v178, v89, s64, v178
v_dot2_f32_bf16 v179, v89, s65, v179
v_dot2_f32_bf16 v180, v90, s64, v180
v_dot2_f32_bf16 v181, v90, s65, v181
v_dot2_f32_bf16 v182, v91, s64, v182
v_dot2_f32_bf16 v183, v91, s65, v183
v_cvt_pk_bf16_f32 v40, v176, v177
v_cvt_pk_bf16_f32 v41, v178, v179
v_cvt_pk_bf16_f32 v42, v180, v181
v_cvt_pk_bf16_f32 v43, v182, v183
s_add_u32 s34, s72, 24576
buffer_store_dwordx4 v[40:43], v5, s[4:7], s34 offen sc1
v_lshlrev_b32 v176, 16, v40
v_and_b32 v177, s67, v40
v_lshlrev_b32 v178, 16, v41
v_and_b32 v179, s67, v41
v_lshlrev_b32 v180, 16, v42
v_and_b32 v181, s67, v42
v_lshlrev_b32 v182, 16, v43
v_and_b32 v183, s67, v43
s_waitcnt vmcnt(8)
v_lshlrev_b32 v184, 16, v44
v_and_b32 v185, s67, v44
v_lshlrev_b32 v186, 16, v45
v_and_b32 v187, s67, v45
v_lshlrev_b32 v188, 16, v46
v_and_b32 v189, s67, v46
v_lshlrev_b32 v190, 16, v47
v_and_b32 v191, s67, v47
v_dot2_f32_bf16 v184, v92, s64, v184
v_dot2_f32_bf16 v185, v92, s65, v185
v_dot2_f32_bf16 v186, v93, s64, v186
v_dot2_f32_bf16 v187, v93, s65, v187
v_dot2_f32_bf16 v188, v94, s64, v188
v_dot2_f32_bf16 v189, v94, s65, v189
v_dot2_f32_bf16 v190, v95, s64, v190
v_dot2_f32_bf16 v191, v95, s65, v191
v_cvt_pk_bf16_f32 v44, v184, v185
v_cvt_pk_bf16_f32 v45, v186, v187
v_cvt_pk_bf16_f32 v46, v188, v189
v_cvt_pk_bf16_f32 v47, v190, v191
s_add_u32 s34, s72, 28672
buffer_store_dwordx4 v[44:47], v5, s[4:7], s34 offen sc1
v_lshlrev_b32 v184, 16, v44
v_and_b32 v185, s67, v44
v_lshlrev_b32 v186, 16, v45
v_and_b32 v187, s67, v45
v_lshlrev_b32 v188, 16, v46
v_and_b32 v189, s67, v46
v_lshlrev_b32 v190, 16, v47
v_and_b32 v191, s67, v47
s_waitcnt vmcnt(8)
v_lshlrev_b32 v192, 16, v48
v_and_b32 v193, s67, v48
v_lshlrev_b32 v194, 16, v49
v_and_b32 v195, s67, v49
v_lshlrev_b32 v196, 16, v50
v_and_b32 v197, s67, v50
v_lshlrev_b32 v198, 16, v51
v_and_b32 v199, s67, v51
v_dot2_f32_bf16 v192, v96, s64, v192
v_dot2_f32_bf16 v193, v96, s65, v193
v_dot2_f32_bf16 v194, v97, s64, v194
v_dot2_f32_bf16 v195, v97, s65, v195
v_dot2_f32_bf16 v196, v98, s64, v196
v_dot2_f32_bf16 v197, v98, s65, v197
v_dot2_f32_bf16 v198, v99, s64, v198
v_dot2_f32_bf16 v199, v99, s65, v199
v_cvt_pk_bf16_f32 v48, v192, v193
v_cvt_pk_bf16_f32 v49, v194, v195
v_cvt_pk_bf16_f32 v50, v196, v197
v_cvt_pk_bf16_f32 v51, v198, v199
s_add_u32 s34, s72, 32768
buffer_store_dwordx4 v[48:51], v5, s[4:7], s34 offen sc1
v_lshlrev_b32 v192, 16, v48
v_and_b32 v193, s67, v48
v_lshlrev_b32 v194, 16, v49
v_and_b32 v195, s67, v49
v_lshlrev_b32 v196, 16, v50
v_and_b32 v197, s67, v50
v_lshlrev_b32 v198, 16, v51
v_and_b32 v199, s67, v51
v_pk_add_f32 v[208:209], v[128:129], v[136:137]
v_pk_add_f32 v[210:211], v[130:131], v[138:139]
v_pk_add_f32 v[212:213], v[132:133], v[140:141]
v_pk_add_f32 v[214:215], v[134:135], v[142:143]
v_pk_add_f32 v[208:209], v[208:209], v[144:145]
v_pk_add_f32 v[210:211], v[210:211], v[146:147]
v_pk_add_f32 v[212:213], v[212:213], v[148:149]
v_pk_add_f32 v[214:215], v[214:215], v[150:151]
v_pk_add_f32 v[208:209], v[208:209], v[152:153]
v_pk_add_f32 v[210:211], v[210:211], v[154:155]
v_pk_add_f32 v[212:213], v[212:213], v[156:157]
v_pk_add_f32 v[214:215], v[214:215], v[158:159]
v_pk_add_f32 v[208:209], v[208:209], v[160:161]
v_pk_add_f32 v[210:211], v[210:211], v[162:163]
v_pk_add_f32 v[212:213], v[212:213], v[164:165]
v_pk_add_f32 v[214:215], v[214:215], v[166:167]
v_pk_add_f32 v[208:209], v[208:209], v[168:169]
v_pk_add_f32 v[210:211], v[210:211], v[170:171]
v_pk_add_f32 v[212:213], v[212:213], v[172:173]
v_pk_add_f32 v[214:215], v[214:215], v[174:175]
v_pk_add_f32 v[208:209], v[208:209], v[176:177]
v_pk_add_f32 v[210:211], v[210:211], v[178:179]
v_pk_add_f32 v[212:213], v[212:213], v[180:181]
v_pk_add_f32 v[214:215], v[214:215], v[182:183]
v_pk_add_f32 v[208:209], v[208:209], v[184:185]
v_pk_add_f32 v[210:211], v[210:211], v[186:187]
v_pk_add_f32 v[212:213], v[212:213], v[188:189]
v_pk_add_f32 v[214:215], v[214:215], v[190:191]
v_pk_add_f32 v[208:209], v[208:209], v[192:193]
v_pk_add_f32 v[210:211], v[210:211], v[194:195]
v_pk_add_f32 v[212:213], v[212:213], v[196:197]
v_pk_add_f32 v[214:215], v[214:215], v[198:199]
v_pk_add_f32 v[208:209], v[208:209], v[210:211]
v_pk_add_f32 v[212:213], v[212:213], v[214:215]
v_pk_add_f32 v[208:209], v[208:209], v[212:213]
v_add_f32 v208, v208, v209
s_nop 1
v_add_f32_dpp v208, v208, v208 row_ror:8 row_mask:0xf bank_mask:0xf
v_mov_b32 v209, v208
s_nop 1
v_permlane16_swap_b32 v208, v209
v_add_f32 v208, v208, v209
v_mov_b32 v209, v208
s_nop 1
v_permlane32_swap_b32 v208, v209
v_add_f32 v208, v208, v209
v_mul_f32 v208, s68, v208
v_sub_f32 v216, 0, v208
v_mov_b32 v217, v216
v_pk_add_f32 v[128:129], v[128:129], v[216:217]
v_pk_add_f32 v[130:131], v[130:131], v[216:217]
v_pk_add_f32 v[132:133], v[132:133], v[216:217]
v_pk_add_f32 v[134:135], v[134:135], v[216:217]
v_pk_add_f32 v[136:137], v[136:137], v[216:217]
v_pk_add_f32 v[138:139], v[138:139], v[216:217]
v_pk_add_f32 v[140:141], v[140:141], v[216:217]
v_pk_add_f32 v[142:143], v[142:143], v[216:217]
v_pk_add_f32 v[144:145], v[144:145], v[216:217]
v_pk_add_f32 v[146:147], v[146:147], v[216:217]
v_pk_add_f32 v[148:149], v[148:149], v[216:217]
v_pk_add_f32 v[150:151], v[150:151], v[216:217]
v_pk_add_f32 v[152:153], v[152:153], v[216:217]
v_pk_add_f32 v[154:155], v[154:155], v[216:217]
v_pk_add_f32 v[156:157], v[156:157], v[216:217]
v_pk_add_f32 v[158:159], v[158:159], v[216:217]
v_pk_add_f32 v[160:161], v[160:161], v[216:217]
v_pk_add_f32 v[162:163], v[162:163], v[216:217]
v_pk_add_f32 v[164:165], v[164:165], v[216:217]
v_pk_add_f32 v[166:167], v[166:167], v[216:217]
v_pk_add_f32 v[168:169], v[168:169], v[216:217]
v_pk_add_f32 v[170:171], v[170:171], v[216:217]
v_pk_add_f32 v[172:173], v[172:173], v[216:217]
v_pk_add_f32 v[174:175], v[174:175], v[216:217]
v_pk_add_f32 v[176:177], v[176:177], v[216:217]
v_pk_add_f32 v[178:179], v[178:179], v[216:217]
v_pk_add_f32 v[180:181], v[180:181], v[216:217]
v_pk_add_f32 v[182:183], v[182:183], v[216:217]
v_pk_add_f32 v[184:185], v[184:185], v[216:217]
v_pk_add_f32 v[186:187], v[186:187], v[216:217]
v_pk_add_f32 v[188:189], v[188:189], v[216:217]
v_pk_add_f32 v[190:191], v[190:191], v[216:217]
v_pk_add_f32 v[192:193], v[192:193], v[216:217]
v_pk_add_f32 v[194:195], v[194:195], v[216:217]
v_pk_add_f32 v[196:197], v[196:197], v[216:217]
v_pk_add_f32 v[198:199], v[198:199], v[216:217]
v_pk_mul_f32 v[208:209], v[128:129], v[128:129]
v_pk_mul_f32 v[210:211], v[130:131], v[130:131]
v_pk_mul_f32 v[212:213], v[132:133], v[132:133]
v_pk_mul_f32 v[214:215], v[134:135], v[134:135]
v_pk_fma_f32 v[208:209], v[136:137], v[136:137], v[208:209]
v_pk_fma_f32 v[210:211], v[138:139], v[138:139], v[210:211]
v_pk_fma_f32 v[212:213], v[140:141], v[140:141], v[212:213]
v_pk_fma_f32 v[214:215], v[142:143], v[142:143], v[214:215]
v_pk_fma_f32 v[208:209], v[144:145], v[144:145], v[208:209]
v_pk_fma_f32 v[210:211], v[146:147], v[146:147], v[210:211]
v_pk_fma_f32 v[212:213], v[148:149], v[148:149], v[212:213]
v_pk_fma_f32 v[214:215], v[150:151], v[150:151], v[214:215]
v_pk_fma_f32 v[208:209], v[152:153], v[152:153], v[208:209]
v_pk_fma_f32 v[210:211], v[154:155], v[154:155], v[210:211]
v_pk_fma_f32 v[212:213], v[156:157], v[156:157], v[212:213]
v_pk_fma_f32 v[214:215], v[158:159], v[158:159], v[214:215]
v_pk_fma_f32 v[208:209], v[160:161], v[160:161], v[208:209]
v_pk_fma_f32 v[210:211], v[162:163], v[162:163], v[210:211]
v_pk_fma_f32 v[212:213], v[164:165], v[164:165], v[212:213]
v_pk_fma_f32 v[214:215], v[166:167], v[166:167], v[214:215]
v_pk_fma_f32 v[208:209], v[168:169], v[168:169], v[208:209]
v_pk_fma_f32 v[210:211], v[170:171], v[170:171], v[210:211]
v_pk_fma_f32 v[212:213], v[172:173], v[172:173], v[212:213]
v_pk_fma_f32 v[214:215], v[174:175], v[174:175], v[214:215]
v_pk_fma_f32 v[208:209], v[176:177], v[176:177], v[208:209]
v_pk_fma_f32 v[210:211], v[178:179], v[178:179], v[210:211]
v_pk_fma_f32 v[212:213], v[180:181], v[180:181], v[212:213]
v_pk_fma_f32 v[214:215], v[182:183], v[182:183], v[214:215]
v_pk_fma_f32 v[208:209], v[184:185], v[184:185], v[208:209]
v_pk_fma_f32 v[210:211], v[186:187], v[186:187], v[210:211]
v_pk_fma_f32 v[212:213], v[188:189], v[188:189], v[212:213]
v_pk_fma_f32 v[214:215], v[190:191], v[190:191], v[214:215]
v_pk_fma_f32 v[208:209], v[192:193], v[192:193], v[208:209]
v_pk_fma_f32 v[210:211], v[194:195], v[194:195], v[210:211]
v_pk_fma_f32 v[212:213], v[196:197], v[196:197], v[212:213]
v_pk_fma_f32 v[214:215], v[198:199], v[198:199], v[214:215]
v_pk_add_f32 v[208:209], v[208:209], v[210:211]
v_pk_add_f32 v[212:213], v[212:213], v[214:215]
v_pk_add_f32 v[208:209], v[208:209], v[212:213]
v_add_f32 v208, v208, v209
s_nop 1
v_add_f32_dpp v208, v208, v208 row_ror:8 row_mask:0xf bank_mask:0xf
v_mov_b32 v209, v208
s_nop 1
v_permlane16_swap_b32 v208, v209
v_add_f32 v208, v208, v209
v_mov_b32 v209, v208
s_nop 1
v_permlane32_swap_b32 v208, v209
v_add_f32 v208, v208, v209
v_mov_b32 v209, s69
v_fma_f32 v208, v208, s68, v209
v_rsq_f32 v216, v208
s_nop 0
v_mov_b32 v217, v216
v_pk_mul_f32 v[128:129], v[128:129], v[216:217]
v_pk_mul_f32 v[130:131], v[130:131], v[216:217]
v_pk_mul_f32 v[132:133], v[132:133], v[216:217]
v_pk_mul_f32 v[134:135], v[134:135], v[216:217]
v_cvt_pk_bf16_f32 v64, v128, v129
v_cvt_pk_bf16_f32 v65, v130, v131
v_cvt_pk_bf16_f32 v66, v132, v133
v_cvt_pk_bf16_f32 v67, v134, v135
s_add_u32 s34, s73, 0
buffer_store_dwordx4 v[64:67], v5, s[4:7], s34 offen sc1
v_pk_mul_f32 v[136:137], v[136:137], v[216:217]
v_pk_mul_f32 v[138:139], v[138:139], v[216:217]
v_pk_mul_f32 v[140:141], v[140:141], v[216:217]
v_pk_mul_f32 v[142:143], v[142:143], v[216:217]
v_cvt_pk_bf16_f32 v68, v136, v137
v_cvt_pk_bf16_f32 v69, v138, v139
v_cvt_pk_bf16_f32 v70, v140, v141
v_cvt_pk_bf16_f32 v71, v142, v143
s_add_u32 s34, s73, 4096
buffer_store_dwordx4 v[68:71], v5, s[4:7], s34 offen sc1
v_pk_mul_f32 v[144:145], v[144:145], v[216:217]
v_pk_mul_f32 v[146:147], v[146:147], v[216:217]
v_pk_mul_f32 v[148:149], v[148:149], v[216:217]
v_pk_mul_f32 v[150:151], v[150:151], v[216:217]
v_cvt_pk_bf16_f32 v72, v144, v145
v_cvt_pk_bf16_f32 v73, v146, v147
v_cvt_pk_bf16_f32 v74, v148, v149
v_cvt_pk_bf16_f32 v75, v150, v151
s_add_u32 s34, s73, 8192
buffer_store_dwordx4 v[72:75], v5, s[4:7], s34 offen sc1
v_pk_mul_f32 v[152:153], v[152:153], v[216:217]
v_pk_mul_f32 v[154:155], v[154:155], v[216:217]
v_pk_mul_f32 v[156:157], v[156:157], v[216:217]
v_pk_mul_f32 v[158:159], v[158:159], v[216:217]
v_cvt_pk_bf16_f32 v76, v152, v153
v_cvt_pk_bf16_f32 v77, v154, v155
v_cvt_pk_bf16_f32 v78, v156, v157
v_cvt_pk_bf16_f32 v79, v158, v159
s_add_u32 s34, s73, 12288
buffer_store_dwordx4 v[76:79], v5, s[4:7], s34 offen sc1
v_pk_mul_f32 v[160:161], v[160:161], v[216:217]
v_pk_mul_f32 v[162:163], v[162:163], v[216:217]
v_pk_mul_f32 v[164:165], v[164:165], v[216:217]
v_pk_mul_f32 v[166:167], v[166:167], v[216:217]
v_cvt_pk_bf16_f32 v80, v160, v161
v_cvt_pk_bf16_f32 v81, v162, v163
v_cvt_pk_bf16_f32 v82, v164, v165
v_cvt_pk_bf16_f32 v83, v166, v167
s_add_u32 s34, s73, 16384
buffer_store_dwordx4 v[80:83], v5, s[4:7], s34 offen sc1
v_pk_mul_f32 v[168:169], v[168:169], v[216:217]
v_pk_mul_f32 v[170:171], v[170:171], v[216:217]
v_pk_mul_f32 v[172:173], v[172:173], v[216:217]
v_pk_mul_f32 v[174:175], v[174:175], v[216:217]
v_cvt_pk_bf16_f32 v84, v168, v169
v_cvt_pk_bf16_f32 v85, v170, v171
v_cvt_pk_bf16_f32 v86, v172, v173
v_cvt_pk_bf16_f32 v87, v174, v175
s_add_u32 s34, s73, 20480
buffer_store_dwordx4 v[84:87], v5, s[4:7], s34 offen sc1
v_pk_mul_f32 v[176:177], v[176:177], v[216:217]
v_pk_mul_f32 v[178:179], v[178:179], v[216:217]
v_pk_mul_f32 v[180:181], v[180:181], v[216:217]
v_pk_mul_f32 v[182:183], v[182:183], v[216:217]
v_cvt_pk_bf16_f32 v88, v176, v177
v_cvt_pk_bf16_f32 v89, v178, v179
v_cvt_pk_bf16_f32 v90, v180, v181
v_cvt_pk_bf16_f32 v91, v182, v183
s_add_u32 s34, s73, 24576
buffer_store_dwordx4 v[88:91], v5, s[4:7], s34 offen sc1
v_pk_mul_f32 v[184:185], v[184:185], v[216:217]
v_pk_mul_f32 v[186:187], v[186:187], v[216:217]
v_pk_mul_f32 v[188:189], v[188:189], v[216:217]
v_pk_mul_f32 v[190:191], v[190:191], v[216:217]
v_cvt_pk_bf16_f32 v92, v184, v185
v_cvt_pk_bf16_f32 v93, v186, v187
v_cvt_pk_bf16_f32 v94, v188, v189
v_cvt_pk_bf16_f32 v95, v190, v191
s_add_u32 s34, s73, 28672
buffer_store_dwordx4 v[92:95], v5, s[4:7], s34 offen sc1
v_pk_mul_f32 v[192:193], v[192:193], v[216:217]
v_pk_mul_f32 v[194:195], v[194:195], v[216:217]
v_pk_mul_f32 v[196:197], v[196:197], v[216:217]
v_pk_mul_f32 v[198:199], v[198:199], v[216:217]
v_cvt_pk_bf16_f32 v96, v192, v193
v_cvt_pk_bf16_f32 v97, v194, v195
v_cvt_pk_bf16_f32 v98, v196, v197
v_cvt_pk_bf16_f32 v99, v198, v199
s_add_u32 s34, s73, 32768
buffer_store_dwordx4 v[96:99], v5, s[4:7], s34 offen sc1
s_mov_b32 s39, s29
s_add_u32 s70, s70, 73728
s_add_u32 s71, s71, 73728
s_add_u32 s28, s28, 128
s_add_u32 s72, s72, 73728
s_add_u32 s73, s73, 73728
s_add_u32 s29, s29, 128
s_add_u32 s23, s23, 2
s_cmp_lt_u32 s23, 64
s_cbranch_scc1 L_fin_top3
s_waitcnt vmcnt(0)
s_mov_b64 exec, 1
v_mov_b32 v13, 1
buffer_atomic_add v13, off, s[4:7], s39 sc1
s_mov_b64 exec, -1
s_waitcnt vmcnt(0)
s_branch L_END
L_fin_n3:
s_sub_u32 s3, s60, 7
s_mul_i32 s23, s20, 3
s_add_u32 s3, s3, s23
s_lshr_b32 s23, s3, 2
s_and_b32 s3, s3, 3
s_lshl_b32 s3, s3, 3
v_and_b32 v8, 7, v1
v_add_u32 v8, s3, v8
v_lshrrev_b32 v9, 3, v1
v_lshrrev_b32 v10, 1, v9
v_lshlrev_b32 v10, 10, v10
v_and_b32 v11, 1, v9
v_lshl_add_u32 v10, v11, 9, v10
v_lshl_add_u32 v5, v8, 4, v10
v_mul_u32_u24 v10, 1152, v8
v_lshl_add_u32 v6, v9, 4, v10
s_mov_b32 s70, 0x1280000
s_mul_i32 s3, s23, 0x9000
s_add_u32 s70, s70, s3
s_mov_b32 s71, 0x4900000
s_mul_i32 s3, s23, 0x24000
s_add_u32 s71, s71, s3
s_mov_b32 s28, 0xb000
s_mul_i32 s3, s23, 0x40
s_add_u32 s28, s28, s3
s_mov_b32 s72, 0x0
s_mul_i32 s3, s23, 0x9000
s_add_u32 s72, s72, s3
L_fin_top4:
buffer_load_dword v15, off, s[4:7], s28 sc1
s_mov_b32 s91, 0
s_waitcnt vmcnt(0)
s_mov_b64 exec, 1
v_mov_b32 v13, 1
buffer_atomic_add v13, off, s[4:7], s39 sc1
s_mov_b64 exec, -1
v_cmp_gt_u32 vcc, 36, v15
s_nop 0
s_nop 2
s_cbranch_vccz L_spd_129
L_sp_128:
buffer_load_dword v15, off, s[4:7], s28 sc1
s_add_u32 s91, s91, 1
s_cmp_gt_u32 s91, 200000
s_cbranch_scc1 L_FAIL
s_waitcnt vmcnt(0)
v_cmp_gt_u32 vcc, 36, v15
s_nop 0
s_nop 2
s_cbranch_vccnz L_sp_128
L_spd_129:
s_add_u32 s34, s70, 0
buffer_load_dwordx4 v[16:19], v5, s[4:7], s34 offen
s_add_u32 s34, s70, 4096
buffer_load_dwordx4 v[20:23], v5, s[4:7], s34 offen
s_add_u32 s34, s70, 8192
buffer_load_dwordx4 v[24:27], v5, s[4:7], s34 offen
s_add_u32 s34, s70, 12288
buffer_load_dwordx4 v[28:31], v5, s[4:7], s34 offen
s_add_u32 s34, s70, 16384
buffer_load_dwordx4 v[32:35], v5, s[4:7], s34 offen
s_add_u32 s34, s70, 20480
buffer_load_dwordx4 v[36:39], v5, s[4:7], s34 offen
s_add_u32 s34, s70, 24576
buffer_load_dwordx4 v[40:43], v5, s[4:7], s34 offen
s_add_u32 s34, s70, 28672
buffer_load_dwordx4 v[44:47], v5, s[4:7], s34 offen
s_add_u32 s34, s70, 32768
buffer_load_dwordx4 v[48:51], v5, s[4:7], s34 offen
s_add_u32 s34, s71, 0
buffer_load_dwordx4 v[64:67], v5, s[4:7], s34 offen
s_add_u32 s34, s71, 4096
buffer_load_dwordx4 v[68:71], v5, s[4:7], s34 offen
s_add_u32 s34, s71, 8192
buffer_load_dwordx4 v[72:75], v5, s[4:7], s34 offen
s_add_u32 s34, s71, 12288
buffer_load_dwordx4 v[76:79], v5, s[4:7], s34 offen
s_add_u32 s34, s71, 16384
buffer_load_dwordx4 v[80:83], v5, s[4:7], s34 offen
s_add_u32 s34, s71, 20480
buffer_load_dwordx4 v[84:87], v5, s[4:7], s34 offen
s_add_u32 s34, s71, 24576
buffer_load_dwordx4 v[88:91], v5, s[4:7], s34 offen
s_add_u32 s34, s71, 28672
buffer_load_dwordx4 v[92:95], v5, s[4:7], s34 offen
s_add_u32 s34, s71, 32768
buffer_load_dwordx4 v[96:99], v5, s[4:7], s34 offen
s_add_u32 s34, s71, 36864
buffer_load_dwordx4 v[100:103], v5, s[4:7], s34 offen
s_add_u32 s34, s71, 40960
buffer_load_dwordx4 v[104:107], v5, s[4:7], s34 offen
s_add_u32 s34, s71, 45056
buffer_load_dwordx4 v[108:111], v5, s[4:7], s34 offen
s_add_u32 s34, s71, 49152
buffer_load_dwordx4 v[112:115], v5, s[4:7], s34 offen
s_add_u32 s34, s71, 53248
buffer_load_dwordx4 v[116:119], v5, s[4:7], s34 offen
s_add_u32 s34, s71, 57344
buffer_load_dwordx4 v[120:123], v5, s[4:7], s34 offen
s_add_u32 s34, s71, 61440
buffer_load_dwordx4 v[124:127], v5, s[4:7], s34 offen
s_add_u32 s34, s71, 65536
buffer_load_dwordx4 v[128:131], v5, s[4:7], s34 offen
s_add_u32 s34, s71, 69632
buffer_load_dwordx4 v[132:135], v5, s[4:7], s34 offen
s_add_u32 s34, s71, 73728
buffer_load_dwordx4 v[136:139], v5, s[4:7], s34 offen
s_add_u32 s34, s71, 77824
buffer_load_dwordx4 v[140:143], v5, s[4:7], s34 offen
s_add_u32 s34, s71, 81920
buffer_load_dwordx4 v[144:147], v5, s[4:7], s34 offen
s_add_u32 s34, s71, 86016
buffer_load_dwordx4 v[148:151], v5, s[4:7], s34 offen
s_add_u32 s34, s71, 90112
buffer_load_dwordx4 v[152:155], v5, s[4:7], s34 offen
s_add_u32 s34, s71, 94208
buffer_load_dwordx4 v[156:159], v5, s[4:7], s34 offen
s_add_u32 s34, s71, 98304
buffer_load_dwordx4 v[160:163], v5, s[4:7], s34 offen
s_add_u32 s34, s71, 102400
buffer_load_dwordx4 v[164:167], v5, s[4:7], s34 offen
s_add_u32 s34, s71, 106496
buffer_load_dwordx4 v[168:171], v5, s[4:7], s34 offen
s_add_u32 s34, s71, 110592
buffer_load_dwordx4 v[172:175], v5, s[4:7], s34 offen
s_add_u32 s34, s71, 114688
buffer_load_dwordx4 v[176:179], v5, s[4:7], s34 offen
s_add_u32 s34, s71, 118784
buffer_load_dwordx4 v[180:183], v5, s[4:7], s34 offen
s_add_u32 s34, s71, 122880
buffer_load_dwordx4 v[184:187], v5, s[4:7], s34 offen
s_add_u32 s34, s71, 126976
buffer_load_dwordx4 v[188:191], v5, s[4:7], s34 offen
s_add_u32 s34, s71, 131072
buffer_load_dwordx4 v[192:195], v5, s[4:7], s34 offen
s_add_u32 s34, s71, 135168
buffer_load_dwordx4 v[196:199], v5, s[4:7], s34 offen
s_add_u32 s34, s71, 139264
buffer_load_dwordx4 v[200:203], v5, s[4:7], s34 offen
s_add_u32 s34, s71, 143360
buffer_load_dwordx4 v[204:207], v5, s[4:7], s34 offen
s_waitcnt vmcnt(8)
v_lshlrev_b32 v208, 16, v64
v_and_b32 v209, s67, v64
v_lshlrev_b32 v210, 16, v65
v_and_b32 v211, s67, v65
v_lshlrev_b32 v212, 16, v66
v_and_b32 v213, s67, v66
v_lshlrev_b32 v214, 16, v67
v_and_b32 v215, s67, v67
v_dot2_f32_bf16 v208, v100, s64, v208
v_dot2_f32_bf16 v209, v100, s65, v209
v_dot2_f32_bf16 v210, v101, s64, v210
v_dot2_f32_bf16 v211, v101, s65, v211
v_dot2_f32_bf16 v212, v102, s64, v212
v_dot2_f32_bf16 v213, v102, s65, v213
v_dot2_f32_bf16 v214, v103, s64, v214
v_dot2_f32_bf16 v215, v103, s65, v215
v_dot2_f32_bf16 v208, v136, s64, v208
v_dot2_f32_bf16 v209, v136, s65, v209
v_dot2_f32_bf16 v210, v137, s64, v210
v_dot2_f32_bf16 v211, v137, s65, v211
v_dot2_f32_bf16 v212, v138, s64, v212
v_dot2_f32_bf16 v213, v138, s65, v213
v_dot2_f32_bf16 v214, v139, s64, v214
v_dot2_f32_bf16 v215, v139, s65, v215
v_dot2_f32_bf16 v208, v172, s64, v208
v_dot2_f32_bf16 v209, v172, s65, v209
v_dot2_f32_bf16 v210, v173, s64, v210
v_dot2_f32_bf16 v211, v173, s65, v211
v_dot2_f32_bf16 v212, v174, s64, v212
v_dot2_f32_bf16 v213, v174, s65, v213
v_dot2_f32_bf16 v214, v175, s64, v214
v_dot2_f32_bf16 v215, v175, s65, v215
v_cvt_pk_bf16_f32 v64, v208, v209
v_cvt_pk_bf16_f32 v65, v210, v211
v_cvt_pk_bf16_f32 v66, v212, v213
v_cvt_pk_bf16_f32 v67, v214, v215
s_waitcnt vmcnt(7)
v_lshlrev_b32 v208, 16, v68
v_and_b32 v209, s67, v68
v_lshlrev_b32 v210, 16, v69
v_and_b32 v211, s67, v69
v_lshlrev_b32 v212, 16, v70
v_and_b32 v213, s67, v70
v_lshlrev_b32 v214, 16, v71
v_and_b32 v215, s67, v71
v_dot2_f32_bf16 v208, v104, s64, v208
v_dot2_f32_bf16 v209, v104, s65, v209
v_dot2_f32_bf16 v210, v105, s64, v210
v_dot2_f32_bf16 v211, v105, s65, v211
v_dot2_f32_bf16 v212, v106, s64, v212
v_dot2_f32_bf16 v213, v106, s65, v213
v_dot2_f32_bf16 v214, v107, s64, v214
v_dot2_f32_bf16 v215, v107, s65, v215
v_dot2_f32_bf16 v208, v140, s64, v208
v_dot2_f32_bf16 v209, v140, s65, v209
v_dot2_f32_bf16 v210, v141, s64, v210
v_dot2_f32_bf16 v211, v141, s65, v211
v_dot2_f32_bf16 v212, v142, s64, v212
v_dot2_f32_bf16 v213, v142, s65, v213
v_dot2_f32_bf16 v214, v143, s64, v214
v_dot2_f32_bf16 v215, v143, s65, v215
v_dot2_f32_bf16 v208, v176, s64, v208
v_dot2_f32_bf16 v209, v176, s65, v209
v_dot2_f32_bf16 v210, v177, s64, v210
v_dot2_f32_bf16 v211, v177, s65, v211
v_dot2_f32_bf16 v212, v178, s64, v212
v_dot2_f32_bf16 v213, v178, s65, v213
v_dot2_f32_bf16 v214, v179, s64, v214
v_dot2_f32_bf16 v215, v179, s65, v215
v_cvt_pk_bf16_f32 v68, v208, v209
v_cvt_pk_bf16_f32 v69, v210, v211
v_cvt_pk_bf16_f32 v70, v212, v213
v_cvt_pk_bf16_f32 v71, v214, v215
s_waitcnt vmcnt(6)
v_lshlrev_b32 v208, 16, v72
v_and_b32 v209, s67, v72
v_lshlrev_b32 v210, 16, v73
v_and_b32 v211, s67, v73
v_lshlrev_b32 v212, 16, v74
v_and_b32 v213, s67, v74
v_lshlrev_b32 v214, 16, v75
v_and_b32 v215, s67, v75
v_dot2_f32_bf16 v208, v108, s64, v208
v_dot2_f32_bf16 v209, v108, s65, v209
v_dot2_f32_bf16 v210, v109, s64, v210
v_dot2_f32_bf16 v211, v109, s65, v211
v_dot2_f32_bf16 v212, v110, s64, v212
v_dot2_f32_bf16 v213, v110, s65, v213
v_dot2_f32_bf16 v214, v111, s64, v214
v_dot2_f32_bf16 v215, v111, s65, v215
v_dot2_f32_bf16 v208, v144, s64, v208
v_dot2_f32_bf16 v209, v144, s65, v209
v_dot2_f32_bf16 v210, v145, s64, v210
v_dot2_f32_bf16 v211, v145, s65, v211
v_dot2_f32_bf16 v212, v146, s64, v212
v_dot2_f32_bf16 v213, v146, s65, v213
v_dot2_f32_bf16 v214, v147, s64, v214
v_dot2_f32_bf16 v215, v147, s65, v215
v_dot2_f32_bf16 v208, v180, s64, v208
v_dot2_f32_bf16 v209, v180, s65, v209
v_dot2_f32_bf16 v210, v181, s64, v210
v_dot2_f32_bf16 v211, v181, s65, v211
v_dot2_f32_bf16 v212, v182, s64, v212
v_dot2_f32_bf16 v213, v182, s65, v213
v_dot2_f32_bf16 v214, v183, s64, v214
v_dot2_f32_bf16 v215, v183, s65, v215
v_cvt_pk_bf16_f32 v72, v208, v209
v_cvt_pk_bf16_f32 v73, v210, v211
v_cvt_pk_bf16_f32 v74, v212, v213
v_cvt_pk_bf16_f32 v75, v214, v215
s_waitcnt vmcnt(5)
v_lshlrev_b32 v208, 16, v76
v_and_b32 v209, s67, v76
v_lshlrev_b32 v210, 16, v77
v_and_b32 v211, s67, v77
v_lshlrev_b32 v212, 16, v78
v_and_b32 v213, s67, v78
v_lshlrev_b32 v214, 16, v79
v_and_b32 v215, s67, v79
v_dot2_f32_bf16 v208, v112, s64, v208
v_dot2_f32_bf16 v209, v112, s65, v209
v_dot2_f32_bf16 v210, v113, s64, v210
v_dot2_f32_bf16 v211, v113, s65, v211
v_dot2_f32_bf16 v212, v114, s64, v212
v_dot2_f32_bf16 v213, v114, s65, v213
v_dot2_f32_bf16 v214, v115, s64, v214
v_dot2_f32_bf16 v215, v115, s65, v215
v_dot2_f32_bf16 v208, v148, s64, v208
v_dot2_f32_bf16 v209, v148, s65, v209
v_dot2_f32_bf16 v210, v149, s64, v210
v_dot2_f32_bf16 v211, v149, s65, v211
v_dot2_f32_bf16 v212, v150, s64, v212
v_dot2_f32_bf16 v213, v150, s65, v213
v_dot2_f32_bf16 v214, v151, s64, v214
v_dot2_f32_bf16 v215, v151, s65, v215
v_dot2_f32_bf16 v208, v184, s64, v208
v_dot2_f32_bf16 v209, v184, s65, v209
v_dot2_f32_bf16 v210, v185, s64, v210
v_dot2_f32_bf16 v211, v185, s65, v211
v_dot2_f32_bf16 v212, v186, s64, v212
v_dot2_f32_bf16 v213, v186, s65, v213
v_dot2_f32_bf16 v214, v187, s64, v214
v_dot2_f32_bf16 v215, v187, s65, v215
v_cvt_pk_bf16_f32 v76, v208, v209
v_cvt_pk_bf16_f32 v77, v210, v211
v_cvt_pk_bf16_f32 v78, v212, v213
v_cvt_pk_bf16_f32 v79, v214, v215
s_waitcnt vmcnt(4)
v_lshlrev_b32 v208, 16, v80
v_and_b32 v209, s67, v80
v_lshlrev_b32 v210, 16, v81
v_and_b32 v211, s67, v81
v_lshlrev_b32 v212, 16, v82
v_and_b32 v213, s67, v82
v_lshlrev_b32 v214, 16, v83
v_and_b32 v215, s67, v83
v_dot2_f32_bf16 v208, v116, s64, v208
v_dot2_f32_bf16 v209, v116, s65, v209
v_dot2_f32_bf16 v210, v117, s64, v210
v_dot2_f32_bf16 v211, v117, s65, v211
v_dot2_f32_bf16 v212, v118, s64, v212
v_dot2_f32_bf16 v213, v118, s65, v213
v_dot2_f32_bf16 v214, v119, s64, v214
v_dot2_f32_bf16 v215, v119, s65, v215
v_dot2_f32_bf16 v208, v152, s64, v208
v_dot2_f32_bf16 v209, v152, s65, v209
v_dot2_f32_bf16 v210, v153, s64, v210
v_dot2_f32_bf16 v211, v153, s65, v211
v_dot2_f32_bf16 v212, v154, s64, v212
v_dot2_f32_bf16 v213, v154, s65, v213
v_dot2_f32_bf16 v214, v155, s64, v214
v_dot2_f32_bf16 v215, v155, s65, v215
v_dot2_f32_bf16 v208, v188, s64, v208
v_dot2_f32_bf16 v209, v188, s65, v209
v_dot2_f32_bf16 v210, v189, s64, v210
v_dot2_f32_bf16 v211, v189, s65, v211
v_dot2_f32_bf16 v212, v190, s64, v212
v_dot2_f32_bf16 v213, v190, s65, v213
v_dot2_f32_bf16 v214, v191, s64, v214
v_dot2_f32_bf16 v215, v191, s65, v215
v_cvt_pk_bf16_f32 v80, v208, v209
v_cvt_pk_bf16_f32 v81, v210, v211
v_cvt_pk_bf16_f32 v82, v212, v213
v_cvt_pk_bf16_f32 v83, v214, v215
s_waitcnt vmcnt(3)
v_lshlrev_b32 v208, 16, v84
v_and_b32 v209, s67, v84
v_lshlrev_b32 v210, 16, v85
v_and_b32 v211, s67, v85
v_lshlrev_b32 v212, 16, v86
v_and_b32 v213, s67, v86
v_lshlrev_b32 v214, 16, v87
v_and_b32 v215, s67, v87
v_dot2_f32_bf16 v208, v120, s64, v208
v_dot2_f32_bf16 v209, v120, s65, v209
v_dot2_f32_bf16 v210, v121, s64, v210
v_dot2_f32_bf16 v211, v121, s65, v211
v_dot2_f32_bf16 v212, v122, s64, v212
v_dot2_f32_bf16 v213, v122, s65, v213
v_dot2_f32_bf16 v214, v123, s64, v214
v_dot2_f32_bf16 v215, v123, s65, v215
v_dot2_f32_bf16 v208, v156, s64, v208
v_dot2_f32_bf16 v209, v156, s65, v209
v_dot2_f32_bf16 v210, v157, s64, v210
v_dot2_f32_bf16 v211, v157, s65, v211
v_dot2_f32_bf16 v212, v158, s64, v212
v_dot2_f32_bf16 v213, v158, s65, v213
v_dot2_f32_bf16 v214, v159, s64, v214
v_dot2_f32_bf16 v215, v159, s65, v215
v_dot2_f32_bf16 v208, v192, s64, v208
v_dot2_f32_bf16 v209, v192, s65, v209
v_dot2_f32_bf16 v210, v193, s64, v210
v_dot2_f32_bf16 v211, v193, s65, v211
v_dot2_f32_bf16 v212, v194, s64, v212
v_dot2_f32_bf16 v213, v194, s65, v213
v_dot2_f32_bf16 v214, v195, s64, v214
v_dot2_f32_bf16 v215, v195, s65, v215
v_cvt_pk_bf16_f32 v84, v208, v209
v_cvt_pk_bf16_f32 v85, v210, v211
v_cvt_pk_bf16_f32 v86, v212, v213
v_cvt_pk_bf16_f32 v87, v214, v215
s_waitcnt vmcnt(2)
v_lshlrev_b32 v208, 16, v88
v_and_b32 v209, s67, v88
v_lshlrev_b32 v210, 16, v89
v_and_b32 v211, s67, v89
v_lshlrev_b32 v212, 16, v90
v_and_b32 v213, s67, v90
v_lshlrev_b32 v214, 16, v91
v_and_b32 v215, s67, v91
v_dot2_f32_bf16 v208, v124, s64, v208
v_dot2_f32_bf16 v209, v124, s65, v209
v_dot2_f32_bf16 v210, v125, s64, v210
v_dot2_f32_bf16 v211, v125, s65, v211
v_dot2_f32_bf16 v212, v126, s64, v212
v_dot2_f32_bf16 v213, v126, s65, v213
v_dot2_f32_bf16 v214, v127, s64, v214
v_dot2_f32_bf16 v215, v127, s65, v215
v_dot2_f32_bf16 v208, v160, s64, v208
v_dot2_f32_bf16 v209, v160, s65, v209
v_dot2_f32_bf16 v210, v161, s64, v210
v_dot2_f32_bf16 v211, v161, s65, v211
v_dot2_f32_bf16 v212, v162, s64, v212
v_dot2_f32_bf16 v213, v162, s65, v213
v_dot2_f32_bf16 v214, v163, s64, v214
v_dot2_f32_bf16 v215, v163, s65, v215
v_dot2_f32_bf16 v208, v196, s64, v208
v_dot2_f32_bf16 v209, v196, s65, v209
v_dot2_f32_bf16 v210, v197, s64, v210
v_dot2_f32_bf16 v211, v197, s65, v211
v_dot2_f32_bf16 v212, v198, s64, v212
v_dot2_f32_bf16 v213, v198, s65, v213
v_dot2_f32_bf16 v214, v199, s64, v214
v_dot2_f32_bf16 v215, v199, s65, v215
v_cvt_pk_bf16_f32 v88, v208, v209
v_cvt_pk_bf16_f32 v89, v210, v211
v_cvt_pk_bf16_f32 v90, v212, v213
v_cvt_pk_bf16_f32 v91, v214, v215
s_waitcnt vmcnt(1)
v_lshlrev_b32 v208, 16, v92
v_and_b32 v209, s67, v92
v_lshlrev_b32 v210, 16, v93
v_and_b32 v211, s67, v93
v_lshlrev_b32 v212, 16, v94
v_and_b32 v213, s67, v94
v_lshlrev_b32 v214, 16, v95
v_and_b32 v215, s67, v95
v_dot2_f32_bf16 v208, v128, s64, v208
v_dot2_f32_bf16 v209, v128, s65, v209
v_dot2_f32_bf16 v210, v129, s64, v210
v_dot2_f32_bf16 v211, v129, s65, v211
v_dot2_f32_bf16 v212, v130, s64, v212
v_dot2_f32_bf16 v213, v130, s65, v213
v_dot2_f32_bf16 v214, v131, s64, v214
v_dot2_f32_bf16 v215, v131, s65, v215
v_dot2_f32_bf16 v208, v164, s64, v208
v_dot2_f32_bf16 v209, v164, s65, v209
v_dot2_f32_bf16 v210, v165, s64, v210
v_dot2_f32_bf16 v211, v165, s65, v211
v_dot2_f32_bf16 v212, v166, s64, v212
v_dot2_f32_bf16 v213, v166, s65, v213
v_dot2_f32_bf16 v214, v167, s64, v214
v_dot2_f32_bf16 v215, v167, s65, v215
v_dot2_f32_bf16 v208, v200, s64, v208
v_dot2_f32_bf16 v209, v200, s65, v209
v_dot2_f32_bf16 v210, v201, s64, v210
v_dot2_f32_bf16 v211, v201, s65, v211
v_dot2_f32_bf16 v212, v202, s64, v212
v_dot2_f32_bf16 v213, v202, s65, v213
v_dot2_f32_bf16 v214, v203, s64, v214
v_dot2_f32_bf16 v215, v203, s65, v215
v_cvt_pk_bf16_f32 v92, v208, v209
v_cvt_pk_bf16_f32 v93, v210, v211
v_cvt_pk_bf16_f32 v94, v212, v213
v_cvt_pk_bf16_f32 v95, v214, v215
s_waitcnt vmcnt(0)
v_lshlrev_b32 v208, 16, v96
v_and_b32 v209, s67, v96
v_lshlrev_b32 v210, 16, v97
v_and_b32 v211, s67, v97
v_lshlrev_b32 v212, 16, v98
v_and_b32 v213, s67, v98
v_lshlrev_b32 v214, 16, v99
v_and_b32 v215, s67, v99
v_dot2_f32_bf16 v208, v132, s64, v208
v_dot2_f32_bf16 v209, v132, s65, v209
v_dot2_f32_bf16 v210, v133, s64, v210
v_dot2_f32_bf16 v211, v133, s65, v211
v_dot2_f32_bf16 v212, v134, s64, v212
v_dot2_f32_bf16 v213, v134, s65, v213
v_dot2_f32_bf16 v214, v135, s64, v214
v_dot2_f32_bf16 v215, v135, s65, v215
v_dot2_f32_bf16 v208, v168, s64, v208
v_dot2_f32_bf16 v209, v168, s65, v209
v_dot2_f32_bf16 v210, v169, s64, v210
v_dot2_f32_bf16 v211, v169, s65, v211
v_dot2_f32_bf16 v212, v170, s64, v212
v_dot2_f32_bf16 v213, v170, s65, v213
v_dot2_f32_bf16 v214, v171, s64, v214
v_dot2_f32_bf16 v215, v171, s65, v215
v_dot2_f32_bf16 v208, v204, s64, v208
v_dot2_f32_bf16 v209, v204, s65, v209
v_dot2_f32_bf16 v210, v205, s64, v210
v_dot2_f32_bf16 v211, v205, s65, v211
v_dot2_f32_bf16 v212, v206, s64, v212
v_dot2_f32_bf16 v213, v206, s65, v213
v_dot2_f32_bf16 v214, v207, s64, v214
v_dot2_f32_bf16 v215, v207, s65, v215
v_cvt_pk_bf16_f32 v96, v208, v209
v_cvt_pk_bf16_f32 v97, v210, v211
v_cvt_pk_bf16_f32 v98, v212, v213
v_cvt_pk_bf16_f32 v99, v214, v215
s_waitcnt vmcnt(44)
v_lshlrev_b32 v128, 16, v16
v_and_b32 v129, s67, v16
v_lshlrev_b32 v130, 16, v17
v_and_b32 v131, s67, v17
v_lshlrev_b32 v132, 16, v18
v_and_b32 v133, s67, v18
v_lshlrev_b32 v134, 16, v19
v_and_b32 v135, s67, v19
v_dot2_f32_bf16 v128, v64, s64, v128
v_dot2_f32_bf16 v129, v64, s65, v129
v_dot2_f32_bf16 v130, v65, s64, v130
v_dot2_f32_bf16 v131, v65, s65, v131
v_dot2_f32_bf16 v132, v66, s64, v132
v_dot2_f32_bf16 v133, v66, s65, v133
v_dot2_f32_bf16 v134, v67, s64, v134
v_dot2_f32_bf16 v135, v67, s65, v135
v_cvt_pk_bf16_f32 v16, v128, v129
v_cvt_pk_bf16_f32 v17, v130, v131
v_cvt_pk_bf16_f32 v18, v132, v133
v_cvt_pk_bf16_f32 v19, v134, v135
buffer_store_dwordx4 v[16:19], v6, s[12:15], s72 offen offset:0
s_waitcnt vmcnt(44)
v_lshlrev_b32 v136, 16, v20
v_and_b32 v137, s67, v20
v_lshlrev_b32 v138, 16, v21
v_and_b32 v139, s67, v21
v_lshlrev_b32 v140, 16, v22
v_and_b32 v141, s67, v22
v_lshlrev_b32 v142, 16, v23
v_and_b32 v143, s67, v23
v_dot2_f32_bf16 v136, v68, s64, v136
v_dot2_f32_bf16 v137, v68, s65, v137
v_dot2_f32_bf16 v138, v69, s64, v138
v_dot2_f32_bf16 v139, v69, s65, v139
v_dot2_f32_bf16 v140, v70, s64, v140
v_dot2_f32_bf16 v141, v70, s65, v141
v_dot2_f32_bf16 v142, v71, s64, v142
v_dot2_f32_bf16 v143, v71, s65, v143
v_cvt_pk_bf16_f32 v20, v136, v137
v_cvt_pk_bf16_f32 v21, v138, v139
v_cvt_pk_bf16_f32 v22, v140, v141
v_cvt_pk_bf16_f32 v23, v142, v143
buffer_store_dwordx4 v[20:23], v6, s[12:15], s72 offen offset:128
s_waitcnt vmcnt(44)
v_lshlrev_b32 v144, 16, v24
v_and_b32 v145, s67, v24
v_lshlrev_b32 v146, 16, v25
v_and_b32 v147, s67, v25
v_lshlrev_b32 v148, 16, v26
v_and_b32 v149, s67, v26
v_lshlrev_b32 v150, 16, v27
v_and_b32 v151, s67, v27
v_dot2_f32_bf16 v144, v72, s64, v144
v_dot2_f32_bf16 v145, v72, s65, v145
v_dot2_f32_bf16 v146, v73, s64, v146
v_dot2_f32_bf16 v147, v73, s65, v147
v_dot2_f32_bf16 v148, v74, s64, v148
v_dot2_f32_bf16 v149, v74, s65, v149
v_dot2_f32_bf16 v150, v75, s64, v150
v_dot2_f32_bf16 v151, v75, s65, v151
v_cvt_pk_bf16_f32 v24, v144, v145
v_cvt_pk_bf16_f32 v25, v146, v147
v_cvt_pk_bf16_f32 v26, v148, v149
v_cvt_pk_bf16_f32 v27, v150, v151
buffer_store_dwordx4 v[24:27], v6, s[12:15], s72 offen offset:256
s_waitcnt vmcnt(44)
v_lshlrev_b32 v152, 16, v28
v_and_b32 v153, s67, v28
v_lshlrev_b32 v154, 16, v29
v_and_b32 v155, s67, v29
v_lshlrev_b32 v156, 16, v30
v_and_b32 v157, s67, v30
v_lshlrev_b32 v158, 16, v31
v_and_b32 v159, s67, v31
v_dot2_f32_bf16 v152, v76, s64, v152
v_dot2_f32_bf16 v153, v76, s65, v153
v_dot2_f32_bf16 v154, v77, s64, v154
v_dot2_f32_bf16 v155, v77, s65, v155
v_dot2_f32_bf16 v156, v78, s64, v156
v_dot2_f32_bf16 v157, v78, s65, v157
v_dot2_f32_bf16 v158, v79, s64, v158
v_dot2_f32_bf16 v159, v79, s65, v159
v_cvt_pk_bf16_f32 v28, v152, v153
v_cvt_pk_bf16_f32 v29, v154, v155
v_cvt_pk_bf16_f32 v30, v156, v157
v_cvt_pk_bf16_f32 v31, v158, v159
buffer_store_dwordx4 v[28:31], v6, s[12:15], s72 offen offset:384
s_waitcnt vmcnt(44)
v_lshlrev_b32 v160, 16, v32
v_and_b32 v161, s67, v32
v_lshlrev_b32 v162, 16, v33
v_and_b32 v163, s67, v33
v_lshlrev_b32 v164, 16, v34
v_and_b32 v165, s67, v34
v_lshlrev_b32 v166, 16, v35
v_and_b32 v167, s67, v35
v_dot2_f32_bf16 v160, v80, s64, v160
v_dot2_f32_bf16 v161, v80, s65, v161
v_dot2_f32_bf16 v162, v81, s64, v162
v_dot2_f32_bf16 v163, v81, s65, v163
v_dot2_f32_bf16 v164, v82, s64, v164
v_dot2_f32_bf16 v165, v82, s65, v165
v_dot2_f32_bf16 v166, v83, s64, v166
v_dot2_f32_bf16 v167, v83, s65, v167
v_cvt_pk_bf16_f32 v32, v160, v161
v_cvt_pk_bf16_f32 v33, v162, v163
v_cvt_pk_bf16_f32 v34, v164, v165
v_cvt_pk_bf16_f32 v35, v166, v167
buffer_store_dwordx4 v[32:35], v6, s[12:15], s72 offen offset:512
s_waitcnt vmcnt(44)
v_lshlrev_b32 v168, 16, v36
v_and_b32 v169, s67, v36
v_lshlrev_b32 v170, 16, v37
v_and_b32 v171, s67, v37
v_lshlrev_b32 v172, 16, v38
v_and_b32 v173, s67, v38
v_lshlrev_b32 v174, 16, v39
v_and_b32 v175, s67, v39
v_dot2_f32_bf16 v168, v84, s64, v168
v_dot2_f32_bf16 v169, v84, s65, v169
v_dot2_f32_bf16 v170, v85, s64, v170
v_dot2_f32_bf16 v171, v85, s65, v171
v_dot2_f32_bf16 v172, v86, s64, v172
v_dot2_f32_bf16 v173, v86, s65, v173
v_dot2_f32_bf16 v174, v87, s64, v174
v_dot2_f32_bf16 v175, v87, s65, v175
v_cvt_pk_bf16_f32 v36, v168, v169
v_cvt_pk_bf16_f32 v37, v170, v171
v_cvt_pk_bf16_f32 v38, v172, v173
v_cvt_pk_bf16_f32 v39, v174, v175
buffer_store_dwordx4 v[36:39], v6, s[12:15], s72 offen offset:640
s_waitcnt vmcnt(44)
v_lshlrev_b32 v176, 16, v40
v_and_b32 v177, s67, v40
v_lshlrev_b32 v178, 16, v41
v_and_b32 v179, s67, v41
v_lshlrev_b32 v180, 16, v42
v_and_b32 v181, s67, v42
v_lshlrev_b32 v182, 16, v43
v_and_b32 v183, s67, v43
v_dot2_f32_bf16 v176, v88, s64, v176
v_dot2_f32_bf16 v177, v88, s65, v177
v_dot2_f32_bf16 v178, v89, s64, v178
v_dot2_f32_bf16 v179, v89, s65, v179
v_dot2_f32_bf16 v180, v90, s64, v180
v_dot2_f32_bf16 v181, v90, s65, v181
v_dot2_f32_bf16 v182, v91, s64, v182
v_dot2_f32_bf16 v183, v91, s65, v183
v_cvt_pk_bf16_f32 v40, v176, v177
v_cvt_pk_bf16_f32 v41, v178, v179
v_cvt_pk_bf16_f32 v42, v180, v181
v_cvt_pk_bf16_f32 v43, v182, v183
buffer_store_dwordx4 v[40:43], v6, s[12:15], s72 offen offset:768
s_waitcnt vmcnt(44)
v_lshlrev_b32 v184, 16, v44
v_and_b32 v185, s67, v44
v_lshlrev_b32 v186, 16, v45
v_and_b32 v187, s67, v45
v_lshlrev_b32 v188, 16, v46
v_and_b32 v189, s67, v46
v_lshlrev_b32 v190, 16, v47
v_and_b32 v191, s67, v47
v_dot2_f32_bf16 v184, v92, s64, v184
v_dot2_f32_bf16 v185, v92, s65, v185
v_dot2_f32_bf16 v186, v93, s64, v186
v_dot2_f32_bf16 v187, v93, s65, v187
v_dot2_f32_bf16 v188, v94, s64, v188
v_dot2_f32_bf16 v189, v94, s65, v189
v_dot2_f32_bf16 v190, v95, s64, v190
v_dot2_f32_bf16 v191, v95, s65, v191
v_cvt_pk_bf16_f32 v44, v184, v185
v_cvt_pk_bf16_f32 v45, v186, v187
v_cvt_pk_bf16_f32 v46, v188, v189
v_cvt_pk_bf16_f32 v47, v190, v191
buffer_store_dwordx4 v[44:47], v6, s[12:15], s72 offen offset:896
s_waitcnt vmcnt(44)
v_lshlrev_b32 v192, 16, v48
v_and_b32 v193, s67, v48
v_lshlrev_b32 v194, 16, v49
v_and_b32 v195, s67, v49
v_lshlrev_b32 v196, 16, v50
v_and_b32 v197, s67, v50
v_lshlrev_b32 v198, 16, v51
v_and_b32 v199, s67, v51
v_dot2_f32_bf16 v192, v96, s64, v192
v_dot2_f32_bf16 v193, v96, s65, v193
v_dot2_f32_bf16 v194, v97, s64, v194
v_dot2_f32_bf16 v195, v97, s65, v195
v_dot2_f32_bf16 v196, v98, s64, v196
v_dot2_f32_bf16 v197, v98, s65, v197
v_dot2_f32_bf16 v198, v99, s64, v198
v_dot2_f32_bf16 v199, v99, s65, v199
v_cvt_pk_bf16_f32 v48, v192, v193
v_cvt_pk_bf16_f32 v49, v194, v195
v_cvt_pk_bf16_f32 v50, v196, v197
v_cvt_pk_bf16_f32 v51, v198, v199
buffer_store_dwordx4 v[48:51], v6, s[12:15], s72 offen offset:1024
s_add_u32 s70, s70, 110592
s_add_u32 s71, s71, 442368
s_add_u32 s28, s28, 192
s_add_u32 s72, s72, 110592
s_add_u32 s23, s23, 3
s_cmp_lt_u32 s23, 64
s_cbranch_scc1 L_fin_top4
s_waitcnt vmcnt(0)
s_mov_b64 exec, 1
v_mov_b32 v13, 1
buffer_atomic_add v13, off, s[4:7], s39 sc1
s_mov_b64 exec, -1
s_waitcnt vmcnt(0)
s_branch L_END
L_fin_n4:
s_endpgm
L_FAIL:
s_mov_b64 exec, 1
v_mov_b32 v1, s2
v_add_u32 v1, 0x1000, v1
buffer_store_dword v1, off, s[16:19], 0 offset:16
s_waitcnt vmcnt(0)
L_END:
s_endpgm
.section .rodata,"a"
.p2align 6
.amdhsa_kernel interleave_layers__sliding_block__memory_aug_recurrent_mem_tr__prompt_kernel
  .amdhsa_next_free_vgpr 512
  .amdhsa_next_free_sgpr 102
  .amdhsa_accum_offset 256
  .amdhsa_group_segment_fixed_size 0
  .amdhsa_kernarg_size 104
  .amdhsa_user_sgpr_count 2
  .amdhsa_user_sgpr_kernarg_segment_ptr 1
  .amdhsa_system_sgpr_workgroup_id_x 1
.end_amdhsa_kernel
```
